```python
import torch

def _softmax(x, axis=-1):
    return torch.softmax(x, dim=axis)

def _gelu(x):
    return torch.nn.functional.gelu(x, approximate='tanh')

def _silu(x):
    return torch.nn.functional.silu(x)

def _sigmoid(x):
    return torch.sigmoid(x)

def _layernorm(x, axis=-1, eps=1e-05):
    m = x.mean(dim=axis, keepdim=True)
    v = x.var(dim=axis, keepdim=True, unbiased=False)
    return (x - m) / torch.sqrt(v + eps)

def _scatter_add(tgt, idx, src, axis=0):
    return tgt.clone().index_add_(axis, idx, src)

def _segment_sum(src, seg, n):
    out = torch.zeros((n,) + src.shape[1:], dtype=src.dtype)
    return out.index_add_(0, seg, src)

def _pad(x, pw):
    flat = tuple((v for pair in reversed(pw) for v in pair))
    return torch.nn.functional.pad(x, flat)
kernel_name = 'recurrent_scan__sliding_local_dilated__mixer_gmlp__prompt'

def setup_inputs():

    _w = lambda a: (lambda t: t.to(torch.bfloat16) if t.is_floating_point() else t)(torch.as_tensor(a))

    def _A_setup():
        B, S, D = (1, 2048, 576)
        return {'x': _w((lambda *s: torch.randn(*s, dtype=torch.bfloat16) * 0.05)(B, S, D)), 'wqkv': _w((lambda *s: torch.randn(*s, dtype=torch.bfloat16) * 0.05)(D, 3 * D)), 'wo': _w((lambda *s: torch.randn(*s, dtype=torch.bfloat16) * 0.05)(D, D))}
    _A_in = _A_setup()

    def _B_setup():
        B, S, D, F = (1, 2048, 576, 4608)
        Fh = F // 2
        return {'x': _w((lambda *s: torch.randn(*s, dtype=torch.bfloat16) * 0.05)(B, S, D)), 'w_in': _w((lambda *s: torch.randn(*s, dtype=torch.bfloat16) * 0.8)(D, 2 * Fh)), 'w_sp': _w(0.01 * (lambda *s: torch.randn(*s, dtype=torch.bfloat16) * 0.8)(S, S)), 'b_sp': _w(1.0 + 0.01 * (lambda *s: torch.randn(*s, dtype=torch.bfloat16) * 0.05)(S)), 'w_out': _w((lambda *s: torch.randn(*s, dtype=torch.bfloat16) * 0.05)(Fh, D))}
    _B_in = _B_setup()
    return {'A_x': _A_in['x'], 'A_wqkv': _A_in['wqkv'], 'A_wo': _A_in['wo'], 'B_x': _B_in['x'], 'B_w_in': _B_in['w_in'], 'B_w_sp': _B_in['w_sp'], 'B_b_sp': _B_in['b_sp'], 'B_w_out': _B_in['w_out']}

def reference(A_x, A_wqkv, A_wo, B_x, B_w_in, B_w_sp, B_b_sp, B_w_out):

    def _A_ref(x, wqkv, wo):
        B, S, D = x.shape
        H = 32
        Dh = D // H
        W, dil = (8, 2)
        qkv = (lambda x, *d: x.permute(*d))((x @ wqkv).reshape(B, S, 3, H, Dh), 2, 0, 3, 1, 4)
        q, k, v = (qkv[0], qkv[1], qkv[2])
        scale = Dh ** (-0.5)
        pos = torch.arange(S)
        off = torch.arange(W) * dil
        idx = pos[:, None] - off[None, :]
        mask = idx >= 0
        idx_c = torch.where(mask, idx, 0).reshape(-1)
        kg = k[:, :, idx_c, :].reshape(B, H, S, W, Dh)
        vg = v[:, :, idx_c, :].reshape(B, H, S, W, Dh)
        logits = torch.einsum('bhsd,bhswd->bhsw', q, kg) * scale
        logits = torch.where(mask[None, None, :, :], logits, -1000000000.0)
        attn = _softmax(logits, axis=-1)
        o = torch.einsum('bhsw,bhswd->bhsd', attn, vg)
        return (lambda x, *d: x.permute(*d))(o, 0, 2, 1, 3).reshape(B, S, D) @ wo

    def _B_ref(x, w_in, w_sp, b_sp, w_out):
        B, S, D = x.shape
        F = w_in.shape[-1]
        Fh = F // 2
        z = _gelu(torch.einsum('bsd,df->bsf', x, w_in))
        z1 = z[..., :Fh].clone()
        z2 = _layernorm(z[..., Fh:], axis=-1)
        g = torch.einsum('ts,bsf->btf', w_sp, z2) + b_sp[None, :, None]
        return torch.einsum('bsf,fd->bsd', z1 * g, w_out)
    x = A_x
    xn = _layernorm(x, axis=-1)
    s = _A_ref(xn, A_wqkv, A_wo)
    g = _silu(_B_ref(xn, B_w_in, B_w_sp, B_b_sp, B_w_out))
    return x + s * g
```

```asm
; @launch grid=(256,1,1) block=(512,1,1) lds=163840
.amdgcn_target "amdgcn-amd-amdhsa--gfx950"
.text
.globl recurrent_scan__sliding_local_dilated__mixer_gmlp__prompt_kernel
.p2align 8
.type recurrent_scan__sliding_local_dilated__mixer_gmlp__prompt_kernel,@function
recurrent_scan__sliding_local_dilated__mixer_gmlp__prompt_kernel:
    s_cmp_ge_u32 s2, 256
    s_cbranch_scc1 L_end
    s_load_dwordx4 s[4:7], s[0:1], 0
    s_load_dwordx4 s[8:11], s[0:1], 32
    s_load_dwordx4 s[44:47], s[0:1], 72
    s_memrealtime s[80:81]
    s_load_dwordx2 s[72:73], s[0:1], 16
    s_load_dwordx4 s[76:79], s[0:1], 56
    s_and_b32 s50, s2, 7
    s_lshr_b32 s51, s2, 3
    s_lshr_b32 s48, s50, 2
    s_lshl_b32 s48, s48, 3
    s_lshr_b32 s52, s51, 2
    s_add_u32 s48, s48, s52
    s_and_b32 s49, s50, 3
    s_lshl_b32 s49, s49, 2
    s_and_b32 s52, s51, 3
    s_add_u32 s49, s49, s52
    v_lshrrev_b32 v1, 6, v0
    v_and_b32 v0, 63, v0
    v_readfirstlane_b32 s50, v1
    s_nop 3
    s_and_b32 s51, s50, 3
    s_cmp_ge_u32 s50, 4
    s_cbranch_scc1 L_H
    v_lshrrev_b32 v14, 2, v0
    s_and_b32 s3, s49, 3
    s_mov_b32 s3, 0
    s_add_u32 s3, s3, s50
    s_and_b32 s3, s3, 7
    s_lshl_b32 s3, s3, 4
    s_lshl_b32 s52, s48, 7
    s_add_u32 s52, s52, s3
    v_add_u32 v14, s52, v14
    v_mul_u32_u24 v14, 1152, v14
    v_and_b32 v15, 3, v0
    v_lshl_add_u32 v14, v15, 4, v14
    s_waitcnt lgkmcnt(0)
    s_mov_b32 s12, s4
    s_mov_b32 s13, s5
    s_mov_b32 s14, 2359296
    s_mov_b32 s15, 0x00020000
    buffer_load_dwordx4 v[32:35], v14, s[12:15], 0 offen offset:0
    buffer_load_dwordx4 v[36:39], v14, s[12:15], 0 offen offset:64
    buffer_load_dwordx4 v[40:43], v14, s[12:15], 0 offen offset:128
    buffer_load_dwordx4 v[44:47], v14, s[12:15], 0 offen offset:192
    buffer_load_dwordx4 v[48:51], v14, s[12:15], 0 offen offset:256
    buffer_load_dwordx4 v[52:55], v14, s[12:15], 0 offen offset:320
    buffer_load_dwordx4 v[128:131], v14, s[12:15], 0 offen offset:384
    buffer_load_dwordx4 v[132:135], v14, s[12:15], 0 offen offset:448
    buffer_load_dwordx4 v[136:139], v14, s[12:15], 0 offen offset:512
    buffer_load_dwordx4 v[140:143], v14, s[12:15], 0 offen offset:576
    buffer_load_dwordx4 v[144:147], v14, s[12:15], 0 offen offset:640
    buffer_load_dwordx4 v[148:151], v14, s[12:15], 0 offen offset:704
    buffer_load_dwordx4 v[152:155], v14, s[12:15], 0 offen offset:768
    buffer_load_dwordx4 v[156:159], v14, s[12:15], 0 offen offset:832
    buffer_load_dwordx4 v[160:163], v14, s[12:15], 0 offen offset:896
    buffer_load_dwordx4 v[164:167], v14, s[12:15], 0 offen offset:960
    buffer_load_dwordx4 v[168:171], v14, s[12:15], 0 offen offset:1024
    buffer_load_dwordx4 v[172:175], v14, s[12:15], 0 offen offset:1088
    v_lshrrev_b32 v248, 2, v0
    v_add_u32 v248, s3, v248
    v_mul_u32_u24 v248, 416, v248
    v_and_b32 v4, 1, v0
    v_lshlrev_b32 v4, 4, v4
    v_and_b32 v5, 2, v0
    v_lshlrev_b32 v5, 2, v5
    v_add3_u32 v248, v248, v4, v5
    v_add_u32 v248, 110592, v248
    v_lshrrev_b32 v4, 2, v0
    v_mul_u32_u24 v1, 288, v4
    v_and_b32 v4, 3, v0
    v_lshl_add_u32 v1, v4, 3, v1
    s_mul_i32 s52, s51, 9216
    v_lshlrev_b32 v2, 4, v0
    v_and_b32 v4, 15, v0
    s_lshl_b32 s53, s51, 5
    v_add_u32 v4, s53, v4
    v_mul_u32_u24 v4, 416, v4
    v_bfe_u32 v5, v0, 4, 1
    v_lshl_add_u32 v4, v5, 5, v4
    v_lshrrev_b32 v5, 5, v0
    v_lshl_add_u32 v4, v5, 4, v4
    v_add_u32 v3, 110592, v4
    s_lshr_b32 s52, s2, 3
    s_lshl_b32 s52, s52, 2
    s_add_u32 s52, s52, s51
    s_and_b32 s52, s52, 31
    s_lshl_b32 s53, s52, 21
    s_waitcnt lgkmcnt(0)
    s_add_u32 s68, s46, s53
    s_addc_u32 s69, s47, 0
    s_sub_u32 s53, s52, 22
    s_lshl_b32 s53, s53, 21
    s_add_u32 s70, s10, s53
    s_addc_u32 s71, s11, 0
    s_cmp_ge_u32 s52, 22
    s_cselect_b32 s68, s70, s68
    s_cselect_b32 s69, s71, s69
    s_sub_u32 s53, s52, 26
    s_lshl_b32 s53, s53, 20
    s_add_u32 s70, s72, s53
    s_addc_u32 s71, s73, 0
    s_cmp_ge_u32 s52, 26
    s_cselect_b32 s68, s70, s68
    s_cselect_b32 s69, s71, s69
    s_sub_u32 s53, s52, 27
    s_lshl_b32 s53, s53, 20
    s_add_u32 s70, s76, s53
    s_addc_u32 s71, s77, 0
    s_cmp_ge_u32 s52, 27
    s_cselect_b32 s68, s70, s68
    s_cselect_b32 s69, s71, s69
    s_sub_u32 s53, s52, 29
    s_lshl_b32 s53, s53, 20
    s_add_u32 s70, s78, s53
    s_addc_u32 s71, s79, 0
    s_cmp_ge_u32 s52, 29
    s_cselect_b32 s68, s70, s68
    s_cselect_b32 s69, s71, s69
    s_getpc_b64 s[14:15]
L_pc_1:
    s_sub_u32 s14, s14, L_pc_1-recurrent_scan__sliding_local_dilated__mixer_gmlp__prompt_kernel
    s_subb_u32 s15, s15, 0
    s_lshr_b32 s52, s2, 3
    s_lshl_b32 s52, s52, 2
    s_add_u32 s52, s52, s51
    s_lshl_b32 s52, s52, 10
    s_min_u32 s52, s52, L_end-recurrent_scan__sliding_local_dilated__mixer_gmlp__prompt_kernel-1020
    v_lshlrev_b32 v4, 4, v0
    v_add_u32 v4, s52, v4
    global_load_dwordx4 v[252:255], v4, s[14:15]
    s_mov_b32 s61, 0x3f803f80
    s_mov_b32 s62, 0xffff0000
    v_mov_b32 v4, 0
    v_mov_b32 v5, 0
    v_mov_b32 v6, 0
    v_mov_b32 v7, 0
    s_waitcnt vmcnt(18)
    v_dot2_f32_bf16 v4, v32, s61, v4
    v_dot2_f32_bf16 v5, v32, v32, v5
    v_dot2_f32_bf16 v6, v33, s61, v6
    v_dot2_f32_bf16 v7, v33, v33, v7
    v_dot2_f32_bf16 v4, v34, s61, v4
    v_dot2_f32_bf16 v5, v34, v34, v5
    v_dot2_f32_bf16 v6, v35, s61, v6
    v_dot2_f32_bf16 v7, v35, v35, v7
    s_waitcnt vmcnt(17)
    v_dot2_f32_bf16 v4, v36, s61, v4
    v_dot2_f32_bf16 v5, v36, v36, v5
    v_dot2_f32_bf16 v6, v37, s61, v6
    v_dot2_f32_bf16 v7, v37, v37, v7
    v_dot2_f32_bf16 v4, v38, s61, v4
    v_dot2_f32_bf16 v5, v38, v38, v5
    v_dot2_f32_bf16 v6, v39, s61, v6
    v_dot2_f32_bf16 v7, v39, v39, v7
    s_waitcnt vmcnt(16)
    v_dot2_f32_bf16 v4, v40, s61, v4
    v_dot2_f32_bf16 v5, v40, v40, v5
    v_dot2_f32_bf16 v6, v41, s61, v6
    v_dot2_f32_bf16 v7, v41, v41, v7
    v_dot2_f32_bf16 v4, v42, s61, v4
    v_dot2_f32_bf16 v5, v42, v42, v5
    v_dot2_f32_bf16 v6, v43, s61, v6
    v_dot2_f32_bf16 v7, v43, v43, v7
    s_waitcnt vmcnt(15)
    v_dot2_f32_bf16 v4, v44, s61, v4
    v_dot2_f32_bf16 v5, v44, v44, v5
    v_dot2_f32_bf16 v6, v45, s61, v6
    v_dot2_f32_bf16 v7, v45, v45, v7
    v_dot2_f32_bf16 v4, v46, s61, v4
    v_dot2_f32_bf16 v5, v46, v46, v5
    v_dot2_f32_bf16 v6, v47, s61, v6
    v_dot2_f32_bf16 v7, v47, v47, v7
    s_waitcnt vmcnt(14)
    v_dot2_f32_bf16 v4, v48, s61, v4
    v_dot2_f32_bf16 v5, v48, v48, v5
    v_dot2_f32_bf16 v6, v49, s61, v6
    v_dot2_f32_bf16 v7, v49, v49, v7
    v_dot2_f32_bf16 v4, v50, s61, v4
    v_dot2_f32_bf16 v5, v50, v50, v5
    v_dot2_f32_bf16 v6, v51, s61, v6
    v_dot2_f32_bf16 v7, v51, v51, v7
    s_waitcnt vmcnt(13)
    v_dot2_f32_bf16 v4, v52, s61, v4
    v_dot2_f32_bf16 v5, v52, v52, v5
    v_dot2_f32_bf16 v6, v53, s61, v6
    v_dot2_f32_bf16 v7, v53, v53, v7
    v_dot2_f32_bf16 v4, v54, s61, v4
    v_dot2_f32_bf16 v5, v54, v54, v5
    v_dot2_f32_bf16 v6, v55, s61, v6
    v_dot2_f32_bf16 v7, v55, v55, v7
    s_waitcnt vmcnt(12)
    v_dot2_f32_bf16 v4, v128, s61, v4
    v_dot2_f32_bf16 v5, v128, v128, v5
    v_dot2_f32_bf16 v6, v129, s61, v6
    v_dot2_f32_bf16 v7, v129, v129, v7
    v_dot2_f32_bf16 v4, v130, s61, v4
    v_dot2_f32_bf16 v5, v130, v130, v5
    v_dot2_f32_bf16 v6, v131, s61, v6
    v_dot2_f32_bf16 v7, v131, v131, v7
    s_waitcnt vmcnt(11)
    v_dot2_f32_bf16 v4, v132, s61, v4
    v_dot2_f32_bf16 v5, v132, v132, v5
    v_dot2_f32_bf16 v6, v133, s61, v6
    v_dot2_f32_bf16 v7, v133, v133, v7
    v_dot2_f32_bf16 v4, v134, s61, v4
    v_dot2_f32_bf16 v5, v134, v134, v5
    v_dot2_f32_bf16 v6, v135, s61, v6
    v_dot2_f32_bf16 v7, v135, v135, v7
    s_waitcnt vmcnt(10)
    v_dot2_f32_bf16 v4, v136, s61, v4
    v_dot2_f32_bf16 v5, v136, v136, v5
    v_dot2_f32_bf16 v6, v137, s61, v6
    v_dot2_f32_bf16 v7, v137, v137, v7
    v_dot2_f32_bf16 v4, v138, s61, v4
    v_dot2_f32_bf16 v5, v138, v138, v5
    v_dot2_f32_bf16 v6, v139, s61, v6
    v_dot2_f32_bf16 v7, v139, v139, v7
    s_waitcnt vmcnt(9)
    v_dot2_f32_bf16 v4, v140, s61, v4
    v_dot2_f32_bf16 v5, v140, v140, v5
    v_dot2_f32_bf16 v6, v141, s61, v6
    v_dot2_f32_bf16 v7, v141, v141, v7
    v_dot2_f32_bf16 v4, v142, s61, v4
    v_dot2_f32_bf16 v5, v142, v142, v5
    v_dot2_f32_bf16 v6, v143, s61, v6
    v_dot2_f32_bf16 v7, v143, v143, v7
    s_waitcnt vmcnt(8)
    v_dot2_f32_bf16 v4, v144, s61, v4
    v_dot2_f32_bf16 v5, v144, v144, v5
    v_dot2_f32_bf16 v6, v145, s61, v6
    v_dot2_f32_bf16 v7, v145, v145, v7
    v_dot2_f32_bf16 v4, v146, s61, v4
    v_dot2_f32_bf16 v5, v146, v146, v5
    v_dot2_f32_bf16 v6, v147, s61, v6
    v_dot2_f32_bf16 v7, v147, v147, v7
    s_waitcnt vmcnt(7)
    v_dot2_f32_bf16 v4, v148, s61, v4
    v_dot2_f32_bf16 v5, v148, v148, v5
    v_dot2_f32_bf16 v6, v149, s61, v6
    v_dot2_f32_bf16 v7, v149, v149, v7
    v_dot2_f32_bf16 v4, v150, s61, v4
    v_dot2_f32_bf16 v5, v150, v150, v5
    v_dot2_f32_bf16 v6, v151, s61, v6
    v_dot2_f32_bf16 v7, v151, v151, v7
    s_waitcnt vmcnt(6)
    v_dot2_f32_bf16 v4, v152, s61, v4
    v_dot2_f32_bf16 v5, v152, v152, v5
    v_dot2_f32_bf16 v6, v153, s61, v6
    v_dot2_f32_bf16 v7, v153, v153, v7
    v_dot2_f32_bf16 v4, v154, s61, v4
    v_dot2_f32_bf16 v5, v154, v154, v5
    v_dot2_f32_bf16 v6, v155, s61, v6
    v_dot2_f32_bf16 v7, v155, v155, v7
    s_waitcnt vmcnt(5)
    v_dot2_f32_bf16 v4, v156, s61, v4
    v_dot2_f32_bf16 v5, v156, v156, v5
    v_dot2_f32_bf16 v6, v157, s61, v6
    v_dot2_f32_bf16 v7, v157, v157, v7
    v_dot2_f32_bf16 v4, v158, s61, v4
    v_dot2_f32_bf16 v5, v158, v158, v5
    v_dot2_f32_bf16 v6, v159, s61, v6
    v_dot2_f32_bf16 v7, v159, v159, v7
    s_waitcnt vmcnt(4)
    v_dot2_f32_bf16 v4, v160, s61, v4
    v_dot2_f32_bf16 v5, v160, v160, v5
    v_dot2_f32_bf16 v6, v161, s61, v6
    v_dot2_f32_bf16 v7, v161, v161, v7
    v_dot2_f32_bf16 v4, v162, s61, v4
    v_dot2_f32_bf16 v5, v162, v162, v5
    v_dot2_f32_bf16 v6, v163, s61, v6
    v_dot2_f32_bf16 v7, v163, v163, v7
    s_waitcnt vmcnt(3)
    v_dot2_f32_bf16 v4, v164, s61, v4
    v_dot2_f32_bf16 v5, v164, v164, v5
    v_dot2_f32_bf16 v6, v165, s61, v6
    v_dot2_f32_bf16 v7, v165, v165, v7
    v_dot2_f32_bf16 v4, v166, s61, v4
    v_dot2_f32_bf16 v5, v166, v166, v5
    v_dot2_f32_bf16 v6, v167, s61, v6
    v_dot2_f32_bf16 v7, v167, v167, v7
    s_waitcnt vmcnt(2)
    v_dot2_f32_bf16 v4, v168, s61, v4
    v_dot2_f32_bf16 v5, v168, v168, v5
    v_dot2_f32_bf16 v6, v169, s61, v6
    v_dot2_f32_bf16 v7, v169, v169, v7
    v_dot2_f32_bf16 v4, v170, s61, v4
    v_dot2_f32_bf16 v5, v170, v170, v5
    v_dot2_f32_bf16 v6, v171, s61, v6
    v_dot2_f32_bf16 v7, v171, v171, v7
    s_waitcnt vmcnt(1)
    v_dot2_f32_bf16 v4, v172, s61, v4
    v_dot2_f32_bf16 v5, v172, v172, v5
    v_dot2_f32_bf16 v6, v173, s61, v6
    v_dot2_f32_bf16 v7, v173, v173, v7
    v_dot2_f32_bf16 v4, v174, s61, v4
    v_dot2_f32_bf16 v5, v174, v174, v5
    v_dot2_f32_bf16 v6, v175, s61, v6
    v_dot2_f32_bf16 v7, v175, v175, v7
    s_nop 1
    v_add_f32 v4, v4, v6
    v_add_f32 v5, v5, v7
    s_nop 0
    v_add_f32_dpp v4, v4, v4 quad_perm:[1,0,3,2] row_mask:0xf bank_mask:0xf
    v_add_f32_dpp v5, v5, v5 quad_perm:[1,0,3,2] row_mask:0xf bank_mask:0xf
    s_nop 0
    v_add_f32_dpp v4, v4, v4 quad_perm:[2,3,0,1] row_mask:0xf bank_mask:0xf
    v_add_f32_dpp v5, v5, v5 quad_perm:[2,3,0,1] row_mask:0xf bank_mask:0xf
    v_mul_f32 v4, 0x3ae38e39, v4
    v_mul_f32 v5, 0x3ae38e39, v5
    v_fma_f32 v5, -v4, v4, v5
    v_max_f32 v5, 0, v5
    v_add_f32 v5, 0x3727c5ac, v5
    v_rsq_f32 v6, v5
    s_nop 0
    v_mul_f32 v4, -v4, v6
    v_lshlrev_b32 v8, 16, v32
    v_and_b32 v9, s62, v32
    v_lshlrev_b32 v10, 16, v33
    v_and_b32 v11, s62, v33
    v_pk_fma_f32 v[8:9], v[8:9], v[6:7], v[4:5] op_sel_hi:[1,0,0]
    v_pk_fma_f32 v[10:11], v[10:11], v[6:7], v[4:5] op_sel_hi:[1,0,0]
    v_cvt_pk_bf16_f32 v32, v8, v9
    v_cvt_pk_bf16_f32 v33, v10, v11
    v_lshlrev_b32 v12, 16, v34
    v_and_b32 v13, s62, v34
    v_lshlrev_b32 v14, 16, v35
    v_and_b32 v15, s62, v35
    v_pk_fma_f32 v[12:13], v[12:13], v[6:7], v[4:5] op_sel_hi:[1,0,0]
    v_pk_fma_f32 v[14:15], v[14:15], v[6:7], v[4:5] op_sel_hi:[1,0,0]
    v_cvt_pk_bf16_f32 v34, v12, v13
    v_cvt_pk_bf16_f32 v35, v14, v15
    ds_write2_b64 v248, v[32:33], v[34:35] offset0:0 offset1:4
    v_lshlrev_b32 v8, 16, v36
    v_and_b32 v9, s62, v36
    v_lshlrev_b32 v10, 16, v37
    v_and_b32 v11, s62, v37
    v_pk_fma_f32 v[8:9], v[8:9], v[6:7], v[4:5] op_sel_hi:[1,0,0]
    v_pk_fma_f32 v[10:11], v[10:11], v[6:7], v[4:5] op_sel_hi:[1,0,0]
    v_cvt_pk_bf16_f32 v36, v8, v9
    v_cvt_pk_bf16_f32 v37, v10, v11
    v_lshlrev_b32 v12, 16, v38
    v_and_b32 v13, s62, v38
    v_lshlrev_b32 v14, 16, v39
    v_and_b32 v15, s62, v39
    v_pk_fma_f32 v[12:13], v[12:13], v[6:7], v[4:5] op_sel_hi:[1,0,0]
    v_pk_fma_f32 v[14:15], v[14:15], v[6:7], v[4:5] op_sel_hi:[1,0,0]
    v_cvt_pk_bf16_f32 v38, v12, v13
    v_cvt_pk_bf16_f32 v39, v14, v15
    ds_write2_b64 v248, v[36:37], v[38:39] offset0:8 offset1:12
    v_lshlrev_b32 v8, 16, v40
    v_and_b32 v9, s62, v40
    v_lshlrev_b32 v10, 16, v41
    v_and_b32 v11, s62, v41
    v_pk_fma_f32 v[8:9], v[8:9], v[6:7], v[4:5] op_sel_hi:[1,0,0]
    v_pk_fma_f32 v[10:11], v[10:11], v[6:7], v[4:5] op_sel_hi:[1,0,0]
    v_cvt_pk_bf16_f32 v40, v8, v9
    v_cvt_pk_bf16_f32 v41, v10, v11
    v_lshlrev_b32 v12, 16, v42
    v_and_b32 v13, s62, v42
    v_lshlrev_b32 v14, 16, v43
    v_and_b32 v15, s62, v43
    v_pk_fma_f32 v[12:13], v[12:13], v[6:7], v[4:5] op_sel_hi:[1,0,0]
    v_pk_fma_f32 v[14:15], v[14:15], v[6:7], v[4:5] op_sel_hi:[1,0,0]
    v_cvt_pk_bf16_f32 v42, v12, v13
    v_cvt_pk_bf16_f32 v43, v14, v15
    ds_write2_b64 v248, v[40:41], v[42:43] offset0:16 offset1:20
    v_lshlrev_b32 v8, 16, v44
    v_and_b32 v9, s62, v44
    v_lshlrev_b32 v10, 16, v45
    v_and_b32 v11, s62, v45
    v_pk_fma_f32 v[8:9], v[8:9], v[6:7], v[4:5] op_sel_hi:[1,0,0]
    v_pk_fma_f32 v[10:11], v[10:11], v[6:7], v[4:5] op_sel_hi:[1,0,0]
    v_cvt_pk_bf16_f32 v44, v8, v9
    v_cvt_pk_bf16_f32 v45, v10, v11
    v_lshlrev_b32 v12, 16, v46
    v_and_b32 v13, s62, v46
    v_lshlrev_b32 v14, 16, v47
    v_and_b32 v15, s62, v47
    v_pk_fma_f32 v[12:13], v[12:13], v[6:7], v[4:5] op_sel_hi:[1,0,0]
    v_pk_fma_f32 v[14:15], v[14:15], v[6:7], v[4:5] op_sel_hi:[1,0,0]
    v_cvt_pk_bf16_f32 v46, v12, v13
    v_cvt_pk_bf16_f32 v47, v14, v15
    ds_write2_b64 v248, v[44:45], v[46:47] offset0:24 offset1:28
    v_lshlrev_b32 v8, 16, v48
    v_and_b32 v9, s62, v48
    v_lshlrev_b32 v10, 16, v49
    v_and_b32 v11, s62, v49
    v_pk_fma_f32 v[8:9], v[8:9], v[6:7], v[4:5] op_sel_hi:[1,0,0]
    v_pk_fma_f32 v[10:11], v[10:11], v[6:7], v[4:5] op_sel_hi:[1,0,0]
    v_cvt_pk_bf16_f32 v48, v8, v9
    v_cvt_pk_bf16_f32 v49, v10, v11
    v_lshlrev_b32 v12, 16, v50
    v_and_b32 v13, s62, v50
    v_lshlrev_b32 v14, 16, v51
    v_and_b32 v15, s62, v51
    v_pk_fma_f32 v[12:13], v[12:13], v[6:7], v[4:5] op_sel_hi:[1,0,0]
    v_pk_fma_f32 v[14:15], v[14:15], v[6:7], v[4:5] op_sel_hi:[1,0,0]
    v_cvt_pk_bf16_f32 v50, v12, v13
    v_cvt_pk_bf16_f32 v51, v14, v15
    ds_write2_b64 v248, v[48:49], v[50:51] offset0:32 offset1:36
    v_lshlrev_b32 v8, 16, v52
    v_and_b32 v9, s62, v52
    v_lshlrev_b32 v10, 16, v53
    v_and_b32 v11, s62, v53
    v_pk_fma_f32 v[8:9], v[8:9], v[6:7], v[4:5] op_sel_hi:[1,0,0]
    v_pk_fma_f32 v[10:11], v[10:11], v[6:7], v[4:5] op_sel_hi:[1,0,0]
    v_cvt_pk_bf16_f32 v52, v8, v9
    v_cvt_pk_bf16_f32 v53, v10, v11
    v_lshlrev_b32 v12, 16, v54
    v_and_b32 v13, s62, v54
    v_lshlrev_b32 v14, 16, v55
    v_and_b32 v15, s62, v55
    v_pk_fma_f32 v[12:13], v[12:13], v[6:7], v[4:5] op_sel_hi:[1,0,0]
    v_pk_fma_f32 v[14:15], v[14:15], v[6:7], v[4:5] op_sel_hi:[1,0,0]
    v_cvt_pk_bf16_f32 v54, v12, v13
    v_cvt_pk_bf16_f32 v55, v14, v15
    ds_write2_b64 v248, v[52:53], v[54:55] offset0:40 offset1:44
    v_lshlrev_b32 v8, 16, v128
    v_and_b32 v9, s62, v128
    v_lshlrev_b32 v10, 16, v129
    v_and_b32 v11, s62, v129
    v_pk_fma_f32 v[8:9], v[8:9], v[6:7], v[4:5] op_sel_hi:[1,0,0]
    v_pk_fma_f32 v[10:11], v[10:11], v[6:7], v[4:5] op_sel_hi:[1,0,0]
    v_cvt_pk_bf16_f32 v128, v8, v9
    v_cvt_pk_bf16_f32 v129, v10, v11
    v_lshlrev_b32 v12, 16, v130
    v_and_b32 v13, s62, v130
    v_lshlrev_b32 v14, 16, v131
    v_and_b32 v15, s62, v131
    v_pk_fma_f32 v[12:13], v[12:13], v[6:7], v[4:5] op_sel_hi:[1,0,0]
    v_pk_fma_f32 v[14:15], v[14:15], v[6:7], v[4:5] op_sel_hi:[1,0,0]
    v_cvt_pk_bf16_f32 v130, v12, v13
    v_cvt_pk_bf16_f32 v131, v14, v15
    v_lshlrev_b32 v8, 16, v132
    v_and_b32 v9, s62, v132
    v_lshlrev_b32 v10, 16, v133
    v_and_b32 v11, s62, v133
    v_pk_fma_f32 v[8:9], v[8:9], v[6:7], v[4:5] op_sel_hi:[1,0,0]
    v_pk_fma_f32 v[10:11], v[10:11], v[6:7], v[4:5] op_sel_hi:[1,0,0]
    v_cvt_pk_bf16_f32 v132, v8, v9
    v_cvt_pk_bf16_f32 v133, v10, v11
    v_lshlrev_b32 v12, 16, v134
    v_and_b32 v13, s62, v134
    v_lshlrev_b32 v14, 16, v135
    v_and_b32 v15, s62, v135
    v_pk_fma_f32 v[12:13], v[12:13], v[6:7], v[4:5] op_sel_hi:[1,0,0]
    v_pk_fma_f32 v[14:15], v[14:15], v[6:7], v[4:5] op_sel_hi:[1,0,0]
    v_cvt_pk_bf16_f32 v134, v12, v13
    v_cvt_pk_bf16_f32 v135, v14, v15
    v_lshlrev_b32 v8, 16, v136
    v_and_b32 v9, s62, v136
    v_lshlrev_b32 v10, 16, v137
    v_and_b32 v11, s62, v137
    v_pk_fma_f32 v[8:9], v[8:9], v[6:7], v[4:5] op_sel_hi:[1,0,0]
    v_pk_fma_f32 v[10:11], v[10:11], v[6:7], v[4:5] op_sel_hi:[1,0,0]
    v_cvt_pk_bf16_f32 v136, v8, v9
    v_cvt_pk_bf16_f32 v137, v10, v11
    v_lshlrev_b32 v12, 16, v138
    v_and_b32 v13, s62, v138
    v_lshlrev_b32 v14, 16, v139
    v_and_b32 v15, s62, v139
    v_pk_fma_f32 v[12:13], v[12:13], v[6:7], v[4:5] op_sel_hi:[1,0,0]
    v_pk_fma_f32 v[14:15], v[14:15], v[6:7], v[4:5] op_sel_hi:[1,0,0]
    v_cvt_pk_bf16_f32 v138, v12, v13
    v_cvt_pk_bf16_f32 v139, v14, v15
    v_lshlrev_b32 v8, 16, v140
    v_and_b32 v9, s62, v140
    v_lshlrev_b32 v10, 16, v141
    v_and_b32 v11, s62, v141
    v_pk_fma_f32 v[8:9], v[8:9], v[6:7], v[4:5] op_sel_hi:[1,0,0]
    v_pk_fma_f32 v[10:11], v[10:11], v[6:7], v[4:5] op_sel_hi:[1,0,0]
    v_cvt_pk_bf16_f32 v140, v8, v9
    v_cvt_pk_bf16_f32 v141, v10, v11
    v_lshlrev_b32 v12, 16, v142
    v_and_b32 v13, s62, v142
    v_lshlrev_b32 v14, 16, v143
    v_and_b32 v15, s62, v143
    v_pk_fma_f32 v[12:13], v[12:13], v[6:7], v[4:5] op_sel_hi:[1,0,0]
    v_pk_fma_f32 v[14:15], v[14:15], v[6:7], v[4:5] op_sel_hi:[1,0,0]
    v_cvt_pk_bf16_f32 v142, v12, v13
    v_cvt_pk_bf16_f32 v143, v14, v15
    v_lshlrev_b32 v8, 16, v144
    v_and_b32 v9, s62, v144
    v_lshlrev_b32 v10, 16, v145
    v_and_b32 v11, s62, v145
    v_pk_fma_f32 v[8:9], v[8:9], v[6:7], v[4:5] op_sel_hi:[1,0,0]
    v_pk_fma_f32 v[10:11], v[10:11], v[6:7], v[4:5] op_sel_hi:[1,0,0]
    v_cvt_pk_bf16_f32 v144, v8, v9
    v_cvt_pk_bf16_f32 v145, v10, v11
    v_lshlrev_b32 v12, 16, v146
    v_and_b32 v13, s62, v146
    v_lshlrev_b32 v14, 16, v147
    v_and_b32 v15, s62, v147
    v_pk_fma_f32 v[12:13], v[12:13], v[6:7], v[4:5] op_sel_hi:[1,0,0]
    v_pk_fma_f32 v[14:15], v[14:15], v[6:7], v[4:5] op_sel_hi:[1,0,0]
    v_cvt_pk_bf16_f32 v146, v12, v13
    v_cvt_pk_bf16_f32 v147, v14, v15
    v_lshlrev_b32 v8, 16, v148
    v_and_b32 v9, s62, v148
    v_lshlrev_b32 v10, 16, v149
    v_and_b32 v11, s62, v149
    v_pk_fma_f32 v[8:9], v[8:9], v[6:7], v[4:5] op_sel_hi:[1,0,0]
    v_pk_fma_f32 v[10:11], v[10:11], v[6:7], v[4:5] op_sel_hi:[1,0,0]
    v_cvt_pk_bf16_f32 v148, v8, v9
    v_cvt_pk_bf16_f32 v149, v10, v11
    v_lshlrev_b32 v12, 16, v150
    v_and_b32 v13, s62, v150
    v_lshlrev_b32 v14, 16, v151
    v_and_b32 v15, s62, v151
    v_pk_fma_f32 v[12:13], v[12:13], v[6:7], v[4:5] op_sel_hi:[1,0,0]
    v_pk_fma_f32 v[14:15], v[14:15], v[6:7], v[4:5] op_sel_hi:[1,0,0]
    v_cvt_pk_bf16_f32 v150, v12, v13
    v_cvt_pk_bf16_f32 v151, v14, v15
    v_lshlrev_b32 v8, 16, v152
    v_and_b32 v9, s62, v152
    v_lshlrev_b32 v10, 16, v153
    v_and_b32 v11, s62, v153
    v_pk_fma_f32 v[8:9], v[8:9], v[6:7], v[4:5] op_sel_hi:[1,0,0]
    v_pk_fma_f32 v[10:11], v[10:11], v[6:7], v[4:5] op_sel_hi:[1,0,0]
    v_cvt_pk_bf16_f32 v152, v8, v9
    v_cvt_pk_bf16_f32 v153, v10, v11
    v_lshlrev_b32 v12, 16, v154
    v_and_b32 v13, s62, v154
    v_lshlrev_b32 v14, 16, v155
    v_and_b32 v15, s62, v155
    v_pk_fma_f32 v[12:13], v[12:13], v[6:7], v[4:5] op_sel_hi:[1,0,0]
    v_pk_fma_f32 v[14:15], v[14:15], v[6:7], v[4:5] op_sel_hi:[1,0,0]
    v_cvt_pk_bf16_f32 v154, v12, v13
    v_cvt_pk_bf16_f32 v155, v14, v15
    v_lshlrev_b32 v8, 16, v156
    v_and_b32 v9, s62, v156
    v_lshlrev_b32 v10, 16, v157
    v_and_b32 v11, s62, v157
    v_pk_fma_f32 v[8:9], v[8:9], v[6:7], v[4:5] op_sel_hi:[1,0,0]
    v_pk_fma_f32 v[10:11], v[10:11], v[6:7], v[4:5] op_sel_hi:[1,0,0]
    v_cvt_pk_bf16_f32 v156, v8, v9
    v_cvt_pk_bf16_f32 v157, v10, v11
    v_lshlrev_b32 v12, 16, v158
    v_and_b32 v13, s62, v158
    v_lshlrev_b32 v14, 16, v159
    v_and_b32 v15, s62, v159
    v_pk_fma_f32 v[12:13], v[12:13], v[6:7], v[4:5] op_sel_hi:[1,0,0]
    v_pk_fma_f32 v[14:15], v[14:15], v[6:7], v[4:5] op_sel_hi:[1,0,0]
    v_cvt_pk_bf16_f32 v158, v12, v13
    v_cvt_pk_bf16_f32 v159, v14, v15
    v_lshlrev_b32 v8, 16, v160
    v_and_b32 v9, s62, v160
    v_lshlrev_b32 v10, 16, v161
    v_and_b32 v11, s62, v161
    v_pk_fma_f32 v[8:9], v[8:9], v[6:7], v[4:5] op_sel_hi:[1,0,0]
    v_pk_fma_f32 v[10:11], v[10:11], v[6:7], v[4:5] op_sel_hi:[1,0,0]
    v_cvt_pk_bf16_f32 v160, v8, v9
    v_cvt_pk_bf16_f32 v161, v10, v11
    v_lshlrev_b32 v12, 16, v162
    v_and_b32 v13, s62, v162
    v_lshlrev_b32 v14, 16, v163
    v_and_b32 v15, s62, v163
    v_pk_fma_f32 v[12:13], v[12:13], v[6:7], v[4:5] op_sel_hi:[1,0,0]
    v_pk_fma_f32 v[14:15], v[14:15], v[6:7], v[4:5] op_sel_hi:[1,0,0]
    v_cvt_pk_bf16_f32 v162, v12, v13
    v_cvt_pk_bf16_f32 v163, v14, v15
    v_lshlrev_b32 v8, 16, v164
    v_and_b32 v9, s62, v164
    v_lshlrev_b32 v10, 16, v165
    v_and_b32 v11, s62, v165
    v_pk_fma_f32 v[8:9], v[8:9], v[6:7], v[4:5] op_sel_hi:[1,0,0]
    v_pk_fma_f32 v[10:11], v[10:11], v[6:7], v[4:5] op_sel_hi:[1,0,0]
    v_cvt_pk_bf16_f32 v164, v8, v9
    v_cvt_pk_bf16_f32 v165, v10, v11
    v_lshlrev_b32 v12, 16, v166
    v_and_b32 v13, s62, v166
    v_lshlrev_b32 v14, 16, v167
    v_and_b32 v15, s62, v167
    v_pk_fma_f32 v[12:13], v[12:13], v[6:7], v[4:5] op_sel_hi:[1,0,0]
    v_pk_fma_f32 v[14:15], v[14:15], v[6:7], v[4:5] op_sel_hi:[1,0,0]
    v_cvt_pk_bf16_f32 v166, v12, v13
    v_cvt_pk_bf16_f32 v167, v14, v15
    v_lshlrev_b32 v8, 16, v168
    v_and_b32 v9, s62, v168
    v_lshlrev_b32 v10, 16, v169
    v_and_b32 v11, s62, v169
    v_pk_fma_f32 v[8:9], v[8:9], v[6:7], v[4:5] op_sel_hi:[1,0,0]
    v_pk_fma_f32 v[10:11], v[10:11], v[6:7], v[4:5] op_sel_hi:[1,0,0]
    v_cvt_pk_bf16_f32 v168, v8, v9
    v_cvt_pk_bf16_f32 v169, v10, v11
    v_lshlrev_b32 v12, 16, v170
    v_and_b32 v13, s62, v170
    v_lshlrev_b32 v14, 16, v171
    v_and_b32 v15, s62, v171
    v_pk_fma_f32 v[12:13], v[12:13], v[6:7], v[4:5] op_sel_hi:[1,0,0]
    v_pk_fma_f32 v[14:15], v[14:15], v[6:7], v[4:5] op_sel_hi:[1,0,0]
    v_cvt_pk_bf16_f32 v170, v12, v13
    v_cvt_pk_bf16_f32 v171, v14, v15
    v_lshlrev_b32 v8, 16, v172
    v_and_b32 v9, s62, v172
    v_lshlrev_b32 v10, 16, v173
    v_and_b32 v11, s62, v173
    v_pk_fma_f32 v[8:9], v[8:9], v[6:7], v[4:5] op_sel_hi:[1,0,0]
    v_pk_fma_f32 v[10:11], v[10:11], v[6:7], v[4:5] op_sel_hi:[1,0,0]
    v_cvt_pk_bf16_f32 v172, v8, v9
    v_cvt_pk_bf16_f32 v173, v10, v11
    v_lshlrev_b32 v12, 16, v174
    v_and_b32 v13, s62, v174
    v_lshlrev_b32 v14, 16, v175
    v_and_b32 v15, s62, v175
    v_pk_fma_f32 v[12:13], v[12:13], v[6:7], v[4:5] op_sel_hi:[1,0,0]
    v_pk_fma_f32 v[14:15], v[14:15], v[6:7], v[4:5] op_sel_hi:[1,0,0]
    v_cvt_pk_bf16_f32 v174, v12, v13
    v_cvt_pk_bf16_f32 v175, v14, v15
    s_waitcnt lgkmcnt(0)
    s_barrier
    ds_read_b128 v[104:107], v3 offset:0
    ds_read_b128 v[176:179], v3 offset:6656
    ds_read_b128 v[108:111], v3 offset:64
    ds_read_b128 v[180:183], v3 offset:6720
    ds_read_b128 v[112:115], v3 offset:128
    ds_read_b128 v[184:187], v3 offset:6784
    ds_read_b128 v[116:119], v3 offset:192
    ds_read_b128 v[188:191], v3 offset:6848
    ds_read_b128 v[120:123], v3 offset:256
    ds_read_b128 v[192:195], v3 offset:6912
    ds_read_b128 v[124:127], v3 offset:320
    ds_read_b128 v[196:199], v3 offset:6976
    v_mov_b32 v251, 0
    s_mov_b64 exec, 1
    global_load_dword v251, v251, s[68:69]
    s_mov_b64 exec, -1
    s_waitcnt lgkmcnt(0)
    s_barrier
    ds_read_b64_tr_b16 v[4:5], v1 offset:0
    ds_read_b64_tr_b16 v[6:7], v1 offset:4608
    ds_read_b64_tr_b16 v[8:9], v1 offset:32
    ds_read_b64_tr_b16 v[10:11], v1 offset:4640
    ds_read_b64_tr_b16 v[12:13], v1 offset:64
    ds_read_b64_tr_b16 v[14:15], v1 offset:4672
    ds_read_b64_tr_b16 v[16:17], v1 offset:96
    ds_read_b64_tr_b16 v[18:19], v1 offset:4704
    ds_read_b64_tr_b16 v[20:21], v1 offset:128
    ds_read_b64_tr_b16 v[22:23], v1 offset:4736
    ds_read_b64_tr_b16 v[24:25], v1 offset:160
    ds_read_b64_tr_b16 v[26:27], v1 offset:4768
    ds_read_b64_tr_b16 v[28:29], v1 offset:192
    ds_read_b64_tr_b16 v[30:31], v1 offset:4800
    ds_write2_b64 v248, v[128:129], v[130:131] offset0:0 offset1:4
    s_waitcnt lgkmcnt(13)
    v_mfma_f32_16x16x32_bf16 v[32:35], v[4:7], v[104:107], 0
    v_mfma_f32_16x16x32_bf16 v[36:39], v[4:7], v[176:179], 0
    ds_read_b64_tr_b16 v[4:5], v1 offset:224
    ds_read_b64_tr_b16 v[6:7], v1 offset:4832
    s_waitcnt lgkmcnt(13)
    v_mfma_f32_16x16x32_bf16 v[40:43], v[8:11], v[104:107], 0
    v_mfma_f32_16x16x32_bf16 v[44:47], v[8:11], v[176:179], 0
    ds_read_b64_tr_b16 v[8:9], v1 offset:256
    ds_read_b64_tr_b16 v[10:11], v1 offset:4864
    ds_write2_b64 v248, v[132:133], v[134:135] offset0:8 offset1:12
    s_waitcnt lgkmcnt(14)
    v_mfma_f32_16x16x32_bf16 v[48:51], v[12:15], v[104:107], 0
    v_mfma_f32_16x16x32_bf16 v[52:55], v[12:15], v[176:179], 0
    ds_read_b64_tr_b16 v[12:13], v1 offset:9216
    ds_read_b64_tr_b16 v[14:15], v1 offset:13824
    s_waitcnt lgkmcnt(14)
    v_mfma_f32_16x16x32_bf16 v[56:59], v[16:19], v[104:107], 0
    v_mfma_f32_16x16x32_bf16 v[60:63], v[16:19], v[176:179], 0
    ds_read_b64_tr_b16 v[16:17], v1 offset:9248
    ds_read_b64_tr_b16 v[18:19], v1 offset:13856
    s_waitcnt lgkmcnt(14)
    v_mfma_f32_16x16x32_bf16 v[64:67], v[20:23], v[104:107], 0
    v_mfma_f32_16x16x32_bf16 v[68:71], v[20:23], v[176:179], 0
    ds_read_b64_tr_b16 v[20:21], v1 offset:9280
    ds_read_b64_tr_b16 v[22:23], v1 offset:13888
    s_waitcnt lgkmcnt(14)
    v_mfma_f32_16x16x32_bf16 v[72:75], v[24:27], v[104:107], 0
    v_mfma_f32_16x16x32_bf16 v[76:79], v[24:27], v[176:179], 0
    ds_read_b64_tr_b16 v[24:25], v1 offset:9312
    ds_read_b64_tr_b16 v[26:27], v1 offset:13920
    s_waitcnt lgkmcnt(14)
    v_mfma_f32_16x16x32_bf16 v[80:83], v[28:31], v[104:107], 0
    v_mfma_f32_16x16x32_bf16 v[84:87], v[28:31], v[176:179], 0
    ds_read_b64_tr_b16 v[28:29], v1 offset:9344
    ds_read_b64_tr_b16 v[30:31], v1 offset:13952
    s_waitcnt lgkmcnt(13)
    v_mfma_f32_16x16x32_bf16 v[88:91], v[4:7], v[104:107], 0
    v_mfma_f32_16x16x32_bf16 v[92:95], v[4:7], v[176:179], 0
    ds_read_b64_tr_b16 v[4:5], v1 offset:9376
    ds_read_b64_tr_b16 v[6:7], v1 offset:13984
    s_waitcnt lgkmcnt(13)
    v_mfma_f32_16x16x32_bf16 v[96:99], v[8:11], v[104:107], 0
    v_mfma_f32_16x16x32_bf16 v[100:103], v[8:11], v[176:179], 0
    ds_read_b64_tr_b16 v[8:9], v1 offset:9408
    ds_read_b64_tr_b16 v[10:11], v1 offset:14016
    s_waitcnt lgkmcnt(12)
    v_mfma_f32_16x16x32_bf16 v[32:35], v[12:15], v[108:111], v[32:35]
    v_mfma_f32_16x16x32_bf16 v[36:39], v[12:15], v[180:183], v[36:39]
    ds_read_b64_tr_b16 v[12:13], v1 offset:9440
    ds_read_b64_tr_b16 v[14:15], v1 offset:14048
    s_waitcnt lgkmcnt(12)
    v_mfma_f32_16x16x32_bf16 v[40:43], v[16:19], v[108:111], v[40:43]
    v_mfma_f32_16x16x32_bf16 v[44:47], v[16:19], v[180:183], v[44:47]
    ds_read_b64_tr_b16 v[16:17], v1 offset:9472
    ds_read_b64_tr_b16 v[18:19], v1 offset:14080
    s_waitcnt lgkmcnt(12)
    v_mfma_f32_16x16x32_bf16 v[48:51], v[20:23], v[108:111], v[48:51]
    v_mfma_f32_16x16x32_bf16 v[52:55], v[20:23], v[180:183], v[52:55]
    v_add_u32 v1, 18432, v1
    ds_read_b64_tr_b16 v[20:21], v1 offset:0
    ds_read_b64_tr_b16 v[22:23], v1 offset:4608
    s_waitcnt lgkmcnt(12)
    v_mfma_f32_16x16x32_bf16 v[56:59], v[24:27], v[108:111], v[56:59]
    v_mfma_f32_16x16x32_bf16 v[60:63], v[24:27], v[180:183], v[60:63]
    ds_read_b64_tr_b16 v[24:25], v1 offset:32
    ds_read_b64_tr_b16 v[26:27], v1 offset:4640
    s_waitcnt lgkmcnt(12)
    v_mfma_f32_16x16x32_bf16 v[64:67], v[28:31], v[108:111], v[64:67]
    v_mfma_f32_16x16x32_bf16 v[68:71], v[28:31], v[180:183], v[68:71]
    ds_read_b64_tr_b16 v[28:29], v1 offset:64
    ds_read_b64_tr_b16 v[30:31], v1 offset:4672
    s_waitcnt lgkmcnt(12)
    v_mfma_f32_16x16x32_bf16 v[72:75], v[4:7], v[108:111], v[72:75]
    v_mfma_f32_16x16x32_bf16 v[76:79], v[4:7], v[180:183], v[76:79]
    ds_read_b64_tr_b16 v[4:5], v1 offset:96
    ds_read_b64_tr_b16 v[6:7], v1 offset:4704
    s_waitcnt lgkmcnt(12)
    v_mfma_f32_16x16x32_bf16 v[80:83], v[8:11], v[108:111], v[80:83]
    v_mfma_f32_16x16x32_bf16 v[84:87], v[8:11], v[180:183], v[84:87]
    ds_read_b64_tr_b16 v[8:9], v1 offset:128
    ds_read_b64_tr_b16 v[10:11], v1 offset:4736
    s_waitcnt lgkmcnt(12)
    v_mfma_f32_16x16x32_bf16 v[88:91], v[12:15], v[108:111], v[88:91]
    v_mfma_f32_16x16x32_bf16 v[92:95], v[12:15], v[180:183], v[92:95]
    ds_read_b64_tr_b16 v[12:13], v1 offset:160
    ds_read_b64_tr_b16 v[14:15], v1 offset:4768
    s_waitcnt lgkmcnt(12)
    v_mfma_f32_16x16x32_bf16 v[96:99], v[16:19], v[108:111], v[96:99]
    v_mfma_f32_16x16x32_bf16 v[100:103], v[16:19], v[180:183], v[100:103]
    s_barrier
    ds_read_b64_tr_b16 v[16:17], v1 offset:192
    ds_read_b64_tr_b16 v[18:19], v1 offset:4800
    ds_write2_b64 v248, v[136:137], v[138:139] offset0:16 offset1:20
    s_waitcnt lgkmcnt(13)
    v_mfma_f32_16x16x32_bf16 v[32:35], v[20:23], v[112:115], v[32:35]
    v_mfma_f32_16x16x32_bf16 v[36:39], v[20:23], v[184:187], v[36:39]
    ds_read_b64_tr_b16 v[20:21], v1 offset:224
    ds_read_b64_tr_b16 v[22:23], v1 offset:4832
    s_waitcnt lgkmcnt(13)
    v_mfma_f32_16x16x32_bf16 v[40:43], v[24:27], v[112:115], v[40:43]
    v_mfma_f32_16x16x32_bf16 v[44:47], v[24:27], v[184:187], v[44:47]
    ds_read_b64_tr_b16 v[24:25], v1 offset:256
    ds_read_b64_tr_b16 v[26:27], v1 offset:4864
    ds_write2_b64 v248, v[140:141], v[142:143] offset0:24 offset1:28
    s_waitcnt lgkmcnt(14)
    v_mfma_f32_16x16x32_bf16 v[48:51], v[28:31], v[112:115], v[48:51]
    v_mfma_f32_16x16x32_bf16 v[52:55], v[28:31], v[184:187], v[52:55]
    ds_read_b64_tr_b16 v[28:29], v1 offset:9216
    ds_read_b64_tr_b16 v[30:31], v1 offset:13824
    s_waitcnt lgkmcnt(14)
    v_mfma_f32_16x16x32_bf16 v[56:59], v[4:7], v[112:115], v[56:59]
    v_mfma_f32_16x16x32_bf16 v[60:63], v[4:7], v[184:187], v[60:63]
    ds_read_b64_tr_b16 v[4:5], v1 offset:9248
    ds_read_b64_tr_b16 v[6:7], v1 offset:13856
    s_waitcnt lgkmcnt(14)
    v_mfma_f32_16x16x32_bf16 v[64:67], v[8:11], v[112:115], v[64:67]
    v_mfma_f32_16x16x32_bf16 v[68:71], v[8:11], v[184:187], v[68:71]
    ds_read_b64_tr_b16 v[8:9], v1 offset:9280
    ds_read_b64_tr_b16 v[10:11], v1 offset:13888
    s_waitcnt lgkmcnt(14)
    v_mfma_f32_16x16x32_bf16 v[72:75], v[12:15], v[112:115], v[72:75]
    v_mfma_f32_16x16x32_bf16 v[76:79], v[12:15], v[184:187], v[76:79]
    ds_read_b64_tr_b16 v[12:13], v1 offset:9312
    ds_read_b64_tr_b16 v[14:15], v1 offset:13920
    s_waitcnt lgkmcnt(14)
    v_mfma_f32_16x16x32_bf16 v[80:83], v[16:19], v[112:115], v[80:83]
    v_mfma_f32_16x16x32_bf16 v[84:87], v[16:19], v[184:187], v[84:87]
    ds_read_b64_tr_b16 v[16:17], v1 offset:9344
    ds_read_b64_tr_b16 v[18:19], v1 offset:13952
    s_waitcnt lgkmcnt(13)
    v_mfma_f32_16x16x32_bf16 v[88:91], v[20:23], v[112:115], v[88:91]
    v_mfma_f32_16x16x32_bf16 v[92:95], v[20:23], v[184:187], v[92:95]
    ds_read_b64_tr_b16 v[20:21], v1 offset:9376
    ds_read_b64_tr_b16 v[22:23], v1 offset:13984
    s_waitcnt lgkmcnt(13)
    v_mfma_f32_16x16x32_bf16 v[96:99], v[24:27], v[112:115], v[96:99]
    v_mfma_f32_16x16x32_bf16 v[100:103], v[24:27], v[184:187], v[100:103]
    ds_read_b64_tr_b16 v[24:25], v1 offset:9408
    ds_read_b64_tr_b16 v[26:27], v1 offset:14016
    s_waitcnt lgkmcnt(12)
    v_mfma_f32_16x16x32_bf16 v[32:35], v[28:31], v[116:119], v[32:35]
    v_mfma_f32_16x16x32_bf16 v[36:39], v[28:31], v[188:191], v[36:39]
    ds_read_b64_tr_b16 v[28:29], v1 offset:9440
    ds_read_b64_tr_b16 v[30:31], v1 offset:14048
    s_waitcnt lgkmcnt(12)
    v_mfma_f32_16x16x32_bf16 v[40:43], v[4:7], v[116:119], v[40:43]
    v_mfma_f32_16x16x32_bf16 v[44:47], v[4:7], v[188:191], v[44:47]
    ds_read_b64_tr_b16 v[4:5], v1 offset:9472
    ds_read_b64_tr_b16 v[6:7], v1 offset:14080
    s_waitcnt lgkmcnt(12)
    v_mfma_f32_16x16x32_bf16 v[48:51], v[8:11], v[116:119], v[48:51]
    v_mfma_f32_16x16x32_bf16 v[52:55], v[8:11], v[188:191], v[52:55]
    v_add_u32 v1, 18432, v1
    ds_read_b64_tr_b16 v[8:9], v1 offset:0
    ds_read_b64_tr_b16 v[10:11], v1 offset:4608
    s_waitcnt lgkmcnt(12)
    v_mfma_f32_16x16x32_bf16 v[56:59], v[12:15], v[116:119], v[56:59]
    v_mfma_f32_16x16x32_bf16 v[60:63], v[12:15], v[188:191], v[60:63]
    ds_read_b64_tr_b16 v[12:13], v1 offset:32
    ds_read_b64_tr_b16 v[14:15], v1 offset:4640
    s_waitcnt lgkmcnt(12)
    v_mfma_f32_16x16x32_bf16 v[64:67], v[16:19], v[116:119], v[64:67]
    v_mfma_f32_16x16x32_bf16 v[68:71], v[16:19], v[188:191], v[68:71]
    ds_read_b64_tr_b16 v[16:17], v1 offset:64
    ds_read_b64_tr_b16 v[18:19], v1 offset:4672
    s_waitcnt lgkmcnt(12)
    v_mfma_f32_16x16x32_bf16 v[72:75], v[20:23], v[116:119], v[72:75]
    v_mfma_f32_16x16x32_bf16 v[76:79], v[20:23], v[188:191], v[76:79]
    ds_read_b64_tr_b16 v[20:21], v1 offset:96
    ds_read_b64_tr_b16 v[22:23], v1 offset:4704
    s_waitcnt lgkmcnt(12)
    v_mfma_f32_16x16x32_bf16 v[80:83], v[24:27], v[116:119], v[80:83]
    v_mfma_f32_16x16x32_bf16 v[84:87], v[24:27], v[188:191], v[84:87]
    ds_read_b64_tr_b16 v[24:25], v1 offset:128
    ds_read_b64_tr_b16 v[26:27], v1 offset:4736
    s_waitcnt lgkmcnt(12)
    v_mfma_f32_16x16x32_bf16 v[88:91], v[28:31], v[116:119], v[88:91]
    v_mfma_f32_16x16x32_bf16 v[92:95], v[28:31], v[188:191], v[92:95]
    ds_read_b64_tr_b16 v[28:29], v1 offset:160
    ds_read_b64_tr_b16 v[30:31], v1 offset:4768
    s_waitcnt lgkmcnt(12)
    v_mfma_f32_16x16x32_bf16 v[96:99], v[4:7], v[116:119], v[96:99]
    v_mfma_f32_16x16x32_bf16 v[100:103], v[4:7], v[188:191], v[100:103]
    s_barrier
    ds_read_b64_tr_b16 v[4:5], v1 offset:192
    ds_read_b64_tr_b16 v[6:7], v1 offset:4800
    ds_write2_b64 v248, v[144:145], v[146:147] offset0:32 offset1:36
    s_waitcnt lgkmcnt(13)
    v_mfma_f32_16x16x32_bf16 v[32:35], v[8:11], v[120:123], v[32:35]
    v_mfma_f32_16x16x32_bf16 v[36:39], v[8:11], v[192:195], v[36:39]
    ds_read_b64_tr_b16 v[8:9], v1 offset:224
    ds_read_b64_tr_b16 v[10:11], v1 offset:4832
    s_waitcnt lgkmcnt(13)
    v_mfma_f32_16x16x32_bf16 v[40:43], v[12:15], v[120:123], v[40:43]
    v_mfma_f32_16x16x32_bf16 v[44:47], v[12:15], v[192:195], v[44:47]
    ds_read_b64_tr_b16 v[12:13], v1 offset:256
    ds_read_b64_tr_b16 v[14:15], v1 offset:4864
    ds_write2_b64 v248, v[148:149], v[150:151] offset0:40 offset1:44
    s_waitcnt lgkmcnt(14)
    v_mfma_f32_16x16x32_bf16 v[48:51], v[16:19], v[120:123], v[48:51]
    v_mfma_f32_16x16x32_bf16 v[52:55], v[16:19], v[192:195], v[52:55]
    ds_read_b64_tr_b16 v[16:17], v1 offset:9216
    ds_read_b64_tr_b16 v[18:19], v1 offset:13824
    s_waitcnt lgkmcnt(14)
    v_mfma_f32_16x16x32_bf16 v[56:59], v[20:23], v[120:123], v[56:59]
    v_mfma_f32_16x16x32_bf16 v[60:63], v[20:23], v[192:195], v[60:63]
    ds_read_b64_tr_b16 v[20:21], v1 offset:9248
    ds_read_b64_tr_b16 v[22:23], v1 offset:13856
    ds_read_b128 v[128:131], v3 offset:0
    s_waitcnt lgkmcnt(15)
    v_mfma_f32_16x16x32_bf16 v[64:67], v[24:27], v[120:123], v[64:67]
    v_mfma_f32_16x16x32_bf16 v[68:71], v[24:27], v[192:195], v[68:71]
    ds_read_b64_tr_b16 v[24:25], v1 offset:9280
    ds_read_b64_tr_b16 v[26:27], v1 offset:13888
    s_waitcnt lgkmcnt(15)
    v_mfma_f32_16x16x32_bf16 v[72:75], v[28:31], v[120:123], v[72:75]
    v_mfma_f32_16x16x32_bf16 v[76:79], v[28:31], v[192:195], v[76:79]
    ds_read_b64_tr_b16 v[28:29], v1 offset:9312
    ds_read_b64_tr_b16 v[30:31], v1 offset:13920
    ds_read_b128 v[200:203], v3 offset:6656
    s_waitcnt lgkmcnt(15)
    v_mfma_f32_16x16x32_bf16 v[80:83], v[4:7], v[120:123], v[80:83]
    v_mfma_f32_16x16x32_bf16 v[84:87], v[4:7], v[192:195], v[84:87]
    ds_read_b64_tr_b16 v[4:5], v1 offset:9344
    ds_read_b64_tr_b16 v[6:7], v1 offset:13952
    s_waitcnt lgkmcnt(15)
    v_mfma_f32_16x16x32_bf16 v[88:91], v[8:11], v[120:123], v[88:91]
    v_mfma_f32_16x16x32_bf16 v[92:95], v[8:11], v[192:195], v[92:95]
    ds_read_b64_tr_b16 v[8:9], v1 offset:9376
    ds_read_b64_tr_b16 v[10:11], v1 offset:13984
    ds_read_b128 v[132:135], v3 offset:64
    s_waitcnt lgkmcnt(15)
    v_mfma_f32_16x16x32_bf16 v[96:99], v[12:15], v[120:123], v[96:99]
    v_mfma_f32_16x16x32_bf16 v[100:103], v[12:15], v[192:195], v[100:103]
    ds_read_b64_tr_b16 v[12:13], v1 offset:9408
    ds_read_b64_tr_b16 v[14:15], v1 offset:14016
    s_waitcnt lgkmcnt(15)
    v_mfma_f32_16x16x32_bf16 v[32:35], v[16:19], v[124:127], v[32:35]
    v_mfma_f32_16x16x32_bf16 v[36:39], v[16:19], v[196:199], v[36:39]
    ds_read_b64_tr_b16 v[16:17], v1 offset:9440
    ds_read_b64_tr_b16 v[18:19], v1 offset:14048
    ds_read_b128 v[204:207], v3 offset:6720
    s_waitcnt lgkmcnt(15)
    v_mfma_f32_16x16x32_bf16 v[40:43], v[20:23], v[124:127], v[40:43]
    v_mfma_f32_16x16x32_bf16 v[44:47], v[20:23], v[196:199], v[44:47]
    ds_read_b64_tr_b16 v[20:21], v1 offset:9472
    ds_read_b64_tr_b16 v[22:23], v1 offset:14080
    s_waitcnt lgkmcnt(15)
    v_mfma_f32_16x16x32_bf16 v[48:51], v[24:27], v[124:127], v[48:51]
    v_mfma_f32_16x16x32_bf16 v[52:55], v[24:27], v[196:199], v[52:55]
    v_add_u32 v1, 18432, v1
    ds_read_b64_tr_b16 v[24:25], v1 offset:0
    ds_read_b64_tr_b16 v[26:27], v1 offset:4608
    s_waitcnt lgkmcnt(15)
    v_mfma_f32_16x16x32_bf16 v[56:59], v[28:31], v[124:127], v[56:59]
    v_mfma_f32_16x16x32_bf16 v[60:63], v[28:31], v[196:199], v[60:63]
    ds_read_b64_tr_b16 v[28:29], v1 offset:32
    ds_read_b64_tr_b16 v[30:31], v1 offset:4640
    s_waitcnt lgkmcnt(14)
    v_mfma_f32_16x16x32_bf16 v[64:67], v[4:7], v[124:127], v[64:67]
    v_mfma_f32_16x16x32_bf16 v[68:71], v[4:7], v[196:199], v[68:71]
    ds_read_b64_tr_b16 v[4:5], v1 offset:64
    ds_read_b64_tr_b16 v[6:7], v1 offset:4672
    s_waitcnt lgkmcnt(14)
    v_mfma_f32_16x16x32_bf16 v[72:75], v[8:11], v[124:127], v[72:75]
    v_mfma_f32_16x16x32_bf16 v[76:79], v[8:11], v[196:199], v[76:79]
    ds_read_b64_tr_b16 v[8:9], v1 offset:96
    ds_read_b64_tr_b16 v[10:11], v1 offset:4704
    s_waitcnt lgkmcnt(13)
    v_mfma_f32_16x16x32_bf16 v[80:83], v[12:15], v[124:127], v[80:83]
    v_mfma_f32_16x16x32_bf16 v[84:87], v[12:15], v[196:199], v[84:87]
    ds_read_b64_tr_b16 v[12:13], v1 offset:128
    ds_read_b64_tr_b16 v[14:15], v1 offset:4736
    s_waitcnt lgkmcnt(13)
    v_mfma_f32_16x16x32_bf16 v[88:91], v[16:19], v[124:127], v[88:91]
    v_mfma_f32_16x16x32_bf16 v[92:95], v[16:19], v[196:199], v[92:95]
    ds_read_b64_tr_b16 v[16:17], v1 offset:160
    ds_read_b64_tr_b16 v[18:19], v1 offset:4768
    s_waitcnt lgkmcnt(12)
    v_mfma_f32_16x16x32_bf16 v[96:99], v[20:23], v[124:127], v[96:99]
    v_mfma_f32_16x16x32_bf16 v[100:103], v[20:23], v[196:199], v[100:103]
    s_barrier
    ds_read_b64_tr_b16 v[20:21], v1 offset:192
    ds_read_b64_tr_b16 v[22:23], v1 offset:4800
    ds_write2_b64 v248, v[152:153], v[154:155] offset0:0 offset1:4
    s_waitcnt lgkmcnt(13)
    v_mfma_f32_16x16x32_bf16 v[32:35], v[24:27], v[128:131], v[32:35]
    v_mfma_f32_16x16x32_bf16 v[36:39], v[24:27], v[200:203], v[36:39]
    ds_read_b64_tr_b16 v[24:25], v1 offset:224
    ds_read_b64_tr_b16 v[26:27], v1 offset:4832
    s_waitcnt lgkmcnt(13)
    v_mfma_f32_16x16x32_bf16 v[40:43], v[28:31], v[128:131], v[40:43]
    v_mfma_f32_16x16x32_bf16 v[44:47], v[28:31], v[200:203], v[44:47]
    ds_read_b64_tr_b16 v[28:29], v1 offset:256
    ds_read_b64_tr_b16 v[30:31], v1 offset:4864
    ds_write2_b64 v248, v[156:157], v[158:159] offset0:8 offset1:12
    s_waitcnt lgkmcnt(14)
    v_mfma_f32_16x16x32_bf16 v[48:51], v[4:7], v[128:131], v[48:51]
    v_mfma_f32_16x16x32_bf16 v[52:55], v[4:7], v[200:203], v[52:55]
    ds_read_b64_tr_b16 v[4:5], v1 offset:9216
    ds_read_b64_tr_b16 v[6:7], v1 offset:13824
    s_waitcnt lgkmcnt(14)
    v_mfma_f32_16x16x32_bf16 v[56:59], v[8:11], v[128:131], v[56:59]
    v_mfma_f32_16x16x32_bf16 v[60:63], v[8:11], v[200:203], v[60:63]
    ds_read_b64_tr_b16 v[8:9], v1 offset:9248
    ds_read_b64_tr_b16 v[10:11], v1 offset:13856
    ds_read_b128 v[136:139], v3 offset:128
    s_waitcnt lgkmcnt(15)
    v_mfma_f32_16x16x32_bf16 v[64:67], v[12:15], v[128:131], v[64:67]
    v_mfma_f32_16x16x32_bf16 v[68:71], v[12:15], v[200:203], v[68:71]
    ds_read_b64_tr_b16 v[12:13], v1 offset:9280
    ds_read_b64_tr_b16 v[14:15], v1 offset:13888
    s_waitcnt lgkmcnt(15)
    v_mfma_f32_16x16x32_bf16 v[72:75], v[16:19], v[128:131], v[72:75]
    v_mfma_f32_16x16x32_bf16 v[76:79], v[16:19], v[200:203], v[76:79]
    ds_read_b64_tr_b16 v[16:17], v1 offset:9312
    ds_read_b64_tr_b16 v[18:19], v1 offset:13920
    ds_read_b128 v[208:211], v3 offset:6784
    s_waitcnt lgkmcnt(15)
    v_mfma_f32_16x16x32_bf16 v[80:83], v[20:23], v[128:131], v[80:83]
    v_mfma_f32_16x16x32_bf16 v[84:87], v[20:23], v[200:203], v[84:87]
    ds_read_b64_tr_b16 v[20:21], v1 offset:9344
    ds_read_b64_tr_b16 v[22:23], v1 offset:13952
    s_waitcnt lgkmcnt(15)
    v_mfma_f32_16x16x32_bf16 v[88:91], v[24:27], v[128:131], v[88:91]
    v_mfma_f32_16x16x32_bf16 v[92:95], v[24:27], v[200:203], v[92:95]
    ds_read_b64_tr_b16 v[24:25], v1 offset:9376
    ds_read_b64_tr_b16 v[26:27], v1 offset:13984
    ds_read_b128 v[140:143], v3 offset:192
    s_waitcnt lgkmcnt(15)
    v_mfma_f32_16x16x32_bf16 v[96:99], v[28:31], v[128:131], v[96:99]
    v_mfma_f32_16x16x32_bf16 v[100:103], v[28:31], v[200:203], v[100:103]
    ds_read_b64_tr_b16 v[28:29], v1 offset:9408
    ds_read_b64_tr_b16 v[30:31], v1 offset:14016
    s_waitcnt lgkmcnt(15)
    v_mfma_f32_16x16x32_bf16 v[32:35], v[4:7], v[132:135], v[32:35]
    v_mfma_f32_16x16x32_bf16 v[36:39], v[4:7], v[204:207], v[36:39]
    ds_read_b64_tr_b16 v[4:5], v1 offset:9440
    ds_read_b64_tr_b16 v[6:7], v1 offset:14048
    ds_read_b128 v[212:215], v3 offset:6848
    s_waitcnt lgkmcnt(15)
    v_mfma_f32_16x16x32_bf16 v[40:43], v[8:11], v[132:135], v[40:43]
    v_mfma_f32_16x16x32_bf16 v[44:47], v[8:11], v[204:207], v[44:47]
    ds_read_b64_tr_b16 v[8:9], v1 offset:9472
    ds_read_b64_tr_b16 v[10:11], v1 offset:14080
    s_waitcnt lgkmcnt(15)
    v_mfma_f32_16x16x32_bf16 v[48:51], v[12:15], v[132:135], v[48:51]
    v_mfma_f32_16x16x32_bf16 v[52:55], v[12:15], v[204:207], v[52:55]
    v_add_u32 v1, 18432, v1
    ds_read_b64_tr_b16 v[12:13], v1 offset:0
    ds_read_b64_tr_b16 v[14:15], v1 offset:4608
    s_waitcnt lgkmcnt(15)
    v_mfma_f32_16x16x32_bf16 v[56:59], v[16:19], v[132:135], v[56:59]
    v_mfma_f32_16x16x32_bf16 v[60:63], v[16:19], v[204:207], v[60:63]
    ds_read_b64_tr_b16 v[16:17], v1 offset:32
    ds_read_b64_tr_b16 v[18:19], v1 offset:4640
    s_waitcnt lgkmcnt(14)
    v_mfma_f32_16x16x32_bf16 v[64:67], v[20:23], v[132:135], v[64:67]
    v_mfma_f32_16x16x32_bf16 v[68:71], v[20:23], v[204:207], v[68:71]
    ds_read_b64_tr_b16 v[20:21], v1 offset:64
    ds_read_b64_tr_b16 v[22:23], v1 offset:4672
    s_waitcnt lgkmcnt(14)
    v_mfma_f32_16x16x32_bf16 v[72:75], v[24:27], v[132:135], v[72:75]
    v_mfma_f32_16x16x32_bf16 v[76:79], v[24:27], v[204:207], v[76:79]
    ds_read_b64_tr_b16 v[24:25], v1 offset:96
    ds_read_b64_tr_b16 v[26:27], v1 offset:4704
    s_waitcnt lgkmcnt(13)
    v_mfma_f32_16x16x32_bf16 v[80:83], v[28:31], v[132:135], v[80:83]
    v_mfma_f32_16x16x32_bf16 v[84:87], v[28:31], v[204:207], v[84:87]
    ds_read_b64_tr_b16 v[28:29], v1 offset:128
    ds_read_b64_tr_b16 v[30:31], v1 offset:4736
    s_waitcnt lgkmcnt(13)
    v_mfma_f32_16x16x32_bf16 v[88:91], v[4:7], v[132:135], v[88:91]
    v_mfma_f32_16x16x32_bf16 v[92:95], v[4:7], v[204:207], v[92:95]
    ds_read_b64_tr_b16 v[4:5], v1 offset:160
    ds_read_b64_tr_b16 v[6:7], v1 offset:4768
    s_waitcnt lgkmcnt(12)
    v_mfma_f32_16x16x32_bf16 v[96:99], v[8:11], v[132:135], v[96:99]
    v_mfma_f32_16x16x32_bf16 v[100:103], v[8:11], v[204:207], v[100:103]
    s_barrier
    ds_read_b64_tr_b16 v[8:9], v1 offset:192
    ds_read_b64_tr_b16 v[10:11], v1 offset:4800
    ds_write2_b64 v248, v[160:161], v[162:163] offset0:16 offset1:20
    s_waitcnt lgkmcnt(13)
    v_mfma_f32_16x16x32_bf16 v[32:35], v[12:15], v[136:139], v[32:35]
    v_mfma_f32_16x16x32_bf16 v[36:39], v[12:15], v[208:211], v[36:39]
    ds_read_b64_tr_b16 v[12:13], v1 offset:224
    ds_read_b64_tr_b16 v[14:15], v1 offset:4832
    s_waitcnt lgkmcnt(13)
    v_mfma_f32_16x16x32_bf16 v[40:43], v[16:19], v[136:139], v[40:43]
    v_mfma_f32_16x16x32_bf16 v[44:47], v[16:19], v[208:211], v[44:47]
    ds_read_b64_tr_b16 v[16:17], v1 offset:256
    ds_read_b64_tr_b16 v[18:19], v1 offset:4864
    ds_write2_b64 v248, v[164:165], v[166:167] offset0:24 offset1:28
    s_waitcnt lgkmcnt(14)
    v_mfma_f32_16x16x32_bf16 v[48:51], v[20:23], v[136:139], v[48:51]
    v_mfma_f32_16x16x32_bf16 v[52:55], v[20:23], v[208:211], v[52:55]
    ds_read_b64_tr_b16 v[20:21], v1 offset:9216
    ds_read_b64_tr_b16 v[22:23], v1 offset:13824
    s_waitcnt lgkmcnt(14)
    v_mfma_f32_16x16x32_bf16 v[56:59], v[24:27], v[136:139], v[56:59]
    v_mfma_f32_16x16x32_bf16 v[60:63], v[24:27], v[208:211], v[60:63]
    ds_read_b64_tr_b16 v[24:25], v1 offset:9248
    ds_read_b64_tr_b16 v[26:27], v1 offset:13856
    ds_read_b128 v[144:147], v3 offset:256
    s_waitcnt lgkmcnt(15)
    v_mfma_f32_16x16x32_bf16 v[64:67], v[28:31], v[136:139], v[64:67]
    v_mfma_f32_16x16x32_bf16 v[68:71], v[28:31], v[208:211], v[68:71]
    ds_read_b64_tr_b16 v[28:29], v1 offset:9280
    ds_read_b64_tr_b16 v[30:31], v1 offset:13888
    s_waitcnt lgkmcnt(15)
    v_mfma_f32_16x16x32_bf16 v[72:75], v[4:7], v[136:139], v[72:75]
    v_mfma_f32_16x16x32_bf16 v[76:79], v[4:7], v[208:211], v[76:79]
    ds_read_b64_tr_b16 v[4:5], v1 offset:9312
    ds_read_b64_tr_b16 v[6:7], v1 offset:13920
    ds_read_b128 v[216:219], v3 offset:6912
    s_waitcnt lgkmcnt(15)
    v_mfma_f32_16x16x32_bf16 v[80:83], v[8:11], v[136:139], v[80:83]
    v_mfma_f32_16x16x32_bf16 v[84:87], v[8:11], v[208:211], v[84:87]
    ds_read_b64_tr_b16 v[8:9], v1 offset:9344
    ds_read_b64_tr_b16 v[10:11], v1 offset:13952
    s_waitcnt lgkmcnt(15)
    v_mfma_f32_16x16x32_bf16 v[88:91], v[12:15], v[136:139], v[88:91]
    v_mfma_f32_16x16x32_bf16 v[92:95], v[12:15], v[208:211], v[92:95]
    ds_read_b64_tr_b16 v[12:13], v1 offset:9376
    ds_read_b64_tr_b16 v[14:15], v1 offset:13984
    ds_read_b128 v[148:151], v3 offset:320
    s_waitcnt lgkmcnt(15)
    v_mfma_f32_16x16x32_bf16 v[96:99], v[16:19], v[136:139], v[96:99]
    v_mfma_f32_16x16x32_bf16 v[100:103], v[16:19], v[208:211], v[100:103]
    ds_read_b64_tr_b16 v[16:17], v1 offset:9408
    ds_read_b64_tr_b16 v[18:19], v1 offset:14016
    s_waitcnt lgkmcnt(15)
    v_mfma_f32_16x16x32_bf16 v[32:35], v[20:23], v[140:143], v[32:35]
    v_mfma_f32_16x16x32_bf16 v[36:39], v[20:23], v[212:215], v[36:39]
    ds_read_b64_tr_b16 v[20:21], v1 offset:9440
    ds_read_b64_tr_b16 v[22:23], v1 offset:14048
    ds_read_b128 v[220:223], v3 offset:6976
    s_waitcnt lgkmcnt(15)
    v_mfma_f32_16x16x32_bf16 v[40:43], v[24:27], v[140:143], v[40:43]
    v_mfma_f32_16x16x32_bf16 v[44:47], v[24:27], v[212:215], v[44:47]
    ds_read_b64_tr_b16 v[24:25], v1 offset:9472
    ds_read_b64_tr_b16 v[26:27], v1 offset:14080
    s_waitcnt lgkmcnt(15)
    v_mfma_f32_16x16x32_bf16 v[48:51], v[28:31], v[140:143], v[48:51]
    v_mfma_f32_16x16x32_bf16 v[52:55], v[28:31], v[212:215], v[52:55]
    v_add_u32 v1, 18432, v1
    ds_read_b64_tr_b16 v[28:29], v1 offset:0
    ds_read_b64_tr_b16 v[30:31], v1 offset:4608
    s_waitcnt lgkmcnt(15)
    v_mfma_f32_16x16x32_bf16 v[56:59], v[4:7], v[140:143], v[56:59]
    v_mfma_f32_16x16x32_bf16 v[60:63], v[4:7], v[212:215], v[60:63]
    ds_read_b64_tr_b16 v[4:5], v1 offset:32
    ds_read_b64_tr_b16 v[6:7], v1 offset:4640
    s_waitcnt lgkmcnt(14)
    v_mfma_f32_16x16x32_bf16 v[64:67], v[8:11], v[140:143], v[64:67]
    v_mfma_f32_16x16x32_bf16 v[68:71], v[8:11], v[212:215], v[68:71]
    ds_read_b64_tr_b16 v[8:9], v1 offset:64
    ds_read_b64_tr_b16 v[10:11], v1 offset:4672
    s_waitcnt lgkmcnt(14)
    v_mfma_f32_16x16x32_bf16 v[72:75], v[12:15], v[140:143], v[72:75]
    v_mfma_f32_16x16x32_bf16 v[76:79], v[12:15], v[212:215], v[76:79]
    ds_read_b64_tr_b16 v[12:13], v1 offset:96
    ds_read_b64_tr_b16 v[14:15], v1 offset:4704
    s_waitcnt lgkmcnt(13)
    v_mfma_f32_16x16x32_bf16 v[80:83], v[16:19], v[140:143], v[80:83]
    v_mfma_f32_16x16x32_bf16 v[84:87], v[16:19], v[212:215], v[84:87]
    ds_read_b64_tr_b16 v[16:17], v1 offset:128
    ds_read_b64_tr_b16 v[18:19], v1 offset:4736
    s_waitcnt lgkmcnt(13)
    v_mfma_f32_16x16x32_bf16 v[88:91], v[20:23], v[140:143], v[88:91]
    v_mfma_f32_16x16x32_bf16 v[92:95], v[20:23], v[212:215], v[92:95]
    ds_read_b64_tr_b16 v[20:21], v1 offset:160
    ds_read_b64_tr_b16 v[22:23], v1 offset:4768
    s_waitcnt lgkmcnt(12)
    v_mfma_f32_16x16x32_bf16 v[96:99], v[24:27], v[140:143], v[96:99]
    v_mfma_f32_16x16x32_bf16 v[100:103], v[24:27], v[212:215], v[100:103]
    s_barrier
    ds_read_b64_tr_b16 v[24:25], v1 offset:192
    ds_read_b64_tr_b16 v[26:27], v1 offset:4800
    ds_write2_b64 v248, v[168:169], v[170:171] offset0:32 offset1:36
    s_waitcnt lgkmcnt(13)
    v_mfma_f32_16x16x32_bf16 v[32:35], v[28:31], v[144:147], v[32:35]
    v_mfma_f32_16x16x32_bf16 v[36:39], v[28:31], v[216:219], v[36:39]
    ds_read_b64_tr_b16 v[28:29], v1 offset:224
    ds_read_b64_tr_b16 v[30:31], v1 offset:4832
    s_waitcnt lgkmcnt(13)
    v_mfma_f32_16x16x32_bf16 v[40:43], v[4:7], v[144:147], v[40:43]
    v_mfma_f32_16x16x32_bf16 v[44:47], v[4:7], v[216:219], v[44:47]
    ds_read_b64_tr_b16 v[4:5], v1 offset:256
    ds_read_b64_tr_b16 v[6:7], v1 offset:4864
    ds_write2_b64 v248, v[172:173], v[174:175] offset0:40 offset1:44
    s_waitcnt lgkmcnt(14)
    v_mfma_f32_16x16x32_bf16 v[48:51], v[8:11], v[144:147], v[48:51]
    v_mfma_f32_16x16x32_bf16 v[52:55], v[8:11], v[216:219], v[52:55]
    ds_read_b64_tr_b16 v[8:9], v1 offset:9216
    ds_read_b64_tr_b16 v[10:11], v1 offset:13824
    s_waitcnt lgkmcnt(14)
    v_mfma_f32_16x16x32_bf16 v[56:59], v[12:15], v[144:147], v[56:59]
    v_mfma_f32_16x16x32_bf16 v[60:63], v[12:15], v[216:219], v[60:63]
    ds_read_b64_tr_b16 v[12:13], v1 offset:9248
    ds_read_b64_tr_b16 v[14:15], v1 offset:13856
    ds_read_b128 v[152:155], v3 offset:0
    s_waitcnt lgkmcnt(15)
    v_mfma_f32_16x16x32_bf16 v[64:67], v[16:19], v[144:147], v[64:67]
    v_mfma_f32_16x16x32_bf16 v[68:71], v[16:19], v[216:219], v[68:71]
    ds_read_b64_tr_b16 v[16:17], v1 offset:9280
    ds_read_b64_tr_b16 v[18:19], v1 offset:13888
    s_waitcnt lgkmcnt(15)
    v_mfma_f32_16x16x32_bf16 v[72:75], v[20:23], v[144:147], v[72:75]
    v_mfma_f32_16x16x32_bf16 v[76:79], v[20:23], v[216:219], v[76:79]
    ds_read_b64_tr_b16 v[20:21], v1 offset:9312
    ds_read_b64_tr_b16 v[22:23], v1 offset:13920
    ds_read_b128 v[224:227], v3 offset:6656
    s_waitcnt lgkmcnt(15)
    v_mfma_f32_16x16x32_bf16 v[80:83], v[24:27], v[144:147], v[80:83]
    v_mfma_f32_16x16x32_bf16 v[84:87], v[24:27], v[216:219], v[84:87]
    ds_read_b64_tr_b16 v[24:25], v1 offset:9344
    ds_read_b64_tr_b16 v[26:27], v1 offset:13952
    s_waitcnt lgkmcnt(15)
    v_mfma_f32_16x16x32_bf16 v[88:91], v[28:31], v[144:147], v[88:91]
    v_mfma_f32_16x16x32_bf16 v[92:95], v[28:31], v[216:219], v[92:95]
    ds_read_b64_tr_b16 v[28:29], v1 offset:9376
    ds_read_b64_tr_b16 v[30:31], v1 offset:13984
    ds_read_b128 v[156:159], v3 offset:64
    s_waitcnt lgkmcnt(15)
    v_mfma_f32_16x16x32_bf16 v[96:99], v[4:7], v[144:147], v[96:99]
    v_mfma_f32_16x16x32_bf16 v[100:103], v[4:7], v[216:219], v[100:103]
    ds_read_b64_tr_b16 v[4:5], v1 offset:9408
    ds_read_b64_tr_b16 v[6:7], v1 offset:14016
    s_waitcnt lgkmcnt(15)
    v_mfma_f32_16x16x32_bf16 v[32:35], v[8:11], v[148:151], v[32:35]
    v_mfma_f32_16x16x32_bf16 v[36:39], v[8:11], v[220:223], v[36:39]
    ds_read_b64_tr_b16 v[8:9], v1 offset:9440
    ds_read_b64_tr_b16 v[10:11], v1 offset:14048
    ds_read_b128 v[228:231], v3 offset:6720
    s_waitcnt lgkmcnt(15)
    v_mfma_f32_16x16x32_bf16 v[40:43], v[12:15], v[148:151], v[40:43]
    v_mfma_f32_16x16x32_bf16 v[44:47], v[12:15], v[220:223], v[44:47]
    ds_read_b64_tr_b16 v[12:13], v1 offset:9472
    ds_read_b64_tr_b16 v[14:15], v1 offset:14080
    s_waitcnt lgkmcnt(15)
    v_mfma_f32_16x16x32_bf16 v[48:51], v[16:19], v[148:151], v[48:51]
    v_mfma_f32_16x16x32_bf16 v[52:55], v[16:19], v[220:223], v[52:55]
    v_subrev_u32 v1, 92160, v1
    ds_read_b64_tr_b16 v[16:17], v1 offset:0
    ds_read_b64_tr_b16 v[18:19], v1 offset:4608
    s_waitcnt lgkmcnt(15)
    v_mfma_f32_16x16x32_bf16 v[56:59], v[20:23], v[148:151], v[56:59]
    v_mfma_f32_16x16x32_bf16 v[60:63], v[20:23], v[220:223], v[60:63]
    ds_read_b64_tr_b16 v[20:21], v1 offset:32
    ds_read_b64_tr_b16 v[22:23], v1 offset:4640
    s_waitcnt lgkmcnt(14)
    v_mfma_f32_16x16x32_bf16 v[64:67], v[24:27], v[148:151], v[64:67]
    v_mfma_f32_16x16x32_bf16 v[68:71], v[24:27], v[220:223], v[68:71]
    ds_read_b64_tr_b16 v[24:25], v1 offset:64
    ds_read_b64_tr_b16 v[26:27], v1 offset:4672
    s_waitcnt lgkmcnt(14)
    v_mfma_f32_16x16x32_bf16 v[72:75], v[28:31], v[148:151], v[72:75]
    v_mfma_f32_16x16x32_bf16 v[76:79], v[28:31], v[220:223], v[76:79]
    ds_read_b64_tr_b16 v[28:29], v1 offset:96
    ds_read_b64_tr_b16 v[30:31], v1 offset:4704
    s_waitcnt lgkmcnt(13)
    v_mfma_f32_16x16x32_bf16 v[80:83], v[4:7], v[148:151], v[80:83]
    v_mfma_f32_16x16x32_bf16 v[84:87], v[4:7], v[220:223], v[84:87]
    ds_read_b64_tr_b16 v[4:5], v1 offset:128
    ds_read_b64_tr_b16 v[6:7], v1 offset:4736
    s_waitcnt lgkmcnt(13)
    v_mfma_f32_16x16x32_bf16 v[88:91], v[8:11], v[148:151], v[88:91]
    v_mfma_f32_16x16x32_bf16 v[92:95], v[8:11], v[220:223], v[92:95]
    ds_read_b64_tr_b16 v[8:9], v1 offset:160
    ds_read_b64_tr_b16 v[10:11], v1 offset:4768
    s_waitcnt lgkmcnt(12)
    v_mfma_f32_16x16x32_bf16 v[96:99], v[12:15], v[148:151], v[96:99]
    v_mfma_f32_16x16x32_bf16 v[100:103], v[12:15], v[220:223], v[100:103]
    s_barrier
    ds_read_b64_tr_b16 v[12:13], v1 offset:192
    ds_read_b64_tr_b16 v[14:15], v1 offset:4800
    ds_read_b128 v[160:163], v3 offset:128
    s_waitcnt lgkmcnt(13)
    v_mfma_f32_16x16x32_bf16 v[32:35], v[16:19], v[152:155], v[32:35]
    v_mfma_f32_16x16x32_bf16 v[36:39], v[16:19], v[224:227], v[36:39]
    ds_read_b64_tr_b16 v[16:17], v1 offset:224
    ds_read_b64_tr_b16 v[18:19], v1 offset:4832
    s_waitcnt lgkmcnt(13)
    v_mfma_f32_16x16x32_bf16 v[40:43], v[20:23], v[152:155], v[40:43]
    v_mfma_f32_16x16x32_bf16 v[44:47], v[20:23], v[224:227], v[44:47]
    ds_read_b64_tr_b16 v[20:21], v1 offset:256
    ds_read_b64_tr_b16 v[22:23], v1 offset:4864
    ds_read_b128 v[232:235], v3 offset:6784
    s_waitcnt lgkmcnt(14)
    v_mfma_f32_16x16x32_bf16 v[48:51], v[24:27], v[152:155], v[48:51]
    v_mfma_f32_16x16x32_bf16 v[52:55], v[24:27], v[224:227], v[52:55]
    ds_read_b64_tr_b16 v[24:25], v1 offset:9216
    ds_read_b64_tr_b16 v[26:27], v1 offset:13824
    s_waitcnt lgkmcnt(14)
    v_mfma_f32_16x16x32_bf16 v[56:59], v[28:31], v[152:155], v[56:59]
    v_mfma_f32_16x16x32_bf16 v[60:63], v[28:31], v[224:227], v[60:63]
    ds_read_b64_tr_b16 v[28:29], v1 offset:9248
    ds_read_b64_tr_b16 v[30:31], v1 offset:13856
    ds_read_b128 v[164:167], v3 offset:192
    s_waitcnt lgkmcnt(15)
    v_mfma_f32_16x16x32_bf16 v[64:67], v[4:7], v[152:155], v[64:67]
    v_mfma_f32_16x16x32_bf16 v[68:71], v[4:7], v[224:227], v[68:71]
    ds_read_b64_tr_b16 v[4:5], v1 offset:9280
    ds_read_b64_tr_b16 v[6:7], v1 offset:13888
    s_waitcnt lgkmcnt(15)
    v_mfma_f32_16x16x32_bf16 v[72:75], v[8:11], v[152:155], v[72:75]
    v_mfma_f32_16x16x32_bf16 v[76:79], v[8:11], v[224:227], v[76:79]
    ds_read_b64_tr_b16 v[8:9], v1 offset:9312
    ds_read_b64_tr_b16 v[10:11], v1 offset:13920
    ds_read_b128 v[236:239], v3 offset:6848
    s_waitcnt lgkmcnt(15)
    v_mfma_f32_16x16x32_bf16 v[80:83], v[12:15], v[152:155], v[80:83]
    v_mfma_f32_16x16x32_bf16 v[84:87], v[12:15], v[224:227], v[84:87]
    ds_read_b64_tr_b16 v[12:13], v1 offset:9344
    ds_read_b64_tr_b16 v[14:15], v1 offset:13952
    s_waitcnt lgkmcnt(15)
    v_mfma_f32_16x16x32_bf16 v[88:91], v[16:19], v[152:155], v[88:91]
    v_mfma_f32_16x16x32_bf16 v[92:95], v[16:19], v[224:227], v[92:95]
    ds_read_b64_tr_b16 v[16:17], v1 offset:9376
    ds_read_b64_tr_b16 v[18:19], v1 offset:13984
    s_waitcnt lgkmcnt(15)
    v_mfma_f32_16x16x32_bf16 v[96:99], v[20:23], v[152:155], v[96:99]
    v_mfma_f32_16x16x32_bf16 v[100:103], v[20:23], v[224:227], v[100:103]
    ds_read_b64_tr_b16 v[20:21], v1 offset:9408
    ds_read_b64_tr_b16 v[22:23], v1 offset:14016
    s_waitcnt lgkmcnt(14)
    v_mfma_f32_16x16x32_bf16 v[32:35], v[24:27], v[156:159], v[32:35]
    v_mfma_f32_16x16x32_bf16 v[36:39], v[24:27], v[228:231], v[36:39]
    ds_read_b64_tr_b16 v[24:25], v1 offset:9440
    ds_read_b64_tr_b16 v[26:27], v1 offset:14048
    s_waitcnt lgkmcnt(14)
    v_mfma_f32_16x16x32_bf16 v[40:43], v[28:31], v[156:159], v[40:43]
    v_mfma_f32_16x16x32_bf16 v[44:47], v[28:31], v[228:231], v[44:47]
    ds_read_b64_tr_b16 v[28:29], v1 offset:9472
    ds_read_b64_tr_b16 v[30:31], v1 offset:14080
    s_waitcnt lgkmcnt(13)
    v_mfma_f32_16x16x32_bf16 v[48:51], v[4:7], v[156:159], v[48:51]
    v_mfma_f32_16x16x32_bf16 v[52:55], v[4:7], v[228:231], v[52:55]
    v_add_u32 v1, 18432, v1
    ds_read_b64_tr_b16 v[4:5], v1 offset:0
    ds_read_b64_tr_b16 v[6:7], v1 offset:4608
    s_waitcnt lgkmcnt(13)
    v_mfma_f32_16x16x32_bf16 v[56:59], v[8:11], v[156:159], v[56:59]
    v_mfma_f32_16x16x32_bf16 v[60:63], v[8:11], v[228:231], v[60:63]
    ds_read_b64_tr_b16 v[8:9], v1 offset:32
    ds_read_b64_tr_b16 v[10:11], v1 offset:4640
    s_waitcnt lgkmcnt(12)
    v_mfma_f32_16x16x32_bf16 v[64:67], v[12:15], v[156:159], v[64:67]
    v_mfma_f32_16x16x32_bf16 v[68:71], v[12:15], v[228:231], v[68:71]
    ds_read_b64_tr_b16 v[12:13], v1 offset:64
    ds_read_b64_tr_b16 v[14:15], v1 offset:4672
    s_waitcnt lgkmcnt(12)
    v_mfma_f32_16x16x32_bf16 v[72:75], v[16:19], v[156:159], v[72:75]
    v_mfma_f32_16x16x32_bf16 v[76:79], v[16:19], v[228:231], v[76:79]
    ds_read_b64_tr_b16 v[16:17], v1 offset:96
    ds_read_b64_tr_b16 v[18:19], v1 offset:4704
    s_waitcnt lgkmcnt(12)
    v_mfma_f32_16x16x32_bf16 v[80:83], v[20:23], v[156:159], v[80:83]
    v_mfma_f32_16x16x32_bf16 v[84:87], v[20:23], v[228:231], v[84:87]
    ds_read_b64_tr_b16 v[20:21], v1 offset:128
    ds_read_b64_tr_b16 v[22:23], v1 offset:4736
    s_waitcnt lgkmcnt(12)
    v_mfma_f32_16x16x32_bf16 v[88:91], v[24:27], v[156:159], v[88:91]
    v_mfma_f32_16x16x32_bf16 v[92:95], v[24:27], v[228:231], v[92:95]
    ds_read_b64_tr_b16 v[24:25], v1 offset:160
    ds_read_b64_tr_b16 v[26:27], v1 offset:4768
    s_waitcnt lgkmcnt(12)
    v_mfma_f32_16x16x32_bf16 v[96:99], v[28:31], v[156:159], v[96:99]
    v_mfma_f32_16x16x32_bf16 v[100:103], v[28:31], v[228:231], v[100:103]
    s_barrier
    ds_read_b64_tr_b16 v[28:29], v1 offset:192
    ds_read_b64_tr_b16 v[30:31], v1 offset:4800
    ds_read_b128 v[168:171], v3 offset:256
    s_waitcnt lgkmcnt(13)
    v_mfma_f32_16x16x32_bf16 v[32:35], v[4:7], v[160:163], v[32:35]
    v_mfma_f32_16x16x32_bf16 v[36:39], v[4:7], v[232:235], v[36:39]
    ds_read_b64_tr_b16 v[4:5], v1 offset:224
    ds_read_b64_tr_b16 v[6:7], v1 offset:4832
    s_waitcnt lgkmcnt(13)
    v_mfma_f32_16x16x32_bf16 v[40:43], v[8:11], v[160:163], v[40:43]
    v_mfma_f32_16x16x32_bf16 v[44:47], v[8:11], v[232:235], v[44:47]
    ds_read_b64_tr_b16 v[8:9], v1 offset:256
    ds_read_b64_tr_b16 v[10:11], v1 offset:4864
    ds_read_b128 v[240:243], v3 offset:6912
    s_waitcnt lgkmcnt(14)
    v_mfma_f32_16x16x32_bf16 v[48:51], v[12:15], v[160:163], v[48:51]
    v_mfma_f32_16x16x32_bf16 v[52:55], v[12:15], v[232:235], v[52:55]
    ds_read_b64_tr_b16 v[12:13], v1 offset:9216
    ds_read_b64_tr_b16 v[14:15], v1 offset:13824
    s_waitcnt lgkmcnt(14)
    v_mfma_f32_16x16x32_bf16 v[56:59], v[16:19], v[160:163], v[56:59]
    v_mfma_f32_16x16x32_bf16 v[60:63], v[16:19], v[232:235], v[60:63]
    ds_read_b64_tr_b16 v[16:17], v1 offset:9248
    ds_read_b64_tr_b16 v[18:19], v1 offset:13856
    ds_read_b128 v[172:175], v3 offset:320
    s_waitcnt lgkmcnt(15)
    v_mfma_f32_16x16x32_bf16 v[64:67], v[20:23], v[160:163], v[64:67]
    v_mfma_f32_16x16x32_bf16 v[68:71], v[20:23], v[232:235], v[68:71]
    ds_read_b64_tr_b16 v[20:21], v1 offset:9280
    ds_read_b64_tr_b16 v[22:23], v1 offset:13888
    s_waitcnt lgkmcnt(15)
    v_mfma_f32_16x16x32_bf16 v[72:75], v[24:27], v[160:163], v[72:75]
    v_mfma_f32_16x16x32_bf16 v[76:79], v[24:27], v[232:235], v[76:79]
    ds_read_b64_tr_b16 v[24:25], v1 offset:9312
    ds_read_b64_tr_b16 v[26:27], v1 offset:13920
    ds_read_b128 v[244:247], v3 offset:6976
    s_waitcnt lgkmcnt(15)
    v_mfma_f32_16x16x32_bf16 v[80:83], v[28:31], v[160:163], v[80:83]
    v_mfma_f32_16x16x32_bf16 v[84:87], v[28:31], v[232:235], v[84:87]
    ds_read_b64_tr_b16 v[28:29], v1 offset:9344
    ds_read_b64_tr_b16 v[30:31], v1 offset:13952
    s_waitcnt lgkmcnt(15)
    v_mfma_f32_16x16x32_bf16 v[88:91], v[4:7], v[160:163], v[88:91]
    v_mfma_f32_16x16x32_bf16 v[92:95], v[4:7], v[232:235], v[92:95]
    ds_read_b64_tr_b16 v[4:5], v1 offset:9376
    ds_read_b64_tr_b16 v[6:7], v1 offset:13984
    s_waitcnt lgkmcnt(15)
    v_mfma_f32_16x16x32_bf16 v[96:99], v[8:11], v[160:163], v[96:99]
    v_mfma_f32_16x16x32_bf16 v[100:103], v[8:11], v[232:235], v[100:103]
    ds_read_b64_tr_b16 v[8:9], v1 offset:9408
    ds_read_b64_tr_b16 v[10:11], v1 offset:14016
    s_waitcnt lgkmcnt(14)
    v_mfma_f32_16x16x32_bf16 v[32:35], v[12:15], v[164:167], v[32:35]
    v_mfma_f32_16x16x32_bf16 v[36:39], v[12:15], v[236:239], v[36:39]
    ds_read_b64_tr_b16 v[12:13], v1 offset:9440
    ds_read_b64_tr_b16 v[14:15], v1 offset:14048
    s_waitcnt lgkmcnt(14)
    v_mfma_f32_16x16x32_bf16 v[40:43], v[16:19], v[164:167], v[40:43]
    v_mfma_f32_16x16x32_bf16 v[44:47], v[16:19], v[236:239], v[44:47]
    ds_read_b64_tr_b16 v[16:17], v1 offset:9472
    ds_read_b64_tr_b16 v[18:19], v1 offset:14080
    s_waitcnt lgkmcnt(13)
    v_mfma_f32_16x16x32_bf16 v[48:51], v[20:23], v[164:167], v[48:51]
    v_mfma_f32_16x16x32_bf16 v[52:55], v[20:23], v[236:239], v[52:55]
    v_add_u32 v1, 18432, v1
    ds_read_b64_tr_b16 v[20:21], v1 offset:0
    ds_read_b64_tr_b16 v[22:23], v1 offset:4608
    s_waitcnt lgkmcnt(13)
    v_mfma_f32_16x16x32_bf16 v[56:59], v[24:27], v[164:167], v[56:59]
    v_mfma_f32_16x16x32_bf16 v[60:63], v[24:27], v[236:239], v[60:63]
    ds_read_b64_tr_b16 v[24:25], v1 offset:32
    ds_read_b64_tr_b16 v[26:27], v1 offset:4640
    s_waitcnt lgkmcnt(12)
    v_mfma_f32_16x16x32_bf16 v[64:67], v[28:31], v[164:167], v[64:67]
    v_mfma_f32_16x16x32_bf16 v[68:71], v[28:31], v[236:239], v[68:71]
    ds_read_b64_tr_b16 v[28:29], v1 offset:64
    ds_read_b64_tr_b16 v[30:31], v1 offset:4672
    s_waitcnt lgkmcnt(12)
    v_mfma_f32_16x16x32_bf16 v[72:75], v[4:7], v[164:167], v[72:75]
    v_mfma_f32_16x16x32_bf16 v[76:79], v[4:7], v[236:239], v[76:79]
    ds_read_b64_tr_b16 v[4:5], v1 offset:96
    ds_read_b64_tr_b16 v[6:7], v1 offset:4704
    s_waitcnt lgkmcnt(12)
    v_mfma_f32_16x16x32_bf16 v[80:83], v[8:11], v[164:167], v[80:83]
    v_mfma_f32_16x16x32_bf16 v[84:87], v[8:11], v[236:239], v[84:87]
    ds_read_b64_tr_b16 v[8:9], v1 offset:128
    ds_read_b64_tr_b16 v[10:11], v1 offset:4736
    s_waitcnt lgkmcnt(12)
    v_mfma_f32_16x16x32_bf16 v[88:91], v[12:15], v[164:167], v[88:91]
    v_mfma_f32_16x16x32_bf16 v[92:95], v[12:15], v[236:239], v[92:95]
    ds_read_b64_tr_b16 v[12:13], v1 offset:160
    ds_read_b64_tr_b16 v[14:15], v1 offset:4768
    s_waitcnt lgkmcnt(12)
    v_mfma_f32_16x16x32_bf16 v[96:99], v[16:19], v[164:167], v[96:99]
    v_mfma_f32_16x16x32_bf16 v[100:103], v[16:19], v[236:239], v[100:103]
    s_barrier
    ds_read_b64_tr_b16 v[16:17], v1 offset:192
    ds_read_b64_tr_b16 v[18:19], v1 offset:4800
    s_waitcnt lgkmcnt(12)
    v_mfma_f32_16x16x32_bf16 v[32:35], v[20:23], v[168:171], v[32:35]
    v_mfma_f32_16x16x32_bf16 v[36:39], v[20:23], v[240:243], v[36:39]
    ds_read_b64_tr_b16 v[20:21], v1 offset:224
    ds_read_b64_tr_b16 v[22:23], v1 offset:4832
    s_waitcnt lgkmcnt(12)
    v_mfma_f32_16x16x32_bf16 v[40:43], v[24:27], v[168:171], v[40:43]
    v_mfma_f32_16x16x32_bf16 v[44:47], v[24:27], v[240:243], v[44:47]
    ds_read_b64_tr_b16 v[24:25], v1 offset:256
    ds_read_b64_tr_b16 v[26:27], v1 offset:4864
    s_waitcnt lgkmcnt(12)
    v_mfma_f32_16x16x32_bf16 v[48:51], v[28:31], v[168:171], v[48:51]
    v_mfma_f32_16x16x32_bf16 v[52:55], v[28:31], v[240:243], v[52:55]
    ds_read_b64_tr_b16 v[28:29], v1 offset:9216
    ds_read_b64_tr_b16 v[30:31], v1 offset:13824
    s_waitcnt lgkmcnt(12)
    v_mfma_f32_16x16x32_bf16 v[56:59], v[4:7], v[168:171], v[56:59]
    v_mfma_f32_16x16x32_bf16 v[60:63], v[4:7], v[240:243], v[60:63]
    ds_read_b64_tr_b16 v[4:5], v1 offset:9248
    ds_read_b64_tr_b16 v[6:7], v1 offset:13856
    s_waitcnt lgkmcnt(12)
    v_mfma_f32_16x16x32_bf16 v[64:67], v[8:11], v[168:171], v[64:67]
    v_mfma_f32_16x16x32_bf16 v[68:71], v[8:11], v[240:243], v[68:71]
    ds_read_b64_tr_b16 v[8:9], v1 offset:9280
    ds_read_b64_tr_b16 v[10:11], v1 offset:13888
    s_waitcnt lgkmcnt(12)
    v_mfma_f32_16x16x32_bf16 v[72:75], v[12:15], v[168:171], v[72:75]
    v_mfma_f32_16x16x32_bf16 v[76:79], v[12:15], v[240:243], v[76:79]
    ds_read_b64_tr_b16 v[12:13], v1 offset:9312
    ds_read_b64_tr_b16 v[14:15], v1 offset:13920
    s_waitcnt lgkmcnt(12)
    v_mfma_f32_16x16x32_bf16 v[80:83], v[16:19], v[168:171], v[80:83]
    v_mfma_f32_16x16x32_bf16 v[84:87], v[16:19], v[240:243], v[84:87]
    ds_read_b64_tr_b16 v[16:17], v1 offset:9344
    ds_read_b64_tr_b16 v[18:19], v1 offset:13952
    s_waitcnt lgkmcnt(12)
    v_mfma_f32_16x16x32_bf16 v[88:91], v[20:23], v[168:171], v[88:91]
    v_mfma_f32_16x16x32_bf16 v[92:95], v[20:23], v[240:243], v[92:95]
    ds_read_b64_tr_b16 v[20:21], v1 offset:9376
    ds_read_b64_tr_b16 v[22:23], v1 offset:13984
    s_waitcnt lgkmcnt(12)
    v_mfma_f32_16x16x32_bf16 v[96:99], v[24:27], v[168:171], v[96:99]
    v_mfma_f32_16x16x32_bf16 v[100:103], v[24:27], v[240:243], v[100:103]
    ds_read_b64_tr_b16 v[24:25], v1 offset:9408
    ds_read_b64_tr_b16 v[26:27], v1 offset:14016
    s_waitcnt lgkmcnt(12)
    v_mfma_f32_16x16x32_bf16 v[32:35], v[28:31], v[172:175], v[32:35]
    v_mfma_f32_16x16x32_bf16 v[36:39], v[28:31], v[244:247], v[36:39]
    ds_read_b64_tr_b16 v[28:29], v1 offset:9440
    ds_read_b64_tr_b16 v[30:31], v1 offset:14048
    s_waitcnt lgkmcnt(12)
    v_mfma_f32_16x16x32_bf16 v[40:43], v[4:7], v[172:175], v[40:43]
    v_mfma_f32_16x16x32_bf16 v[44:47], v[4:7], v[244:247], v[44:47]
    ds_read_b64_tr_b16 v[4:5], v1 offset:9472
    ds_read_b64_tr_b16 v[6:7], v1 offset:14080
    s_waitcnt lgkmcnt(12)
    v_mfma_f32_16x16x32_bf16 v[48:51], v[8:11], v[172:175], v[48:51]
    v_mfma_f32_16x16x32_bf16 v[52:55], v[8:11], v[244:247], v[52:55]
    v_add_u32 v1, 18432, v1
    v_lshrrev_b32 v8, 2, v0
    v_lshlrev_b32 v8, 6, v8
    v_sub_u32 v1, v1, v8
    ds_read_b64_tr_b16 v[8:9], v1 offset:0
    ds_read_b64_tr_b16 v[10:11], v1 offset:3584
    s_waitcnt lgkmcnt(12)
    v_mfma_f32_16x16x32_bf16 v[56:59], v[12:15], v[172:175], v[56:59]
    v_mfma_f32_16x16x32_bf16 v[60:63], v[12:15], v[244:247], v[60:63]
    ds_read_b64_tr_b16 v[12:13], v1 offset:32
    ds_read_b64_tr_b16 v[14:15], v1 offset:3616
    s_waitcnt lgkmcnt(12)
    v_mfma_f32_16x16x32_bf16 v[64:67], v[16:19], v[172:175], v[64:67]
    v_mfma_f32_16x16x32_bf16 v[68:71], v[16:19], v[244:247], v[68:71]
    ds_read_b64_tr_b16 v[16:17], v1 offset:64
    ds_read_b64_tr_b16 v[18:19], v1 offset:3648
    s_waitcnt lgkmcnt(12)
    v_mfma_f32_16x16x32_bf16 v[72:75], v[20:23], v[172:175], v[72:75]
    v_mfma_f32_16x16x32_bf16 v[76:79], v[20:23], v[244:247], v[76:79]
    ds_read_b64_tr_b16 v[20:21], v1 offset:96
    ds_read_b64_tr_b16 v[22:23], v1 offset:3680
    s_waitcnt lgkmcnt(12)
    v_mfma_f32_16x16x32_bf16 v[80:83], v[24:27], v[172:175], v[80:83]
    v_mfma_f32_16x16x32_bf16 v[84:87], v[24:27], v[244:247], v[84:87]
    ds_read_b64_tr_b16 v[24:25], v1 offset:128
    ds_read_b64_tr_b16 v[26:27], v1 offset:3712
    s_waitcnt lgkmcnt(12)
    v_mfma_f32_16x16x32_bf16 v[88:91], v[28:31], v[172:175], v[88:91]
    v_mfma_f32_16x16x32_bf16 v[92:95], v[28:31], v[244:247], v[92:95]
    ds_read_b64_tr_b16 v[28:29], v1 offset:160
    ds_read_b64_tr_b16 v[30:31], v1 offset:3744
    s_waitcnt lgkmcnt(12)
    v_mfma_f32_16x16x32_bf16 v[96:99], v[4:7], v[172:175], v[96:99]
    v_mfma_f32_16x16x32_bf16 v[100:103], v[4:7], v[244:247], v[100:103]
    s_barrier
    s_waitcnt vmcnt(0)
    s_and_b32 s52, s51, 1
    s_mul_i32 s52, s52, 9216
    s_cmp_lt_u32 s51, 2
    s_cselect_b32 s53, 7, 2
    s_mul_i32 s53, s53, 18432
    s_add_u32 s52, s52, s53
    v_add_u32 v3, s52, v2
    ds_read_b64_tr_b16 v[4:5], v1 offset:192
    ds_read_b64_tr_b16 v[6:7], v1 offset:3776
    v_cvt_pk_bf16_f32 v32, v32, v33
    v_cvt_pk_bf16_f32 v33, v34, v35
    v_cvt_pk_bf16_f32 v34, v36, v37
    v_cvt_pk_bf16_f32 v35, v38, v39
    ds_write_b128 v3, v[32:35] offset:0
    s_waitcnt lgkmcnt(13)
    v_mfma_f32_16x16x32_bf16 v[32:35], v[8:11], v[104:107], 0
    v_mfma_f32_16x16x32_bf16 v[36:39], v[8:11], v[176:179], 0
    ds_read_b64_tr_b16 v[8:9], v1 offset:7168
    ds_read_b64_tr_b16 v[10:11], v1 offset:10752
    v_cvt_pk_bf16_f32 v40, v40, v41
    v_cvt_pk_bf16_f32 v41, v42, v43
    v_cvt_pk_bf16_f32 v42, v44, v45
    v_cvt_pk_bf16_f32 v43, v46, v47
    ds_write_b128 v3, v[40:43] offset:1024
    s_waitcnt lgkmcnt(14)
    v_mfma_f32_16x16x32_bf16 v[40:43], v[12:15], v[104:107], 0
    v_mfma_f32_16x16x32_bf16 v[44:47], v[12:15], v[176:179], 0
    ds_read_b64_tr_b16 v[12:13], v1 offset:7200
    ds_read_b64_tr_b16 v[14:15], v1 offset:10784
    v_cvt_pk_bf16_f32 v48, v48, v49
    v_cvt_pk_bf16_f32 v49, v50, v51
    v_cvt_pk_bf16_f32 v50, v52, v53
    v_cvt_pk_bf16_f32 v51, v54, v55
    ds_write_b128 v3, v[48:51] offset:2048
    s_waitcnt lgkmcnt(15)
    v_mfma_f32_16x16x32_bf16 v[48:51], v[16:19], v[104:107], 0
    v_mfma_f32_16x16x32_bf16 v[52:55], v[16:19], v[176:179], 0
    ds_read_b64_tr_b16 v[16:17], v1 offset:7232
    ds_read_b64_tr_b16 v[18:19], v1 offset:10816
    v_cvt_pk_bf16_f32 v56, v56, v57
    v_cvt_pk_bf16_f32 v57, v58, v59
    v_cvt_pk_bf16_f32 v58, v60, v61
    v_cvt_pk_bf16_f32 v59, v62, v63
    ds_write_b128 v3, v[56:59] offset:3072
    s_waitcnt lgkmcnt(15)
    v_mfma_f32_16x16x32_bf16 v[56:59], v[20:23], v[104:107], 0
    v_mfma_f32_16x16x32_bf16 v[60:63], v[20:23], v[176:179], 0
    ds_read_b64_tr_b16 v[20:21], v1 offset:7264
    ds_read_b64_tr_b16 v[22:23], v1 offset:10848
    v_cvt_pk_bf16_f32 v64, v64, v65
    v_cvt_pk_bf16_f32 v65, v66, v67
    v_cvt_pk_bf16_f32 v66, v68, v69
    v_cvt_pk_bf16_f32 v67, v70, v71
    ds_write_b128 v3, v[64:67] offset:4096
    s_waitcnt lgkmcnt(15)
    v_mfma_f32_16x16x32_bf16 v[64:67], v[24:27], v[104:107], 0
    v_mfma_f32_16x16x32_bf16 v[68:71], v[24:27], v[176:179], 0
    ds_read_b64_tr_b16 v[24:25], v1 offset:7296
    ds_read_b64_tr_b16 v[26:27], v1 offset:10880
    v_cvt_pk_bf16_f32 v72, v72, v73
    v_cvt_pk_bf16_f32 v73, v74, v75
    v_cvt_pk_bf16_f32 v74, v76, v77
    v_cvt_pk_bf16_f32 v75, v78, v79
    ds_write_b128 v3, v[72:75] offset:5120
    v_mfma_f32_16x16x32_bf16 v[72:75], v[28:31], v[104:107], 0
    v_mfma_f32_16x16x32_bf16 v[76:79], v[28:31], v[176:179], 0
    ds_read_b64_tr_b16 v[28:29], v1 offset:7328
    ds_read_b64_tr_b16 v[30:31], v1 offset:10912
    v_cvt_pk_bf16_f32 v80, v80, v81
    v_cvt_pk_bf16_f32 v81, v82, v83
    v_cvt_pk_bf16_f32 v82, v84, v85
    v_cvt_pk_bf16_f32 v83, v86, v87
    ds_write_b128 v3, v[80:83] offset:6144
    s_waitcnt lgkmcnt(15)
    v_mfma_f32_16x16x32_bf16 v[80:83], v[4:7], v[104:107], 0
    v_mfma_f32_16x16x32_bf16 v[84:87], v[4:7], v[176:179], 0
    ds_read_b64_tr_b16 v[4:5], v1 offset:7360
    ds_read_b64_tr_b16 v[6:7], v1 offset:10944
    v_mfma_f32_16x16x32_bf16 v[32:35], v[8:11], v[108:111], v[32:35]
    v_mul_f32 v248, v88, v88
    v_mul_f32 v249, v89, v89
    v_mfma_f32_16x16x32_bf16 v[36:39], v[8:11], v[180:183], v[36:39]
    v_mul_f32 v250, v90, v90
    v_mul_f32 v251, v91, v91
    v_add_u32 v1, 18432, v1
    ds_read_b64_tr_b16 v[8:9], v1 offset:0
    ds_read_b64_tr_b16 v[10:11], v1 offset:3584
    s_waitcnt lgkmcnt(15)
    v_mfma_f32_16x16x32_bf16 v[40:43], v[12:15], v[108:111], v[40:43]
    v_mul_f32 v252, v92, v92
    v_mul_f32 v253, v93, v93
    v_mfma_f32_16x16x32_bf16 v[44:47], v[12:15], v[180:183], v[44:47]
    v_mul_f32 v254, v94, v94
    v_mul_f32 v255, v95, v95
    ds_read_b64_tr_b16 v[12:13], v1 offset:32
    ds_read_b64_tr_b16 v[14:15], v1 offset:3616
    s_waitcnt lgkmcnt(15)
    v_mfma_f32_16x16x32_bf16 v[48:51], v[16:19], v[108:111], v[48:51]
    v_mul_f32 v248, 0xbdd2d3e8, v248
    v_mul_f32 v249, 0xbdd2d3e8, v249
    v_mfma_f32_16x16x32_bf16 v[52:55], v[16:19], v[180:183], v[52:55]
    v_mul_f32 v250, 0xbdd2d3e8, v250
    v_mul_f32 v251, 0xbdd2d3e8, v251
    ds_read_b64_tr_b16 v[16:17], v1 offset:64
    ds_read_b64_tr_b16 v[18:19], v1 offset:3648
    s_waitcnt lgkmcnt(15)
    v_mfma_f32_16x16x32_bf16 v[56:59], v[20:23], v[108:111], v[56:59]
    v_mul_f32 v252, 0xbdd2d3e8, v252
    v_mul_f32 v253, 0xbdd2d3e8, v253
    v_mfma_f32_16x16x32_bf16 v[60:63], v[20:23], v[180:183], v[60:63]
    v_mul_f32 v254, 0xbdd2d3e8, v254
    v_mul_f32 v255, 0xbdd2d3e8, v255
    ds_read_b64_tr_b16 v[20:21], v1 offset:96
    ds_read_b64_tr_b16 v[22:23], v1 offset:3680
    s_waitcnt lgkmcnt(14)
    v_mfma_f32_16x16x32_bf16 v[64:67], v[24:27], v[108:111], v[64:67]
    v_add_f32 v248, 0xc0135761, v248
    v_add_f32 v249, 0xc0135761, v249
    v_mfma_f32_16x16x32_bf16 v[68:71], v[24:27], v[180:183], v[68:71]
    v_add_f32 v250, 0xc0135761, v250
    v_add_f32 v251, 0xc0135761, v251
    ds_read_b64_tr_b16 v[24:25], v1 offset:128
    ds_read_b64_tr_b16 v[26:27], v1 offset:3712
    s_waitcnt lgkmcnt(13)
    v_mfma_f32_16x16x32_bf16 v[72:75], v[28:31], v[108:111], v[72:75]
    v_add_f32 v252, 0xc0135761, v252
    v_add_f32 v253, 0xc0135761, v253
    v_mfma_f32_16x16x32_bf16 v[76:79], v[28:31], v[180:183], v[76:79]
    v_add_f32 v254, 0xc0135761, v254
    v_add_f32 v255, 0xc0135761, v255
    ds_read_b64_tr_b16 v[28:29], v1 offset:160
    ds_read_b64_tr_b16 v[30:31], v1 offset:3744
    s_waitcnt lgkmcnt(12)
    v_mfma_f32_16x16x32_bf16 v[80:83], v[4:7], v[108:111], v[80:83]
    v_mul_f32 v248, v248, v88
    v_mul_f32 v249, v249, v89
    v_mfma_f32_16x16x32_bf16 v[84:87], v[4:7], v[180:183], v[84:87]
    v_mul_f32 v250, v250, v90
    v_mul_f32 v251, v251, v91
    s_barrier
    ds_read_b64_tr_b16 v[4:5], v1 offset:192
    ds_read_b64_tr_b16 v[6:7], v1 offset:3776
    s_waitcnt lgkmcnt(12)
    v_mfma_f32_16x16x32_bf16 v[32:35], v[8:11], v[112:115], v[32:35]
    v_mul_f32 v252, v252, v92
    v_mul_f32 v253, v253, v93
    v_mfma_f32_16x16x32_bf16 v[36:39], v[8:11], v[184:187], v[36:39]
    v_mul_f32 v254, v254, v94
    v_mul_f32 v255, v255, v95
    ds_read_b64_tr_b16 v[8:9], v1 offset:7168
    ds_read_b64_tr_b16 v[10:11], v1 offset:10752
    s_waitcnt lgkmcnt(12)
    v_mfma_f32_16x16x32_bf16 v[40:43], v[12:15], v[112:115], v[40:43]
    v_exp_f32 v248, v248
    v_exp_f32 v249, v249
    v_mfma_f32_16x16x32_bf16 v[44:47], v[12:15], v[184:187], v[44:47]
    v_exp_f32 v250, v250
    v_exp_f32 v251, v251
    ds_read_b64_tr_b16 v[12:13], v1 offset:7200
    ds_read_b64_tr_b16 v[14:15], v1 offset:10784
    s_waitcnt lgkmcnt(12)
    v_mfma_f32_16x16x32_bf16 v[48:51], v[16:19], v[112:115], v[48:51]
    v_exp_f32 v252, v252
    v_exp_f32 v253, v253
    v_mfma_f32_16x16x32_bf16 v[52:55], v[16:19], v[184:187], v[52:55]
    v_exp_f32 v254, v254
    v_exp_f32 v255, v255
    ds_read_b64_tr_b16 v[16:17], v1 offset:7232
    ds_read_b64_tr_b16 v[18:19], v1 offset:10816
    s_waitcnt lgkmcnt(12)
    v_mfma_f32_16x16x32_bf16 v[56:59], v[20:23], v[112:115], v[56:59]
    v_add_f32 v248, 1.0, v248
    v_add_f32 v249, 1.0, v249
    v_mfma_f32_16x16x32_bf16 v[60:63], v[20:23], v[184:187], v[60:63]
    v_add_f32 v250, 1.0, v250
    v_add_f32 v251, 1.0, v251
    ds_read_b64_tr_b16 v[20:21], v1 offset:7264
    ds_read_b64_tr_b16 v[22:23], v1 offset:10848
    s_waitcnt lgkmcnt(12)
    v_mfma_f32_16x16x32_bf16 v[64:67], v[24:27], v[112:115], v[64:67]
    v_add_f32 v252, 1.0, v252
    v_add_f32 v253, 1.0, v253
    v_mfma_f32_16x16x32_bf16 v[68:71], v[24:27], v[184:187], v[68:71]
    v_add_f32 v254, 1.0, v254
    v_add_f32 v255, 1.0, v255
    ds_read_b64_tr_b16 v[24:25], v1 offset:7296
    ds_read_b64_tr_b16 v[26:27], v1 offset:10880
    s_waitcnt lgkmcnt(12)
    v_mfma_f32_16x16x32_bf16 v[72:75], v[28:31], v[112:115], v[72:75]
    v_rcp_f32 v248, v248
    v_rcp_f32 v249, v249
    v_mfma_f32_16x16x32_bf16 v[76:79], v[28:31], v[184:187], v[76:79]
    v_rcp_f32 v250, v250
    v_rcp_f32 v251, v251
    ds_read_b64_tr_b16 v[28:29], v1 offset:7328
    ds_read_b64_tr_b16 v[30:31], v1 offset:10912
    s_waitcnt lgkmcnt(12)
    v_mfma_f32_16x16x32_bf16 v[80:83], v[4:7], v[112:115], v[80:83]
    v_rcp_f32 v252, v252
    v_rcp_f32 v253, v253
    v_mfma_f32_16x16x32_bf16 v[84:87], v[4:7], v[184:187], v[84:87]
    v_rcp_f32 v254, v254
    v_rcp_f32 v255, v255
    ds_read_b64_tr_b16 v[4:5], v1 offset:7360
    ds_read_b64_tr_b16 v[6:7], v1 offset:10944
    s_waitcnt lgkmcnt(12)
    v_mfma_f32_16x16x32_bf16 v[32:35], v[8:11], v[116:119], v[32:35]
    v_mul_f32 v88, v88, v248
    v_mul_f32 v89, v89, v249
    v_mfma_f32_16x16x32_bf16 v[36:39], v[8:11], v[188:191], v[36:39]
    v_mul_f32 v90, v90, v250
    v_mul_f32 v91, v91, v251
    v_add_u32 v1, 18432, v1
    ds_read_b64_tr_b16 v[8:9], v1 offset:0
    ds_read_b64_tr_b16 v[10:11], v1 offset:3584
    s_waitcnt lgkmcnt(12)
    v_mfma_f32_16x16x32_bf16 v[40:43], v[12:15], v[116:119], v[40:43]
    v_mul_f32 v92, v92, v252
    v_mul_f32 v93, v93, v253
    v_mfma_f32_16x16x32_bf16 v[44:47], v[12:15], v[188:191], v[44:47]
    v_mul_f32 v94, v94, v254
    v_mul_f32 v95, v95, v255
    ds_read_b64_tr_b16 v[12:13], v1 offset:32
    ds_read_b64_tr_b16 v[14:15], v1 offset:3616
    s_waitcnt lgkmcnt(12)
    v_mfma_f32_16x16x32_bf16 v[48:51], v[16:19], v[116:119], v[48:51]
    v_mul_f32 v248, v96, v96
    v_mul_f32 v249, v97, v97
    v_mfma_f32_16x16x32_bf16 v[52:55], v[16:19], v[188:191], v[52:55]
    v_mul_f32 v250, v98, v98
    v_mul_f32 v251, v99, v99
    ds_read_b64_tr_b16 v[16:17], v1 offset:64
    ds_read_b64_tr_b16 v[18:19], v1 offset:3648
    s_waitcnt lgkmcnt(12)
    v_mfma_f32_16x16x32_bf16 v[56:59], v[20:23], v[116:119], v[56:59]
    v_mul_f32 v252, v100, v100
    v_mul_f32 v253, v101, v101
    v_mfma_f32_16x16x32_bf16 v[60:63], v[20:23], v[188:191], v[60:63]
    v_mul_f32 v254, v102, v102
    v_mul_f32 v255, v103, v103
    ds_read_b64_tr_b16 v[20:21], v1 offset:96
    ds_read_b64_tr_b16 v[22:23], v1 offset:3680
    s_waitcnt lgkmcnt(12)
    v_mfma_f32_16x16x32_bf16 v[64:67], v[24:27], v[116:119], v[64:67]
    v_mul_f32 v248, 0xbdd2d3e8, v248
    v_mul_f32 v249, 0xbdd2d3e8, v249
    v_mfma_f32_16x16x32_bf16 v[68:71], v[24:27], v[188:191], v[68:71]
    v_mul_f32 v250, 0xbdd2d3e8, v250
    v_mul_f32 v251, 0xbdd2d3e8, v251
    ds_read_b64_tr_b16 v[24:25], v1 offset:128
    ds_read_b64_tr_b16 v[26:27], v1 offset:3712
    s_waitcnt lgkmcnt(12)
    v_mfma_f32_16x16x32_bf16 v[72:75], v[28:31], v[116:119], v[72:75]
    v_mul_f32 v252, 0xbdd2d3e8, v252
    v_mul_f32 v253, 0xbdd2d3e8, v253
    v_mfma_f32_16x16x32_bf16 v[76:79], v[28:31], v[188:191], v[76:79]
    v_mul_f32 v254, 0xbdd2d3e8, v254
    v_mul_f32 v255, 0xbdd2d3e8, v255
    ds_read_b64_tr_b16 v[28:29], v1 offset:160
    ds_read_b64_tr_b16 v[30:31], v1 offset:3744
    s_waitcnt lgkmcnt(12)
    v_mfma_f32_16x16x32_bf16 v[80:83], v[4:7], v[116:119], v[80:83]
    v_add_f32 v248, 0xc0135761, v248
    v_add_f32 v249, 0xc0135761, v249
    v_mfma_f32_16x16x32_bf16 v[84:87], v[4:7], v[188:191], v[84:87]
    v_add_f32 v250, 0xc0135761, v250
    v_add_f32 v251, 0xc0135761, v251
    s_barrier
    ds_read_b64_tr_b16 v[4:5], v1 offset:192
    ds_read_b64_tr_b16 v[6:7], v1 offset:3776
    s_waitcnt lgkmcnt(12)
    v_mfma_f32_16x16x32_bf16 v[32:35], v[8:11], v[120:123], v[32:35]
    v_add_f32 v252, 0xc0135761, v252
    v_add_f32 v253, 0xc0135761, v253
    v_mfma_f32_16x16x32_bf16 v[36:39], v[8:11], v[192:195], v[36:39]
    v_add_f32 v254, 0xc0135761, v254
    v_add_f32 v255, 0xc0135761, v255
    ds_read_b64_tr_b16 v[8:9], v1 offset:7168
    ds_read_b64_tr_b16 v[10:11], v1 offset:10752
    s_waitcnt lgkmcnt(12)
    v_mfma_f32_16x16x32_bf16 v[40:43], v[12:15], v[120:123], v[40:43]
    v_mul_f32 v248, v248, v96
    v_mul_f32 v249, v249, v97
    v_mfma_f32_16x16x32_bf16 v[44:47], v[12:15], v[192:195], v[44:47]
    v_mul_f32 v250, v250, v98
    v_mul_f32 v251, v251, v99
    ds_read_b64_tr_b16 v[12:13], v1 offset:7200
    ds_read_b64_tr_b16 v[14:15], v1 offset:10784
    s_waitcnt lgkmcnt(12)
    v_mfma_f32_16x16x32_bf16 v[48:51], v[16:19], v[120:123], v[48:51]
    v_mul_f32 v252, v252, v100
    v_mul_f32 v253, v253, v101
    v_mfma_f32_16x16x32_bf16 v[52:55], v[16:19], v[192:195], v[52:55]
    v_mul_f32 v254, v254, v102
    v_mul_f32 v255, v255, v103
    ds_read_b64_tr_b16 v[16:17], v1 offset:7232
    ds_read_b64_tr_b16 v[18:19], v1 offset:10816
    s_waitcnt lgkmcnt(12)
    v_mfma_f32_16x16x32_bf16 v[56:59], v[20:23], v[120:123], v[56:59]
    v_exp_f32 v248, v248
    v_exp_f32 v249, v249
    v_mfma_f32_16x16x32_bf16 v[60:63], v[20:23], v[192:195], v[60:63]
    v_exp_f32 v250, v250
    v_exp_f32 v251, v251
    ds_read_b64_tr_b16 v[20:21], v1 offset:7264
    ds_read_b64_tr_b16 v[22:23], v1 offset:10848
    s_waitcnt lgkmcnt(12)
    v_mfma_f32_16x16x32_bf16 v[64:67], v[24:27], v[120:123], v[64:67]
    v_exp_f32 v252, v252
    v_exp_f32 v253, v253
    v_mfma_f32_16x16x32_bf16 v[68:71], v[24:27], v[192:195], v[68:71]
    v_exp_f32 v254, v254
    v_exp_f32 v255, v255
    ds_read_b64_tr_b16 v[24:25], v1 offset:7296
    ds_read_b64_tr_b16 v[26:27], v1 offset:10880
    s_waitcnt lgkmcnt(12)
    v_mfma_f32_16x16x32_bf16 v[72:75], v[28:31], v[120:123], v[72:75]
    v_add_f32 v248, 1.0, v248
    v_add_f32 v249, 1.0, v249
    v_mfma_f32_16x16x32_bf16 v[76:79], v[28:31], v[192:195], v[76:79]
    v_add_f32 v250, 1.0, v250
    v_add_f32 v251, 1.0, v251
    ds_read_b64_tr_b16 v[28:29], v1 offset:7328
    ds_read_b64_tr_b16 v[30:31], v1 offset:10912
    s_waitcnt lgkmcnt(12)
    v_mfma_f32_16x16x32_bf16 v[80:83], v[4:7], v[120:123], v[80:83]
    v_add_f32 v252, 1.0, v252
    v_add_f32 v253, 1.0, v253
    v_mfma_f32_16x16x32_bf16 v[84:87], v[4:7], v[192:195], v[84:87]
    v_add_f32 v254, 1.0, v254
    v_add_f32 v255, 1.0, v255
    ds_read_b64_tr_b16 v[4:5], v1 offset:7360
    ds_read_b64_tr_b16 v[6:7], v1 offset:10944
    s_waitcnt lgkmcnt(12)
    v_mfma_f32_16x16x32_bf16 v[32:35], v[8:11], v[124:127], v[32:35]
    v_rcp_f32 v248, v248
    v_rcp_f32 v249, v249
    v_mfma_f32_16x16x32_bf16 v[36:39], v[8:11], v[196:199], v[36:39]
    v_rcp_f32 v250, v250
    v_rcp_f32 v251, v251
    v_subrev_u32 v1, 92160, v1
    ds_read_b64_tr_b16 v[8:9], v1 offset:0
    ds_read_b64_tr_b16 v[10:11], v1 offset:3584
    s_waitcnt lgkmcnt(12)
    v_mfma_f32_16x16x32_bf16 v[40:43], v[12:15], v[124:127], v[40:43]
    v_rcp_f32 v252, v252
    v_rcp_f32 v253, v253
    v_mfma_f32_16x16x32_bf16 v[44:47], v[12:15], v[196:199], v[44:47]
    v_rcp_f32 v254, v254
    v_rcp_f32 v255, v255
    ds_read_b64_tr_b16 v[12:13], v1 offset:32
    ds_read_b64_tr_b16 v[14:15], v1 offset:3616
    s_waitcnt lgkmcnt(12)
    v_mfma_f32_16x16x32_bf16 v[48:51], v[16:19], v[124:127], v[48:51]
    v_mul_f32 v96, v96, v248
    v_mul_f32 v97, v97, v249
    v_mfma_f32_16x16x32_bf16 v[52:55], v[16:19], v[196:199], v[52:55]
    v_mul_f32 v98, v98, v250
    v_mul_f32 v99, v99, v251
    ds_read_b64_tr_b16 v[16:17], v1 offset:64
    ds_read_b64_tr_b16 v[18:19], v1 offset:3648
    s_waitcnt lgkmcnt(12)
    v_mfma_f32_16x16x32_bf16 v[56:59], v[20:23], v[124:127], v[56:59]
    v_mul_f32 v100, v100, v252
    v_mul_f32 v101, v101, v253
    v_mfma_f32_16x16x32_bf16 v[60:63], v[20:23], v[196:199], v[60:63]
    v_mul_f32 v102, v102, v254
    v_mul_f32 v103, v103, v255
    ds_read_b64_tr_b16 v[20:21], v1 offset:96
    ds_read_b64_tr_b16 v[22:23], v1 offset:3680
    s_waitcnt lgkmcnt(12)
    v_mfma_f32_16x16x32_bf16 v[64:67], v[24:27], v[124:127], v[64:67]
    v_add_f32 v248, v88, v89
    v_add_f32 v249, v96, v97
    v_mfma_f32_16x16x32_bf16 v[68:71], v[24:27], v[196:199], v[68:71]
    v_mul_f32 v250, v88, v88
    v_mul_f32 v251, v96, v96
    ds_read_b64_tr_b16 v[24:25], v1 offset:128
    ds_read_b64_tr_b16 v[26:27], v1 offset:3712
    s_waitcnt lgkmcnt(12)
    v_mfma_f32_16x16x32_bf16 v[72:75], v[28:31], v[124:127], v[72:75]
    v_fmac_f32 v250, v89, v89
    v_fmac_f32 v251, v97, v97
    v_mfma_f32_16x16x32_bf16 v[76:79], v[28:31], v[196:199], v[76:79]
    v_fmac_f32 v250, v90, v90
    v_fmac_f32 v251, v98, v98
    ds_read_b64_tr_b16 v[28:29], v1 offset:160
    ds_read_b64_tr_b16 v[30:31], v1 offset:3744
    s_waitcnt lgkmcnt(12)
    v_mfma_f32_16x16x32_bf16 v[80:83], v[4:7], v[124:127], v[80:83]
    v_add_f32 v248, v248, v90
    v_add_f32 v249, v249, v98
    v_mfma_f32_16x16x32_bf16 v[84:87], v[4:7], v[196:199], v[84:87]
    v_fmac_f32 v250, v91, v91
    v_fmac_f32 v251, v99, v99
    s_barrier
    ds_read_b64_tr_b16 v[4:5], v1 offset:192
    ds_read_b64_tr_b16 v[6:7], v1 offset:3776
    s_waitcnt lgkmcnt(12)
    v_mfma_f32_16x16x32_bf16 v[32:35], v[8:11], v[128:131], v[32:35]
    v_add_f32 v248, v248, v91
    v_add_f32 v249, v249, v99
    v_mfma_f32_16x16x32_bf16 v[36:39], v[8:11], v[200:203], v[36:39]
    v_add_f32 v252, v92, v93
    v_add_f32 v253, v100, v101
    ds_read_b64_tr_b16 v[8:9], v1 offset:7168
    ds_read_b64_tr_b16 v[10:11], v1 offset:10752
    s_waitcnt lgkmcnt(12)
    v_mfma_f32_16x16x32_bf16 v[40:43], v[12:15], v[128:131], v[40:43]
    v_mul_f32 v254, v92, v92
    v_mul_f32 v255, v100, v100
    v_mfma_f32_16x16x32_bf16 v[44:47], v[12:15], v[200:203], v[44:47]
    v_fmac_f32 v254, v93, v93
    v_fmac_f32 v255, v101, v101
    ds_read_b64_tr_b16 v[12:13], v1 offset:7200
    ds_read_b64_tr_b16 v[14:15], v1 offset:10784
    s_waitcnt lgkmcnt(12)
    v_mfma_f32_16x16x32_bf16 v[48:51], v[16:19], v[128:131], v[48:51]
    v_fmac_f32 v254, v94, v94
    v_fmac_f32 v255, v102, v102
    v_mfma_f32_16x16x32_bf16 v[52:55], v[16:19], v[200:203], v[52:55]
    v_add_f32 v252, v252, v94
    v_add_f32 v253, v253, v102
    ds_read_b64_tr_b16 v[16:17], v1 offset:7232
    ds_read_b64_tr_b16 v[18:19], v1 offset:10816
    s_waitcnt lgkmcnt(12)
    v_mfma_f32_16x16x32_bf16 v[56:59], v[20:23], v[128:131], v[56:59]
    v_fmac_f32 v254, v95, v95
    v_fmac_f32 v255, v103, v103
    v_mfma_f32_16x16x32_bf16 v[60:63], v[20:23], v[200:203], v[60:63]
    v_add_f32 v252, v252, v95
    v_add_f32 v253, v253, v103
    ds_read_b64_tr_b16 v[20:21], v1 offset:7264
    ds_read_b64_tr_b16 v[22:23], v1 offset:10848
    s_waitcnt lgkmcnt(12)
    v_mfma_f32_16x16x32_bf16 v[64:67], v[24:27], v[128:131], v[64:67]
    v_cvt_pk_bf16_f32 v88, v88, v89
    v_cvt_pk_bf16_f32 v89, v90, v91
    v_mfma_f32_16x16x32_bf16 v[68:71], v[24:27], v[200:203], v[68:71]
    v_cvt_pk_bf16_f32 v90, v92, v93
    v_cvt_pk_bf16_f32 v91, v94, v95
    ds_read_b64_tr_b16 v[24:25], v1 offset:7296
    ds_read_b64_tr_b16 v[26:27], v1 offset:10880
    s_waitcnt lgkmcnt(12)
    v_mfma_f32_16x16x32_bf16 v[72:75], v[28:31], v[128:131], v[72:75]
    v_cvt_pk_bf16_f32 v96, v96, v97
    v_cvt_pk_bf16_f32 v97, v98, v99
    v_mfma_f32_16x16x32_bf16 v[76:79], v[28:31], v[200:203], v[76:79]
    v_cvt_pk_bf16_f32 v98, v100, v101
    v_cvt_pk_bf16_f32 v99, v102, v103
    ds_read_b64_tr_b16 v[28:29], v1 offset:7328
    ds_read_b64_tr_b16 v[30:31], v1 offset:10912
    s_waitcnt lgkmcnt(12)
    v_mfma_f32_16x16x32_bf16 v[80:83], v[4:7], v[128:131], v[80:83]
    s_lshl_b32 s52, s51, 12
    s_add_u32 s52, s52, 147456
    v_mfma_f32_16x16x32_bf16 v[84:87], v[4:7], v[200:203], v[84:87]
    v_add_u32 v92, s52, v2
    ds_write_b128 v92, v[88:91]
    ds_read_b64_tr_b16 v[4:5], v1 offset:7360
    ds_read_b64_tr_b16 v[6:7], v1 offset:10944
    s_waitcnt lgkmcnt(13)
    v_mfma_f32_16x16x32_bf16 v[32:35], v[8:11], v[132:135], v[32:35]
    ds_write_b128 v92, v[96:99] offset:1024
    ds_write_b128 v92, v[248:251] offset:2048
    v_mfma_f32_16x16x32_bf16 v[36:39], v[8:11], v[204:207], v[36:39]
    ds_write_b128 v92, v[252:255] offset:3072
    v_add_u32 v1, 18432, v1
    ds_read_b64_tr_b16 v[8:9], v1 offset:0
    ds_read_b64_tr_b16 v[10:11], v1 offset:3584
    s_waitcnt lgkmcnt(15)
    v_mfma_f32_16x16x32_bf16 v[40:43], v[12:15], v[132:135], v[40:43]
    v_mfma_f32_16x16x32_bf16 v[44:47], v[12:15], v[204:207], v[44:47]
    ds_read_b64_tr_b16 v[12:13], v1 offset:32
    ds_read_b64_tr_b16 v[14:15], v1 offset:3616
    s_waitcnt lgkmcnt(15)
    v_mfma_f32_16x16x32_bf16 v[48:51], v[16:19], v[132:135], v[48:51]
    v_mfma_f32_16x16x32_bf16 v[52:55], v[16:19], v[204:207], v[52:55]
    ds_read_b64_tr_b16 v[16:17], v1 offset:64
    ds_read_b64_tr_b16 v[18:19], v1 offset:3648
    s_waitcnt lgkmcnt(15)
    v_mfma_f32_16x16x32_bf16 v[56:59], v[20:23], v[132:135], v[56:59]
    v_mfma_f32_16x16x32_bf16 v[60:63], v[20:23], v[204:207], v[60:63]
    ds_read_b64_tr_b16 v[20:21], v1 offset:96
    ds_read_b64_tr_b16 v[22:23], v1 offset:3680
    s_waitcnt lgkmcnt(15)
    v_mfma_f32_16x16x32_bf16 v[64:67], v[24:27], v[132:135], v[64:67]
    v_mfma_f32_16x16x32_bf16 v[68:71], v[24:27], v[204:207], v[68:71]
    ds_read_b64_tr_b16 v[24:25], v1 offset:128
    ds_read_b64_tr_b16 v[26:27], v1 offset:3712
    s_waitcnt lgkmcnt(15)
    v_mfma_f32_16x16x32_bf16 v[72:75], v[28:31], v[132:135], v[72:75]
    v_mfma_f32_16x16x32_bf16 v[76:79], v[28:31], v[204:207], v[76:79]
    ds_read_b64_tr_b16 v[28:29], v1 offset:160
    ds_read_b64_tr_b16 v[30:31], v1 offset:3744
    s_waitcnt lgkmcnt(15)
    v_mfma_f32_16x16x32_bf16 v[80:83], v[4:7], v[132:135], v[80:83]
    v_mfma_f32_16x16x32_bf16 v[84:87], v[4:7], v[204:207], v[84:87]
    s_waitcnt lgkmcnt(12)
    s_barrier
    ds_read_b64_tr_b16 v[4:5], v1 offset:192
    ds_read_b64_tr_b16 v[6:7], v1 offset:3776
    s_waitcnt lgkmcnt(12)
    v_mfma_f32_16x16x32_bf16 v[32:35], v[8:11], v[136:139], v[32:35]
    v_mfma_f32_16x16x32_bf16 v[36:39], v[8:11], v[208:211], v[36:39]
    ds_read_b64_tr_b16 v[8:9], v1 offset:7168
    ds_read_b64_tr_b16 v[10:11], v1 offset:10752
    s_waitcnt lgkmcnt(12)
    v_mfma_f32_16x16x32_bf16 v[40:43], v[12:15], v[136:139], v[40:43]
    v_mfma_f32_16x16x32_bf16 v[44:47], v[12:15], v[208:211], v[44:47]
    ds_read_b64_tr_b16 v[12:13], v1 offset:7200
    ds_read_b64_tr_b16 v[14:15], v1 offset:10784
    s_waitcnt lgkmcnt(12)
    v_mfma_f32_16x16x32_bf16 v[48:51], v[16:19], v[136:139], v[48:51]
    v_mfma_f32_16x16x32_bf16 v[52:55], v[16:19], v[208:211], v[52:55]
    ds_read_b64_tr_b16 v[16:17], v1 offset:7232
    ds_read_b64_tr_b16 v[18:19], v1 offset:10816
    s_waitcnt lgkmcnt(12)
    v_mfma_f32_16x16x32_bf16 v[56:59], v[20:23], v[136:139], v[56:59]
    v_mfma_f32_16x16x32_bf16 v[60:63], v[20:23], v[208:211], v[60:63]
    ds_read_b64_tr_b16 v[20:21], v1 offset:7264
    ds_read_b64_tr_b16 v[22:23], v1 offset:10848
    s_waitcnt lgkmcnt(12)
    v_mfma_f32_16x16x32_bf16 v[64:67], v[24:27], v[136:139], v[64:67]
    v_mfma_f32_16x16x32_bf16 v[68:71], v[24:27], v[208:211], v[68:71]
    ds_read_b64_tr_b16 v[24:25], v1 offset:7296
    ds_read_b64_tr_b16 v[26:27], v1 offset:10880
    s_waitcnt lgkmcnt(12)
    v_mfma_f32_16x16x32_bf16 v[72:75], v[28:31], v[136:139], v[72:75]
    v_mfma_f32_16x16x32_bf16 v[76:79], v[28:31], v[208:211], v[76:79]
    ds_read_b64_tr_b16 v[28:29], v1 offset:7328
    ds_read_b64_tr_b16 v[30:31], v1 offset:10912
    s_waitcnt lgkmcnt(12)
    v_mfma_f32_16x16x32_bf16 v[80:83], v[4:7], v[136:139], v[80:83]
    v_mfma_f32_16x16x32_bf16 v[84:87], v[4:7], v[208:211], v[84:87]
    ds_read_b64_tr_b16 v[4:5], v1 offset:7360
    ds_read_b64_tr_b16 v[6:7], v1 offset:10944
    s_waitcnt lgkmcnt(12)
    v_mfma_f32_16x16x32_bf16 v[32:35], v[8:11], v[140:143], v[32:35]
    v_mfma_f32_16x16x32_bf16 v[36:39], v[8:11], v[212:215], v[36:39]
    v_add_u32 v1, 92160, v1
    ds_read_b64_tr_b16 v[8:9], v1 offset:0
    ds_read_b64_tr_b16 v[10:11], v1 offset:3584
    s_waitcnt lgkmcnt(12)
    v_mfma_f32_16x16x32_bf16 v[40:43], v[12:15], v[140:143], v[40:43]
    v_mfma_f32_16x16x32_bf16 v[44:47], v[12:15], v[212:215], v[44:47]
    ds_read_b64_tr_b16 v[12:13], v1 offset:32
    ds_read_b64_tr_b16 v[14:15], v1 offset:3616
    s_waitcnt lgkmcnt(12)
    v_mfma_f32_16x16x32_bf16 v[48:51], v[16:19], v[140:143], v[48:51]
    v_mfma_f32_16x16x32_bf16 v[52:55], v[16:19], v[212:215], v[52:55]
    ds_read_b64_tr_b16 v[16:17], v1 offset:64
    ds_read_b64_tr_b16 v[18:19], v1 offset:3648
    s_waitcnt lgkmcnt(12)
    v_mfma_f32_16x16x32_bf16 v[56:59], v[20:23], v[140:143], v[56:59]
    v_mfma_f32_16x16x32_bf16 v[60:63], v[20:23], v[212:215], v[60:63]
    ds_read_b64_tr_b16 v[20:21], v1 offset:96
    ds_read_b64_tr_b16 v[22:23], v1 offset:3680
    s_waitcnt lgkmcnt(12)
    v_mfma_f32_16x16x32_bf16 v[64:67], v[24:27], v[140:143], v[64:67]
    v_mfma_f32_16x16x32_bf16 v[68:71], v[24:27], v[212:215], v[68:71]
    ds_read_b64_tr_b16 v[24:25], v1 offset:128
    ds_read_b64_tr_b16 v[26:27], v1 offset:3712
    s_waitcnt lgkmcnt(12)
    v_mfma_f32_16x16x32_bf16 v[72:75], v[28:31], v[140:143], v[72:75]
    v_mfma_f32_16x16x32_bf16 v[76:79], v[28:31], v[212:215], v[76:79]
    ds_read_b64_tr_b16 v[28:29], v1 offset:160
    ds_read_b64_tr_b16 v[30:31], v1 offset:3744
    s_waitcnt lgkmcnt(12)
    v_mfma_f32_16x16x32_bf16 v[80:83], v[4:7], v[140:143], v[80:83]
    v_mfma_f32_16x16x32_bf16 v[84:87], v[4:7], v[212:215], v[84:87]
    s_barrier
    ds_read_b64_tr_b16 v[4:5], v1 offset:192
    ds_read_b64_tr_b16 v[6:7], v1 offset:3776
    s_waitcnt lgkmcnt(12)
    v_mfma_f32_16x16x32_bf16 v[32:35], v[8:11], v[144:147], v[32:35]
    v_mfma_f32_16x16x32_bf16 v[36:39], v[8:11], v[216:219], v[36:39]
    ds_read_b64_tr_b16 v[8:9], v1 offset:7168
    ds_read_b64_tr_b16 v[10:11], v1 offset:10752
    s_waitcnt lgkmcnt(12)
    v_mfma_f32_16x16x32_bf16 v[40:43], v[12:15], v[144:147], v[40:43]
    v_mfma_f32_16x16x32_bf16 v[44:47], v[12:15], v[216:219], v[44:47]
    ds_read_b64_tr_b16 v[12:13], v1 offset:7200
    ds_read_b64_tr_b16 v[14:15], v1 offset:10784
    s_waitcnt lgkmcnt(12)
    v_mfma_f32_16x16x32_bf16 v[48:51], v[16:19], v[144:147], v[48:51]
    v_mfma_f32_16x16x32_bf16 v[52:55], v[16:19], v[216:219], v[52:55]
    ds_read_b64_tr_b16 v[16:17], v1 offset:7232
    ds_read_b64_tr_b16 v[18:19], v1 offset:10816
    s_waitcnt lgkmcnt(12)
    v_mfma_f32_16x16x32_bf16 v[56:59], v[20:23], v[144:147], v[56:59]
    v_mfma_f32_16x16x32_bf16 v[60:63], v[20:23], v[216:219], v[60:63]
    ds_read_b64_tr_b16 v[20:21], v1 offset:7264
    ds_read_b64_tr_b16 v[22:23], v1 offset:10848
    s_waitcnt lgkmcnt(12)
    v_mfma_f32_16x16x32_bf16 v[64:67], v[24:27], v[144:147], v[64:67]
    v_mfma_f32_16x16x32_bf16 v[68:71], v[24:27], v[216:219], v[68:71]
    ds_read_b64_tr_b16 v[24:25], v1 offset:7296
    ds_read_b64_tr_b16 v[26:27], v1 offset:10880
    s_waitcnt lgkmcnt(12)
    v_mfma_f32_16x16x32_bf16 v[72:75], v[28:31], v[144:147], v[72:75]
    v_mfma_f32_16x16x32_bf16 v[76:79], v[28:31], v[216:219], v[76:79]
    ds_read_b64_tr_b16 v[28:29], v1 offset:7328
    ds_read_b64_tr_b16 v[30:31], v1 offset:10912
    s_waitcnt lgkmcnt(12)
    v_mfma_f32_16x16x32_bf16 v[80:83], v[4:7], v[144:147], v[80:83]
    v_mfma_f32_16x16x32_bf16 v[84:87], v[4:7], v[216:219], v[84:87]
    ds_read_b64_tr_b16 v[4:5], v1 offset:7360
    ds_read_b64_tr_b16 v[6:7], v1 offset:10944
    s_waitcnt lgkmcnt(12)
    v_mfma_f32_16x16x32_bf16 v[32:35], v[8:11], v[148:151], v[32:35]
    v_mfma_f32_16x16x32_bf16 v[36:39], v[8:11], v[220:223], v[36:39]
    v_subrev_u32 v1, 55296, v1
    ds_read_b64_tr_b16 v[8:9], v1 offset:0
    ds_read_b64_tr_b16 v[10:11], v1 offset:3584
    s_waitcnt lgkmcnt(12)
    v_mfma_f32_16x16x32_bf16 v[40:43], v[12:15], v[148:151], v[40:43]
    v_mfma_f32_16x16x32_bf16 v[44:47], v[12:15], v[220:223], v[44:47]
    ds_read_b64_tr_b16 v[12:13], v1 offset:32
    ds_read_b64_tr_b16 v[14:15], v1 offset:3616
    s_waitcnt lgkmcnt(12)
    v_mfma_f32_16x16x32_bf16 v[48:51], v[16:19], v[148:151], v[48:51]
    v_mfma_f32_16x16x32_bf16 v[52:55], v[16:19], v[220:223], v[52:55]
    ds_read_b64_tr_b16 v[16:17], v1 offset:64
    ds_read_b64_tr_b16 v[18:19], v1 offset:3648
    s_waitcnt lgkmcnt(12)
    v_mfma_f32_16x16x32_bf16 v[56:59], v[20:23], v[148:151], v[56:59]
    v_mfma_f32_16x16x32_bf16 v[60:63], v[20:23], v[220:223], v[60:63]
    ds_read_b64_tr_b16 v[20:21], v1 offset:96
    ds_read_b64_tr_b16 v[22:23], v1 offset:3680
    s_waitcnt lgkmcnt(12)
    v_mfma_f32_16x16x32_bf16 v[64:67], v[24:27], v[148:151], v[64:67]
    v_mfma_f32_16x16x32_bf16 v[68:71], v[24:27], v[220:223], v[68:71]
    ds_read_b64_tr_b16 v[24:25], v1 offset:128
    ds_read_b64_tr_b16 v[26:27], v1 offset:3712
    s_waitcnt lgkmcnt(12)
    v_mfma_f32_16x16x32_bf16 v[72:75], v[28:31], v[148:151], v[72:75]
    v_mfma_f32_16x16x32_bf16 v[76:79], v[28:31], v[220:223], v[76:79]
    ds_read_b64_tr_b16 v[28:29], v1 offset:160
    ds_read_b64_tr_b16 v[30:31], v1 offset:3744
    s_waitcnt lgkmcnt(12)
    v_mfma_f32_16x16x32_bf16 v[80:83], v[4:7], v[148:151], v[80:83]
    v_mfma_f32_16x16x32_bf16 v[84:87], v[4:7], v[220:223], v[84:87]
    s_barrier
    ds_read_b64_tr_b16 v[4:5], v1 offset:192
    ds_read_b64_tr_b16 v[6:7], v1 offset:3776
    s_waitcnt lgkmcnt(12)
    v_mfma_f32_16x16x32_bf16 v[32:35], v[8:11], v[152:155], v[32:35]
    v_mfma_f32_16x16x32_bf16 v[36:39], v[8:11], v[224:227], v[36:39]
    ds_read_b64_tr_b16 v[8:9], v1 offset:7168
    ds_read_b64_tr_b16 v[10:11], v1 offset:10752
    s_waitcnt lgkmcnt(12)
    v_mfma_f32_16x16x32_bf16 v[40:43], v[12:15], v[152:155], v[40:43]
    v_mfma_f32_16x16x32_bf16 v[44:47], v[12:15], v[224:227], v[44:47]
    ds_read_b64_tr_b16 v[12:13], v1 offset:7200
    ds_read_b64_tr_b16 v[14:15], v1 offset:10784
    s_waitcnt lgkmcnt(12)
    v_mfma_f32_16x16x32_bf16 v[48:51], v[16:19], v[152:155], v[48:51]
    v_mfma_f32_16x16x32_bf16 v[52:55], v[16:19], v[224:227], v[52:55]
    ds_read_b64_tr_b16 v[16:17], v1 offset:7232
    ds_read_b64_tr_b16 v[18:19], v1 offset:10816
    s_waitcnt lgkmcnt(12)
    v_mfma_f32_16x16x32_bf16 v[56:59], v[20:23], v[152:155], v[56:59]
    v_mfma_f32_16x16x32_bf16 v[60:63], v[20:23], v[224:227], v[60:63]
    ds_read_b64_tr_b16 v[20:21], v1 offset:7264
    ds_read_b64_tr_b16 v[22:23], v1 offset:10848
    s_waitcnt lgkmcnt(12)
    v_mfma_f32_16x16x32_bf16 v[64:67], v[24:27], v[152:155], v[64:67]
    v_mfma_f32_16x16x32_bf16 v[68:71], v[24:27], v[224:227], v[68:71]
    ds_read_b64_tr_b16 v[24:25], v1 offset:7296
    ds_read_b64_tr_b16 v[26:27], v1 offset:10880
    s_waitcnt lgkmcnt(12)
    v_mfma_f32_16x16x32_bf16 v[72:75], v[28:31], v[152:155], v[72:75]
    v_mfma_f32_16x16x32_bf16 v[76:79], v[28:31], v[224:227], v[76:79]
    ds_read_b64_tr_b16 v[28:29], v1 offset:7328
    ds_read_b64_tr_b16 v[30:31], v1 offset:10912
    s_waitcnt lgkmcnt(12)
    v_mfma_f32_16x16x32_bf16 v[80:83], v[4:7], v[152:155], v[80:83]
    v_mfma_f32_16x16x32_bf16 v[84:87], v[4:7], v[224:227], v[84:87]
    ds_read_b64_tr_b16 v[4:5], v1 offset:7360
    ds_read_b64_tr_b16 v[6:7], v1 offset:10944
    s_waitcnt lgkmcnt(12)
    v_mfma_f32_16x16x32_bf16 v[32:35], v[8:11], v[156:159], v[32:35]
    v_mfma_f32_16x16x32_bf16 v[36:39], v[8:11], v[228:231], v[36:39]
    v_add_u32 v1, 18432, v1
    ds_read_b64_tr_b16 v[8:9], v1 offset:0
    ds_read_b64_tr_b16 v[10:11], v1 offset:3584
    s_waitcnt lgkmcnt(12)
    v_mfma_f32_16x16x32_bf16 v[40:43], v[12:15], v[156:159], v[40:43]
    v_mfma_f32_16x16x32_bf16 v[44:47], v[12:15], v[228:231], v[44:47]
    ds_read_b64_tr_b16 v[12:13], v1 offset:32
    ds_read_b64_tr_b16 v[14:15], v1 offset:3616
    s_waitcnt lgkmcnt(12)
    v_mfma_f32_16x16x32_bf16 v[48:51], v[16:19], v[156:159], v[48:51]
    v_mfma_f32_16x16x32_bf16 v[52:55], v[16:19], v[228:231], v[52:55]
    ds_read_b64_tr_b16 v[16:17], v1 offset:64
    ds_read_b64_tr_b16 v[18:19], v1 offset:3648
    s_waitcnt lgkmcnt(12)
    v_mfma_f32_16x16x32_bf16 v[56:59], v[20:23], v[156:159], v[56:59]
    v_mfma_f32_16x16x32_bf16 v[60:63], v[20:23], v[228:231], v[60:63]
    ds_read_b64_tr_b16 v[20:21], v1 offset:96
    ds_read_b64_tr_b16 v[22:23], v1 offset:3680
    s_waitcnt lgkmcnt(12)
    v_mfma_f32_16x16x32_bf16 v[64:67], v[24:27], v[156:159], v[64:67]
    v_mfma_f32_16x16x32_bf16 v[68:71], v[24:27], v[228:231], v[68:71]
    ds_read_b64_tr_b16 v[24:25], v1 offset:128
    ds_read_b64_tr_b16 v[26:27], v1 offset:3712
    s_waitcnt lgkmcnt(12)
    v_mfma_f32_16x16x32_bf16 v[72:75], v[28:31], v[156:159], v[72:75]
    v_mfma_f32_16x16x32_bf16 v[76:79], v[28:31], v[228:231], v[76:79]
    ds_read_b64_tr_b16 v[28:29], v1 offset:160
    ds_read_b64_tr_b16 v[30:31], v1 offset:3744
    s_waitcnt lgkmcnt(12)
    v_mfma_f32_16x16x32_bf16 v[80:83], v[4:7], v[156:159], v[80:83]
    v_mfma_f32_16x16x32_bf16 v[84:87], v[4:7], v[228:231], v[84:87]
    s_barrier
    ds_read_b64_tr_b16 v[4:5], v1 offset:192
    ds_read_b64_tr_b16 v[6:7], v1 offset:3776
    s_waitcnt lgkmcnt(12)
    v_mfma_f32_16x16x32_bf16 v[32:35], v[8:11], v[160:163], v[32:35]
    v_mfma_f32_16x16x32_bf16 v[36:39], v[8:11], v[232:235], v[36:39]
    ds_read_b64_tr_b16 v[8:9], v1 offset:7168
    ds_read_b64_tr_b16 v[10:11], v1 offset:10752
    s_waitcnt lgkmcnt(12)
    v_mfma_f32_16x16x32_bf16 v[40:43], v[12:15], v[160:163], v[40:43]
    v_mfma_f32_16x16x32_bf16 v[44:47], v[12:15], v[232:235], v[44:47]
    ds_read_b64_tr_b16 v[12:13], v1 offset:7200
    ds_read_b64_tr_b16 v[14:15], v1 offset:10784
    s_waitcnt lgkmcnt(12)
    v_mfma_f32_16x16x32_bf16 v[48:51], v[16:19], v[160:163], v[48:51]
    v_mfma_f32_16x16x32_bf16 v[52:55], v[16:19], v[232:235], v[52:55]
    ds_read_b64_tr_b16 v[16:17], v1 offset:7232
    ds_read_b64_tr_b16 v[18:19], v1 offset:10816
    s_waitcnt lgkmcnt(12)
    v_mfma_f32_16x16x32_bf16 v[56:59], v[20:23], v[160:163], v[56:59]
    v_mfma_f32_16x16x32_bf16 v[60:63], v[20:23], v[232:235], v[60:63]
    ds_read_b64_tr_b16 v[20:21], v1 offset:7264
    ds_read_b64_tr_b16 v[22:23], v1 offset:10848
    s_waitcnt lgkmcnt(12)
    v_mfma_f32_16x16x32_bf16 v[64:67], v[24:27], v[160:163], v[64:67]
    v_mfma_f32_16x16x32_bf16 v[68:71], v[24:27], v[232:235], v[68:71]
    ds_read_b64_tr_b16 v[24:25], v1 offset:7296
    ds_read_b64_tr_b16 v[26:27], v1 offset:10880
    s_waitcnt lgkmcnt(12)
    v_mfma_f32_16x16x32_bf16 v[72:75], v[28:31], v[160:163], v[72:75]
    v_mfma_f32_16x16x32_bf16 v[76:79], v[28:31], v[232:235], v[76:79]
    ds_read_b64_tr_b16 v[28:29], v1 offset:7328
    ds_read_b64_tr_b16 v[30:31], v1 offset:10912
    s_waitcnt lgkmcnt(12)
    v_mfma_f32_16x16x32_bf16 v[80:83], v[4:7], v[160:163], v[80:83]
    v_mfma_f32_16x16x32_bf16 v[84:87], v[4:7], v[232:235], v[84:87]
    ds_read_b64_tr_b16 v[4:5], v1 offset:7360
    ds_read_b64_tr_b16 v[6:7], v1 offset:10944
    s_waitcnt lgkmcnt(12)
    v_mfma_f32_16x16x32_bf16 v[32:35], v[8:11], v[164:167], v[32:35]
    v_mfma_f32_16x16x32_bf16 v[36:39], v[8:11], v[236:239], v[36:39]
    v_add_u32 v1, 55296, v1
    ds_read_b64_tr_b16 v[8:9], v1 offset:0
    ds_read_b64_tr_b16 v[10:11], v1 offset:3584
    s_waitcnt lgkmcnt(12)
    v_mfma_f32_16x16x32_bf16 v[40:43], v[12:15], v[164:167], v[40:43]
    v_mfma_f32_16x16x32_bf16 v[44:47], v[12:15], v[236:239], v[44:47]
    ds_read_b64_tr_b16 v[12:13], v1 offset:32
    ds_read_b64_tr_b16 v[14:15], v1 offset:3616
    s_waitcnt lgkmcnt(12)
    v_mfma_f32_16x16x32_bf16 v[48:51], v[16:19], v[164:167], v[48:51]
    v_mfma_f32_16x16x32_bf16 v[52:55], v[16:19], v[236:239], v[52:55]
    ds_read_b64_tr_b16 v[16:17], v1 offset:64
    ds_read_b64_tr_b16 v[18:19], v1 offset:3648
    s_waitcnt lgkmcnt(12)
    v_mfma_f32_16x16x32_bf16 v[56:59], v[20:23], v[164:167], v[56:59]
    v_mfma_f32_16x16x32_bf16 v[60:63], v[20:23], v[236:239], v[60:63]
    ds_read_b64_tr_b16 v[20:21], v1 offset:96
    ds_read_b64_tr_b16 v[22:23], v1 offset:3680
    s_waitcnt lgkmcnt(12)
    v_mfma_f32_16x16x32_bf16 v[64:67], v[24:27], v[164:167], v[64:67]
    v_mfma_f32_16x16x32_bf16 v[68:71], v[24:27], v[236:239], v[68:71]
    ds_read_b64_tr_b16 v[24:25], v1 offset:128
    ds_read_b64_tr_b16 v[26:27], v1 offset:3712
    s_waitcnt lgkmcnt(12)
    v_mfma_f32_16x16x32_bf16 v[72:75], v[28:31], v[164:167], v[72:75]
    v_mfma_f32_16x16x32_bf16 v[76:79], v[28:31], v[236:239], v[76:79]
    ds_read_b64_tr_b16 v[28:29], v1 offset:160
    ds_read_b64_tr_b16 v[30:31], v1 offset:3744
    s_waitcnt lgkmcnt(12)
    v_mfma_f32_16x16x32_bf16 v[80:83], v[4:7], v[164:167], v[80:83]
    v_mfma_f32_16x16x32_bf16 v[84:87], v[4:7], v[236:239], v[84:87]
    s_barrier
    ds_read_b64_tr_b16 v[4:5], v1 offset:192
    ds_read_b64_tr_b16 v[6:7], v1 offset:3776
    s_waitcnt lgkmcnt(12)
    v_mfma_f32_16x16x32_bf16 v[32:35], v[8:11], v[168:171], v[32:35]
    v_mfma_f32_16x16x32_bf16 v[36:39], v[8:11], v[240:243], v[36:39]
    ds_read_b64_tr_b16 v[8:9], v1 offset:7168
    ds_read_b64_tr_b16 v[10:11], v1 offset:10752
    s_waitcnt lgkmcnt(12)
    v_mfma_f32_16x16x32_bf16 v[40:43], v[12:15], v[168:171], v[40:43]
    v_mfma_f32_16x16x32_bf16 v[44:47], v[12:15], v[240:243], v[44:47]
    ds_read_b64_tr_b16 v[12:13], v1 offset:7200
    ds_read_b64_tr_b16 v[14:15], v1 offset:10784
    s_waitcnt lgkmcnt(12)
    v_mfma_f32_16x16x32_bf16 v[48:51], v[16:19], v[168:171], v[48:51]
    v_mfma_f32_16x16x32_bf16 v[52:55], v[16:19], v[240:243], v[52:55]
    ds_read_b64_tr_b16 v[16:17], v1 offset:7232
    ds_read_b64_tr_b16 v[18:19], v1 offset:10816
    s_waitcnt lgkmcnt(12)
    v_mfma_f32_16x16x32_bf16 v[56:59], v[20:23], v[168:171], v[56:59]
    v_mfma_f32_16x16x32_bf16 v[60:63], v[20:23], v[240:243], v[60:63]
    ds_read_b64_tr_b16 v[20:21], v1 offset:7264
    ds_read_b64_tr_b16 v[22:23], v1 offset:10848
    s_waitcnt lgkmcnt(12)
    v_mfma_f32_16x16x32_bf16 v[64:67], v[24:27], v[168:171], v[64:67]
    v_mfma_f32_16x16x32_bf16 v[68:71], v[24:27], v[240:243], v[68:71]
    ds_read_b64_tr_b16 v[24:25], v1 offset:7296
    ds_read_b64_tr_b16 v[26:27], v1 offset:10880
    s_waitcnt lgkmcnt(12)
    v_mfma_f32_16x16x32_bf16 v[72:75], v[28:31], v[168:171], v[72:75]
    v_mfma_f32_16x16x32_bf16 v[76:79], v[28:31], v[240:243], v[76:79]
    ds_read_b64_tr_b16 v[28:29], v1 offset:7328
    ds_read_b64_tr_b16 v[30:31], v1 offset:10912
    s_waitcnt lgkmcnt(12)
    v_mfma_f32_16x16x32_bf16 v[80:83], v[4:7], v[168:171], v[80:83]
    v_mfma_f32_16x16x32_bf16 v[84:87], v[4:7], v[240:243], v[84:87]
    ds_read_b64_tr_b16 v[4:5], v1 offset:7360
    ds_read_b64_tr_b16 v[6:7], v1 offset:10944
    s_waitcnt lgkmcnt(12)
    v_mfma_f32_16x16x32_bf16 v[32:35], v[8:11], v[172:175], v[32:35]
    v_mfma_f32_16x16x32_bf16 v[36:39], v[8:11], v[244:247], v[36:39]
    v_subrev_u32 v1, 92160, v1
    v_lshrrev_b32 v8, 2, v0
    v_lshlrev_b32 v8, 6, v8
    v_add_u32 v1, v1, v8
    ds_read_b64_tr_b16 v[8:9], v1 offset:0
    ds_read_b64_tr_b16 v[10:11], v1 offset:4608
    s_waitcnt lgkmcnt(12)
    v_mfma_f32_16x16x32_bf16 v[40:43], v[12:15], v[172:175], v[40:43]
    v_mfma_f32_16x16x32_bf16 v[44:47], v[12:15], v[244:247], v[44:47]
    ds_read_b64_tr_b16 v[12:13], v1 offset:32
    ds_read_b64_tr_b16 v[14:15], v1 offset:4640
    s_waitcnt lgkmcnt(12)
    v_mfma_f32_16x16x32_bf16 v[48:51], v[16:19], v[172:175], v[48:51]
    v_mfma_f32_16x16x32_bf16 v[52:55], v[16:19], v[244:247], v[52:55]
    ds_read_b64_tr_b16 v[16:17], v1 offset:64
    ds_read_b64_tr_b16 v[18:19], v1 offset:4672
    s_waitcnt lgkmcnt(12)
    v_mfma_f32_16x16x32_bf16 v[56:59], v[20:23], v[172:175], v[56:59]
    v_mfma_f32_16x16x32_bf16 v[60:63], v[20:23], v[244:247], v[60:63]
    ds_read_b64_tr_b16 v[20:21], v1 offset:96
    ds_read_b64_tr_b16 v[22:23], v1 offset:4704
    s_waitcnt lgkmcnt(12)
    v_mfma_f32_16x16x32_bf16 v[64:67], v[24:27], v[172:175], v[64:67]
    v_mfma_f32_16x16x32_bf16 v[68:71], v[24:27], v[244:247], v[68:71]
    ds_read_b64_tr_b16 v[24:25], v1 offset:128
    ds_read_b64_tr_b16 v[26:27], v1 offset:4736
    s_waitcnt lgkmcnt(12)
    v_mfma_f32_16x16x32_bf16 v[72:75], v[28:31], v[172:175], v[72:75]
    v_mfma_f32_16x16x32_bf16 v[76:79], v[28:31], v[244:247], v[76:79]
    ds_read_b64_tr_b16 v[28:29], v1 offset:160
    ds_read_b64_tr_b16 v[30:31], v1 offset:4768
    s_waitcnt lgkmcnt(12)
    v_mfma_f32_16x16x32_bf16 v[80:83], v[4:7], v[172:175], v[80:83]
    v_mfma_f32_16x16x32_bf16 v[84:87], v[4:7], v[244:247], v[84:87]
    s_barrier
    s_and_b32 s52, s51, 1
    s_mul_i32 s52, s52, 9216
    s_cmp_lt_u32 s51, 2
    s_cselect_b32 s53, 4, 7
    s_mul_i32 s53, s53, 18432
    s_add_u32 s52, s52, s53
    v_add_u32 v3, s52, v2
    ds_read_b64_tr_b16 v[4:5], v1 offset:192
    ds_read_b64_tr_b16 v[6:7], v1 offset:4800
    v_cvt_pk_bf16_f32 v32, v32, v33
    v_cvt_pk_bf16_f32 v33, v34, v35
    v_cvt_pk_bf16_f32 v34, v36, v37
    v_cvt_pk_bf16_f32 v35, v38, v39
    ds_write_b128 v3, v[32:35] offset:0
    s_waitcnt lgkmcnt(13)
    v_mfma_f32_16x16x32_bf16 v[32:35], v[8:11], v[104:107], 0
    v_mfma_f32_16x16x32_bf16 v[36:39], v[8:11], v[176:179], 0
    ds_read_b64_tr_b16 v[8:9], v1 offset:224
    ds_read_b64_tr_b16 v[10:11], v1 offset:4832
    v_cvt_pk_bf16_f32 v40, v40, v41
    v_cvt_pk_bf16_f32 v41, v42, v43
    v_cvt_pk_bf16_f32 v42, v44, v45
    v_cvt_pk_bf16_f32 v43, v46, v47
    ds_write_b128 v3, v[40:43] offset:1024
    s_waitcnt lgkmcnt(14)
    v_mfma_f32_16x16x32_bf16 v[40:43], v[12:15], v[104:107], 0
    v_mfma_f32_16x16x32_bf16 v[44:47], v[12:15], v[176:179], 0
    ds_read_b64_tr_b16 v[12:13], v1 offset:256
    ds_read_b64_tr_b16 v[14:15], v1 offset:4864
    v_cvt_pk_bf16_f32 v48, v48, v49
    v_cvt_pk_bf16_f32 v49, v50, v51
    v_cvt_pk_bf16_f32 v50, v52, v53
    v_cvt_pk_bf16_f32 v51, v54, v55
    ds_write_b128 v3, v[48:51] offset:2048
    s_waitcnt lgkmcnt(15)
    v_mfma_f32_16x16x32_bf16 v[48:51], v[16:19], v[104:107], 0
    v_mfma_f32_16x16x32_bf16 v[52:55], v[16:19], v[176:179], 0
    ds_read_b64_tr_b16 v[16:17], v1 offset:9216
    ds_read_b64_tr_b16 v[18:19], v1 offset:13824
    v_cvt_pk_bf16_f32 v56, v56, v57
    v_cvt_pk_bf16_f32 v57, v58, v59
    v_cvt_pk_bf16_f32 v58, v60, v61
    v_cvt_pk_bf16_f32 v59, v62, v63
    ds_write_b128 v3, v[56:59] offset:3072
    s_waitcnt lgkmcnt(15)
    v_mfma_f32_16x16x32_bf16 v[56:59], v[20:23], v[104:107], 0
    v_mfma_f32_16x16x32_bf16 v[60:63], v[20:23], v[176:179], 0
    ds_read_b64_tr_b16 v[20:21], v1 offset:9248
    ds_read_b64_tr_b16 v[22:23], v1 offset:13856
    v_cvt_pk_bf16_f32 v64, v64, v65
    v_cvt_pk_bf16_f32 v65, v66, v67
    v_cvt_pk_bf16_f32 v66, v68, v69
    v_cvt_pk_bf16_f32 v67, v70, v71
    ds_write_b128 v3, v[64:67] offset:4096
    s_waitcnt lgkmcnt(15)
    v_mfma_f32_16x16x32_bf16 v[64:67], v[24:27], v[104:107], 0
    v_mfma_f32_16x16x32_bf16 v[68:71], v[24:27], v[176:179], 0
    ds_read_b64_tr_b16 v[24:25], v1 offset:9280
    ds_read_b64_tr_b16 v[26:27], v1 offset:13888
    v_cvt_pk_bf16_f32 v72, v72, v73
    v_cvt_pk_bf16_f32 v73, v74, v75
    v_cvt_pk_bf16_f32 v74, v76, v77
    v_cvt_pk_bf16_f32 v75, v78, v79
    ds_write_b128 v3, v[72:75] offset:5120
    v_mfma_f32_16x16x32_bf16 v[72:75], v[28:31], v[104:107], 0
    v_mfma_f32_16x16x32_bf16 v[76:79], v[28:31], v[176:179], 0
    ds_read_b64_tr_b16 v[28:29], v1 offset:9312
    ds_read_b64_tr_b16 v[30:31], v1 offset:13920
    v_cvt_pk_bf16_f32 v80, v80, v81
    v_cvt_pk_bf16_f32 v81, v82, v83
    v_cvt_pk_bf16_f32 v82, v84, v85
    v_cvt_pk_bf16_f32 v83, v86, v87
    ds_write_b128 v3, v[80:83] offset:6144
    s_waitcnt lgkmcnt(15)
    v_mfma_f32_16x16x32_bf16 v[80:83], v[4:7], v[104:107], 0
    v_mfma_f32_16x16x32_bf16 v[84:87], v[4:7], v[176:179], 0
    ds_read_b64_tr_b16 v[4:5], v1 offset:9344
    ds_read_b64_tr_b16 v[6:7], v1 offset:13952
    v_mfma_f32_16x16x32_bf16 v[88:91], v[8:11], v[104:107], 0
    v_mfma_f32_16x16x32_bf16 v[92:95], v[8:11], v[176:179], 0
    ds_read_b64_tr_b16 v[8:9], v1 offset:9376
    ds_read_b64_tr_b16 v[10:11], v1 offset:13984
    s_waitcnt lgkmcnt(15)
    v_mfma_f32_16x16x32_bf16 v[96:99], v[12:15], v[104:107], 0
    v_mfma_f32_16x16x32_bf16 v[100:103], v[12:15], v[176:179], 0
    ds_read_b64_tr_b16 v[12:13], v1 offset:9408
    ds_read_b64_tr_b16 v[14:15], v1 offset:14016
    s_waitcnt lgkmcnt(15)
    v_mfma_f32_16x16x32_bf16 v[32:35], v[16:19], v[108:111], v[32:35]
    v_mfma_f32_16x16x32_bf16 v[36:39], v[16:19], v[180:183], v[36:39]
    ds_read_b64_tr_b16 v[16:17], v1 offset:9440
    ds_read_b64_tr_b16 v[18:19], v1 offset:14048
    s_waitcnt lgkmcnt(15)
    v_mfma_f32_16x16x32_bf16 v[40:43], v[20:23], v[108:111], v[40:43]
    v_mfma_f32_16x16x32_bf16 v[44:47], v[20:23], v[180:183], v[44:47]
    ds_read_b64_tr_b16 v[20:21], v1 offset:9472
    ds_read_b64_tr_b16 v[22:23], v1 offset:14080
    s_waitcnt lgkmcnt(14)
    v_mfma_f32_16x16x32_bf16 v[48:51], v[24:27], v[108:111], v[48:51]
    v_mfma_f32_16x16x32_bf16 v[52:55], v[24:27], v[180:183], v[52:55]
    v_add_u32 v1, 55296, v1
    ds_read_b64_tr_b16 v[24:25], v1 offset:0
    ds_read_b64_tr_b16 v[26:27], v1 offset:4608
    s_waitcnt lgkmcnt(13)
    v_mfma_f32_16x16x32_bf16 v[56:59], v[28:31], v[108:111], v[56:59]
    v_mfma_f32_16x16x32_bf16 v[60:63], v[28:31], v[180:183], v[60:63]
    ds_read_b64_tr_b16 v[28:29], v1 offset:32
    ds_read_b64_tr_b16 v[30:31], v1 offset:4640
    s_waitcnt lgkmcnt(12)
    v_mfma_f32_16x16x32_bf16 v[64:67], v[4:7], v[108:111], v[64:67]
    v_mfma_f32_16x16x32_bf16 v[68:71], v[4:7], v[180:183], v[68:71]
    ds_read_b64_tr_b16 v[4:5], v1 offset:64
    ds_read_b64_tr_b16 v[6:7], v1 offset:4672
    s_waitcnt lgkmcnt(12)
    v_mfma_f32_16x16x32_bf16 v[72:75], v[8:11], v[108:111], v[72:75]
    v_mfma_f32_16x16x32_bf16 v[76:79], v[8:11], v[180:183], v[76:79]
    ds_read_b64_tr_b16 v[8:9], v1 offset:96
    ds_read_b64_tr_b16 v[10:11], v1 offset:4704
    s_waitcnt lgkmcnt(12)
    v_mfma_f32_16x16x32_bf16 v[80:83], v[12:15], v[108:111], v[80:83]
    v_mfma_f32_16x16x32_bf16 v[84:87], v[12:15], v[180:183], v[84:87]
    ds_read_b64_tr_b16 v[12:13], v1 offset:128
    ds_read_b64_tr_b16 v[14:15], v1 offset:4736
    s_waitcnt lgkmcnt(12)
    v_mfma_f32_16x16x32_bf16 v[88:91], v[16:19], v[108:111], v[88:91]
    v_mfma_f32_16x16x32_bf16 v[92:95], v[16:19], v[180:183], v[92:95]
    ds_read_b64_tr_b16 v[16:17], v1 offset:160
    ds_read_b64_tr_b16 v[18:19], v1 offset:4768
    s_waitcnt lgkmcnt(12)
    v_mfma_f32_16x16x32_bf16 v[96:99], v[20:23], v[108:111], v[96:99]
    v_mfma_f32_16x16x32_bf16 v[100:103], v[20:23], v[180:183], v[100:103]
    s_barrier
    ds_read_b64_tr_b16 v[20:21], v1 offset:192
    ds_read_b64_tr_b16 v[22:23], v1 offset:4800
    s_waitcnt lgkmcnt(12)
    v_mfma_f32_16x16x32_bf16 v[32:35], v[24:27], v[112:115], v[32:35]
    v_mfma_f32_16x16x32_bf16 v[36:39], v[24:27], v[184:187], v[36:39]
    ds_read_b64_tr_b16 v[24:25], v1 offset:224
    ds_read_b64_tr_b16 v[26:27], v1 offset:4832
    s_waitcnt lgkmcnt(12)
    v_mfma_f32_16x16x32_bf16 v[40:43], v[28:31], v[112:115], v[40:43]
    v_mfma_f32_16x16x32_bf16 v[44:47], v[28:31], v[184:187], v[44:47]
    ds_read_b64_tr_b16 v[28:29], v1 offset:256
    ds_read_b64_tr_b16 v[30:31], v1 offset:4864
    s_waitcnt lgkmcnt(12)
    v_mfma_f32_16x16x32_bf16 v[48:51], v[4:7], v[112:115], v[48:51]
    v_mfma_f32_16x16x32_bf16 v[52:55], v[4:7], v[184:187], v[52:55]
    ds_read_b64_tr_b16 v[4:5], v1 offset:9216
    ds_read_b64_tr_b16 v[6:7], v1 offset:13824
    s_waitcnt lgkmcnt(12)
    v_mfma_f32_16x16x32_bf16 v[56:59], v[8:11], v[112:115], v[56:59]
    v_mfma_f32_16x16x32_bf16 v[60:63], v[8:11], v[184:187], v[60:63]
    ds_read_b64_tr_b16 v[8:9], v1 offset:9248
    ds_read_b64_tr_b16 v[10:11], v1 offset:13856
    s_waitcnt lgkmcnt(12)
    v_mfma_f32_16x16x32_bf16 v[64:67], v[12:15], v[112:115], v[64:67]
    v_mfma_f32_16x16x32_bf16 v[68:71], v[12:15], v[184:187], v[68:71]
    ds_read_b64_tr_b16 v[12:13], v1 offset:9280
    ds_read_b64_tr_b16 v[14:15], v1 offset:13888
    s_waitcnt lgkmcnt(12)
    v_mfma_f32_16x16x32_bf16 v[72:75], v[16:19], v[112:115], v[72:75]
    v_mfma_f32_16x16x32_bf16 v[76:79], v[16:19], v[184:187], v[76:79]
    ds_read_b64_tr_b16 v[16:17], v1 offset:9312
    ds_read_b64_tr_b16 v[18:19], v1 offset:13920
    s_waitcnt lgkmcnt(12)
    v_mfma_f32_16x16x32_bf16 v[80:83], v[20:23], v[112:115], v[80:83]
    v_mfma_f32_16x16x32_bf16 v[84:87], v[20:23], v[184:187], v[84:87]
    ds_read_b64_tr_b16 v[20:21], v1 offset:9344
    ds_read_b64_tr_b16 v[22:23], v1 offset:13952
    s_waitcnt lgkmcnt(12)
    v_mfma_f32_16x16x32_bf16 v[88:91], v[24:27], v[112:115], v[88:91]
    v_mfma_f32_16x16x32_bf16 v[92:95], v[24:27], v[184:187], v[92:95]
    ds_read_b64_tr_b16 v[24:25], v1 offset:9376
    ds_read_b64_tr_b16 v[26:27], v1 offset:13984
    s_waitcnt lgkmcnt(12)
    v_mfma_f32_16x16x32_bf16 v[96:99], v[28:31], v[112:115], v[96:99]
    v_mfma_f32_16x16x32_bf16 v[100:103], v[28:31], v[184:187], v[100:103]
    ds_read_b64_tr_b16 v[28:29], v1 offset:9408
    ds_read_b64_tr_b16 v[30:31], v1 offset:14016
    s_waitcnt lgkmcnt(12)
    v_mfma_f32_16x16x32_bf16 v[32:35], v[4:7], v[116:119], v[32:35]
    v_mfma_f32_16x16x32_bf16 v[36:39], v[4:7], v[188:191], v[36:39]
    ds_read_b64_tr_b16 v[4:5], v1 offset:9440
    ds_read_b64_tr_b16 v[6:7], v1 offset:14048
    s_waitcnt lgkmcnt(12)
    v_mfma_f32_16x16x32_bf16 v[40:43], v[8:11], v[116:119], v[40:43]
    v_mfma_f32_16x16x32_bf16 v[44:47], v[8:11], v[188:191], v[44:47]
    ds_read_b64_tr_b16 v[8:9], v1 offset:9472
    ds_read_b64_tr_b16 v[10:11], v1 offset:14080
    s_waitcnt lgkmcnt(12)
    v_mfma_f32_16x16x32_bf16 v[48:51], v[12:15], v[116:119], v[48:51]
    v_mfma_f32_16x16x32_bf16 v[52:55], v[12:15], v[188:191], v[52:55]
    v_subrev_u32 v1, 92160, v1
    ds_read_b64_tr_b16 v[12:13], v1 offset:0
    ds_read_b64_tr_b16 v[14:15], v1 offset:4608
    s_waitcnt lgkmcnt(12)
    v_mfma_f32_16x16x32_bf16 v[56:59], v[16:19], v[116:119], v[56:59]
    v_mfma_f32_16x16x32_bf16 v[60:63], v[16:19], v[188:191], v[60:63]
    ds_read_b64_tr_b16 v[16:17], v1 offset:32
    ds_read_b64_tr_b16 v[18:19], v1 offset:4640
    s_waitcnt lgkmcnt(12)
    v_mfma_f32_16x16x32_bf16 v[64:67], v[20:23], v[116:119], v[64:67]
    v_mfma_f32_16x16x32_bf16 v[68:71], v[20:23], v[188:191], v[68:71]
    ds_read_b64_tr_b16 v[20:21], v1 offset:64
    ds_read_b64_tr_b16 v[22:23], v1 offset:4672
    s_waitcnt lgkmcnt(12)
    v_mfma_f32_16x16x32_bf16 v[72:75], v[24:27], v[116:119], v[72:75]
    v_mfma_f32_16x16x32_bf16 v[76:79], v[24:27], v[188:191], v[76:79]
    ds_read_b64_tr_b16 v[24:25], v1 offset:96
    ds_read_b64_tr_b16 v[26:27], v1 offset:4704
    s_waitcnt lgkmcnt(12)
    v_mfma_f32_16x16x32_bf16 v[80:83], v[28:31], v[116:119], v[80:83]
    v_mfma_f32_16x16x32_bf16 v[84:87], v[28:31], v[188:191], v[84:87]
    ds_read_b64_tr_b16 v[28:29], v1 offset:128
    ds_read_b64_tr_b16 v[30:31], v1 offset:4736
    s_waitcnt lgkmcnt(12)
    v_mfma_f32_16x16x32_bf16 v[88:91], v[4:7], v[116:119], v[88:91]
    v_mfma_f32_16x16x32_bf16 v[92:95], v[4:7], v[188:191], v[92:95]
    ds_read_b64_tr_b16 v[4:5], v1 offset:160
    ds_read_b64_tr_b16 v[6:7], v1 offset:4768
    s_waitcnt lgkmcnt(12)
    v_mfma_f32_16x16x32_bf16 v[96:99], v[8:11], v[116:119], v[96:99]
    v_mfma_f32_16x16x32_bf16 v[100:103], v[8:11], v[188:191], v[100:103]
    s_barrier
    ds_read_b64_tr_b16 v[8:9], v1 offset:192
    ds_read_b64_tr_b16 v[10:11], v1 offset:4800
    s_waitcnt lgkmcnt(12)
    v_mfma_f32_16x16x32_bf16 v[32:35], v[12:15], v[120:123], v[32:35]
    v_mfma_f32_16x16x32_bf16 v[36:39], v[12:15], v[192:195], v[36:39]
    ds_read_b64_tr_b16 v[12:13], v1 offset:224
    ds_read_b64_tr_b16 v[14:15], v1 offset:4832
    s_waitcnt lgkmcnt(12)
    v_mfma_f32_16x16x32_bf16 v[40:43], v[16:19], v[120:123], v[40:43]
    v_mfma_f32_16x16x32_bf16 v[44:47], v[16:19], v[192:195], v[44:47]
    ds_read_b64_tr_b16 v[16:17], v1 offset:256
    ds_read_b64_tr_b16 v[18:19], v1 offset:4864
    s_waitcnt lgkmcnt(12)
    v_mfma_f32_16x16x32_bf16 v[48:51], v[20:23], v[120:123], v[48:51]
    v_mfma_f32_16x16x32_bf16 v[52:55], v[20:23], v[192:195], v[52:55]
    ds_read_b64_tr_b16 v[20:21], v1 offset:9216
    ds_read_b64_tr_b16 v[22:23], v1 offset:13824
    s_waitcnt lgkmcnt(12)
    v_mfma_f32_16x16x32_bf16 v[56:59], v[24:27], v[120:123], v[56:59]
    v_mfma_f32_16x16x32_bf16 v[60:63], v[24:27], v[192:195], v[60:63]
    ds_read_b64_tr_b16 v[24:25], v1 offset:9248
    ds_read_b64_tr_b16 v[26:27], v1 offset:13856
    s_waitcnt lgkmcnt(12)
    v_mfma_f32_16x16x32_bf16 v[64:67], v[28:31], v[120:123], v[64:67]
    v_mfma_f32_16x16x32_bf16 v[68:71], v[28:31], v[192:195], v[68:71]
    ds_read_b64_tr_b16 v[28:29], v1 offset:9280
    ds_read_b64_tr_b16 v[30:31], v1 offset:13888
    s_waitcnt lgkmcnt(12)
    v_mfma_f32_16x16x32_bf16 v[72:75], v[4:7], v[120:123], v[72:75]
    v_mfma_f32_16x16x32_bf16 v[76:79], v[4:7], v[192:195], v[76:79]
    ds_read_b64_tr_b16 v[4:5], v1 offset:9312
    ds_read_b64_tr_b16 v[6:7], v1 offset:13920
    s_waitcnt lgkmcnt(12)
    v_mfma_f32_16x16x32_bf16 v[80:83], v[8:11], v[120:123], v[80:83]
    v_mfma_f32_16x16x32_bf16 v[84:87], v[8:11], v[192:195], v[84:87]
    ds_read_b64_tr_b16 v[8:9], v1 offset:9344
    ds_read_b64_tr_b16 v[10:11], v1 offset:13952
    s_waitcnt lgkmcnt(12)
    v_mfma_f32_16x16x32_bf16 v[88:91], v[12:15], v[120:123], v[88:91]
    v_mfma_f32_16x16x32_bf16 v[92:95], v[12:15], v[192:195], v[92:95]
    ds_read_b64_tr_b16 v[12:13], v1 offset:9376
    ds_read_b64_tr_b16 v[14:15], v1 offset:13984
    s_waitcnt lgkmcnt(12)
    v_mfma_f32_16x16x32_bf16 v[96:99], v[16:19], v[120:123], v[96:99]
    v_mfma_f32_16x16x32_bf16 v[100:103], v[16:19], v[192:195], v[100:103]
    ds_read_b64_tr_b16 v[16:17], v1 offset:9408
    ds_read_b64_tr_b16 v[18:19], v1 offset:14016
    s_waitcnt lgkmcnt(12)
    v_mfma_f32_16x16x32_bf16 v[32:35], v[20:23], v[124:127], v[32:35]
    v_mfma_f32_16x16x32_bf16 v[36:39], v[20:23], v[196:199], v[36:39]
    ds_read_b64_tr_b16 v[20:21], v1 offset:9440
    ds_read_b64_tr_b16 v[22:23], v1 offset:14048
    s_waitcnt lgkmcnt(12)
    v_mfma_f32_16x16x32_bf16 v[40:43], v[24:27], v[124:127], v[40:43]
    v_mfma_f32_16x16x32_bf16 v[44:47], v[24:27], v[196:199], v[44:47]
    ds_read_b64_tr_b16 v[24:25], v1 offset:9472
    ds_read_b64_tr_b16 v[26:27], v1 offset:14080
    s_waitcnt lgkmcnt(12)
    v_mfma_f32_16x16x32_bf16 v[48:51], v[28:31], v[124:127], v[48:51]
    v_mfma_f32_16x16x32_bf16 v[52:55], v[28:31], v[196:199], v[52:55]
    v_add_u32 v1, 18432, v1
    ds_read_b64_tr_b16 v[28:29], v1 offset:0
    ds_read_b64_tr_b16 v[30:31], v1 offset:4608
    s_waitcnt lgkmcnt(12)
    v_mfma_f32_16x16x32_bf16 v[56:59], v[4:7], v[124:127], v[56:59]
    v_mfma_f32_16x16x32_bf16 v[60:63], v[4:7], v[196:199], v[60:63]
    ds_read_b64_tr_b16 v[4:5], v1 offset:32
    ds_read_b64_tr_b16 v[6:7], v1 offset:4640
    s_waitcnt lgkmcnt(12)
    v_mfma_f32_16x16x32_bf16 v[64:67], v[8:11], v[124:127], v[64:67]
    v_mfma_f32_16x16x32_bf16 v[68:71], v[8:11], v[196:199], v[68:71]
    ds_read_b64_tr_b16 v[8:9], v1 offset:64
    ds_read_b64_tr_b16 v[10:11], v1 offset:4672
    s_waitcnt lgkmcnt(12)
    v_mfma_f32_16x16x32_bf16 v[72:75], v[12:15], v[124:127], v[72:75]
    v_mfma_f32_16x16x32_bf16 v[76:79], v[12:15], v[196:199], v[76:79]
    ds_read_b64_tr_b16 v[12:13], v1 offset:96
    ds_read_b64_tr_b16 v[14:15], v1 offset:4704
    s_waitcnt lgkmcnt(12)
    v_mfma_f32_16x16x32_bf16 v[80:83], v[16:19], v[124:127], v[80:83]
    v_mfma_f32_16x16x32_bf16 v[84:87], v[16:19], v[196:199], v[84:87]
    ds_read_b64_tr_b16 v[16:17], v1 offset:128
    ds_read_b64_tr_b16 v[18:19], v1 offset:4736
    s_waitcnt lgkmcnt(12)
    v_mfma_f32_16x16x32_bf16 v[88:91], v[20:23], v[124:127], v[88:91]
    v_mfma_f32_16x16x32_bf16 v[92:95], v[20:23], v[196:199], v[92:95]
    ds_read_b64_tr_b16 v[20:21], v1 offset:160
    ds_read_b64_tr_b16 v[22:23], v1 offset:4768
    s_waitcnt lgkmcnt(12)
    v_mfma_f32_16x16x32_bf16 v[96:99], v[24:27], v[124:127], v[96:99]
    v_mfma_f32_16x16x32_bf16 v[100:103], v[24:27], v[196:199], v[100:103]
    s_barrier
    ds_read_b64_tr_b16 v[24:25], v1 offset:192
    ds_read_b64_tr_b16 v[26:27], v1 offset:4800
    s_waitcnt lgkmcnt(12)
    v_mfma_f32_16x16x32_bf16 v[32:35], v[28:31], v[128:131], v[32:35]
    v_mfma_f32_16x16x32_bf16 v[36:39], v[28:31], v[200:203], v[36:39]
    ds_read_b64_tr_b16 v[28:29], v1 offset:224
    ds_read_b64_tr_b16 v[30:31], v1 offset:4832
    s_waitcnt lgkmcnt(12)
    v_mfma_f32_16x16x32_bf16 v[40:43], v[4:7], v[128:131], v[40:43]
    v_mfma_f32_16x16x32_bf16 v[44:47], v[4:7], v[200:203], v[44:47]
    ds_read_b64_tr_b16 v[4:5], v1 offset:256
    ds_read_b64_tr_b16 v[6:7], v1 offset:4864
    s_waitcnt lgkmcnt(12)
    v_mfma_f32_16x16x32_bf16 v[48:51], v[8:11], v[128:131], v[48:51]
    v_mfma_f32_16x16x32_bf16 v[52:55], v[8:11], v[200:203], v[52:55]
    ds_read_b64_tr_b16 v[8:9], v1 offset:9216
    ds_read_b64_tr_b16 v[10:11], v1 offset:13824
    s_waitcnt lgkmcnt(12)
    v_mfma_f32_16x16x32_bf16 v[56:59], v[12:15], v[128:131], v[56:59]
    v_mfma_f32_16x16x32_bf16 v[60:63], v[12:15], v[200:203], v[60:63]
    ds_read_b64_tr_b16 v[12:13], v1 offset:9248
    ds_read_b64_tr_b16 v[14:15], v1 offset:13856
    s_waitcnt lgkmcnt(12)
    v_mfma_f32_16x16x32_bf16 v[64:67], v[16:19], v[128:131], v[64:67]
    v_mfma_f32_16x16x32_bf16 v[68:71], v[16:19], v[200:203], v[68:71]
    ds_read_b64_tr_b16 v[16:17], v1 offset:9280
    ds_read_b64_tr_b16 v[18:19], v1 offset:13888
    s_waitcnt lgkmcnt(12)
    v_mfma_f32_16x16x32_bf16 v[72:75], v[20:23], v[128:131], v[72:75]
    v_mfma_f32_16x16x32_bf16 v[76:79], v[20:23], v[200:203], v[76:79]
    ds_read_b64_tr_b16 v[20:21], v1 offset:9312
    ds_read_b64_tr_b16 v[22:23], v1 offset:13920
    s_waitcnt lgkmcnt(12)
    v_mfma_f32_16x16x32_bf16 v[80:83], v[24:27], v[128:131], v[80:83]
    v_mfma_f32_16x16x32_bf16 v[84:87], v[24:27], v[200:203], v[84:87]
    ds_read_b64_tr_b16 v[24:25], v1 offset:9344
    ds_read_b64_tr_b16 v[26:27], v1 offset:13952
    s_waitcnt lgkmcnt(12)
    v_mfma_f32_16x16x32_bf16 v[88:91], v[28:31], v[128:131], v[88:91]
    v_mfma_f32_16x16x32_bf16 v[92:95], v[28:31], v[200:203], v[92:95]
    ds_read_b64_tr_b16 v[28:29], v1 offset:9376
    ds_read_b64_tr_b16 v[30:31], v1 offset:13984
    s_waitcnt lgkmcnt(12)
    v_mfma_f32_16x16x32_bf16 v[96:99], v[4:7], v[128:131], v[96:99]
    v_mfma_f32_16x16x32_bf16 v[100:103], v[4:7], v[200:203], v[100:103]
    ds_read_b64_tr_b16 v[4:5], v1 offset:9408
    ds_read_b64_tr_b16 v[6:7], v1 offset:14016
    s_waitcnt lgkmcnt(12)
    v_mfma_f32_16x16x32_bf16 v[32:35], v[8:11], v[132:135], v[32:35]
    v_mfma_f32_16x16x32_bf16 v[36:39], v[8:11], v[204:207], v[36:39]
    ds_read_b64_tr_b16 v[8:9], v1 offset:9440
    ds_read_b64_tr_b16 v[10:11], v1 offset:14048
    s_waitcnt lgkmcnt(12)
    v_mfma_f32_16x16x32_bf16 v[40:43], v[12:15], v[132:135], v[40:43]
    v_mfma_f32_16x16x32_bf16 v[44:47], v[12:15], v[204:207], v[44:47]
    ds_read_b64_tr_b16 v[12:13], v1 offset:9472
    ds_read_b64_tr_b16 v[14:15], v1 offset:14080
    s_waitcnt lgkmcnt(12)
    v_mfma_f32_16x16x32_bf16 v[48:51], v[16:19], v[132:135], v[48:51]
    v_mfma_f32_16x16x32_bf16 v[52:55], v[16:19], v[204:207], v[52:55]
    v_add_u32 v1, 92160, v1
    ds_read_b64_tr_b16 v[16:17], v1 offset:0
    ds_read_b64_tr_b16 v[18:19], v1 offset:4608
    s_waitcnt lgkmcnt(12)
    v_mfma_f32_16x16x32_bf16 v[56:59], v[20:23], v[132:135], v[56:59]
    v_mfma_f32_16x16x32_bf16 v[60:63], v[20:23], v[204:207], v[60:63]
    ds_read_b64_tr_b16 v[20:21], v1 offset:32
    ds_read_b64_tr_b16 v[22:23], v1 offset:4640
    s_waitcnt lgkmcnt(12)
    v_mfma_f32_16x16x32_bf16 v[64:67], v[24:27], v[132:135], v[64:67]
    v_mfma_f32_16x16x32_bf16 v[68:71], v[24:27], v[204:207], v[68:71]
    ds_read_b64_tr_b16 v[24:25], v1 offset:64
    ds_read_b64_tr_b16 v[26:27], v1 offset:4672
    s_waitcnt lgkmcnt(12)
    v_mfma_f32_16x16x32_bf16 v[72:75], v[28:31], v[132:135], v[72:75]
    v_mfma_f32_16x16x32_bf16 v[76:79], v[28:31], v[204:207], v[76:79]
    ds_read_b64_tr_b16 v[28:29], v1 offset:96
    ds_read_b64_tr_b16 v[30:31], v1 offset:4704
    s_waitcnt lgkmcnt(12)
    v_mfma_f32_16x16x32_bf16 v[80:83], v[4:7], v[132:135], v[80:83]
    v_mfma_f32_16x16x32_bf16 v[84:87], v[4:7], v[204:207], v[84:87]
    ds_read_b64_tr_b16 v[4:5], v1 offset:128
    ds_read_b64_tr_b16 v[6:7], v1 offset:4736
    s_waitcnt lgkmcnt(12)
    v_mfma_f32_16x16x32_bf16 v[88:91], v[8:11], v[132:135], v[88:91]
    v_mfma_f32_16x16x32_bf16 v[92:95], v[8:11], v[204:207], v[92:95]
    ds_read_b64_tr_b16 v[8:9], v1 offset:160
    ds_read_b64_tr_b16 v[10:11], v1 offset:4768
    s_waitcnt lgkmcnt(12)
    v_mfma_f32_16x16x32_bf16 v[96:99], v[12:15], v[132:135], v[96:99]
    v_mfma_f32_16x16x32_bf16 v[100:103], v[12:15], v[204:207], v[100:103]
    s_barrier
    ds_read_b64_tr_b16 v[12:13], v1 offset:192
    ds_read_b64_tr_b16 v[14:15], v1 offset:4800
    s_waitcnt lgkmcnt(12)
    v_mfma_f32_16x16x32_bf16 v[32:35], v[16:19], v[136:139], v[32:35]
    v_mfma_f32_16x16x32_bf16 v[36:39], v[16:19], v[208:211], v[36:39]
    ds_read_b64_tr_b16 v[16:17], v1 offset:224
    ds_read_b64_tr_b16 v[18:19], v1 offset:4832
    s_waitcnt lgkmcnt(12)
    v_mfma_f32_16x16x32_bf16 v[40:43], v[20:23], v[136:139], v[40:43]
    v_mfma_f32_16x16x32_bf16 v[44:47], v[20:23], v[208:211], v[44:47]
    ds_read_b64_tr_b16 v[20:21], v1 offset:256
    ds_read_b64_tr_b16 v[22:23], v1 offset:4864
    s_waitcnt lgkmcnt(12)
    v_mfma_f32_16x16x32_bf16 v[48:51], v[24:27], v[136:139], v[48:51]
    v_mfma_f32_16x16x32_bf16 v[52:55], v[24:27], v[208:211], v[52:55]
    ds_read_b64_tr_b16 v[24:25], v1 offset:9216
    ds_read_b64_tr_b16 v[26:27], v1 offset:13824
    s_waitcnt lgkmcnt(12)
    v_mfma_f32_16x16x32_bf16 v[56:59], v[28:31], v[136:139], v[56:59]
    v_mfma_f32_16x16x32_bf16 v[60:63], v[28:31], v[208:211], v[60:63]
    ds_read_b64_tr_b16 v[28:29], v1 offset:9248
    ds_read_b64_tr_b16 v[30:31], v1 offset:13856
    s_waitcnt lgkmcnt(12)
    v_mfma_f32_16x16x32_bf16 v[64:67], v[4:7], v[136:139], v[64:67]
    v_mfma_f32_16x16x32_bf16 v[68:71], v[4:7], v[208:211], v[68:71]
    ds_read_b64_tr_b16 v[4:5], v1 offset:9280
    ds_read_b64_tr_b16 v[6:7], v1 offset:13888
    s_waitcnt lgkmcnt(12)
    v_mfma_f32_16x16x32_bf16 v[72:75], v[8:11], v[136:139], v[72:75]
    v_mfma_f32_16x16x32_bf16 v[76:79], v[8:11], v[208:211], v[76:79]
    ds_read_b64_tr_b16 v[8:9], v1 offset:9312
    ds_read_b64_tr_b16 v[10:11], v1 offset:13920
    s_waitcnt lgkmcnt(12)
    v_mfma_f32_16x16x32_bf16 v[80:83], v[12:15], v[136:139], v[80:83]
    v_mfma_f32_16x16x32_bf16 v[84:87], v[12:15], v[208:211], v[84:87]
    ds_read_b64_tr_b16 v[12:13], v1 offset:9344
    ds_read_b64_tr_b16 v[14:15], v1 offset:13952
    s_waitcnt lgkmcnt(12)
    v_mfma_f32_16x16x32_bf16 v[88:91], v[16:19], v[136:139], v[88:91]
    v_mfma_f32_16x16x32_bf16 v[92:95], v[16:19], v[208:211], v[92:95]
    ds_read_b64_tr_b16 v[16:17], v1 offset:9376
    ds_read_b64_tr_b16 v[18:19], v1 offset:13984
    s_waitcnt lgkmcnt(12)
    v_mfma_f32_16x16x32_bf16 v[96:99], v[20:23], v[136:139], v[96:99]
    v_mfma_f32_16x16x32_bf16 v[100:103], v[20:23], v[208:211], v[100:103]
    ds_read_b64_tr_b16 v[20:21], v1 offset:9408
    ds_read_b64_tr_b16 v[22:23], v1 offset:14016
    s_waitcnt lgkmcnt(12)
    v_mfma_f32_16x16x32_bf16 v[32:35], v[24:27], v[140:143], v[32:35]
    v_mfma_f32_16x16x32_bf16 v[36:39], v[24:27], v[212:215], v[36:39]
    ds_read_b64_tr_b16 v[24:25], v1 offset:9440
    ds_read_b64_tr_b16 v[26:27], v1 offset:14048
    s_waitcnt lgkmcnt(12)
    v_mfma_f32_16x16x32_bf16 v[40:43], v[28:31], v[140:143], v[40:43]
    v_mfma_f32_16x16x32_bf16 v[44:47], v[28:31], v[212:215], v[44:47]
    ds_read_b64_tr_b16 v[28:29], v1 offset:9472
    ds_read_b64_tr_b16 v[30:31], v1 offset:14080
    s_waitcnt lgkmcnt(12)
    v_mfma_f32_16x16x32_bf16 v[48:51], v[4:7], v[140:143], v[48:51]
    v_mfma_f32_16x16x32_bf16 v[52:55], v[4:7], v[212:215], v[52:55]
    v_subrev_u32 v1, 55296, v1
    ds_read_b64_tr_b16 v[4:5], v1 offset:0
    ds_read_b64_tr_b16 v[6:7], v1 offset:4608
    s_waitcnt lgkmcnt(12)
    v_mfma_f32_16x16x32_bf16 v[56:59], v[8:11], v[140:143], v[56:59]
    v_mfma_f32_16x16x32_bf16 v[60:63], v[8:11], v[212:215], v[60:63]
    ds_read_b64_tr_b16 v[8:9], v1 offset:32
    ds_read_b64_tr_b16 v[10:11], v1 offset:4640
    s_waitcnt lgkmcnt(12)
    v_mfma_f32_16x16x32_bf16 v[64:67], v[12:15], v[140:143], v[64:67]
    v_mfma_f32_16x16x32_bf16 v[68:71], v[12:15], v[212:215], v[68:71]
    ds_read_b64_tr_b16 v[12:13], v1 offset:64
    ds_read_b64_tr_b16 v[14:15], v1 offset:4672
    s_waitcnt lgkmcnt(12)
    v_mfma_f32_16x16x32_bf16 v[72:75], v[16:19], v[140:143], v[72:75]
    v_mfma_f32_16x16x32_bf16 v[76:79], v[16:19], v[212:215], v[76:79]
    ds_read_b64_tr_b16 v[16:17], v1 offset:96
    ds_read_b64_tr_b16 v[18:19], v1 offset:4704
    s_waitcnt lgkmcnt(12)
    v_mfma_f32_16x16x32_bf16 v[80:83], v[20:23], v[140:143], v[80:83]
    v_mfma_f32_16x16x32_bf16 v[84:87], v[20:23], v[212:215], v[84:87]
    ds_read_b64_tr_b16 v[20:21], v1 offset:128
    ds_read_b64_tr_b16 v[22:23], v1 offset:4736
    s_waitcnt lgkmcnt(12)
    v_mfma_f32_16x16x32_bf16 v[88:91], v[24:27], v[140:143], v[88:91]
    v_mfma_f32_16x16x32_bf16 v[92:95], v[24:27], v[212:215], v[92:95]
    ds_read_b64_tr_b16 v[24:25], v1 offset:160
    ds_read_b64_tr_b16 v[26:27], v1 offset:4768
    s_waitcnt lgkmcnt(12)
    v_mfma_f32_16x16x32_bf16 v[96:99], v[28:31], v[140:143], v[96:99]
    v_mfma_f32_16x16x32_bf16 v[100:103], v[28:31], v[212:215], v[100:103]
    s_barrier
    ds_read_b64_tr_b16 v[28:29], v1 offset:192
    ds_read_b64_tr_b16 v[30:31], v1 offset:4800
    s_waitcnt lgkmcnt(12)
    v_mfma_f32_16x16x32_bf16 v[32:35], v[4:7], v[144:147], v[32:35]
    v_mfma_f32_16x16x32_bf16 v[36:39], v[4:7], v[216:219], v[36:39]
    ds_read_b64_tr_b16 v[4:5], v1 offset:224
    ds_read_b64_tr_b16 v[6:7], v1 offset:4832
    s_waitcnt lgkmcnt(12)
    v_mfma_f32_16x16x32_bf16 v[40:43], v[8:11], v[144:147], v[40:43]
    v_mfma_f32_16x16x32_bf16 v[44:47], v[8:11], v[216:219], v[44:47]
    ds_read_b64_tr_b16 v[8:9], v1 offset:256
    ds_read_b64_tr_b16 v[10:11], v1 offset:4864
    s_waitcnt lgkmcnt(12)
    v_mfma_f32_16x16x32_bf16 v[48:51], v[12:15], v[144:147], v[48:51]
    v_mfma_f32_16x16x32_bf16 v[52:55], v[12:15], v[216:219], v[52:55]
    ds_read_b64_tr_b16 v[12:13], v1 offset:9216
    ds_read_b64_tr_b16 v[14:15], v1 offset:13824
    s_waitcnt lgkmcnt(12)
    v_mfma_f32_16x16x32_bf16 v[56:59], v[16:19], v[144:147], v[56:59]
    v_mfma_f32_16x16x32_bf16 v[60:63], v[16:19], v[216:219], v[60:63]
    ds_read_b64_tr_b16 v[16:17], v1 offset:9248
    ds_read_b64_tr_b16 v[18:19], v1 offset:13856
    s_waitcnt lgkmcnt(12)
    v_mfma_f32_16x16x32_bf16 v[64:67], v[20:23], v[144:147], v[64:67]
    v_mfma_f32_16x16x32_bf16 v[68:71], v[20:23], v[216:219], v[68:71]
    ds_read_b64_tr_b16 v[20:21], v1 offset:9280
    ds_read_b64_tr_b16 v[22:23], v1 offset:13888
    s_waitcnt lgkmcnt(12)
    v_mfma_f32_16x16x32_bf16 v[72:75], v[24:27], v[144:147], v[72:75]
    v_mfma_f32_16x16x32_bf16 v[76:79], v[24:27], v[216:219], v[76:79]
    ds_read_b64_tr_b16 v[24:25], v1 offset:9312
    ds_read_b64_tr_b16 v[26:27], v1 offset:13920
    s_waitcnt lgkmcnt(12)
    v_mfma_f32_16x16x32_bf16 v[80:83], v[28:31], v[144:147], v[80:83]
    v_mfma_f32_16x16x32_bf16 v[84:87], v[28:31], v[216:219], v[84:87]
    ds_read_b64_tr_b16 v[28:29], v1 offset:9344
    ds_read_b64_tr_b16 v[30:31], v1 offset:13952
    s_waitcnt lgkmcnt(12)
    v_mfma_f32_16x16x32_bf16 v[88:91], v[4:7], v[144:147], v[88:91]
    v_mfma_f32_16x16x32_bf16 v[92:95], v[4:7], v[216:219], v[92:95]
    ds_read_b64_tr_b16 v[4:5], v1 offset:9376
    ds_read_b64_tr_b16 v[6:7], v1 offset:13984
    s_waitcnt lgkmcnt(12)
    v_mfma_f32_16x16x32_bf16 v[96:99], v[8:11], v[144:147], v[96:99]
    v_mfma_f32_16x16x32_bf16 v[100:103], v[8:11], v[216:219], v[100:103]
    ds_read_b64_tr_b16 v[8:9], v1 offset:9408
    ds_read_b64_tr_b16 v[10:11], v1 offset:14016
    s_waitcnt lgkmcnt(12)
    v_mfma_f32_16x16x32_bf16 v[32:35], v[12:15], v[148:151], v[32:35]
    v_mfma_f32_16x16x32_bf16 v[36:39], v[12:15], v[220:223], v[36:39]
    ds_read_b64_tr_b16 v[12:13], v1 offset:9440
    ds_read_b64_tr_b16 v[14:15], v1 offset:14048
    s_waitcnt lgkmcnt(12)
    v_mfma_f32_16x16x32_bf16 v[40:43], v[16:19], v[148:151], v[40:43]
    v_mfma_f32_16x16x32_bf16 v[44:47], v[16:19], v[220:223], v[44:47]
    ds_read_b64_tr_b16 v[16:17], v1 offset:9472
    ds_read_b64_tr_b16 v[18:19], v1 offset:14080
    s_waitcnt lgkmcnt(12)
    v_mfma_f32_16x16x32_bf16 v[48:51], v[20:23], v[148:151], v[48:51]
    v_mfma_f32_16x16x32_bf16 v[52:55], v[20:23], v[220:223], v[52:55]
    v_subrev_u32 v1, 18432, v1
    ds_read_b64_tr_b16 v[20:21], v1 offset:0
    ds_read_b64_tr_b16 v[22:23], v1 offset:4608
    s_waitcnt lgkmcnt(12)
    v_mfma_f32_16x16x32_bf16 v[56:59], v[24:27], v[148:151], v[56:59]
    v_mfma_f32_16x16x32_bf16 v[60:63], v[24:27], v[220:223], v[60:63]
    ds_read_b64_tr_b16 v[24:25], v1 offset:32
    ds_read_b64_tr_b16 v[26:27], v1 offset:4640
    s_waitcnt lgkmcnt(12)
    v_mfma_f32_16x16x32_bf16 v[64:67], v[28:31], v[148:151], v[64:67]
    v_mfma_f32_16x16x32_bf16 v[68:71], v[28:31], v[220:223], v[68:71]
    ds_read_b64_tr_b16 v[28:29], v1 offset:64
    ds_read_b64_tr_b16 v[30:31], v1 offset:4672
    s_waitcnt lgkmcnt(12)
    v_mfma_f32_16x16x32_bf16 v[72:75], v[4:7], v[148:151], v[72:75]
    v_mfma_f32_16x16x32_bf16 v[76:79], v[4:7], v[220:223], v[76:79]
    ds_read_b64_tr_b16 v[4:5], v1 offset:96
    ds_read_b64_tr_b16 v[6:7], v1 offset:4704
    s_waitcnt lgkmcnt(12)
    v_mfma_f32_16x16x32_bf16 v[80:83], v[8:11], v[148:151], v[80:83]
    v_mfma_f32_16x16x32_bf16 v[84:87], v[8:11], v[220:223], v[84:87]
    ds_read_b64_tr_b16 v[8:9], v1 offset:128
    ds_read_b64_tr_b16 v[10:11], v1 offset:4736
    s_waitcnt lgkmcnt(12)
    v_mfma_f32_16x16x32_bf16 v[88:91], v[12:15], v[148:151], v[88:91]
    v_mfma_f32_16x16x32_bf16 v[92:95], v[12:15], v[220:223], v[92:95]
    ds_read_b64_tr_b16 v[12:13], v1 offset:160
    ds_read_b64_tr_b16 v[14:15], v1 offset:4768
    s_waitcnt lgkmcnt(12)
    v_mfma_f32_16x16x32_bf16 v[96:99], v[16:19], v[148:151], v[96:99]
    v_mfma_f32_16x16x32_bf16 v[100:103], v[16:19], v[220:223], v[100:103]
    ds_read_b64_tr_b16 v[16:17], v1 offset:192
    ds_read_b64_tr_b16 v[18:19], v1 offset:4800
    s_waitcnt lgkmcnt(12)
    v_mfma_f32_16x16x32_bf16 v[32:35], v[20:23], v[152:155], v[32:35]
    v_mfma_f32_16x16x32_bf16 v[36:39], v[20:23], v[224:227], v[36:39]
    ds_read_b64_tr_b16 v[20:21], v1 offset:224
    ds_read_b64_tr_b16 v[22:23], v1 offset:4832
    s_waitcnt lgkmcnt(12)
    v_mfma_f32_16x16x32_bf16 v[40:43], v[24:27], v[152:155], v[40:43]
    v_mfma_f32_16x16x32_bf16 v[44:47], v[24:27], v[224:227], v[44:47]
    ds_read_b64_tr_b16 v[24:25], v1 offset:256
    ds_read_b64_tr_b16 v[26:27], v1 offset:4864
    s_waitcnt lgkmcnt(12)
    v_mfma_f32_16x16x32_bf16 v[48:51], v[28:31], v[152:155], v[48:51]
    v_mfma_f32_16x16x32_bf16 v[52:55], v[28:31], v[224:227], v[52:55]
    ds_read_b64_tr_b16 v[28:29], v1 offset:9216
    ds_read_b64_tr_b16 v[30:31], v1 offset:13824
    s_waitcnt lgkmcnt(12)
    v_mfma_f32_16x16x32_bf16 v[56:59], v[4:7], v[152:155], v[56:59]
    v_mfma_f32_16x16x32_bf16 v[60:63], v[4:7], v[224:227], v[60:63]
    ds_read_b64_tr_b16 v[4:5], v1 offset:9248
    ds_read_b64_tr_b16 v[6:7], v1 offset:13856
    s_waitcnt lgkmcnt(12)
    v_mfma_f32_16x16x32_bf16 v[64:67], v[8:11], v[152:155], v[64:67]
    v_mfma_f32_16x16x32_bf16 v[68:71], v[8:11], v[224:227], v[68:71]
    ds_read_b64_tr_b16 v[8:9], v1 offset:9280
    ds_read_b64_tr_b16 v[10:11], v1 offset:13888
    s_waitcnt lgkmcnt(12)
    v_mfma_f32_16x16x32_bf16 v[72:75], v[12:15], v[152:155], v[72:75]
    v_mfma_f32_16x16x32_bf16 v[76:79], v[12:15], v[224:227], v[76:79]
    ds_read_b64_tr_b16 v[12:13], v1 offset:9312
    ds_read_b64_tr_b16 v[14:15], v1 offset:13920
    s_waitcnt lgkmcnt(12)
    v_mfma_f32_16x16x32_bf16 v[80:83], v[16:19], v[152:155], v[80:83]
    v_mfma_f32_16x16x32_bf16 v[84:87], v[16:19], v[224:227], v[84:87]
    ds_read_b64_tr_b16 v[16:17], v1 offset:9344
    ds_read_b64_tr_b16 v[18:19], v1 offset:13952
    s_waitcnt lgkmcnt(12)
    v_mfma_f32_16x16x32_bf16 v[88:91], v[20:23], v[152:155], v[88:91]
    v_mfma_f32_16x16x32_bf16 v[92:95], v[20:23], v[224:227], v[92:95]
    ds_read_b64_tr_b16 v[20:21], v1 offset:9376
    ds_read_b64_tr_b16 v[22:23], v1 offset:13984
    s_waitcnt lgkmcnt(12)
    v_mfma_f32_16x16x32_bf16 v[96:99], v[24:27], v[152:155], v[96:99]
    v_mfma_f32_16x16x32_bf16 v[100:103], v[24:27], v[224:227], v[100:103]
    ds_read_b64_tr_b16 v[24:25], v1 offset:9408
    ds_read_b64_tr_b16 v[26:27], v1 offset:14016
    s_waitcnt lgkmcnt(12)
    v_mfma_f32_16x16x32_bf16 v[32:35], v[28:31], v[156:159], v[32:35]
    v_mfma_f32_16x16x32_bf16 v[36:39], v[28:31], v[228:231], v[36:39]
    ds_read_b64_tr_b16 v[28:29], v1 offset:9440
    ds_read_b64_tr_b16 v[30:31], v1 offset:14048
    s_waitcnt lgkmcnt(12)
    v_mfma_f32_16x16x32_bf16 v[40:43], v[4:7], v[156:159], v[40:43]
    v_mfma_f32_16x16x32_bf16 v[44:47], v[4:7], v[228:231], v[44:47]
    ds_read_b64_tr_b16 v[4:5], v1 offset:9472
    ds_read_b64_tr_b16 v[6:7], v1 offset:14080
    s_waitcnt lgkmcnt(12)
    v_mfma_f32_16x16x32_bf16 v[48:51], v[8:11], v[156:159], v[48:51]
    v_mfma_f32_16x16x32_bf16 v[52:55], v[8:11], v[228:231], v[52:55]
    v_add_u32 v1, 55296, v1
    ds_read_b64_tr_b16 v[8:9], v1 offset:0
    ds_read_b64_tr_b16 v[10:11], v1 offset:4608
    s_waitcnt lgkmcnt(12)
    v_mfma_f32_16x16x32_bf16 v[56:59], v[12:15], v[156:159], v[56:59]
    v_mfma_f32_16x16x32_bf16 v[60:63], v[12:15], v[228:231], v[60:63]
    ds_read_b64_tr_b16 v[12:13], v1 offset:32
    ds_read_b64_tr_b16 v[14:15], v1 offset:4640
    s_waitcnt lgkmcnt(12)
    v_mfma_f32_16x16x32_bf16 v[64:67], v[16:19], v[156:159], v[64:67]
    v_mfma_f32_16x16x32_bf16 v[68:71], v[16:19], v[228:231], v[68:71]
    ds_read_b64_tr_b16 v[16:17], v1 offset:64
    ds_read_b64_tr_b16 v[18:19], v1 offset:4672
    s_waitcnt lgkmcnt(12)
    v_mfma_f32_16x16x32_bf16 v[72:75], v[20:23], v[156:159], v[72:75]
    v_mfma_f32_16x16x32_bf16 v[76:79], v[20:23], v[228:231], v[76:79]
    ds_read_b64_tr_b16 v[20:21], v1 offset:96
    ds_read_b64_tr_b16 v[22:23], v1 offset:4704
    s_waitcnt lgkmcnt(12)
    v_mfma_f32_16x16x32_bf16 v[80:83], v[24:27], v[156:159], v[80:83]
    v_mfma_f32_16x16x32_bf16 v[84:87], v[24:27], v[228:231], v[84:87]
    ds_read_b64_tr_b16 v[24:25], v1 offset:128
    ds_read_b64_tr_b16 v[26:27], v1 offset:4736
    s_waitcnt lgkmcnt(12)
    v_mfma_f32_16x16x32_bf16 v[88:91], v[28:31], v[156:159], v[88:91]
    v_mfma_f32_16x16x32_bf16 v[92:95], v[28:31], v[228:231], v[92:95]
    ds_read_b64_tr_b16 v[28:29], v1 offset:160
    ds_read_b64_tr_b16 v[30:31], v1 offset:4768
    s_waitcnt lgkmcnt(12)
    v_mfma_f32_16x16x32_bf16 v[96:99], v[4:7], v[156:159], v[96:99]
    v_mfma_f32_16x16x32_bf16 v[100:103], v[4:7], v[228:231], v[100:103]
    ds_read_b64_tr_b16 v[4:5], v1 offset:192
    ds_read_b64_tr_b16 v[6:7], v1 offset:4800
    s_waitcnt lgkmcnt(12)
    v_mfma_f32_16x16x32_bf16 v[32:35], v[8:11], v[160:163], v[32:35]
    v_mfma_f32_16x16x32_bf16 v[36:39], v[8:11], v[232:235], v[36:39]
    ds_read_b64_tr_b16 v[8:9], v1 offset:224
    ds_read_b64_tr_b16 v[10:11], v1 offset:4832
    s_waitcnt lgkmcnt(12)
    v_mfma_f32_16x16x32_bf16 v[40:43], v[12:15], v[160:163], v[40:43]
    v_mfma_f32_16x16x32_bf16 v[44:47], v[12:15], v[232:235], v[44:47]
    ds_read_b64_tr_b16 v[12:13], v1 offset:256
    ds_read_b64_tr_b16 v[14:15], v1 offset:4864
    s_waitcnt lgkmcnt(12)
    v_mfma_f32_16x16x32_bf16 v[48:51], v[16:19], v[160:163], v[48:51]
    v_mfma_f32_16x16x32_bf16 v[52:55], v[16:19], v[232:235], v[52:55]
    ds_read_b64_tr_b16 v[16:17], v1 offset:9216
    ds_read_b64_tr_b16 v[18:19], v1 offset:13824
    s_waitcnt lgkmcnt(12)
    v_mfma_f32_16x16x32_bf16 v[56:59], v[20:23], v[160:163], v[56:59]
    v_mfma_f32_16x16x32_bf16 v[60:63], v[20:23], v[232:235], v[60:63]
    ds_read_b64_tr_b16 v[20:21], v1 offset:9248
    ds_read_b64_tr_b16 v[22:23], v1 offset:13856
    s_waitcnt lgkmcnt(12)
    v_mfma_f32_16x16x32_bf16 v[64:67], v[24:27], v[160:163], v[64:67]
    v_mfma_f32_16x16x32_bf16 v[68:71], v[24:27], v[232:235], v[68:71]
    ds_read_b64_tr_b16 v[24:25], v1 offset:9280
    ds_read_b64_tr_b16 v[26:27], v1 offset:13888
    s_waitcnt lgkmcnt(12)
    v_mfma_f32_16x16x32_bf16 v[72:75], v[28:31], v[160:163], v[72:75]
    v_mfma_f32_16x16x32_bf16 v[76:79], v[28:31], v[232:235], v[76:79]
    ds_read_b64_tr_b16 v[28:29], v1 offset:9312
    ds_read_b64_tr_b16 v[30:31], v1 offset:13920
    s_waitcnt lgkmcnt(12)
    v_mfma_f32_16x16x32_bf16 v[80:83], v[4:7], v[160:163], v[80:83]
    v_mfma_f32_16x16x32_bf16 v[84:87], v[4:7], v[232:235], v[84:87]
    ds_read_b64_tr_b16 v[4:5], v1 offset:9344
    ds_read_b64_tr_b16 v[6:7], v1 offset:13952
    s_waitcnt lgkmcnt(12)
    v_mfma_f32_16x16x32_bf16 v[88:91], v[8:11], v[160:163], v[88:91]
    v_mfma_f32_16x16x32_bf16 v[92:95], v[8:11], v[232:235], v[92:95]
    ds_read_b64_tr_b16 v[8:9], v1 offset:9376
    ds_read_b64_tr_b16 v[10:11], v1 offset:13984
    s_waitcnt lgkmcnt(12)
    v_mfma_f32_16x16x32_bf16 v[96:99], v[12:15], v[160:163], v[96:99]
    v_mfma_f32_16x16x32_bf16 v[100:103], v[12:15], v[232:235], v[100:103]
    ds_read_b64_tr_b16 v[12:13], v1 offset:9408
    ds_read_b64_tr_b16 v[14:15], v1 offset:14016
    s_waitcnt lgkmcnt(12)
    v_mfma_f32_16x16x32_bf16 v[32:35], v[16:19], v[164:167], v[32:35]
    v_mfma_f32_16x16x32_bf16 v[36:39], v[16:19], v[236:239], v[36:39]
    ds_read_b64_tr_b16 v[16:17], v1 offset:9440
    ds_read_b64_tr_b16 v[18:19], v1 offset:14048
    s_waitcnt lgkmcnt(12)
    v_mfma_f32_16x16x32_bf16 v[40:43], v[20:23], v[164:167], v[40:43]
    v_mfma_f32_16x16x32_bf16 v[44:47], v[20:23], v[236:239], v[44:47]
    ds_read_b64_tr_b16 v[20:21], v1 offset:9472
    ds_read_b64_tr_b16 v[22:23], v1 offset:14080
    s_waitcnt lgkmcnt(12)
    v_mfma_f32_16x16x32_bf16 v[48:51], v[24:27], v[164:167], v[48:51]
    v_mfma_f32_16x16x32_bf16 v[52:55], v[24:27], v[236:239], v[52:55]
    v_subrev_u32 v1, 18432, v1
    ds_read_b64_tr_b16 v[24:25], v1 offset:0
    ds_read_b64_tr_b16 v[26:27], v1 offset:4608
    s_waitcnt lgkmcnt(12)
    v_mfma_f32_16x16x32_bf16 v[56:59], v[28:31], v[164:167], v[56:59]
    v_mfma_f32_16x16x32_bf16 v[60:63], v[28:31], v[236:239], v[60:63]
    ds_read_b64_tr_b16 v[28:29], v1 offset:32
    ds_read_b64_tr_b16 v[30:31], v1 offset:4640
    s_waitcnt lgkmcnt(12)
    v_mfma_f32_16x16x32_bf16 v[64:67], v[4:7], v[164:167], v[64:67]
    v_mfma_f32_16x16x32_bf16 v[68:71], v[4:7], v[236:239], v[68:71]
    ds_read_b64_tr_b16 v[4:5], v1 offset:64
    ds_read_b64_tr_b16 v[6:7], v1 offset:4672
    s_waitcnt lgkmcnt(12)
    v_mfma_f32_16x16x32_bf16 v[72:75], v[8:11], v[164:167], v[72:75]
    v_mfma_f32_16x16x32_bf16 v[76:79], v[8:11], v[236:239], v[76:79]
    ds_read_b64_tr_b16 v[8:9], v1 offset:96
    ds_read_b64_tr_b16 v[10:11], v1 offset:4704
    s_waitcnt lgkmcnt(12)
    v_mfma_f32_16x16x32_bf16 v[80:83], v[12:15], v[164:167], v[80:83]
    v_mfma_f32_16x16x32_bf16 v[84:87], v[12:15], v[236:239], v[84:87]
    ds_read_b64_tr_b16 v[12:13], v1 offset:128
    ds_read_b64_tr_b16 v[14:15], v1 offset:4736
    s_waitcnt lgkmcnt(12)
    v_mfma_f32_16x16x32_bf16 v[88:91], v[16:19], v[164:167], v[88:91]
    v_mfma_f32_16x16x32_bf16 v[92:95], v[16:19], v[236:239], v[92:95]
    ds_read_b64_tr_b16 v[16:17], v1 offset:160
    ds_read_b64_tr_b16 v[18:19], v1 offset:4768
    s_waitcnt lgkmcnt(12)
    v_mfma_f32_16x16x32_bf16 v[96:99], v[20:23], v[164:167], v[96:99]
    v_mfma_f32_16x16x32_bf16 v[100:103], v[20:23], v[236:239], v[100:103]
    ds_read_b64_tr_b16 v[20:21], v1 offset:192
    ds_read_b64_tr_b16 v[22:23], v1 offset:4800
    s_waitcnt lgkmcnt(12)
    v_mfma_f32_16x16x32_bf16 v[32:35], v[24:27], v[168:171], v[32:35]
    v_mfma_f32_16x16x32_bf16 v[36:39], v[24:27], v[240:243], v[36:39]
    ds_read_b64_tr_b16 v[24:25], v1 offset:224
    ds_read_b64_tr_b16 v[26:27], v1 offset:4832
    s_waitcnt lgkmcnt(12)
    v_mfma_f32_16x16x32_bf16 v[40:43], v[28:31], v[168:171], v[40:43]
    v_mfma_f32_16x16x32_bf16 v[44:47], v[28:31], v[240:243], v[44:47]
    ds_read_b64_tr_b16 v[28:29], v1 offset:256
    ds_read_b64_tr_b16 v[30:31], v1 offset:4864
    s_waitcnt lgkmcnt(12)
    v_mfma_f32_16x16x32_bf16 v[48:51], v[4:7], v[168:171], v[48:51]
    v_mfma_f32_16x16x32_bf16 v[52:55], v[4:7], v[240:243], v[52:55]
    ds_read_b64_tr_b16 v[4:5], v1 offset:9216
    ds_read_b64_tr_b16 v[6:7], v1 offset:13824
    s_waitcnt lgkmcnt(12)
    v_mfma_f32_16x16x32_bf16 v[56:59], v[8:11], v[168:171], v[56:59]
    v_mfma_f32_16x16x32_bf16 v[60:63], v[8:11], v[240:243], v[60:63]
    ds_read_b64_tr_b16 v[8:9], v1 offset:9248
    ds_read_b64_tr_b16 v[10:11], v1 offset:13856
    s_waitcnt lgkmcnt(12)
    v_mfma_f32_16x16x32_bf16 v[64:67], v[12:15], v[168:171], v[64:67]
    v_mfma_f32_16x16x32_bf16 v[68:71], v[12:15], v[240:243], v[68:71]
    ds_read_b64_tr_b16 v[12:13], v1 offset:9280
    ds_read_b64_tr_b16 v[14:15], v1 offset:13888
    s_waitcnt lgkmcnt(12)
    v_mfma_f32_16x16x32_bf16 v[72:75], v[16:19], v[168:171], v[72:75]
    v_mfma_f32_16x16x32_bf16 v[76:79], v[16:19], v[240:243], v[76:79]
    ds_read_b64_tr_b16 v[16:17], v1 offset:9312
    ds_read_b64_tr_b16 v[18:19], v1 offset:13920
    s_waitcnt lgkmcnt(12)
    v_mfma_f32_16x16x32_bf16 v[80:83], v[20:23], v[168:171], v[80:83]
    v_mfma_f32_16x16x32_bf16 v[84:87], v[20:23], v[240:243], v[84:87]
    ds_read_b64_tr_b16 v[20:21], v1 offset:9344
    ds_read_b64_tr_b16 v[22:23], v1 offset:13952
    s_waitcnt lgkmcnt(12)
    v_mfma_f32_16x16x32_bf16 v[88:91], v[24:27], v[168:171], v[88:91]
    v_mfma_f32_16x16x32_bf16 v[92:95], v[24:27], v[240:243], v[92:95]
    ds_read_b64_tr_b16 v[24:25], v1 offset:9376
    ds_read_b64_tr_b16 v[26:27], v1 offset:13984
    s_waitcnt lgkmcnt(12)
    v_mfma_f32_16x16x32_bf16 v[96:99], v[28:31], v[168:171], v[96:99]
    v_mfma_f32_16x16x32_bf16 v[100:103], v[28:31], v[240:243], v[100:103]
    ds_read_b64_tr_b16 v[28:29], v1 offset:9408
    ds_read_b64_tr_b16 v[30:31], v1 offset:14016
    s_waitcnt lgkmcnt(12)
    v_mfma_f32_16x16x32_bf16 v[32:35], v[4:7], v[172:175], v[32:35]
    v_mfma_f32_16x16x32_bf16 v[36:39], v[4:7], v[244:247], v[36:39]
    ds_read_b64_tr_b16 v[4:5], v1 offset:9440
    ds_read_b64_tr_b16 v[6:7], v1 offset:14048
    s_waitcnt lgkmcnt(12)
    v_mfma_f32_16x16x32_bf16 v[40:43], v[8:11], v[172:175], v[40:43]
    v_mfma_f32_16x16x32_bf16 v[44:47], v[8:11], v[244:247], v[44:47]
    ds_read_b64_tr_b16 v[8:9], v1 offset:9472
    ds_read_b64_tr_b16 v[10:11], v1 offset:14080
    s_waitcnt lgkmcnt(12)
    v_mfma_f32_16x16x32_bf16 v[48:51], v[12:15], v[172:175], v[48:51]
    v_mfma_f32_16x16x32_bf16 v[52:55], v[12:15], v[244:247], v[52:55]
    s_waitcnt lgkmcnt(10)
    v_mfma_f32_16x16x32_bf16 v[56:59], v[16:19], v[172:175], v[56:59]
    v_mfma_f32_16x16x32_bf16 v[60:63], v[16:19], v[244:247], v[60:63]
    s_waitcnt lgkmcnt(8)
    v_mfma_f32_16x16x32_bf16 v[64:67], v[20:23], v[172:175], v[64:67]
    v_mfma_f32_16x16x32_bf16 v[68:71], v[20:23], v[244:247], v[68:71]
    s_waitcnt lgkmcnt(6)
    v_mfma_f32_16x16x32_bf16 v[72:75], v[24:27], v[172:175], v[72:75]
    v_mfma_f32_16x16x32_bf16 v[76:79], v[24:27], v[244:247], v[76:79]
    s_waitcnt lgkmcnt(4)
    v_mfma_f32_16x16x32_bf16 v[80:83], v[28:31], v[172:175], v[80:83]
    v_mfma_f32_16x16x32_bf16 v[84:87], v[28:31], v[244:247], v[84:87]
    s_waitcnt lgkmcnt(2)
    v_mfma_f32_16x16x32_bf16 v[88:91], v[4:7], v[172:175], v[88:91]
    v_mfma_f32_16x16x32_bf16 v[92:95], v[4:7], v[244:247], v[92:95]
    s_waitcnt lgkmcnt(0)
    v_mfma_f32_16x16x32_bf16 v[96:99], v[8:11], v[172:175], v[96:99]
    v_mfma_f32_16x16x32_bf16 v[100:103], v[8:11], v[244:247], v[100:103]
    s_barrier
    s_mul_i32 s52, s51, 9216
    s_add_u32 s52, s52, 126976
    v_add_u32 v3, s52, v2
    v_mov_b32 v4, 0xc0135761
    v_mul_f32 v8, v32, v32
    v_mul_f32 v9, v33, v33
    v_mul_f32 v10, v34, v34
    v_mul_f32 v11, v35, v35
    v_mul_f32 v12, v36, v36
    v_mul_f32 v13, v37, v37
    v_mul_f32 v14, v38, v38
    v_mul_f32 v15, v39, v39
    v_fmamk_f32 v8, v8, 0xbdd2d3e8, v4
    v_fmamk_f32 v9, v9, 0xbdd2d3e8, v4
    v_fmamk_f32 v10, v10, 0xbdd2d3e8, v4
    v_fmamk_f32 v11, v11, 0xbdd2d3e8, v4
    v_fmamk_f32 v12, v12, 0xbdd2d3e8, v4
    v_fmamk_f32 v13, v13, 0xbdd2d3e8, v4
    v_fmamk_f32 v14, v14, 0xbdd2d3e8, v4
    v_fmamk_f32 v15, v15, 0xbdd2d3e8, v4
    v_mul_f32 v8, v8, v32
    v_mul_f32 v9, v9, v33
    v_mul_f32 v10, v10, v34
    v_mul_f32 v11, v11, v35
    v_mul_f32 v12, v12, v36
    v_mul_f32 v13, v13, v37
    v_mul_f32 v14, v14, v38
    v_mul_f32 v15, v15, v39
    v_exp_f32 v8, v8
    v_exp_f32 v9, v9
    v_exp_f32 v10, v10
    v_exp_f32 v11, v11
    v_exp_f32 v12, v12
    v_exp_f32 v13, v13
    v_exp_f32 v14, v14
    v_exp_f32 v15, v15
    v_add_f32 v8, 1.0, v8
    v_add_f32 v9, 1.0, v9
    v_add_f32 v10, 1.0, v10
    v_add_f32 v11, 1.0, v11
    v_add_f32 v12, 1.0, v12
    v_add_f32 v13, 1.0, v13
    v_add_f32 v14, 1.0, v14
    v_add_f32 v15, 1.0, v15
    v_rcp_f32 v8, v8
    v_rcp_f32 v9, v9
    v_rcp_f32 v10, v10
    v_rcp_f32 v11, v11
    v_rcp_f32 v12, v12
    v_rcp_f32 v13, v13
    v_rcp_f32 v14, v14
    v_rcp_f32 v15, v15
    v_mul_f32 v32, v32, v8
    v_mul_f32 v33, v33, v9
    v_mul_f32 v34, v34, v10
    v_mul_f32 v35, v35, v11
    v_mul_f32 v36, v36, v12
    v_mul_f32 v37, v37, v13
    v_mul_f32 v38, v38, v14
    v_mul_f32 v39, v39, v15
    v_cvt_pk_bf16_f32 v32, v32, v33
    v_cvt_pk_bf16_f32 v33, v34, v35
    v_cvt_pk_bf16_f32 v34, v36, v37
    v_cvt_pk_bf16_f32 v35, v38, v39
    ds_write_b128 v3, v[32:35] offset:0
    v_mul_f32 v16, v40, v40
    v_mul_f32 v17, v41, v41
    v_mul_f32 v18, v42, v42
    v_mul_f32 v19, v43, v43
    v_mul_f32 v20, v44, v44
    v_mul_f32 v21, v45, v45
    v_mul_f32 v22, v46, v46
    v_mul_f32 v23, v47, v47
    v_fmamk_f32 v16, v16, 0xbdd2d3e8, v4
    v_fmamk_f32 v17, v17, 0xbdd2d3e8, v4
    v_fmamk_f32 v18, v18, 0xbdd2d3e8, v4
    v_fmamk_f32 v19, v19, 0xbdd2d3e8, v4
    v_fmamk_f32 v20, v20, 0xbdd2d3e8, v4
    v_fmamk_f32 v21, v21, 0xbdd2d3e8, v4
    v_fmamk_f32 v22, v22, 0xbdd2d3e8, v4
    v_fmamk_f32 v23, v23, 0xbdd2d3e8, v4
    v_mul_f32 v16, v16, v40
    v_mul_f32 v17, v17, v41
    v_mul_f32 v18, v18, v42
    v_mul_f32 v19, v19, v43
    v_mul_f32 v20, v20, v44
    v_mul_f32 v21, v21, v45
    v_mul_f32 v22, v22, v46
    v_mul_f32 v23, v23, v47
    v_exp_f32 v16, v16
    v_exp_f32 v17, v17
    v_exp_f32 v18, v18
    v_exp_f32 v19, v19
    v_exp_f32 v20, v20
    v_exp_f32 v21, v21
    v_exp_f32 v22, v22
    v_exp_f32 v23, v23
    v_add_f32 v16, 1.0, v16
    v_add_f32 v17, 1.0, v17
    v_add_f32 v18, 1.0, v18
    v_add_f32 v19, 1.0, v19
    v_add_f32 v20, 1.0, v20
    v_add_f32 v21, 1.0, v21
    v_add_f32 v22, 1.0, v22
    v_add_f32 v23, 1.0, v23
    v_rcp_f32 v16, v16
    v_rcp_f32 v17, v17
    v_rcp_f32 v18, v18
    v_rcp_f32 v19, v19
    v_rcp_f32 v20, v20
    v_rcp_f32 v21, v21
    v_rcp_f32 v22, v22
    v_rcp_f32 v23, v23
    v_mul_f32 v40, v40, v16
    v_mul_f32 v41, v41, v17
    v_mul_f32 v42, v42, v18
    v_mul_f32 v43, v43, v19
    v_mul_f32 v44, v44, v20
    v_mul_f32 v45, v45, v21
    v_mul_f32 v46, v46, v22
    v_mul_f32 v47, v47, v23
    v_cvt_pk_bf16_f32 v40, v40, v41
    v_cvt_pk_bf16_f32 v41, v42, v43
    v_cvt_pk_bf16_f32 v42, v44, v45
    v_cvt_pk_bf16_f32 v43, v46, v47
    ds_write_b128 v3, v[40:43] offset:1024
    v_mul_f32 v8, v48, v48
    v_mul_f32 v9, v49, v49
    v_mul_f32 v10, v50, v50
    v_mul_f32 v11, v51, v51
    v_mul_f32 v12, v52, v52
    v_mul_f32 v13, v53, v53
    v_mul_f32 v14, v54, v54
    v_mul_f32 v15, v55, v55
    v_fmamk_f32 v8, v8, 0xbdd2d3e8, v4
    v_fmamk_f32 v9, v9, 0xbdd2d3e8, v4
    v_fmamk_f32 v10, v10, 0xbdd2d3e8, v4
    v_fmamk_f32 v11, v11, 0xbdd2d3e8, v4
    v_fmamk_f32 v12, v12, 0xbdd2d3e8, v4
    v_fmamk_f32 v13, v13, 0xbdd2d3e8, v4
    v_fmamk_f32 v14, v14, 0xbdd2d3e8, v4
    v_fmamk_f32 v15, v15, 0xbdd2d3e8, v4
    v_mul_f32 v8, v8, v48
    v_mul_f32 v9, v9, v49
    v_mul_f32 v10, v10, v50
    v_mul_f32 v11, v11, v51
    v_mul_f32 v12, v12, v52
    v_mul_f32 v13, v13, v53
    v_mul_f32 v14, v14, v54
    v_mul_f32 v15, v15, v55
    v_exp_f32 v8, v8
    v_exp_f32 v9, v9
    v_exp_f32 v10, v10
    v_exp_f32 v11, v11
    v_exp_f32 v12, v12
    v_exp_f32 v13, v13
    v_exp_f32 v14, v14
    v_exp_f32 v15, v15
    v_add_f32 v8, 1.0, v8
    v_add_f32 v9, 1.0, v9
    v_add_f32 v10, 1.0, v10
    v_add_f32 v11, 1.0, v11
    v_add_f32 v12, 1.0, v12
    v_add_f32 v13, 1.0, v13
    v_add_f32 v14, 1.0, v14
    v_add_f32 v15, 1.0, v15
    v_rcp_f32 v8, v8
    v_rcp_f32 v9, v9
    v_rcp_f32 v10, v10
    v_rcp_f32 v11, v11
    v_rcp_f32 v12, v12
    v_rcp_f32 v13, v13
    v_rcp_f32 v14, v14
    v_rcp_f32 v15, v15
    v_mul_f32 v48, v48, v8
    v_mul_f32 v49, v49, v9
    v_mul_f32 v50, v50, v10
    v_mul_f32 v51, v51, v11
    v_mul_f32 v52, v52, v12
    v_mul_f32 v53, v53, v13
    v_mul_f32 v54, v54, v14
    v_mul_f32 v55, v55, v15
    v_cvt_pk_bf16_f32 v48, v48, v49
    v_cvt_pk_bf16_f32 v49, v50, v51
    v_cvt_pk_bf16_f32 v50, v52, v53
    v_cvt_pk_bf16_f32 v51, v54, v55
    ds_write_b128 v3, v[48:51] offset:2048
    v_mul_f32 v16, v56, v56
    v_mul_f32 v17, v57, v57
    v_mul_f32 v18, v58, v58
    v_mul_f32 v19, v59, v59
    v_mul_f32 v20, v60, v60
    v_mul_f32 v21, v61, v61
    v_mul_f32 v22, v62, v62
    v_mul_f32 v23, v63, v63
    v_fmamk_f32 v16, v16, 0xbdd2d3e8, v4
    v_fmamk_f32 v17, v17, 0xbdd2d3e8, v4
    v_fmamk_f32 v18, v18, 0xbdd2d3e8, v4
    v_fmamk_f32 v19, v19, 0xbdd2d3e8, v4
    v_fmamk_f32 v20, v20, 0xbdd2d3e8, v4
    v_fmamk_f32 v21, v21, 0xbdd2d3e8, v4
    v_fmamk_f32 v22, v22, 0xbdd2d3e8, v4
    v_fmamk_f32 v23, v23, 0xbdd2d3e8, v4
    v_mul_f32 v16, v16, v56
    v_mul_f32 v17, v17, v57
    v_mul_f32 v18, v18, v58
    v_mul_f32 v19, v19, v59
    v_mul_f32 v20, v20, v60
    v_mul_f32 v21, v21, v61
    v_mul_f32 v22, v22, v62
    v_mul_f32 v23, v23, v63
    v_exp_f32 v16, v16
    v_exp_f32 v17, v17
    v_exp_f32 v18, v18
    v_exp_f32 v19, v19
    v_exp_f32 v20, v20
    v_exp_f32 v21, v21
    v_exp_f32 v22, v22
    v_exp_f32 v23, v23
    v_add_f32 v16, 1.0, v16
    v_add_f32 v17, 1.0, v17
    v_add_f32 v18, 1.0, v18
    v_add_f32 v19, 1.0, v19
    v_add_f32 v20, 1.0, v20
    v_add_f32 v21, 1.0, v21
    v_add_f32 v22, 1.0, v22
    v_add_f32 v23, 1.0, v23
    v_rcp_f32 v16, v16
    v_rcp_f32 v17, v17
    v_rcp_f32 v18, v18
    v_rcp_f32 v19, v19
    v_rcp_f32 v20, v20
    v_rcp_f32 v21, v21
    v_rcp_f32 v22, v22
    v_rcp_f32 v23, v23
    v_mul_f32 v56, v56, v16
    v_mul_f32 v57, v57, v17
    v_mul_f32 v58, v58, v18
    v_mul_f32 v59, v59, v19
    v_mul_f32 v60, v60, v20
    v_mul_f32 v61, v61, v21
    v_mul_f32 v62, v62, v22
    v_mul_f32 v63, v63, v23
    v_cvt_pk_bf16_f32 v56, v56, v57
    v_cvt_pk_bf16_f32 v57, v58, v59
    v_cvt_pk_bf16_f32 v58, v60, v61
    v_cvt_pk_bf16_f32 v59, v62, v63
    ds_write_b128 v3, v[56:59] offset:3072
    v_mul_f32 v8, v64, v64
    v_mul_f32 v9, v65, v65
    v_mul_f32 v10, v66, v66
    v_mul_f32 v11, v67, v67
    v_mul_f32 v12, v68, v68
    v_mul_f32 v13, v69, v69
    v_mul_f32 v14, v70, v70
    v_mul_f32 v15, v71, v71
    v_fmamk_f32 v8, v8, 0xbdd2d3e8, v4
    v_fmamk_f32 v9, v9, 0xbdd2d3e8, v4
    v_fmamk_f32 v10, v10, 0xbdd2d3e8, v4
    v_fmamk_f32 v11, v11, 0xbdd2d3e8, v4
    v_fmamk_f32 v12, v12, 0xbdd2d3e8, v4
    v_fmamk_f32 v13, v13, 0xbdd2d3e8, v4
    v_fmamk_f32 v14, v14, 0xbdd2d3e8, v4
    v_fmamk_f32 v15, v15, 0xbdd2d3e8, v4
    v_mul_f32 v8, v8, v64
    v_mul_f32 v9, v9, v65
    v_mul_f32 v10, v10, v66
    v_mul_f32 v11, v11, v67
    v_mul_f32 v12, v12, v68
    v_mul_f32 v13, v13, v69
    v_mul_f32 v14, v14, v70
    v_mul_f32 v15, v15, v71
    v_exp_f32 v8, v8
    v_exp_f32 v9, v9
    v_exp_f32 v10, v10
    v_exp_f32 v11, v11
    v_exp_f32 v12, v12
    v_exp_f32 v13, v13
    v_exp_f32 v14, v14
    v_exp_f32 v15, v15
    v_add_f32 v8, 1.0, v8
    v_add_f32 v9, 1.0, v9
    v_add_f32 v10, 1.0, v10
    v_add_f32 v11, 1.0, v11
    v_add_f32 v12, 1.0, v12
    v_add_f32 v13, 1.0, v13
    v_add_f32 v14, 1.0, v14
    v_add_f32 v15, 1.0, v15
    v_rcp_f32 v8, v8
    v_rcp_f32 v9, v9
    v_rcp_f32 v10, v10
    v_rcp_f32 v11, v11
    v_rcp_f32 v12, v12
    v_rcp_f32 v13, v13
    v_rcp_f32 v14, v14
    v_rcp_f32 v15, v15
    v_mul_f32 v64, v64, v8
    v_mul_f32 v65, v65, v9
    v_mul_f32 v66, v66, v10
    v_mul_f32 v67, v67, v11
    v_mul_f32 v68, v68, v12
    v_mul_f32 v69, v69, v13
    v_mul_f32 v70, v70, v14
    v_mul_f32 v71, v71, v15
    v_cvt_pk_bf16_f32 v64, v64, v65
    v_cvt_pk_bf16_f32 v65, v66, v67
    v_cvt_pk_bf16_f32 v66, v68, v69
    v_cvt_pk_bf16_f32 v67, v70, v71
    ds_write_b128 v3, v[64:67] offset:4096
    v_mul_f32 v16, v72, v72
    v_mul_f32 v17, v73, v73
    v_mul_f32 v18, v74, v74
    v_mul_f32 v19, v75, v75
    v_mul_f32 v20, v76, v76
    v_mul_f32 v21, v77, v77
    v_mul_f32 v22, v78, v78
    v_mul_f32 v23, v79, v79
    v_fmamk_f32 v16, v16, 0xbdd2d3e8, v4
    v_fmamk_f32 v17, v17, 0xbdd2d3e8, v4
    v_fmamk_f32 v18, v18, 0xbdd2d3e8, v4
    v_fmamk_f32 v19, v19, 0xbdd2d3e8, v4
    v_fmamk_f32 v20, v20, 0xbdd2d3e8, v4
    v_fmamk_f32 v21, v21, 0xbdd2d3e8, v4
    v_fmamk_f32 v22, v22, 0xbdd2d3e8, v4
    v_fmamk_f32 v23, v23, 0xbdd2d3e8, v4
    v_mul_f32 v16, v16, v72
    v_mul_f32 v17, v17, v73
    v_mul_f32 v18, v18, v74
    v_mul_f32 v19, v19, v75
    v_mul_f32 v20, v20, v76
    v_mul_f32 v21, v21, v77
    v_mul_f32 v22, v22, v78
    v_mul_f32 v23, v23, v79
    v_exp_f32 v16, v16
    v_exp_f32 v17, v17
    v_exp_f32 v18, v18
    v_exp_f32 v19, v19
    v_exp_f32 v20, v20
    v_exp_f32 v21, v21
    v_exp_f32 v22, v22
    v_exp_f32 v23, v23
    v_add_f32 v16, 1.0, v16
    v_add_f32 v17, 1.0, v17
    v_add_f32 v18, 1.0, v18
    v_add_f32 v19, 1.0, v19
    v_add_f32 v20, 1.0, v20
    v_add_f32 v21, 1.0, v21
    v_add_f32 v22, 1.0, v22
    v_add_f32 v23, 1.0, v23
    v_rcp_f32 v16, v16
    v_rcp_f32 v17, v17
    v_rcp_f32 v18, v18
    v_rcp_f32 v19, v19
    v_rcp_f32 v20, v20
    v_rcp_f32 v21, v21
    v_rcp_f32 v22, v22
    v_rcp_f32 v23, v23
    v_mul_f32 v72, v72, v16
    v_mul_f32 v73, v73, v17
    v_mul_f32 v74, v74, v18
    v_mul_f32 v75, v75, v19
    v_mul_f32 v76, v76, v20
    v_mul_f32 v77, v77, v21
    v_mul_f32 v78, v78, v22
    v_mul_f32 v79, v79, v23
    v_cvt_pk_bf16_f32 v72, v72, v73
    v_cvt_pk_bf16_f32 v73, v74, v75
    v_cvt_pk_bf16_f32 v74, v76, v77
    v_cvt_pk_bf16_f32 v75, v78, v79
    ds_write_b128 v3, v[72:75] offset:5120
    v_mul_f32 v8, v80, v80
    v_mul_f32 v9, v81, v81
    v_mul_f32 v10, v82, v82
    v_mul_f32 v11, v83, v83
    v_mul_f32 v12, v84, v84
    v_mul_f32 v13, v85, v85
    v_mul_f32 v14, v86, v86
    v_mul_f32 v15, v87, v87
    v_fmamk_f32 v8, v8, 0xbdd2d3e8, v4
    v_fmamk_f32 v9, v9, 0xbdd2d3e8, v4
    v_fmamk_f32 v10, v10, 0xbdd2d3e8, v4
    v_fmamk_f32 v11, v11, 0xbdd2d3e8, v4
    v_fmamk_f32 v12, v12, 0xbdd2d3e8, v4
    v_fmamk_f32 v13, v13, 0xbdd2d3e8, v4
    v_fmamk_f32 v14, v14, 0xbdd2d3e8, v4
    v_fmamk_f32 v15, v15, 0xbdd2d3e8, v4
    v_mul_f32 v8, v8, v80
    v_mul_f32 v9, v9, v81
    v_mul_f32 v10, v10, v82
    v_mul_f32 v11, v11, v83
    v_mul_f32 v12, v12, v84
    v_mul_f32 v13, v13, v85
    v_mul_f32 v14, v14, v86
    v_mul_f32 v15, v15, v87
    v_exp_f32 v8, v8
    v_exp_f32 v9, v9
    v_exp_f32 v10, v10
    v_exp_f32 v11, v11
    v_exp_f32 v12, v12
    v_exp_f32 v13, v13
    v_exp_f32 v14, v14
    v_exp_f32 v15, v15
    v_add_f32 v8, 1.0, v8
    v_add_f32 v9, 1.0, v9
    v_add_f32 v10, 1.0, v10
    v_add_f32 v11, 1.0, v11
    v_add_f32 v12, 1.0, v12
    v_add_f32 v13, 1.0, v13
    v_add_f32 v14, 1.0, v14
    v_add_f32 v15, 1.0, v15
    v_rcp_f32 v8, v8
    v_rcp_f32 v9, v9
    v_rcp_f32 v10, v10
    v_rcp_f32 v11, v11
    v_rcp_f32 v12, v12
    v_rcp_f32 v13, v13
    v_rcp_f32 v14, v14
    v_rcp_f32 v15, v15
    v_mul_f32 v80, v80, v8
    v_mul_f32 v81, v81, v9
    v_mul_f32 v82, v82, v10
    v_mul_f32 v83, v83, v11
    v_mul_f32 v84, v84, v12
    v_mul_f32 v85, v85, v13
    v_mul_f32 v86, v86, v14
    v_mul_f32 v87, v87, v15
    v_cvt_pk_bf16_f32 v80, v80, v81
    v_cvt_pk_bf16_f32 v81, v82, v83
    v_cvt_pk_bf16_f32 v82, v84, v85
    v_cvt_pk_bf16_f32 v83, v86, v87
    ds_write_b128 v3, v[80:83] offset:6144
    v_mul_f32 v16, v88, v88
    v_mul_f32 v17, v89, v89
    v_mul_f32 v18, v90, v90
    v_mul_f32 v19, v91, v91
    v_mul_f32 v20, v92, v92
    v_mul_f32 v21, v93, v93
    v_mul_f32 v22, v94, v94
    v_mul_f32 v23, v95, v95
    v_fmamk_f32 v16, v16, 0xbdd2d3e8, v4
    v_fmamk_f32 v17, v17, 0xbdd2d3e8, v4
    v_fmamk_f32 v18, v18, 0xbdd2d3e8, v4
    v_fmamk_f32 v19, v19, 0xbdd2d3e8, v4
    v_fmamk_f32 v20, v20, 0xbdd2d3e8, v4
    v_fmamk_f32 v21, v21, 0xbdd2d3e8, v4
    v_fmamk_f32 v22, v22, 0xbdd2d3e8, v4
    v_fmamk_f32 v23, v23, 0xbdd2d3e8, v4
    v_mul_f32 v16, v16, v88
    v_mul_f32 v17, v17, v89
    v_mul_f32 v18, v18, v90
    v_mul_f32 v19, v19, v91
    v_mul_f32 v20, v20, v92
    v_mul_f32 v21, v21, v93
    v_mul_f32 v22, v22, v94
    v_mul_f32 v23, v23, v95
    v_exp_f32 v16, v16
    v_exp_f32 v17, v17
    v_exp_f32 v18, v18
    v_exp_f32 v19, v19
    v_exp_f32 v20, v20
    v_exp_f32 v21, v21
    v_exp_f32 v22, v22
    v_exp_f32 v23, v23
    v_add_f32 v16, 1.0, v16
    v_add_f32 v17, 1.0, v17
    v_add_f32 v18, 1.0, v18
    v_add_f32 v19, 1.0, v19
    v_add_f32 v20, 1.0, v20
    v_add_f32 v21, 1.0, v21
    v_add_f32 v22, 1.0, v22
    v_add_f32 v23, 1.0, v23
    v_rcp_f32 v16, v16
    v_rcp_f32 v17, v17
    v_rcp_f32 v18, v18
    v_rcp_f32 v19, v19
    v_rcp_f32 v20, v20
    v_rcp_f32 v21, v21
    v_rcp_f32 v22, v22
    v_rcp_f32 v23, v23
    v_mul_f32 v88, v88, v16
    v_mul_f32 v89, v89, v17
    v_mul_f32 v90, v90, v18
    v_mul_f32 v91, v91, v19
    v_mul_f32 v92, v92, v20
    v_mul_f32 v93, v93, v21
    v_mul_f32 v94, v94, v22
    v_mul_f32 v95, v95, v23
    v_cvt_pk_bf16_f32 v88, v88, v89
    v_cvt_pk_bf16_f32 v89, v90, v91
    v_cvt_pk_bf16_f32 v90, v92, v93
    v_cvt_pk_bf16_f32 v91, v94, v95
    ds_write_b128 v3, v[88:91] offset:7168
    v_mul_f32 v8, v96, v96
    v_mul_f32 v9, v97, v97
    v_mul_f32 v10, v98, v98
    v_mul_f32 v11, v99, v99
    v_mul_f32 v12, v100, v100
    v_mul_f32 v13, v101, v101
    v_mul_f32 v14, v102, v102
    v_mul_f32 v15, v103, v103
    v_fmamk_f32 v8, v8, 0xbdd2d3e8, v4
    v_fmamk_f32 v9, v9, 0xbdd2d3e8, v4
    v_fmamk_f32 v10, v10, 0xbdd2d3e8, v4
    v_fmamk_f32 v11, v11, 0xbdd2d3e8, v4
    v_fmamk_f32 v12, v12, 0xbdd2d3e8, v4
    v_fmamk_f32 v13, v13, 0xbdd2d3e8, v4
    v_fmamk_f32 v14, v14, 0xbdd2d3e8, v4
    v_fmamk_f32 v15, v15, 0xbdd2d3e8, v4
    v_mul_f32 v8, v8, v96
    v_mul_f32 v9, v9, v97
    v_mul_f32 v10, v10, v98
    v_mul_f32 v11, v11, v99
    v_mul_f32 v12, v12, v100
    v_mul_f32 v13, v13, v101
    v_mul_f32 v14, v14, v102
    v_mul_f32 v15, v15, v103
    v_exp_f32 v8, v8
    v_exp_f32 v9, v9
    v_exp_f32 v10, v10
    v_exp_f32 v11, v11
    v_exp_f32 v12, v12
    v_exp_f32 v13, v13
    v_exp_f32 v14, v14
    v_exp_f32 v15, v15
    v_add_f32 v8, 1.0, v8
    v_add_f32 v9, 1.0, v9
    v_add_f32 v10, 1.0, v10
    v_add_f32 v11, 1.0, v11
    v_add_f32 v12, 1.0, v12
    v_add_f32 v13, 1.0, v13
    v_add_f32 v14, 1.0, v14
    v_add_f32 v15, 1.0, v15
    v_rcp_f32 v8, v8
    v_rcp_f32 v9, v9
    v_rcp_f32 v10, v10
    v_rcp_f32 v11, v11
    v_rcp_f32 v12, v12
    v_rcp_f32 v13, v13
    v_rcp_f32 v14, v14
    v_rcp_f32 v15, v15
    v_mul_f32 v96, v96, v8
    v_mul_f32 v97, v97, v9
    v_mul_f32 v98, v98, v10
    v_mul_f32 v99, v99, v11
    v_mul_f32 v100, v100, v12
    v_mul_f32 v101, v101, v13
    v_mul_f32 v102, v102, v14
    v_mul_f32 v103, v103, v15
    v_cvt_pk_bf16_f32 v96, v96, v97
    v_cvt_pk_bf16_f32 v97, v98, v99
    v_cvt_pk_bf16_f32 v98, v100, v101
    v_cvt_pk_bf16_f32 v99, v102, v103
    ds_write_b128 v3, v[96:99] offset:8192
    s_load_dwordx2 s[12:13], s[0:1], 48
    s_getpc_b64 s[14:15]
L_pc_2:
    s_sub_u32 s14, s14, L_pc_2-recurrent_scan__sliding_local_dilated__mixer_gmlp__prompt_kernel
    s_subb_u32 s15, s15, 0
    s_lshr_b32 s52, s2, 3
    s_lshl_b32 s52, s52, 2
    s_add_u32 s52, s52, s51
    s_lshl_b32 s52, s52, 10
    s_min_u32 s52, s52, L_end-recurrent_scan__sliding_local_dilated__mixer_gmlp__prompt_kernel-1020
    v_lshlrev_b32 v4, 4, v0
    v_add_u32 v4, s52, v4
    global_load_dwordx4 v[248:251], v4, s[14:15]
    s_mov_b32 s32, s48
    s_mov_b32 s33, s49
    s_mov_b32 s34, s50
    s_add_u32 s72, s46, 41590784
    s_addc_u32 s73, s47, 0
    s_mov_b32 s74, 15360
    s_mov_b32 s75, 0x00020000
    s_and_b32 s38, s34, 1
    s_lshr_b32 s39, s34, 1
    v_and_b32 v1, 15, v0
    s_lshl_b32 s40, s32, 7
    s_lshl_b32 s41, s34, 5
    s_add_u32 s40, s40, s41
    v_add_u32 v7, s40, v1
    v_lshlrev_b32 v7, 1, v7
    v_lshrrev_b32 v3, 4, v0
    v_and_b32 v4, 7, v0
    v_xor_b32 v3, v3, v4
    v_lshlrev_b32 v3, 4, v3
    v_lshlrev_b32 v4, 7, v1
    v_add_u32 v3, v3, v4
    s_lshl_b32 s41, s34, 12
    v_add_u32 v1, s41, v3
    v_xor_b32 v2, 64, v1
    v_and_b32 v8, 3, v0
    v_lshlrev_b32 v3, 8, v8
    v_bfe_u32 v9, v0, 4, 1
    v_lshl_add_u32 v3, v9, 7, v3
    v_bfe_u32 v9, v0, 2, 2
    v_lshl_add_u32 v3, v9, 4, v3
    v_and_b32 v9, 1, v0
    v_lshl_add_u32 v3, v9, 6, v3
    v_lshrrev_b32 v9, 5, v0
    v_lshrrev_b32 v8, 1, v8
    v_xor_b32 v9, v9, v8
    v_lshl_add_u32 v3, v9, 3, v3
    v_add_u32 v3, 16384, v3
    v_xor_b32 v4, 64, v3
    s_waitcnt lgkmcnt(0)
    s_add_u32 s24, s46, 18874368
    s_addc_u32 s25, s47, 0
    s_mov_b32 s26, 11796480
    s_mov_b32 s27, 0x00020000
    s_mov_b32 s28, s12
    s_mov_b32 s29, s13
    s_mov_b32 s30, 4096
    s_mov_b32 s31, 0x00020000
    buffer_load_ushort v5, v7, s[28:31], 0 offen
    buffer_load_ushort v6, v7, s[28:31], 0 offen offset:32
    s_barrier
    ds_read_b64_tr_b16 v[16:17], v3 offset:0
    ds_read_b64_tr_b16 v[18:19], v4 offset:0
    ds_read_b128 v[8:11], v1 offset:0
    ds_read_b128 v[12:15], v1 offset:2048
    ds_read_b64_tr_b16 v[20:21], v3 offset:1024
    ds_read_b64_tr_b16 v[22:23], v4 offset:1024
    ds_read_b64_tr_b16 v[24:25], v3 offset:2048
    ds_read_b64_tr_b16 v[26:27], v4 offset:2048
    ds_read_b64_tr_b16 v[28:29], v3 offset:3072
    ds_read_b64_tr_b16 v[30:31], v4 offset:3072
    ds_read_b64_tr_b16 v[32:33], v3 offset:4096
    ds_read_b64_tr_b16 v[34:35], v4 offset:4096
    ds_read_b64_tr_b16 v[36:37], v3 offset:5120
    ds_read_b64_tr_b16 v[38:39], v4 offset:5120
    ds_read_b64_tr_b16 v[40:41], v3 offset:6144
    ds_read_b64_tr_b16 v[42:43], v4 offset:6144
    ds_read_b64_tr_b16 v[44:45], v3 offset:7168
    ds_read_b64_tr_b16 v[46:47], v4 offset:7168
    ds_read_b64_tr_b16 v[48:49], v3 offset:8192
    ds_read_b64_tr_b16 v[50:51], v4 offset:8192
    ds_read_b64_tr_b16 v[60:61], v3 offset:9216
    ds_read_b64_tr_b16 v[62:63], v4 offset:9216
    ds_read_b128 v[52:55], v2 offset:0
    ds_read_b128 v[56:59], v2 offset:2048
    ds_read_b64_tr_b16 v[64:65], v3 offset:10240
    ds_read_b64_tr_b16 v[66:67], v4 offset:10240
    ds_read_b64_tr_b16 v[68:69], v3 offset:11264
    ds_read_b64_tr_b16 v[70:71], v4 offset:11264
    ds_read_b64_tr_b16 v[72:73], v3 offset:12288
    ds_read_b64_tr_b16 v[74:75], v4 offset:12288
    ds_read_b64_tr_b16 v[76:77], v3 offset:13312
    ds_read_b64_tr_b16 v[78:79], v4 offset:13312
    ds_read_b64_tr_b16 v[80:81], v3 offset:14336
    ds_read_b64_tr_b16 v[82:83], v4 offset:14336
    ds_read_b64_tr_b16 v[84:85], v3 offset:15360
    ds_read_b64_tr_b16 v[86:87], v4 offset:15360
    ds_read_b64_tr_b16 v[88:89], v3 offset:16384
    ds_read_b64_tr_b16 v[90:91], v4 offset:16384
    ds_read_b64_tr_b16 v[92:93], v3 offset:17408
    ds_read_b64_tr_b16 v[94:95], v4 offset:17408
    s_waitcnt vmcnt(2) lgkmcnt(0)
    s_barrier
    s_mov_b32 s43, 0
    v_mfma_f32_16x16x32_bf16 v[184:187], v[16:19], v[8:11], 0
    ds_read_b64_tr_b16 v[104:105], v3 offset:34816
    ds_read_b64_tr_b16 v[106:107], v4 offset:34816
    v_mfma_f32_16x16x32_bf16 v[220:223], v[16:19], v[12:15], 0
    ds_read_b128 v[96:99], v1 offset:34816
    v_mfma_f32_16x16x32_bf16 v[188:191], v[20:23], v[8:11], 0
    ds_read_b128 v[100:103], v1 offset:36864
    v_mfma_f32_16x16x32_bf16 v[224:227], v[20:23], v[12:15], 0
    ds_read_b64_tr_b16 v[108:109], v3 offset:35840
    ds_read_b64_tr_b16 v[110:111], v4 offset:35840
    v_mfma_f32_16x16x32_bf16 v[192:195], v[24:27], v[8:11], 0
    ds_read_b64_tr_b16 v[112:113], v3 offset:36864
    v_mfma_f32_16x16x32_bf16 v[228:231], v[24:27], v[12:15], 0
    ds_read_b64_tr_b16 v[114:115], v4 offset:36864
    v_mfma_f32_16x16x32_bf16 v[196:199], v[28:31], v[8:11], 0
    ds_read_b64_tr_b16 v[116:117], v3 offset:37888
    ds_read_b64_tr_b16 v[118:119], v4 offset:37888
    v_mfma_f32_16x16x32_bf16 v[232:235], v[28:31], v[12:15], 0
    ds_read_b64_tr_b16 v[120:121], v3 offset:38912
    v_mfma_f32_16x16x32_bf16 v[200:203], v[32:35], v[8:11], 0
    ds_read_b64_tr_b16 v[122:123], v4 offset:38912
    v_mfma_f32_16x16x32_bf16 v[236:239], v[32:35], v[12:15], 0
    ds_read_b64_tr_b16 v[124:125], v3 offset:39936
    ds_read_b64_tr_b16 v[126:127], v4 offset:39936
    v_mfma_f32_16x16x32_bf16 v[204:207], v[36:39], v[8:11], 0
    ds_read_b64_tr_b16 v[128:129], v3 offset:40960
    v_mfma_f32_16x16x32_bf16 v[240:243], v[36:39], v[12:15], 0
    ds_read_b64_tr_b16 v[130:131], v4 offset:40960
    v_mfma_f32_16x16x32_bf16 v[208:211], v[40:43], v[8:11], 0
    ds_read_b64_tr_b16 v[132:133], v3 offset:41984
    ds_read_b64_tr_b16 v[134:135], v4 offset:41984
    v_mfma_f32_16x16x32_bf16 v[244:247], v[40:43], v[12:15], 0
    ds_read_b64_tr_b16 v[136:137], v3 offset:43008
    v_mfma_f32_16x16x32_bf16 v[212:215], v[44:47], v[8:11], 0
    ds_read_b64_tr_b16 v[138:139], v4 offset:43008
    v_mfma_f32_16x16x32_bf16 v[248:251], v[44:47], v[12:15], 0
    ds_read_b64_tr_b16 v[148:149], v3 offset:44032
    ds_read_b64_tr_b16 v[150:151], v4 offset:44032
    v_mfma_f32_16x16x32_bf16 v[216:219], v[48:51], v[8:11], 0
    ds_read_b128 v[140:143], v2 offset:34816
    v_mfma_f32_16x16x32_bf16 v[252:255], v[48:51], v[12:15], 0
    ds_read_b128 v[144:147], v2 offset:36864
    v_mfma_f32_16x16x32_bf16 v[184:187], v[60:63], v[52:55], v[184:187]
    ds_read_b64_tr_b16 v[152:153], v3 offset:45056
    ds_read_b64_tr_b16 v[154:155], v4 offset:45056
    v_mfma_f32_16x16x32_bf16 v[220:223], v[60:63], v[56:59], v[220:223]
    ds_read_b64_tr_b16 v[156:157], v3 offset:46080
    v_mfma_f32_16x16x32_bf16 v[188:191], v[64:67], v[52:55], v[188:191]
    ds_read_b64_tr_b16 v[158:159], v4 offset:46080
    v_mfma_f32_16x16x32_bf16 v[224:227], v[64:67], v[56:59], v[224:227]
    ds_read_b64_tr_b16 v[160:161], v3 offset:47104
    ds_read_b64_tr_b16 v[162:163], v4 offset:47104
    v_mfma_f32_16x16x32_bf16 v[192:195], v[68:71], v[52:55], v[192:195]
    ds_read_b64_tr_b16 v[164:165], v3 offset:48128
    v_mfma_f32_16x16x32_bf16 v[228:231], v[68:71], v[56:59], v[228:231]
    ds_read_b64_tr_b16 v[166:167], v4 offset:48128
    v_mfma_f32_16x16x32_bf16 v[196:199], v[72:75], v[52:55], v[196:199]
    ds_read_b64_tr_b16 v[168:169], v3 offset:49152
    ds_read_b64_tr_b16 v[170:171], v4 offset:49152
    v_mfma_f32_16x16x32_bf16 v[232:235], v[72:75], v[56:59], v[232:235]
    ds_read_b64_tr_b16 v[172:173], v3 offset:50176
    v_mfma_f32_16x16x32_bf16 v[200:203], v[76:79], v[52:55], v[200:203]
    ds_read_b64_tr_b16 v[174:175], v4 offset:50176
    v_mfma_f32_16x16x32_bf16 v[236:239], v[76:79], v[56:59], v[236:239]
    ds_read_b64_tr_b16 v[176:177], v3 offset:51200
    ds_read_b64_tr_b16 v[178:179], v4 offset:51200
    v_mfma_f32_16x16x32_bf16 v[204:207], v[80:83], v[52:55], v[204:207]
    ds_read_b64_tr_b16 v[180:181], v3 offset:52224
    v_mfma_f32_16x16x32_bf16 v[240:243], v[80:83], v[56:59], v[240:243]
    ds_read_b64_tr_b16 v[182:183], v4 offset:52224
    v_mfma_f32_16x16x32_bf16 v[208:211], v[84:87], v[52:55], v[208:211]
    v_add_u32 v1, 69632, v1
    v_add_u32 v2, 69632, v2
    v_mfma_f32_16x16x32_bf16 v[244:247], v[84:87], v[56:59], v[244:247]
    v_add_u32 v3, 69632, v3
    v_mfma_f32_16x16x32_bf16 v[212:215], v[88:91], v[52:55], v[212:215]
    v_add_u32 v4, 69632, v4
    v_mfma_f32_16x16x32_bf16 v[248:251], v[88:91], v[56:59], v[248:251]
    v_mfma_f32_16x16x32_bf16 v[216:219], v[92:95], v[52:55], v[216:219]
    v_mfma_f32_16x16x32_bf16 v[252:255], v[92:95], v[56:59], v[252:255]
    s_waitcnt lgkmcnt(0)
    s_barrier
    s_branch L_c1
.p2align 6
L_cloop:
    v_mfma_f32_16x16x32_bf16 v[184:187], v[16:19], v[8:11], v[184:187]
    ds_read_b64_tr_b16 v[104:105], v3 offset:34816
    ds_read_b64_tr_b16 v[106:107], v4 offset:34816
    v_mfma_f32_16x16x32_bf16 v[220:223], v[16:19], v[12:15], v[220:223]
    ds_read_b128 v[96:99], v1 offset:34816
    v_mfma_f32_16x16x32_bf16 v[188:191], v[20:23], v[8:11], v[188:191]
    ds_read_b128 v[100:103], v1 offset:36864
    v_mfma_f32_16x16x32_bf16 v[224:227], v[20:23], v[12:15], v[224:227]
    ds_read_b64_tr_b16 v[108:109], v3 offset:35840
    ds_read_b64_tr_b16 v[110:111], v4 offset:35840
    v_mfma_f32_16x16x32_bf16 v[192:195], v[24:27], v[8:11], v[192:195]
    ds_read_b64_tr_b16 v[112:113], v3 offset:36864
    v_mfma_f32_16x16x32_bf16 v[228:231], v[24:27], v[12:15], v[228:231]
    ds_read_b64_tr_b16 v[114:115], v4 offset:36864
    v_mfma_f32_16x16x32_bf16 v[196:199], v[28:31], v[8:11], v[196:199]
    ds_read_b64_tr_b16 v[116:117], v3 offset:37888
    ds_read_b64_tr_b16 v[118:119], v4 offset:37888
    v_mfma_f32_16x16x32_bf16 v[232:235], v[28:31], v[12:15], v[232:235]
    ds_read_b64_tr_b16 v[120:121], v3 offset:38912
    v_mfma_f32_16x16x32_bf16 v[200:203], v[32:35], v[8:11], v[200:203]
    ds_read_b64_tr_b16 v[122:123], v4 offset:38912
    v_mfma_f32_16x16x32_bf16 v[236:239], v[32:35], v[12:15], v[236:239]
    ds_read_b64_tr_b16 v[124:125], v3 offset:39936
    ds_read_b64_tr_b16 v[126:127], v4 offset:39936
    v_mfma_f32_16x16x32_bf16 v[204:207], v[36:39], v[8:11], v[204:207]
    ds_read_b64_tr_b16 v[128:129], v3 offset:40960
    v_mfma_f32_16x16x32_bf16 v[240:243], v[36:39], v[12:15], v[240:243]
    ds_read_b64_tr_b16 v[130:131], v4 offset:40960
    v_mfma_f32_16x16x32_bf16 v[208:211], v[40:43], v[8:11], v[208:211]
    ds_read_b64_tr_b16 v[132:133], v3 offset:41984
    ds_read_b64_tr_b16 v[134:135], v4 offset:41984
    v_mfma_f32_16x16x32_bf16 v[244:247], v[40:43], v[12:15], v[244:247]
    ds_read_b64_tr_b16 v[136:137], v3 offset:43008
    v_mfma_f32_16x16x32_bf16 v[212:215], v[44:47], v[8:11], v[212:215]
    ds_read_b64_tr_b16 v[138:139], v4 offset:43008
    v_mfma_f32_16x16x32_bf16 v[248:251], v[44:47], v[12:15], v[248:251]
    ds_read_b64_tr_b16 v[148:149], v3 offset:44032
    ds_read_b64_tr_b16 v[150:151], v4 offset:44032
    v_mfma_f32_16x16x32_bf16 v[216:219], v[48:51], v[8:11], v[216:219]
    ds_read_b128 v[140:143], v2 offset:34816
    v_mfma_f32_16x16x32_bf16 v[252:255], v[48:51], v[12:15], v[252:255]
    ds_read_b128 v[144:147], v2 offset:36864
    v_mfma_f32_16x16x32_bf16 v[184:187], v[60:63], v[52:55], v[184:187]
    ds_read_b64_tr_b16 v[152:153], v3 offset:45056
    ds_read_b64_tr_b16 v[154:155], v4 offset:45056
    v_mfma_f32_16x16x32_bf16 v[220:223], v[60:63], v[56:59], v[220:223]
    ds_read_b64_tr_b16 v[156:157], v3 offset:46080
    v_mfma_f32_16x16x32_bf16 v[188:191], v[64:67], v[52:55], v[188:191]
    ds_read_b64_tr_b16 v[158:159], v4 offset:46080
    v_mfma_f32_16x16x32_bf16 v[224:227], v[64:67], v[56:59], v[224:227]
    ds_read_b64_tr_b16 v[160:161], v3 offset:47104
    ds_read_b64_tr_b16 v[162:163], v4 offset:47104
    v_mfma_f32_16x16x32_bf16 v[192:195], v[68:71], v[52:55], v[192:195]
    ds_read_b64_tr_b16 v[164:165], v3 offset:48128
    v_mfma_f32_16x16x32_bf16 v[228:231], v[68:71], v[56:59], v[228:231]
    ds_read_b64_tr_b16 v[166:167], v4 offset:48128
    v_mfma_f32_16x16x32_bf16 v[196:199], v[72:75], v[52:55], v[196:199]
    ds_read_b64_tr_b16 v[168:169], v3 offset:49152
    ds_read_b64_tr_b16 v[170:171], v4 offset:49152
    v_mfma_f32_16x16x32_bf16 v[232:235], v[72:75], v[56:59], v[232:235]
    ds_read_b64_tr_b16 v[172:173], v3 offset:50176
    v_mfma_f32_16x16x32_bf16 v[200:203], v[76:79], v[52:55], v[200:203]
    ds_read_b64_tr_b16 v[174:175], v4 offset:50176
    v_mfma_f32_16x16x32_bf16 v[236:239], v[76:79], v[56:59], v[236:239]
    ds_read_b64_tr_b16 v[176:177], v3 offset:51200
    ds_read_b64_tr_b16 v[178:179], v4 offset:51200
    v_mfma_f32_16x16x32_bf16 v[204:207], v[80:83], v[52:55], v[204:207]
    ds_read_b64_tr_b16 v[180:181], v3 offset:52224
    v_mfma_f32_16x16x32_bf16 v[240:243], v[80:83], v[56:59], v[240:243]
    ds_read_b64_tr_b16 v[182:183], v4 offset:52224
    v_mfma_f32_16x16x32_bf16 v[208:211], v[84:87], v[52:55], v[208:211]
    v_add_u32 v1, 69632, v1
    v_add_u32 v2, 69632, v2
    v_mfma_f32_16x16x32_bf16 v[244:247], v[84:87], v[56:59], v[244:247]
    v_add_u32 v3, 69632, v3
    v_mfma_f32_16x16x32_bf16 v[212:215], v[88:91], v[52:55], v[212:215]
    v_add_u32 v4, 69632, v4
    v_mfma_f32_16x16x32_bf16 v[248:251], v[88:91], v[56:59], v[248:251]
    v_mfma_f32_16x16x32_bf16 v[216:219], v[92:95], v[52:55], v[216:219]
    v_mfma_f32_16x16x32_bf16 v[252:255], v[92:95], v[56:59], v[252:255]
    s_waitcnt lgkmcnt(0)
    s_barrier
L_c1:
    v_mfma_f32_16x16x32_bf16 v[184:187], v[104:107], v[96:99], v[184:187]
    ds_read_b64_tr_b16 v[16:17], v3 offset:0
    ds_read_b64_tr_b16 v[18:19], v4 offset:0
    v_mfma_f32_16x16x32_bf16 v[220:223], v[104:107], v[100:103], v[220:223]
    ds_read_b128 v[8:11], v1 offset:0
    v_mfma_f32_16x16x32_bf16 v[188:191], v[108:111], v[96:99], v[188:191]
    ds_read_b128 v[12:15], v1 offset:2048
    v_mfma_f32_16x16x32_bf16 v[224:227], v[108:111], v[100:103], v[224:227]
    ds_read_b64_tr_b16 v[20:21], v3 offset:1024
    ds_read_b64_tr_b16 v[22:23], v4 offset:1024
    v_mfma_f32_16x16x32_bf16 v[192:195], v[112:115], v[96:99], v[192:195]
    ds_read_b64_tr_b16 v[24:25], v3 offset:2048
    v_mfma_f32_16x16x32_bf16 v[228:231], v[112:115], v[100:103], v[228:231]
    ds_read_b64_tr_b16 v[26:27], v4 offset:2048
    v_mfma_f32_16x16x32_bf16 v[196:199], v[116:119], v[96:99], v[196:199]
    ds_read_b64_tr_b16 v[28:29], v3 offset:3072
    ds_read_b64_tr_b16 v[30:31], v4 offset:3072
    v_mfma_f32_16x16x32_bf16 v[232:235], v[116:119], v[100:103], v[232:235]
    ds_read_b64_tr_b16 v[32:33], v3 offset:4096
    v_mfma_f32_16x16x32_bf16 v[200:203], v[120:123], v[96:99], v[200:203]
    ds_read_b64_tr_b16 v[34:35], v4 offset:4096
    v_mfma_f32_16x16x32_bf16 v[236:239], v[120:123], v[100:103], v[236:239]
    ds_read_b64_tr_b16 v[36:37], v3 offset:5120
    ds_read_b64_tr_b16 v[38:39], v4 offset:5120
    v_mfma_f32_16x16x32_bf16 v[204:207], v[124:127], v[96:99], v[204:207]
    ds_read_b64_tr_b16 v[40:41], v3 offset:6144
    v_mfma_f32_16x16x32_bf16 v[240:243], v[124:127], v[100:103], v[240:243]
    ds_read_b64_tr_b16 v[42:43], v4 offset:6144
    v_mfma_f32_16x16x32_bf16 v[208:211], v[128:131], v[96:99], v[208:211]
    ds_read_b64_tr_b16 v[44:45], v3 offset:7168
    ds_read_b64_tr_b16 v[46:47], v4 offset:7168
    v_mfma_f32_16x16x32_bf16 v[244:247], v[128:131], v[100:103], v[244:247]
    ds_read_b64_tr_b16 v[48:49], v3 offset:8192
    v_mfma_f32_16x16x32_bf16 v[212:215], v[132:135], v[96:99], v[212:215]
    ds_read_b64_tr_b16 v[50:51], v4 offset:8192
    v_mfma_f32_16x16x32_bf16 v[248:251], v[132:135], v[100:103], v[248:251]
    ds_read_b64_tr_b16 v[60:61], v3 offset:9216
    ds_read_b64_tr_b16 v[62:63], v4 offset:9216
    v_mfma_f32_16x16x32_bf16 v[216:219], v[136:139], v[96:99], v[216:219]
    ds_read_b128 v[52:55], v2 offset:0
    v_mfma_f32_16x16x32_bf16 v[252:255], v[136:139], v[100:103], v[252:255]
    ds_read_b128 v[56:59], v2 offset:2048
    v_mfma_f32_16x16x32_bf16 v[184:187], v[148:151], v[140:143], v[184:187]
    ds_read_b64_tr_b16 v[64:65], v3 offset:10240
    ds_read_b64_tr_b16 v[66:67], v4 offset:10240
    v_mfma_f32_16x16x32_bf16 v[220:223], v[148:151], v[144:147], v[220:223]
    ds_read_b64_tr_b16 v[68:69], v3 offset:11264
    v_mfma_f32_16x16x32_bf16 v[188:191], v[152:155], v[140:143], v[188:191]
    ds_read_b64_tr_b16 v[70:71], v4 offset:11264
    v_mfma_f32_16x16x32_bf16 v[224:227], v[152:155], v[144:147], v[224:227]
    ds_read_b64_tr_b16 v[72:73], v3 offset:12288
    ds_read_b64_tr_b16 v[74:75], v4 offset:12288
    v_mfma_f32_16x16x32_bf16 v[192:195], v[156:159], v[140:143], v[192:195]
    ds_read_b64_tr_b16 v[76:77], v3 offset:13312
    v_mfma_f32_16x16x32_bf16 v[228:231], v[156:159], v[144:147], v[228:231]
    ds_read_b64_tr_b16 v[78:79], v4 offset:13312
    v_mfma_f32_16x16x32_bf16 v[196:199], v[160:163], v[140:143], v[196:199]
    ds_read_b64_tr_b16 v[80:81], v3 offset:14336
    ds_read_b64_tr_b16 v[82:83], v4 offset:14336
    v_mfma_f32_16x16x32_bf16 v[232:235], v[160:163], v[144:147], v[232:235]
    ds_read_b64_tr_b16 v[84:85], v3 offset:15360
    v_mfma_f32_16x16x32_bf16 v[200:203], v[164:167], v[140:143], v[200:203]
    ds_read_b64_tr_b16 v[86:87], v4 offset:15360
    v_mfma_f32_16x16x32_bf16 v[236:239], v[164:167], v[144:147], v[236:239]
    ds_read_b64_tr_b16 v[88:89], v3 offset:16384
    ds_read_b64_tr_b16 v[90:91], v4 offset:16384
    v_mfma_f32_16x16x32_bf16 v[204:207], v[168:171], v[140:143], v[204:207]
    ds_read_b64_tr_b16 v[92:93], v3 offset:17408
    v_mfma_f32_16x16x32_bf16 v[240:243], v[168:171], v[144:147], v[240:243]
    ds_read_b64_tr_b16 v[94:95], v4 offset:17408
    v_mfma_f32_16x16x32_bf16 v[208:211], v[172:175], v[140:143], v[208:211]
    v_mfma_f32_16x16x32_bf16 v[244:247], v[172:175], v[144:147], v[244:247]
    v_mfma_f32_16x16x32_bf16 v[212:215], v[176:179], v[140:143], v[212:215]
    v_mfma_f32_16x16x32_bf16 v[248:251], v[176:179], v[144:147], v[248:251]
    v_mfma_f32_16x16x32_bf16 v[216:219], v[180:183], v[140:143], v[216:219]
    v_mfma_f32_16x16x32_bf16 v[252:255], v[180:183], v[144:147], v[252:255]
    s_waitcnt lgkmcnt(0)
    s_barrier
    v_mfma_f32_16x16x32_bf16 v[184:187], v[16:19], v[8:11], v[184:187]
    ds_read_b64_tr_b16 v[104:105], v3 offset:34816
    ds_read_b64_tr_b16 v[106:107], v4 offset:34816
    v_mfma_f32_16x16x32_bf16 v[220:223], v[16:19], v[12:15], v[220:223]
    ds_read_b128 v[96:99], v1 offset:34816
    v_mfma_f32_16x16x32_bf16 v[188:191], v[20:23], v[8:11], v[188:191]
    ds_read_b128 v[100:103], v1 offset:36864
    v_mfma_f32_16x16x32_bf16 v[224:227], v[20:23], v[12:15], v[224:227]
    ds_read_b64_tr_b16 v[108:109], v3 offset:35840
    ds_read_b64_tr_b16 v[110:111], v4 offset:35840
    v_mfma_f32_16x16x32_bf16 v[192:195], v[24:27], v[8:11], v[192:195]
    ds_read_b64_tr_b16 v[112:113], v3 offset:36864
    v_mfma_f32_16x16x32_bf16 v[228:231], v[24:27], v[12:15], v[228:231]
    ds_read_b64_tr_b16 v[114:115], v4 offset:36864
    v_mfma_f32_16x16x32_bf16 v[196:199], v[28:31], v[8:11], v[196:199]
    ds_read_b64_tr_b16 v[116:117], v3 offset:37888
    ds_read_b64_tr_b16 v[118:119], v4 offset:37888
    v_mfma_f32_16x16x32_bf16 v[232:235], v[28:31], v[12:15], v[232:235]
    ds_read_b64_tr_b16 v[120:121], v3 offset:38912
    v_mfma_f32_16x16x32_bf16 v[200:203], v[32:35], v[8:11], v[200:203]
    ds_read_b64_tr_b16 v[122:123], v4 offset:38912
    v_mfma_f32_16x16x32_bf16 v[236:239], v[32:35], v[12:15], v[236:239]
    ds_read_b64_tr_b16 v[124:125], v3 offset:39936
    ds_read_b64_tr_b16 v[126:127], v4 offset:39936
    v_mfma_f32_16x16x32_bf16 v[204:207], v[36:39], v[8:11], v[204:207]
    ds_read_b64_tr_b16 v[128:129], v3 offset:40960
    v_mfma_f32_16x16x32_bf16 v[240:243], v[36:39], v[12:15], v[240:243]
    ds_read_b64_tr_b16 v[130:131], v4 offset:40960
    v_mfma_f32_16x16x32_bf16 v[208:211], v[40:43], v[8:11], v[208:211]
    ds_read_b64_tr_b16 v[132:133], v3 offset:41984
    ds_read_b64_tr_b16 v[134:135], v4 offset:41984
    v_mfma_f32_16x16x32_bf16 v[244:247], v[40:43], v[12:15], v[244:247]
    ds_read_b64_tr_b16 v[136:137], v3 offset:43008
    v_mfma_f32_16x16x32_bf16 v[212:215], v[44:47], v[8:11], v[212:215]
    ds_read_b64_tr_b16 v[138:139], v4 offset:43008
    v_mfma_f32_16x16x32_bf16 v[248:251], v[44:47], v[12:15], v[248:251]
    ds_read_b64_tr_b16 v[148:149], v3 offset:44032
    ds_read_b64_tr_b16 v[150:151], v4 offset:44032
    v_mfma_f32_16x16x32_bf16 v[216:219], v[48:51], v[8:11], v[216:219]
    ds_read_b128 v[140:143], v2 offset:34816
    v_mfma_f32_16x16x32_bf16 v[252:255], v[48:51], v[12:15], v[252:255]
    ds_read_b128 v[144:147], v2 offset:36864
    v_mfma_f32_16x16x32_bf16 v[184:187], v[60:63], v[52:55], v[184:187]
    ds_read_b64_tr_b16 v[152:153], v3 offset:45056
    ds_read_b64_tr_b16 v[154:155], v4 offset:45056
    v_mfma_f32_16x16x32_bf16 v[220:223], v[60:63], v[56:59], v[220:223]
    ds_read_b64_tr_b16 v[156:157], v3 offset:46080
    v_mfma_f32_16x16x32_bf16 v[188:191], v[64:67], v[52:55], v[188:191]
    ds_read_b64_tr_b16 v[158:159], v4 offset:46080
    v_mfma_f32_16x16x32_bf16 v[224:227], v[64:67], v[56:59], v[224:227]
    ds_read_b64_tr_b16 v[160:161], v3 offset:47104
    ds_read_b64_tr_b16 v[162:163], v4 offset:47104
    v_mfma_f32_16x16x32_bf16 v[192:195], v[68:71], v[52:55], v[192:195]
    ds_read_b64_tr_b16 v[164:165], v3 offset:48128
    v_mfma_f32_16x16x32_bf16 v[228:231], v[68:71], v[56:59], v[228:231]
    ds_read_b64_tr_b16 v[166:167], v4 offset:48128
    v_mfma_f32_16x16x32_bf16 v[196:199], v[72:75], v[52:55], v[196:199]
    ds_read_b64_tr_b16 v[168:169], v3 offset:49152
    ds_read_b64_tr_b16 v[170:171], v4 offset:49152
    v_mfma_f32_16x16x32_bf16 v[232:235], v[72:75], v[56:59], v[232:235]
    ds_read_b64_tr_b16 v[172:173], v3 offset:50176
    v_mfma_f32_16x16x32_bf16 v[200:203], v[76:79], v[52:55], v[200:203]
    ds_read_b64_tr_b16 v[174:175], v4 offset:50176
    v_mfma_f32_16x16x32_bf16 v[236:239], v[76:79], v[56:59], v[236:239]
    ds_read_b64_tr_b16 v[176:177], v3 offset:51200
    ds_read_b64_tr_b16 v[178:179], v4 offset:51200
    v_mfma_f32_16x16x32_bf16 v[204:207], v[80:83], v[52:55], v[204:207]
    ds_read_b64_tr_b16 v[180:181], v3 offset:52224
    v_mfma_f32_16x16x32_bf16 v[240:243], v[80:83], v[56:59], v[240:243]
    ds_read_b64_tr_b16 v[182:183], v4 offset:52224
    v_mfma_f32_16x16x32_bf16 v[208:211], v[84:87], v[52:55], v[208:211]
    v_subrev_u32 v1, 69632, v1
    v_subrev_u32 v2, 69632, v2
    v_mfma_f32_16x16x32_bf16 v[244:247], v[84:87], v[56:59], v[244:247]
    v_subrev_u32 v3, 69632, v3
    v_mfma_f32_16x16x32_bf16 v[212:215], v[88:91], v[52:55], v[212:215]
    v_subrev_u32 v4, 69632, v4
    v_mfma_f32_16x16x32_bf16 v[248:251], v[88:91], v[56:59], v[248:251]
    v_mfma_f32_16x16x32_bf16 v[216:219], v[92:95], v[52:55], v[216:219]
    v_mfma_f32_16x16x32_bf16 v[252:255], v[92:95], v[56:59], v[252:255]
    s_waitcnt lgkmcnt(0)
    s_barrier
    v_mfma_f32_16x16x32_bf16 v[184:187], v[104:107], v[96:99], v[184:187]
    ds_read_b64_tr_b16 v[16:17], v3 offset:0
    ds_read_b64_tr_b16 v[18:19], v4 offset:0
    v_mfma_f32_16x16x32_bf16 v[220:223], v[104:107], v[100:103], v[220:223]
    ds_read_b128 v[8:11], v1 offset:0
    v_mfma_f32_16x16x32_bf16 v[188:191], v[108:111], v[96:99], v[188:191]
    ds_read_b128 v[12:15], v1 offset:2048
    v_mfma_f32_16x16x32_bf16 v[224:227], v[108:111], v[100:103], v[224:227]
    ds_read_b64_tr_b16 v[20:21], v3 offset:1024
    ds_read_b64_tr_b16 v[22:23], v4 offset:1024
    v_mfma_f32_16x16x32_bf16 v[192:195], v[112:115], v[96:99], v[192:195]
    ds_read_b64_tr_b16 v[24:25], v3 offset:2048
    v_mfma_f32_16x16x32_bf16 v[228:231], v[112:115], v[100:103], v[228:231]
    ds_read_b64_tr_b16 v[26:27], v4 offset:2048
    v_mfma_f32_16x16x32_bf16 v[196:199], v[116:119], v[96:99], v[196:199]
    ds_read_b64_tr_b16 v[28:29], v3 offset:3072
    ds_read_b64_tr_b16 v[30:31], v4 offset:3072
    v_mfma_f32_16x16x32_bf16 v[232:235], v[116:119], v[100:103], v[232:235]
    ds_read_b64_tr_b16 v[32:33], v3 offset:4096
    v_mfma_f32_16x16x32_bf16 v[200:203], v[120:123], v[96:99], v[200:203]
    ds_read_b64_tr_b16 v[34:35], v4 offset:4096
    v_mfma_f32_16x16x32_bf16 v[236:239], v[120:123], v[100:103], v[236:239]
    ds_read_b64_tr_b16 v[36:37], v3 offset:5120
    ds_read_b64_tr_b16 v[38:39], v4 offset:5120
    v_mfma_f32_16x16x32_bf16 v[204:207], v[124:127], v[96:99], v[204:207]
    ds_read_b64_tr_b16 v[40:41], v3 offset:6144
    v_mfma_f32_16x16x32_bf16 v[240:243], v[124:127], v[100:103], v[240:243]
    ds_read_b64_tr_b16 v[42:43], v4 offset:6144
    v_mfma_f32_16x16x32_bf16 v[208:211], v[128:131], v[96:99], v[208:211]
    ds_read_b64_tr_b16 v[44:45], v3 offset:7168
    ds_read_b64_tr_b16 v[46:47], v4 offset:7168
    v_mfma_f32_16x16x32_bf16 v[244:247], v[128:131], v[100:103], v[244:247]
    ds_read_b64_tr_b16 v[48:49], v3 offset:8192
    v_mfma_f32_16x16x32_bf16 v[212:215], v[132:135], v[96:99], v[212:215]
    ds_read_b64_tr_b16 v[50:51], v4 offset:8192
    v_mfma_f32_16x16x32_bf16 v[248:251], v[132:135], v[100:103], v[248:251]
    ds_read_b64_tr_b16 v[60:61], v3 offset:9216
    ds_read_b64_tr_b16 v[62:63], v4 offset:9216
    v_mfma_f32_16x16x32_bf16 v[216:219], v[136:139], v[96:99], v[216:219]
    ds_read_b128 v[52:55], v2 offset:0
    v_mfma_f32_16x16x32_bf16 v[252:255], v[136:139], v[100:103], v[252:255]
    ds_read_b128 v[56:59], v2 offset:2048
    v_mfma_f32_16x16x32_bf16 v[184:187], v[148:151], v[140:143], v[184:187]
    ds_read_b64_tr_b16 v[64:65], v3 offset:10240
    ds_read_b64_tr_b16 v[66:67], v4 offset:10240
    v_mfma_f32_16x16x32_bf16 v[220:223], v[148:151], v[144:147], v[220:223]
    ds_read_b64_tr_b16 v[68:69], v3 offset:11264
    v_mfma_f32_16x16x32_bf16 v[188:191], v[152:155], v[140:143], v[188:191]
    ds_read_b64_tr_b16 v[70:71], v4 offset:11264
    v_mfma_f32_16x16x32_bf16 v[224:227], v[152:155], v[144:147], v[224:227]
    ds_read_b64_tr_b16 v[72:73], v3 offset:12288
    ds_read_b64_tr_b16 v[74:75], v4 offset:12288
    v_mfma_f32_16x16x32_bf16 v[192:195], v[156:159], v[140:143], v[192:195]
    ds_read_b64_tr_b16 v[76:77], v3 offset:13312
    v_mfma_f32_16x16x32_bf16 v[228:231], v[156:159], v[144:147], v[228:231]
    ds_read_b64_tr_b16 v[78:79], v4 offset:13312
    v_mfma_f32_16x16x32_bf16 v[196:199], v[160:163], v[140:143], v[196:199]
    ds_read_b64_tr_b16 v[80:81], v3 offset:14336
    ds_read_b64_tr_b16 v[82:83], v4 offset:14336
    v_mfma_f32_16x16x32_bf16 v[232:235], v[160:163], v[144:147], v[232:235]
    ds_read_b64_tr_b16 v[84:85], v3 offset:15360
    v_mfma_f32_16x16x32_bf16 v[200:203], v[164:167], v[140:143], v[200:203]
    ds_read_b64_tr_b16 v[86:87], v4 offset:15360
    v_mfma_f32_16x16x32_bf16 v[236:239], v[164:167], v[144:147], v[236:239]
    ds_read_b64_tr_b16 v[88:89], v3 offset:16384
    ds_read_b64_tr_b16 v[90:91], v4 offset:16384
    v_mfma_f32_16x16x32_bf16 v[204:207], v[168:171], v[140:143], v[204:207]
    ds_read_b64_tr_b16 v[92:93], v3 offset:17408
    v_mfma_f32_16x16x32_bf16 v[240:243], v[168:171], v[144:147], v[240:243]
    ds_read_b64_tr_b16 v[94:95], v4 offset:17408
    v_mfma_f32_16x16x32_bf16 v[208:211], v[172:175], v[140:143], v[208:211]
    v_mfma_f32_16x16x32_bf16 v[244:247], v[172:175], v[144:147], v[244:247]
    v_mfma_f32_16x16x32_bf16 v[212:215], v[176:179], v[140:143], v[212:215]
    v_mfma_f32_16x16x32_bf16 v[248:251], v[176:179], v[144:147], v[248:251]
    v_mfma_f32_16x16x32_bf16 v[216:219], v[180:183], v[140:143], v[216:219]
    v_mfma_f32_16x16x32_bf16 v[252:255], v[180:183], v[144:147], v[252:255]
    s_add_u32 s43, s43, 1
    s_cmp_lt_u32 s43, 7
    s_waitcnt lgkmcnt(0)
    s_barrier
    s_cbranch_scc1 L_cloop
    v_mfma_f32_16x16x32_bf16 v[184:187], v[16:19], v[8:11], v[184:187]
    ds_read_b64_tr_b16 v[104:105], v3 offset:34816
    ds_read_b64_tr_b16 v[106:107], v4 offset:34816
    v_mfma_f32_16x16x32_bf16 v[220:223], v[16:19], v[12:15], v[220:223]
    ds_read_b128 v[96:99], v1 offset:34816
    v_mfma_f32_16x16x32_bf16 v[188:191], v[20:23], v[8:11], v[188:191]
    ds_read_b128 v[100:103], v1 offset:36864
    v_mfma_f32_16x16x32_bf16 v[224:227], v[20:23], v[12:15], v[224:227]
    ds_read_b64_tr_b16 v[108:109], v3 offset:35840
    ds_read_b64_tr_b16 v[110:111], v4 offset:35840
    v_mfma_f32_16x16x32_bf16 v[192:195], v[24:27], v[8:11], v[192:195]
    ds_read_b64_tr_b16 v[112:113], v3 offset:36864
    v_mfma_f32_16x16x32_bf16 v[228:231], v[24:27], v[12:15], v[228:231]
    ds_read_b64_tr_b16 v[114:115], v4 offset:36864
    v_mfma_f32_16x16x32_bf16 v[196:199], v[28:31], v[8:11], v[196:199]
    ds_read_b64_tr_b16 v[116:117], v3 offset:37888
    ds_read_b64_tr_b16 v[118:119], v4 offset:37888
    v_mfma_f32_16x16x32_bf16 v[232:235], v[28:31], v[12:15], v[232:235]
    ds_read_b64_tr_b16 v[120:121], v3 offset:38912
    v_mfma_f32_16x16x32_bf16 v[200:203], v[32:35], v[8:11], v[200:203]
    ds_read_b64_tr_b16 v[122:123], v4 offset:38912
    v_mfma_f32_16x16x32_bf16 v[236:239], v[32:35], v[12:15], v[236:239]
    ds_read_b64_tr_b16 v[124:125], v3 offset:39936
    ds_read_b64_tr_b16 v[126:127], v4 offset:39936
    v_mfma_f32_16x16x32_bf16 v[204:207], v[36:39], v[8:11], v[204:207]
    ds_read_b64_tr_b16 v[128:129], v3 offset:40960
    v_mfma_f32_16x16x32_bf16 v[240:243], v[36:39], v[12:15], v[240:243]
    ds_read_b64_tr_b16 v[130:131], v4 offset:40960
    v_mfma_f32_16x16x32_bf16 v[208:211], v[40:43], v[8:11], v[208:211]
    ds_read_b64_tr_b16 v[132:133], v3 offset:41984
    ds_read_b64_tr_b16 v[134:135], v4 offset:41984
    v_mfma_f32_16x16x32_bf16 v[244:247], v[40:43], v[12:15], v[244:247]
    ds_read_b64_tr_b16 v[136:137], v3 offset:43008
    v_mfma_f32_16x16x32_bf16 v[212:215], v[44:47], v[8:11], v[212:215]
    ds_read_b64_tr_b16 v[138:139], v4 offset:43008
    v_mfma_f32_16x16x32_bf16 v[248:251], v[44:47], v[12:15], v[248:251]
    ds_read_b64_tr_b16 v[148:149], v3 offset:44032
    ds_read_b64_tr_b16 v[150:151], v4 offset:44032
    v_mfma_f32_16x16x32_bf16 v[216:219], v[48:51], v[8:11], v[216:219]
    ds_read_b128 v[140:143], v2 offset:34816
    v_mfma_f32_16x16x32_bf16 v[252:255], v[48:51], v[12:15], v[252:255]
    ds_read_b128 v[144:147], v2 offset:36864
    v_mfma_f32_16x16x32_bf16 v[184:187], v[60:63], v[52:55], v[184:187]
    ds_read_b64_tr_b16 v[152:153], v3 offset:45056
    ds_read_b64_tr_b16 v[154:155], v4 offset:45056
    v_mfma_f32_16x16x32_bf16 v[220:223], v[60:63], v[56:59], v[220:223]
    ds_read_b64_tr_b16 v[156:157], v3 offset:46080
    v_mfma_f32_16x16x32_bf16 v[188:191], v[64:67], v[52:55], v[188:191]
    ds_read_b64_tr_b16 v[158:159], v4 offset:46080
    v_mfma_f32_16x16x32_bf16 v[224:227], v[64:67], v[56:59], v[224:227]
    ds_read_b64_tr_b16 v[160:161], v3 offset:47104
    ds_read_b64_tr_b16 v[162:163], v4 offset:47104
    v_mfma_f32_16x16x32_bf16 v[192:195], v[68:71], v[52:55], v[192:195]
    ds_read_b64_tr_b16 v[164:165], v3 offset:48128
    v_mfma_f32_16x16x32_bf16 v[228:231], v[68:71], v[56:59], v[228:231]
    ds_read_b64_tr_b16 v[166:167], v4 offset:48128
    v_mfma_f32_16x16x32_bf16 v[196:199], v[72:75], v[52:55], v[196:199]
    ds_read_b64_tr_b16 v[168:169], v3 offset:49152
    ds_read_b64_tr_b16 v[170:171], v4 offset:49152
    v_mfma_f32_16x16x32_bf16 v[232:235], v[72:75], v[56:59], v[232:235]
    ds_read_b64_tr_b16 v[172:173], v3 offset:50176
    v_mfma_f32_16x16x32_bf16 v[200:203], v[76:79], v[52:55], v[200:203]
    ds_read_b64_tr_b16 v[174:175], v4 offset:50176
    v_mfma_f32_16x16x32_bf16 v[236:239], v[76:79], v[56:59], v[236:239]
    ds_read_b64_tr_b16 v[176:177], v3 offset:51200
    ds_read_b64_tr_b16 v[178:179], v4 offset:51200
    v_mfma_f32_16x16x32_bf16 v[204:207], v[80:83], v[52:55], v[204:207]
    ds_read_b64_tr_b16 v[180:181], v3 offset:52224
    v_mfma_f32_16x16x32_bf16 v[240:243], v[80:83], v[56:59], v[240:243]
    ds_read_b64_tr_b16 v[182:183], v4 offset:52224
    v_mfma_f32_16x16x32_bf16 v[208:211], v[84:87], v[52:55], v[208:211]
    v_add_u32 v1, 69632, v1
    v_add_u32 v2, 69632, v2
    v_mfma_f32_16x16x32_bf16 v[244:247], v[84:87], v[56:59], v[244:247]
    v_add_u32 v3, 69632, v3
    v_mfma_f32_16x16x32_bf16 v[212:215], v[88:91], v[52:55], v[212:215]
    v_add_u32 v4, 69632, v4
    v_mfma_f32_16x16x32_bf16 v[248:251], v[88:91], v[56:59], v[248:251]
    v_mfma_f32_16x16x32_bf16 v[216:219], v[92:95], v[52:55], v[216:219]
    v_mfma_f32_16x16x32_bf16 v[252:255], v[92:95], v[56:59], v[252:255]
    s_waitcnt lgkmcnt(0)
    s_barrier
    v_mfma_f32_16x16x32_bf16 v[184:187], v[104:107], v[96:99], v[184:187]
    ds_read_b64_tr_b16 v[16:17], v3 offset:0
    ds_read_b64_tr_b16 v[18:19], v4 offset:0
    v_mfma_f32_16x16x32_bf16 v[220:223], v[104:107], v[100:103], v[220:223]
    ds_read_b128 v[8:11], v1 offset:0
    v_mfma_f32_16x16x32_bf16 v[188:191], v[108:111], v[96:99], v[188:191]
    ds_read_b128 v[12:15], v1 offset:2048
    v_mfma_f32_16x16x32_bf16 v[224:227], v[108:111], v[100:103], v[224:227]
    ds_read_b64_tr_b16 v[20:21], v3 offset:1024
    ds_read_b64_tr_b16 v[22:23], v4 offset:1024
    v_mfma_f32_16x16x32_bf16 v[192:195], v[112:115], v[96:99], v[192:195]
    ds_read_b64_tr_b16 v[24:25], v3 offset:2048
    v_mfma_f32_16x16x32_bf16 v[228:231], v[112:115], v[100:103], v[228:231]
    ds_read_b64_tr_b16 v[26:27], v4 offset:2048
    v_mfma_f32_16x16x32_bf16 v[196:199], v[116:119], v[96:99], v[196:199]
    ds_read_b64_tr_b16 v[28:29], v3 offset:3072
    ds_read_b64_tr_b16 v[30:31], v4 offset:3072
    v_mfma_f32_16x16x32_bf16 v[232:235], v[116:119], v[100:103], v[232:235]
    ds_read_b64_tr_b16 v[32:33], v3 offset:4096
    v_mfma_f32_16x16x32_bf16 v[200:203], v[120:123], v[96:99], v[200:203]
    ds_read_b64_tr_b16 v[34:35], v4 offset:4096
    v_mfma_f32_16x16x32_bf16 v[236:239], v[120:123], v[100:103], v[236:239]
    ds_read_b64_tr_b16 v[36:37], v3 offset:5120
    ds_read_b64_tr_b16 v[38:39], v4 offset:5120
    v_mfma_f32_16x16x32_bf16 v[204:207], v[124:127], v[96:99], v[204:207]
    ds_read_b64_tr_b16 v[40:41], v3 offset:6144
    v_mfma_f32_16x16x32_bf16 v[240:243], v[124:127], v[100:103], v[240:243]
    ds_read_b64_tr_b16 v[42:43], v4 offset:6144
    v_mfma_f32_16x16x32_bf16 v[208:211], v[128:131], v[96:99], v[208:211]
    ds_read_b64_tr_b16 v[44:45], v3 offset:7168
    ds_read_b64_tr_b16 v[46:47], v4 offset:7168
    v_mfma_f32_16x16x32_bf16 v[244:247], v[128:131], v[100:103], v[244:247]
    ds_read_b64_tr_b16 v[48:49], v3 offset:8192
    v_mfma_f32_16x16x32_bf16 v[212:215], v[132:135], v[96:99], v[212:215]
    ds_read_b64_tr_b16 v[50:51], v4 offset:8192
    v_mfma_f32_16x16x32_bf16 v[248:251], v[132:135], v[100:103], v[248:251]
    ds_read_b64_tr_b16 v[60:61], v3 offset:9216
    ds_read_b64_tr_b16 v[62:63], v4 offset:9216
    v_mfma_f32_16x16x32_bf16 v[216:219], v[136:139], v[96:99], v[216:219]
    ds_read_b128 v[52:55], v2 offset:0
    v_mfma_f32_16x16x32_bf16 v[252:255], v[136:139], v[100:103], v[252:255]
    ds_read_b128 v[56:59], v2 offset:2048
    v_mfma_f32_16x16x32_bf16 v[184:187], v[148:151], v[140:143], v[184:187]
    ds_read_b64_tr_b16 v[64:65], v3 offset:10240
    ds_read_b64_tr_b16 v[66:67], v4 offset:10240
    v_mfma_f32_16x16x32_bf16 v[220:223], v[148:151], v[144:147], v[220:223]
    ds_read_b64_tr_b16 v[68:69], v3 offset:11264
    v_mfma_f32_16x16x32_bf16 v[188:191], v[152:155], v[140:143], v[188:191]
    ds_read_b64_tr_b16 v[70:71], v4 offset:11264
    v_mfma_f32_16x16x32_bf16 v[224:227], v[152:155], v[144:147], v[224:227]
    ds_read_b64_tr_b16 v[72:73], v3 offset:12288
    ds_read_b64_tr_b16 v[74:75], v4 offset:12288
    v_mfma_f32_16x16x32_bf16 v[192:195], v[156:159], v[140:143], v[192:195]
    ds_read_b64_tr_b16 v[76:77], v3 offset:13312
    v_mfma_f32_16x16x32_bf16 v[228:231], v[156:159], v[144:147], v[228:231]
    ds_read_b64_tr_b16 v[78:79], v4 offset:13312
    v_mfma_f32_16x16x32_bf16 v[196:199], v[160:163], v[140:143], v[196:199]
    ds_read_b64_tr_b16 v[80:81], v3 offset:14336
    ds_read_b64_tr_b16 v[82:83], v4 offset:14336
    v_mfma_f32_16x16x32_bf16 v[232:235], v[160:163], v[144:147], v[232:235]
    ds_read_b64_tr_b16 v[84:85], v3 offset:15360
    v_mfma_f32_16x16x32_bf16 v[200:203], v[164:167], v[140:143], v[200:203]
    ds_read_b64_tr_b16 v[86:87], v4 offset:15360
    v_mfma_f32_16x16x32_bf16 v[236:239], v[164:167], v[144:147], v[236:239]
    ds_read_b64_tr_b16 v[88:89], v3 offset:16384
    ds_read_b64_tr_b16 v[90:91], v4 offset:16384
    v_mfma_f32_16x16x32_bf16 v[204:207], v[168:171], v[140:143], v[204:207]
    ds_read_b64_tr_b16 v[92:93], v3 offset:17408
    v_mfma_f32_16x16x32_bf16 v[240:243], v[168:171], v[144:147], v[240:243]
    ds_read_b64_tr_b16 v[94:95], v4 offset:17408
    v_mfma_f32_16x16x32_bf16 v[208:211], v[172:175], v[140:143], v[208:211]
    v_mfma_f32_16x16x32_bf16 v[244:247], v[172:175], v[144:147], v[244:247]
    v_mfma_f32_16x16x32_bf16 v[212:215], v[176:179], v[140:143], v[212:215]
    v_mfma_f32_16x16x32_bf16 v[248:251], v[176:179], v[144:147], v[248:251]
    v_mfma_f32_16x16x32_bf16 v[216:219], v[180:183], v[140:143], v[216:219]
    v_mfma_f32_16x16x32_bf16 v[252:255], v[180:183], v[144:147], v[252:255]
    s_waitcnt lgkmcnt(0)
    s_barrier
    v_mfma_f32_16x16x32_bf16 v[184:187], v[16:19], v[8:11], v[184:187]
    ds_read_b64_tr_b16 v[104:105], v3 offset:34816
    ds_read_b64_tr_b16 v[106:107], v4 offset:34816
    v_mfma_f32_16x16x32_bf16 v[220:223], v[16:19], v[12:15], v[220:223]
    ds_read_b128 v[96:99], v1 offset:34816
    v_mfma_f32_16x16x32_bf16 v[188:191], v[20:23], v[8:11], v[188:191]
    ds_read_b128 v[100:103], v1 offset:36864
    v_mfma_f32_16x16x32_bf16 v[224:227], v[20:23], v[12:15], v[224:227]
    ds_read_b64_tr_b16 v[108:109], v3 offset:35840
    ds_read_b64_tr_b16 v[110:111], v4 offset:35840
    v_mfma_f32_16x16x32_bf16 v[192:195], v[24:27], v[8:11], v[192:195]
    ds_read_b64_tr_b16 v[112:113], v3 offset:36864
    v_mfma_f32_16x16x32_bf16 v[228:231], v[24:27], v[12:15], v[228:231]
    ds_read_b64_tr_b16 v[114:115], v4 offset:36864
    v_mfma_f32_16x16x32_bf16 v[196:199], v[28:31], v[8:11], v[196:199]
    ds_read_b64_tr_b16 v[116:117], v3 offset:37888
    ds_read_b64_tr_b16 v[118:119], v4 offset:37888
    v_mfma_f32_16x16x32_bf16 v[232:235], v[28:31], v[12:15], v[232:235]
    ds_read_b64_tr_b16 v[120:121], v3 offset:38912
    v_mfma_f32_16x16x32_bf16 v[200:203], v[32:35], v[8:11], v[200:203]
    ds_read_b64_tr_b16 v[122:123], v4 offset:38912
    v_mfma_f32_16x16x32_bf16 v[236:239], v[32:35], v[12:15], v[236:239]
    ds_read_b64_tr_b16 v[124:125], v3 offset:39936
    ds_read_b64_tr_b16 v[126:127], v4 offset:39936
    v_mfma_f32_16x16x32_bf16 v[204:207], v[36:39], v[8:11], v[204:207]
    ds_read_b64_tr_b16 v[128:129], v3 offset:40960
    v_mfma_f32_16x16x32_bf16 v[240:243], v[36:39], v[12:15], v[240:243]
    ds_read_b64_tr_b16 v[130:131], v4 offset:40960
    v_mfma_f32_16x16x32_bf16 v[208:211], v[40:43], v[8:11], v[208:211]
    ds_read_b64_tr_b16 v[132:133], v3 offset:41984
    ds_read_b64_tr_b16 v[134:135], v4 offset:41984
    v_mfma_f32_16x16x32_bf16 v[244:247], v[40:43], v[12:15], v[244:247]
    ds_read_b64_tr_b16 v[136:137], v3 offset:43008
    v_mfma_f32_16x16x32_bf16 v[212:215], v[44:47], v[8:11], v[212:215]
    ds_read_b64_tr_b16 v[138:139], v4 offset:43008
    v_mfma_f32_16x16x32_bf16 v[248:251], v[44:47], v[12:15], v[248:251]
    ds_read_b64_tr_b16 v[148:149], v3 offset:44032
    ds_read_b64_tr_b16 v[150:151], v4 offset:44032
    v_mfma_f32_16x16x32_bf16 v[216:219], v[48:51], v[8:11], v[216:219]
    ds_read_b128 v[140:143], v2 offset:34816
    v_mfma_f32_16x16x32_bf16 v[252:255], v[48:51], v[12:15], v[252:255]
    ds_read_b128 v[144:147], v2 offset:36864
    v_mfma_f32_16x16x32_bf16 v[184:187], v[60:63], v[52:55], v[184:187]
    ds_read_b64_tr_b16 v[152:153], v3 offset:45056
    ds_read_b64_tr_b16 v[154:155], v4 offset:45056
    v_mfma_f32_16x16x32_bf16 v[220:223], v[60:63], v[56:59], v[220:223]
    ds_read_b64_tr_b16 v[156:157], v3 offset:46080
    v_mfma_f32_16x16x32_bf16 v[188:191], v[64:67], v[52:55], v[188:191]
    ds_read_b64_tr_b16 v[158:159], v4 offset:46080
    v_mfma_f32_16x16x32_bf16 v[224:227], v[64:67], v[56:59], v[224:227]
    ds_read_b64_tr_b16 v[160:161], v3 offset:47104
    ds_read_b64_tr_b16 v[162:163], v4 offset:47104
    v_mfma_f32_16x16x32_bf16 v[192:195], v[68:71], v[52:55], v[192:195]
    ds_read_b64_tr_b16 v[164:165], v3 offset:48128
    v_mfma_f32_16x16x32_bf16 v[228:231], v[68:71], v[56:59], v[228:231]
    ds_read_b64_tr_b16 v[166:167], v4 offset:48128
    v_mfma_f32_16x16x32_bf16 v[196:199], v[72:75], v[52:55], v[196:199]
    ds_read_b64_tr_b16 v[168:169], v3 offset:49152
    ds_read_b64_tr_b16 v[170:171], v4 offset:49152
    v_mfma_f32_16x16x32_bf16 v[232:235], v[72:75], v[56:59], v[232:235]
    ds_read_b64_tr_b16 v[172:173], v3 offset:50176
    v_mfma_f32_16x16x32_bf16 v[200:203], v[76:79], v[52:55], v[200:203]
    ds_read_b64_tr_b16 v[174:175], v4 offset:50176
    v_mfma_f32_16x16x32_bf16 v[236:239], v[76:79], v[56:59], v[236:239]
    ds_read_b64_tr_b16 v[176:177], v3 offset:51200
    ds_read_b64_tr_b16 v[178:179], v4 offset:51200
    v_mfma_f32_16x16x32_bf16 v[204:207], v[80:83], v[52:55], v[204:207]
    ds_read_b64_tr_b16 v[180:181], v3 offset:52224
    v_mfma_f32_16x16x32_bf16 v[240:243], v[80:83], v[56:59], v[240:243]
    ds_read_b64_tr_b16 v[182:183], v4 offset:52224
    v_mfma_f32_16x16x32_bf16 v[208:211], v[84:87], v[52:55], v[208:211]
    v_subrev_u32 v1, 69632, v1
    v_subrev_u32 v2, 69632, v2
    v_mfma_f32_16x16x32_bf16 v[244:247], v[84:87], v[56:59], v[244:247]
    v_subrev_u32 v3, 69632, v3
    v_mfma_f32_16x16x32_bf16 v[212:215], v[88:91], v[52:55], v[212:215]
    v_subrev_u32 v4, 69632, v4
    v_mfma_f32_16x16x32_bf16 v[248:251], v[88:91], v[56:59], v[248:251]
    v_mfma_f32_16x16x32_bf16 v[216:219], v[92:95], v[52:55], v[216:219]
    v_mfma_f32_16x16x32_bf16 v[252:255], v[92:95], v[56:59], v[252:255]
    s_waitcnt lgkmcnt(0)
    s_barrier
    v_lshlrev_b32 v7, 4, v0
    s_mul_i32 s42, s34, 9216
    v_add_u32 v1, s42, v7
    v_mov_b32 v2, 163832
    ds_read_b32 v2, v2
    ds_read_b128 v[56:59], v1 offset:0
    ds_read_b128 v[60:63], v1 offset:1024
    ds_read_b128 v[64:67], v1 offset:2048
    ds_read_b128 v[68:71], v1 offset:3072
    ds_read_b128 v[72:75], v1 offset:4096
    ds_read_b128 v[76:79], v1 offset:5120
    ds_read_b128 v[80:83], v1 offset:6144
    ds_read_b128 v[84:87], v1 offset:7168
    ds_read_b128 v[88:91], v1 offset:8192
    v_mfma_f32_16x16x32_bf16 v[184:187], v[104:107], v[96:99], v[184:187]
    s_lshl_b32 s49, s32, 4
    s_add_u32 s49, s49, s33
    s_lshl_b32 s49, s49, 2
    s_add_u32 s49, s49, s34
    s_lshl_b32 s49, s49, 2
    s_add_u32 s49, s49, 11264
    s_lshl_b32 s36, s32, 3
    v_mfma_f32_16x16x32_bf16 v[220:223], v[104:107], v[100:103], v[220:223]
    s_lshl_b32 s37, s34, 1
    s_add_u32 s36, s36, s37
    s_mul_i32 s36, s36, 90
    s_add_u32 s36, s36, 18
    s_lshl_b32 s36, s36, 10
    s_lshl_b32 s44, s33, 12
    s_add_u32 s44, s44, s36
    v_mfma_f32_16x16x32_bf16 v[184:187], v[148:151], v[140:143], v[184:187]
    s_lshl_b32 s45, s33, 9
    s_add_u32 s45, s45, s36
    s_add_u32 s45, s45, 0x10000
    v_add_u32 v3, s44, v7
    v_lshlrev_b32 v4, 3, v0
    v_add_u32 v4, s45, v4
    s_mov_b32 s48, 0xffff0000
    v_mfma_f32_16x16x32_bf16 v[220:223], v[148:151], v[144:147], v[220:223]
    s_mov_b32 s37, 92160
    s_waitcnt vmcnt(0)
    v_lshlrev_b32 v5, 16, v5
    v_lshlrev_b32 v6, 16, v6
    v_mfma_f32_16x16x32_bf16 v[188:191], v[108:111], v[96:99], v[188:191]
    s_waitcnt lgkmcnt(8)
    v_lshlrev_b32 v8, 16, v56
    v_and_b32 v9, s48, v56
    v_lshlrev_b32 v10, 16, v57
    v_and_b32 v11, s48, v57
    v_add_f32 v184, v5, v184
    v_add_f32 v185, v5, v185
    v_add_f32 v186, v5, v186
    v_mfma_f32_16x16x32_bf16 v[224:227], v[108:111], v[100:103], v[224:227]
    v_add_f32 v187, v5, v187
    v_mul_f32 v184, v184, v8
    v_mul_f32 v185, v185, v9
    v_mul_f32 v186, v186, v10
    v_mul_f32 v187, v187, v11
    v_cvt_pk_bf16_f32 v16, v184, v185
    v_cvt_pk_bf16_f32 v17, v186, v187
    v_lshlrev_b32 v12, 16, v58
    v_mfma_f32_16x16x32_bf16 v[188:191], v[152:155], v[140:143], v[188:191]
    v_and_b32 v13, s48, v58
    v_lshlrev_b32 v14, 16, v59
    v_and_b32 v15, s48, v59
    v_add_f32 v220, v6, v220
    v_add_f32 v221, v6, v221
    v_add_f32 v222, v6, v222
    v_add_f32 v223, v6, v223
    v_mul_f32 v220, v220, v12
    v_mfma_f32_16x16x32_bf16 v[224:227], v[152:155], v[144:147], v[224:227]
    v_mul_f32 v221, v221, v13
    v_mul_f32 v222, v222, v14
    v_mul_f32 v223, v223, v15
    v_cvt_pk_bf16_f32 v20, v220, v221
    v_cvt_pk_bf16_f32 v21, v222, v223
    v_mfma_f32_16x16x32_bf16 v[192:195], v[112:115], v[96:99], v[192:195]
    s_waitcnt lgkmcnt(7)
    v_lshlrev_b32 v8, 16, v60
    v_and_b32 v9, s48, v60
    v_lshlrev_b32 v10, 16, v61
    v_and_b32 v11, s48, v61
    v_add_f32 v188, v5, v188
    v_add_f32 v189, v5, v189
    v_add_f32 v190, v5, v190
    v_mfma_f32_16x16x32_bf16 v[228:231], v[112:115], v[100:103], v[228:231]
    v_add_f32 v191, v5, v191
    v_mul_f32 v188, v188, v8
    v_mul_f32 v189, v189, v9
    v_mul_f32 v190, v190, v10
    v_mul_f32 v191, v191, v11
    v_cvt_pk_bf16_f32 v18, v188, v189
    v_cvt_pk_bf16_f32 v19, v190, v191
    buffer_store_dwordx4 v[16:19], v3, s[24:27], 0 offen offset:0 sc1
    v_mfma_f32_16x16x32_bf16 v[192:195], v[156:159], v[140:143], v[192:195]
    v_lshlrev_b32 v12, 16, v62
    v_and_b32 v13, s48, v62
    v_lshlrev_b32 v14, 16, v63
    v_and_b32 v15, s48, v63
    v_add_f32 v224, v6, v224
    v_add_f32 v225, v6, v225
    v_add_f32 v226, v6, v226
    v_add_f32 v227, v6, v227
    v_mfma_f32_16x16x32_bf16 v[228:231], v[156:159], v[144:147], v[228:231]
    v_mul_f32 v224, v224, v12
    v_mul_f32 v225, v225, v13
    v_mul_f32 v226, v226, v14
    v_mul_f32 v227, v227, v15
    v_cvt_pk_bf16_f32 v22, v224, v225
    v_cvt_pk_bf16_f32 v23, v226, v227
    buffer_store_dwordx4 v[20:23], v3, s[24:27], s37 offen offset:0 sc1
    v_mfma_f32_16x16x32_bf16 v[196:199], v[116:119], v[96:99], v[196:199]
    s_waitcnt lgkmcnt(6)
    v_lshlrev_b32 v8, 16, v64
    v_and_b32 v9, s48, v64
    v_lshlrev_b32 v10, 16, v65
    v_and_b32 v11, s48, v65
    v_add_f32 v192, v5, v192
    v_add_f32 v193, v5, v193
    v_add_f32 v194, v5, v194
    v_mfma_f32_16x16x32_bf16 v[232:235], v[116:119], v[100:103], v[232:235]
    v_add_f32 v195, v5, v195
    v_mul_f32 v192, v192, v8
    v_mul_f32 v193, v193, v9
    v_mul_f32 v194, v194, v10
    v_mul_f32 v195, v195, v11
    v_cvt_pk_bf16_f32 v24, v192, v193
    v_cvt_pk_bf16_f32 v25, v194, v195
    v_lshlrev_b32 v12, 16, v66
    v_mfma_f32_16x16x32_bf16 v[196:199], v[160:163], v[140:143], v[196:199]
    v_and_b32 v13, s48, v66
    v_lshlrev_b32 v14, 16, v67
    v_and_b32 v15, s48, v67
    v_add_f32 v228, v6, v228
    v_add_f32 v229, v6, v229
    v_add_f32 v230, v6, v230
    v_add_f32 v231, v6, v231
    v_mul_f32 v228, v228, v12
    v_mfma_f32_16x16x32_bf16 v[232:235], v[160:163], v[144:147], v[232:235]
    v_mul_f32 v229, v229, v13
    v_mul_f32 v230, v230, v14
    v_mul_f32 v231, v231, v15
    v_cvt_pk_bf16_f32 v28, v228, v229
    v_cvt_pk_bf16_f32 v29, v230, v231
    v_mfma_f32_16x16x32_bf16 v[200:203], v[120:123], v[96:99], v[200:203]
    s_waitcnt lgkmcnt(5)
    v_lshlrev_b32 v8, 16, v68
    v_and_b32 v9, s48, v68
    v_lshlrev_b32 v10, 16, v69
    v_and_b32 v11, s48, v69
    v_add_f32 v196, v5, v196
    v_add_f32 v197, v5, v197
    v_add_f32 v198, v5, v198
    v_mfma_f32_16x16x32_bf16 v[236:239], v[120:123], v[100:103], v[236:239]
    v_add_f32 v199, v5, v199
    v_mul_f32 v196, v196, v8
    v_mul_f32 v197, v197, v9
    v_mul_f32 v198, v198, v10
    v_mul_f32 v199, v199, v11
    v_cvt_pk_bf16_f32 v26, v196, v197
    v_cvt_pk_bf16_f32 v27, v198, v199
    buffer_store_dwordx4 v[24:27], v3, s[24:27], 0 offen offset:1024 sc1
    v_mfma_f32_16x16x32_bf16 v[200:203], v[164:167], v[140:143], v[200:203]
    v_lshlrev_b32 v12, 16, v70
    v_and_b32 v13, s48, v70
    v_lshlrev_b32 v14, 16, v71
    v_and_b32 v15, s48, v71
    v_add_f32 v232, v6, v232
    v_add_f32 v233, v6, v233
    v_add_f32 v234, v6, v234
    v_add_f32 v235, v6, v235
    v_mfma_f32_16x16x32_bf16 v[236:239], v[164:167], v[144:147], v[236:239]
    v_mul_f32 v232, v232, v12
    v_mul_f32 v233, v233, v13
    v_mul_f32 v234, v234, v14
    v_mul_f32 v235, v235, v15
    v_cvt_pk_bf16_f32 v30, v232, v233
    v_cvt_pk_bf16_f32 v31, v234, v235
    buffer_store_dwordx4 v[28:31], v3, s[24:27], s37 offen offset:1024 sc1
    v_mfma_f32_16x16x32_bf16 v[204:207], v[124:127], v[96:99], v[204:207]
    s_waitcnt lgkmcnt(4)
    v_lshlrev_b32 v8, 16, v72
    v_and_b32 v9, s48, v72
    v_lshlrev_b32 v10, 16, v73
    v_and_b32 v11, s48, v73
    v_add_f32 v200, v5, v200
    v_add_f32 v201, v5, v201
    v_add_f32 v202, v5, v202
    v_mfma_f32_16x16x32_bf16 v[240:243], v[124:127], v[100:103], v[240:243]
    v_add_f32 v203, v5, v203
    v_mul_f32 v200, v200, v8
    v_mul_f32 v201, v201, v9
    v_mul_f32 v202, v202, v10
    v_mul_f32 v203, v203, v11
    v_cvt_pk_bf16_f32 v32, v200, v201
    v_cvt_pk_bf16_f32 v33, v202, v203
    v_lshlrev_b32 v12, 16, v74
    v_mfma_f32_16x16x32_bf16 v[204:207], v[168:171], v[140:143], v[204:207]
    v_and_b32 v13, s48, v74
    v_lshlrev_b32 v14, 16, v75
    v_and_b32 v15, s48, v75
    v_add_f32 v236, v6, v236
    v_add_f32 v237, v6, v237
    v_add_f32 v238, v6, v238
    v_add_f32 v239, v6, v239
    v_mul_f32 v236, v236, v12
    v_mfma_f32_16x16x32_bf16 v[240:243], v[168:171], v[144:147], v[240:243]
    v_mul_f32 v237, v237, v13
    v_mul_f32 v238, v238, v14
    v_mul_f32 v239, v239, v15
    v_cvt_pk_bf16_f32 v36, v236, v237
    v_cvt_pk_bf16_f32 v37, v238, v239
    v_mfma_f32_16x16x32_bf16 v[208:211], v[128:131], v[96:99], v[208:211]
    s_waitcnt lgkmcnt(3)
    v_lshlrev_b32 v8, 16, v76
    v_and_b32 v9, s48, v76
    v_lshlrev_b32 v10, 16, v77
    v_and_b32 v11, s48, v77
    v_add_f32 v204, v5, v204
    v_add_f32 v205, v5, v205
    v_add_f32 v206, v5, v206
    v_mfma_f32_16x16x32_bf16 v[244:247], v[128:131], v[100:103], v[244:247]
    v_add_f32 v207, v5, v207
    v_mul_f32 v204, v204, v8
    v_mul_f32 v205, v205, v9
    v_mul_f32 v206, v206, v10
    v_mul_f32 v207, v207, v11
    v_cvt_pk_bf16_f32 v34, v204, v205
    v_cvt_pk_bf16_f32 v35, v206, v207
    buffer_store_dwordx4 v[32:35], v3, s[24:27], 0 offen offset:2048 sc1
    v_mfma_f32_16x16x32_bf16 v[208:211], v[172:175], v[140:143], v[208:211]
    v_lshlrev_b32 v12, 16, v78
    v_and_b32 v13, s48, v78
    v_lshlrev_b32 v14, 16, v79
    v_and_b32 v15, s48, v79
    v_add_f32 v240, v6, v240
    v_add_f32 v241, v6, v241
    v_add_f32 v242, v6, v242
    v_add_f32 v243, v6, v243
    v_mfma_f32_16x16x32_bf16 v[244:247], v[172:175], v[144:147], v[244:247]
    v_mul_f32 v240, v240, v12
    v_mul_f32 v241, v241, v13
    v_mul_f32 v242, v242, v14
    v_mul_f32 v243, v243, v15
    v_cvt_pk_bf16_f32 v38, v240, v241
    v_cvt_pk_bf16_f32 v39, v242, v243
    buffer_store_dwordx4 v[36:39], v3, s[24:27], s37 offen offset:2048 sc1
    v_mfma_f32_16x16x32_bf16 v[212:215], v[132:135], v[96:99], v[212:215]
    s_waitcnt lgkmcnt(2)
    v_lshlrev_b32 v8, 16, v80
    v_and_b32 v9, s48, v80
    v_lshlrev_b32 v10, 16, v81
    v_and_b32 v11, s48, v81
    v_add_f32 v208, v5, v208
    v_add_f32 v209, v5, v209
    v_add_f32 v210, v5, v210
    v_mfma_f32_16x16x32_bf16 v[248:251], v[132:135], v[100:103], v[248:251]
    v_add_f32 v211, v5, v211
    v_mul_f32 v208, v208, v8
    v_mul_f32 v209, v209, v9
    v_mul_f32 v210, v210, v10
    v_mul_f32 v211, v211, v11
    v_cvt_pk_bf16_f32 v40, v208, v209
    v_cvt_pk_bf16_f32 v41, v210, v211
    v_lshlrev_b32 v12, 16, v82
    v_mfma_f32_16x16x32_bf16 v[212:215], v[176:179], v[140:143], v[212:215]
    v_and_b32 v13, s48, v82
    v_lshlrev_b32 v14, 16, v83
    v_and_b32 v15, s48, v83
    v_add_f32 v244, v6, v244
    v_add_f32 v245, v6, v245
    v_add_f32 v246, v6, v246
    v_add_f32 v247, v6, v247
    v_mul_f32 v244, v244, v12
    v_mfma_f32_16x16x32_bf16 v[248:251], v[176:179], v[144:147], v[248:251]
    v_mul_f32 v245, v245, v13
    v_mul_f32 v246, v246, v14
    v_mul_f32 v247, v247, v15
    v_cvt_pk_bf16_f32 v44, v244, v245
    v_cvt_pk_bf16_f32 v45, v246, v247
    v_mfma_f32_16x16x32_bf16 v[216:219], v[136:139], v[96:99], v[216:219]
    s_waitcnt lgkmcnt(1)
    v_lshlrev_b32 v8, 16, v84
    v_and_b32 v9, s48, v84
    v_lshlrev_b32 v10, 16, v85
    v_and_b32 v11, s48, v85
    v_add_f32 v212, v5, v212
    v_add_f32 v213, v5, v213
    v_add_f32 v214, v5, v214
    v_mfma_f32_16x16x32_bf16 v[252:255], v[136:139], v[100:103], v[252:255]
    v_add_f32 v215, v5, v215
    v_mul_f32 v212, v212, v8
    v_mul_f32 v213, v213, v9
    v_mul_f32 v214, v214, v10
    v_mul_f32 v215, v215, v11
    v_cvt_pk_bf16_f32 v42, v212, v213
    v_cvt_pk_bf16_f32 v43, v214, v215
    buffer_store_dwordx4 v[40:43], v3, s[24:27], 0 offen offset:3072 sc1
    v_mfma_f32_16x16x32_bf16 v[216:219], v[180:183], v[140:143], v[216:219]
    v_lshlrev_b32 v12, 16, v86
    v_and_b32 v13, s48, v86
    v_lshlrev_b32 v14, 16, v87
    v_and_b32 v15, s48, v87
    v_add_f32 v248, v6, v248
    v_add_f32 v249, v6, v249
    v_add_f32 v250, v6, v250
    v_add_f32 v251, v6, v251
    v_mfma_f32_16x16x32_bf16 v[252:255], v[180:183], v[144:147], v[252:255]
    v_mul_f32 v248, v248, v12
    v_mul_f32 v249, v249, v13
    v_mul_f32 v250, v250, v14
    v_mul_f32 v251, v251, v15
    v_cvt_pk_bf16_f32 v46, v248, v249
    v_cvt_pk_bf16_f32 v47, v250, v251
    buffer_store_dwordx4 v[44:47], v3, s[24:27], s37 offen offset:3072 sc1
    s_waitcnt lgkmcnt(0)
    v_lshlrev_b32 v8, 16, v88
    v_and_b32 v9, s48, v88
    v_lshlrev_b32 v10, 16, v89
    v_and_b32 v11, s48, v89
    v_add_f32 v216, v5, v216
    v_add_f32 v217, v5, v217
    v_add_f32 v218, v5, v218
    v_add_f32 v219, v5, v219
    v_mul_f32 v216, v216, v8
    v_mul_f32 v217, v217, v9
    v_mul_f32 v218, v218, v10
    v_mul_f32 v219, v219, v11
    v_cvt_pk_bf16_f32 v48, v216, v217
    v_cvt_pk_bf16_f32 v49, v218, v219
    buffer_store_dwordx2 v[48:49], v4, s[24:27], 0 offen sc1
    v_lshlrev_b32 v12, 16, v90
    v_and_b32 v13, s48, v90
    v_lshlrev_b32 v14, 16, v91
    v_and_b32 v15, s48, v91
    v_add_f32 v252, v6, v252
    v_add_f32 v253, v6, v253
    v_add_f32 v254, v6, v254
    v_add_f32 v255, v6, v255
    v_mul_f32 v252, v252, v12
    v_mul_f32 v253, v253, v13
    v_mul_f32 v254, v254, v14
    v_mul_f32 v255, v255, v15
    v_cvt_pk_bf16_f32 v52, v252, v253
    v_cvt_pk_bf16_f32 v53, v254, v255
    buffer_store_dwordx2 v[52:53], v4, s[24:27], s37 offen sc1
    v_mov_b32 v158, v2
L_p3:
    s_and_b32 s40, s2, 7
    s_lshr_b32 s41, s2, 3
    s_lshr_b32 s32, s40, 1
    s_lshl_b32 s32, s32, 3
    s_lshr_b32 s42, s41, 2
    s_add_u32 s32, s32, s42
    s_and_b32 s33, s40, 1
    s_lshl_b32 s33, s33, 2
    s_and_b32 s42, s41, 3
    s_add_u32 s33, s33, s42
    s_lshl_b32 s40, s32, 6
    s_lshl_b32 s41, s38, 5
    s_add_u32 s40, s40, s41
    s_lshl_b32 s41, s39, 4
    s_add_u32 s40, s40, s41
    v_and_b32 v1, 15, v0
    v_add_u32 v1, s40, v1
    v_mul_u32_u24 v1, 1152, v1
    v_lshrrev_b32 v2, 4, v0
    v_lshlrev_b32 v3, 3, v2
    s_mul_i32 s41, s33, 144
    v_add3_u32 v7, v1, v3, s41
    s_mul_i32 s41, s39, 4608
    s_add_u32 s41, s41, 8192
    v_lshlrev_b32 v3, 7, v2
    v_and_b32 v4, 7, v0
    v_lshl_add_u32 v3, v4, 4, v3
    v_add_u32 v3, s41, v3
    v_lshlrev_b32 v1, 4, v0
    v_add_u32 v2, s41, v1
    s_lshl_b32 s40, s38, 2
    s_add_u32 s40, s40, s39
    s_lshl_b32 s40, s40, 10
    v_add_u32 v156, s40, v1
    v_lshlrev_b32 v157, 3, v0
    v_add_u32 v157, s40, v157
    v_and_b32 v1, 15, v0
    v_lshlrev_b32 v1, 6, v1
    v_lshrrev_b32 v4, 4, v0
    v_lshl_add_u32 v1, v4, 4, v1
    v_add_u32 v1, s40, v1
    s_mov_b32 s12, s4
    s_mov_b32 s13, s5
    s_mov_b32 s14, 2359296
    s_mov_b32 s15, 0x00020000
    s_mov_b32 s16, s78
    s_mov_b32 s17, s79
    s_mov_b32 s18, 2359296
    s_mov_b32 s19, 0x00020000
    s_mov_b32 s42, 36864
    s_mov_b32 s43, 0
    v_add_u32 v4, s42, v1
    v_add_u32 v5, s42, v2
    v_add_u32 v6, s42, v3
    s_add_u32 s42, s42, 17408
    s_cmp_eq_u32 s42, 158720
    s_cselect_b32 s42, 2048, s42
    s_barrier
    ds_read_b128 v[160:163], v4
    ds_read_b128 v[168:171], v5
    ds_read_b128 v[164:167], v4 offset:2048
    ds_read_b128 v[172:175], v5 offset:1024
    ds_read_b128 v[176:179], v5 offset:2048
    ds_read_b128 v[180:183], v5 offset:3072
    ds_read_b128 v[184:187], v6 offset:4096
    v_add_u32 v4, s42, v1
    v_add_u32 v5, s42, v2
    v_add_u32 v6, s42, v3
    s_add_u32 s42, s42, 17408
    s_cmp_eq_u32 s42, 158720
    s_cselect_b32 s42, 2048, s42
    s_waitcnt lgkmcnt(0)
    s_barrier
    ds_read_b128 v[188:191], v4
    v_mfma_f32_16x16x32_bf16 v[64:67], v[168:171], v[160:163], 0
    ds_read_b128 v[196:199], v5
    v_mfma_f32_16x16x32_bf16 v[84:87], v[168:171], v[164:167], 0
    ds_read_b128 v[192:195], v4 offset:2048
    v_mfma_f32_16x16x32_bf16 v[68:71], v[172:175], v[160:163], 0
    ds_read_b128 v[200:203], v5 offset:1024
    v_mfma_f32_16x16x32_bf16 v[88:91], v[172:175], v[164:167], 0
    ds_read_b128 v[204:207], v5 offset:2048
    v_mfma_f32_16x16x32_bf16 v[72:75], v[176:179], v[160:163], 0
    ds_read_b128 v[208:211], v5 offset:3072
    v_mfma_f32_16x16x32_bf16 v[92:95], v[176:179], v[164:167], 0
    ds_read_b128 v[212:215], v6 offset:4096
    v_mfma_f32_16x16x32_bf16 v[76:79], v[180:183], v[160:163], 0
    v_mfma_f32_16x16x32_bf16 v[96:99], v[180:183], v[164:167], 0
    v_add_u32 v4, s42, v1
    v_add_u32 v5, s42, v2
    v_add_u32 v6, s42, v3
    s_add_u32 s42, s42, 17408
    s_cmp_eq_u32 s42, 158720
    s_cselect_b32 s42, 2048, s42
    v_mfma_f32_16x16x32_bf16 v[80:83], v[184:187], v[160:163], 0
    v_mfma_f32_16x16x32_bf16 v[100:103], v[184:187], v[164:167], 0
    s_waitcnt lgkmcnt(0)
    s_barrier
    ds_read_b128 v[160:163], v4
    v_mfma_f32_16x16x32_bf16 v[64:67], v[196:199], v[188:191], v[64:67]
    ds_read_b128 v[168:171], v5
    v_mfma_f32_16x16x32_bf16 v[84:87], v[196:199], v[192:195], v[84:87]
    ds_read_b128 v[164:167], v4 offset:2048
    v_mfma_f32_16x16x32_bf16 v[68:71], v[200:203], v[188:191], v[68:71]
    ds_read_b128 v[172:175], v5 offset:1024
    v_mfma_f32_16x16x32_bf16 v[88:91], v[200:203], v[192:195], v[88:91]
    ds_read_b128 v[176:179], v5 offset:2048
    v_mfma_f32_16x16x32_bf16 v[72:75], v[204:207], v[188:191], v[72:75]
    ds_read_b128 v[180:183], v5 offset:3072
    v_mfma_f32_16x16x32_bf16 v[92:95], v[204:207], v[192:195], v[92:95]
    ds_read_b128 v[184:187], v6 offset:4096
    v_mfma_f32_16x16x32_bf16 v[76:79], v[208:211], v[188:191], v[76:79]
    v_mfma_f32_16x16x32_bf16 v[96:99], v[208:211], v[192:195], v[96:99]
    v_add_u32 v4, s42, v1
    v_add_u32 v5, s42, v2
    v_add_u32 v6, s42, v3
    s_add_u32 s42, s42, 17408
    s_cmp_eq_u32 s42, 158720
    s_cselect_b32 s42, 2048, s42
    v_mfma_f32_16x16x32_bf16 v[80:83], v[212:215], v[188:191], v[80:83]
    v_mfma_f32_16x16x32_bf16 v[100:103], v[212:215], v[192:195], v[100:103]
    s_waitcnt lgkmcnt(0)
    s_barrier
    ds_read_b128 v[188:191], v4
    v_mfma_f32_16x16x32_bf16 v[64:67], v[168:171], v[160:163], v[64:67]
    ds_read_b128 v[196:199], v5
    v_mfma_f32_16x16x32_bf16 v[84:87], v[168:171], v[164:167], v[84:87]
    ds_read_b128 v[192:195], v4 offset:2048
    v_mfma_f32_16x16x32_bf16 v[68:71], v[172:175], v[160:163], v[68:71]
    ds_read_b128 v[200:203], v5 offset:1024
    v_mfma_f32_16x16x32_bf16 v[88:91], v[172:175], v[164:167], v[88:91]
    ds_read_b128 v[204:207], v5 offset:2048
    v_mfma_f32_16x16x32_bf16 v[72:75], v[176:179], v[160:163], v[72:75]
    ds_read_b128 v[208:211], v5 offset:3072
    v_mfma_f32_16x16x32_bf16 v[92:95], v[176:179], v[164:167], v[92:95]
    ds_read_b128 v[212:215], v6 offset:4096
    v_mfma_f32_16x16x32_bf16 v[76:79], v[180:183], v[160:163], v[76:79]
    v_mfma_f32_16x16x32_bf16 v[96:99], v[180:183], v[164:167], v[96:99]
    v_add_u32 v4, s42, v1
    v_add_u32 v5, s42, v2
    v_add_u32 v6, s42, v3
    s_add_u32 s42, s42, 17408
    s_cmp_eq_u32 s42, 158720
    s_cselect_b32 s42, 2048, s42
    v_mfma_f32_16x16x32_bf16 v[80:83], v[184:187], v[160:163], v[80:83]
    v_mfma_f32_16x16x32_bf16 v[100:103], v[184:187], v[164:167], v[100:103]
    s_waitcnt lgkmcnt(0)
    s_barrier
    ds_read_b128 v[160:163], v4
    v_mfma_f32_16x16x32_bf16 v[64:67], v[196:199], v[188:191], v[64:67]
    ds_read_b128 v[168:171], v5
    v_mfma_f32_16x16x32_bf16 v[84:87], v[196:199], v[192:195], v[84:87]
    ds_read_b128 v[164:167], v4 offset:2048
    v_mfma_f32_16x16x32_bf16 v[68:71], v[200:203], v[188:191], v[68:71]
    ds_read_b128 v[172:175], v5 offset:1024
    v_mfma_f32_16x16x32_bf16 v[88:91], v[200:203], v[192:195], v[88:91]
    ds_read_b128 v[176:179], v5 offset:2048
    v_mfma_f32_16x16x32_bf16 v[72:75], v[204:207], v[188:191], v[72:75]
    ds_read_b128 v[180:183], v5 offset:3072
    v_mfma_f32_16x16x32_bf16 v[92:95], v[204:207], v[192:195], v[92:95]
    ds_read_b128 v[184:187], v6 offset:4096
    v_mfma_f32_16x16x32_bf16 v[76:79], v[208:211], v[188:191], v[76:79]
    v_mfma_f32_16x16x32_bf16 v[96:99], v[208:211], v[192:195], v[96:99]
    v_add_u32 v4, s42, v1
    v_add_u32 v5, s42, v2
    v_add_u32 v6, s42, v3
    s_add_u32 s42, s42, 17408
    s_cmp_eq_u32 s42, 158720
    s_cselect_b32 s42, 2048, s42
    v_mfma_f32_16x16x32_bf16 v[80:83], v[212:215], v[188:191], v[80:83]
    v_mfma_f32_16x16x32_bf16 v[100:103], v[212:215], v[192:195], v[100:103]
    s_waitcnt vmcnt(0) lgkmcnt(0)
    s_mov_b64 exec, 1
    buffer_store_dword v158, off, s[72:75], s49 sc1
    s_mov_b64 exec, -1
    s_barrier
    buffer_load_dwordx2 v[144:145], v7, s[12:15], 0 offen offset:0
    buffer_load_dwordx2 v[146:147], v7, s[12:15], 0 offen offset:32
    buffer_load_dwordx2 v[148:149], v7, s[12:15], 0 offen offset:64
    buffer_load_dwordx2 v[150:151], v7, s[12:15], 0 offen offset:96
    buffer_load_dwordx2 v[152:153], v7, s[12:15], 0 offen offset:128
    ds_read_b128 v[188:191], v4
    v_mfma_f32_16x16x32_bf16 v[64:67], v[168:171], v[160:163], v[64:67]
    ds_read_b128 v[196:199], v5
    v_mfma_f32_16x16x32_bf16 v[84:87], v[168:171], v[164:167], v[84:87]
    ds_read_b128 v[192:195], v4 offset:2048
    v_mfma_f32_16x16x32_bf16 v[68:71], v[172:175], v[160:163], v[68:71]
    ds_read_b128 v[200:203], v5 offset:1024
    v_mfma_f32_16x16x32_bf16 v[88:91], v[172:175], v[164:167], v[88:91]
    ds_read_b128 v[204:207], v5 offset:2048
    v_mfma_f32_16x16x32_bf16 v[72:75], v[176:179], v[160:163], v[72:75]
    ds_read_b128 v[208:211], v5 offset:3072
    v_mfma_f32_16x16x32_bf16 v[92:95], v[176:179], v[164:167], v[92:95]
    ds_read_b128 v[212:215], v6 offset:4096
    v_mfma_f32_16x16x32_bf16 v[76:79], v[180:183], v[160:163], v[76:79]
    v_mfma_f32_16x16x32_bf16 v[96:99], v[180:183], v[164:167], v[96:99]
    v_add_u32 v4, s42, v1
    v_add_u32 v5, s42, v2
    v_add_u32 v6, s42, v3
    s_add_u32 s42, s42, 17408
    s_cmp_eq_u32 s42, 158720
    s_cselect_b32 s42, 2048, s42
    v_mfma_f32_16x16x32_bf16 v[80:83], v[184:187], v[160:163], v[80:83]
    v_mfma_f32_16x16x32_bf16 v[100:103], v[184:187], v[164:167], v[100:103]
    s_waitcnt lgkmcnt(0)
    s_barrier
    ds_read_b128 v[160:163], v4
    v_mfma_f32_16x16x32_bf16 v[64:67], v[196:199], v[188:191], v[64:67]
    ds_read_b128 v[168:171], v5
    v_mfma_f32_16x16x32_bf16 v[84:87], v[196:199], v[192:195], v[84:87]
    ds_read_b128 v[164:167], v4 offset:2048
    v_mfma_f32_16x16x32_bf16 v[68:71], v[200:203], v[188:191], v[68:71]
    ds_read_b128 v[172:175], v5 offset:1024
    v_mfma_f32_16x16x32_bf16 v[88:91], v[200:203], v[192:195], v[88:91]
    ds_read_b128 v[176:179], v5 offset:2048
    v_mfma_f32_16x16x32_bf16 v[72:75], v[204:207], v[188:191], v[72:75]
    ds_read_b128 v[180:183], v5 offset:3072
    v_mfma_f32_16x16x32_bf16 v[92:95], v[204:207], v[192:195], v[92:95]
    ds_read_b128 v[184:187], v6 offset:4096
    v_mfma_f32_16x16x32_bf16 v[76:79], v[208:211], v[188:191], v[76:79]
    v_mfma_f32_16x16x32_bf16 v[96:99], v[208:211], v[192:195], v[96:99]
    v_add_u32 v4, s42, v1
    v_add_u32 v5, s42, v2
    v_add_u32 v6, s42, v3
    s_add_u32 s42, s42, 17408
    s_cmp_eq_u32 s42, 158720
    s_cselect_b32 s42, 2048, s42
    v_mfma_f32_16x16x32_bf16 v[80:83], v[212:215], v[188:191], v[80:83]
    v_mfma_f32_16x16x32_bf16 v[100:103], v[212:215], v[192:195], v[100:103]
    s_waitcnt lgkmcnt(0)
    s_barrier
    v_mov_b32 v1, v156
    ds_read_b128 v[188:191], v4
    v_mfma_f32_16x16x32_bf16 v[64:67], v[168:171], v[160:163], v[64:67]
    ds_read_b128 v[196:199], v5
    v_mfma_f32_16x16x32_bf16 v[84:87], v[168:171], v[164:167], v[84:87]
    ds_read_b128 v[192:195], v4 offset:2048
    v_mfma_f32_16x16x32_bf16 v[68:71], v[172:175], v[160:163], v[68:71]
    ds_read_b128 v[200:203], v5 offset:1024
    v_mfma_f32_16x16x32_bf16 v[88:91], v[172:175], v[164:167], v[88:91]
    ds_read_b128 v[204:207], v5 offset:2048
    v_mfma_f32_16x16x32_bf16 v[72:75], v[176:179], v[160:163], v[72:75]
    ds_read_b128 v[208:211], v5 offset:3072
    v_mfma_f32_16x16x32_bf16 v[92:95], v[176:179], v[164:167], v[92:95]
    ds_read_b128 v[212:215], v6 offset:4096
    v_mfma_f32_16x16x32_bf16 v[76:79], v[180:183], v[160:163], v[76:79]
    v_mfma_f32_16x16x32_bf16 v[96:99], v[180:183], v[164:167], v[96:99]
    v_add_u32 v4, s42, v1
    v_add_u32 v5, s42, v2
    v_add_u32 v6, s42, v3
    s_add_u32 s42, s42, 17408
    s_cmp_eq_u32 s42, 158720
    s_cselect_b32 s42, 2048, s42
    v_mfma_f32_16x16x32_bf16 v[80:83], v[184:187], v[160:163], v[80:83]
    v_mfma_f32_16x16x32_bf16 v[100:103], v[184:187], v[164:167], v[100:103]
    s_waitcnt lgkmcnt(0)
    s_barrier
    ds_read_b128 v[160:163], v4
    v_mfma_f32_16x16x32_bf16 v[64:67], v[196:199], v[188:191], v[64:67]
    ds_read_b128 v[168:171], v5
    v_mfma_f32_16x16x32_bf16 v[84:87], v[196:199], v[192:195], v[84:87]
    ds_read_b128 v[164:167], v4 offset:2048
    v_mfma_f32_16x16x32_bf16 v[68:71], v[200:203], v[188:191], v[68:71]
    ds_read_b128 v[172:175], v5 offset:1024
    v_mfma_f32_16x16x32_bf16 v[88:91], v[200:203], v[192:195], v[88:91]
    ds_read_b128 v[176:179], v5 offset:2048
    v_mfma_f32_16x16x32_bf16 v[72:75], v[204:207], v[188:191], v[72:75]
    ds_read_b128 v[180:183], v5 offset:3072
    v_mfma_f32_16x16x32_bf16 v[92:95], v[204:207], v[192:195], v[92:95]
    ds_read_b128 v[184:187], v6 offset:4096
    v_mfma_f32_16x16x32_bf16 v[76:79], v[208:211], v[188:191], v[76:79]
    v_mfma_f32_16x16x32_bf16 v[96:99], v[208:211], v[192:195], v[96:99]
    v_add_u32 v4, s42, v1
    v_add_u32 v5, s42, v2
    v_add_u32 v6, s42, v3
    s_add_u32 s42, s42, 17408
    s_cmp_eq_u32 s42, 158720
    s_cselect_b32 s42, 2048, s42
    v_mfma_f32_16x16x32_bf16 v[80:83], v[212:215], v[188:191], v[80:83]
    v_mfma_f32_16x16x32_bf16 v[100:103], v[212:215], v[192:195], v[100:103]
    s_waitcnt lgkmcnt(0)
    s_barrier
    ds_read_b128 v[188:191], v4
    v_mfma_f32_16x16x32_bf16 v[64:67], v[168:171], v[160:163], v[64:67]
    ds_read_b128 v[196:199], v5
    v_mfma_f32_16x16x32_bf16 v[84:87], v[168:171], v[164:167], v[84:87]
    ds_read_b128 v[192:195], v4 offset:2048
    v_mfma_f32_16x16x32_bf16 v[68:71], v[172:175], v[160:163], v[68:71]
    ds_read_b128 v[200:203], v5 offset:1024
    v_mfma_f32_16x16x32_bf16 v[88:91], v[172:175], v[164:167], v[88:91]
    ds_read_b128 v[204:207], v5 offset:2048
    v_mfma_f32_16x16x32_bf16 v[72:75], v[176:179], v[160:163], v[72:75]
    ds_read_b128 v[208:211], v5 offset:3072
    v_mfma_f32_16x16x32_bf16 v[92:95], v[176:179], v[164:167], v[92:95]
    ds_read_b128 v[212:215], v6 offset:4096
    v_mfma_f32_16x16x32_bf16 v[76:79], v[180:183], v[160:163], v[76:79]
    v_mfma_f32_16x16x32_bf16 v[96:99], v[180:183], v[164:167], v[96:99]
    v_add_u32 v4, s42, v1
    v_add_u32 v5, s42, v2
    v_add_u32 v6, s42, v3
    s_add_u32 s42, s42, 17408
    s_cmp_eq_u32 s42, 158720
    s_cselect_b32 s42, 2048, s42
    v_mfma_f32_16x16x32_bf16 v[80:83], v[184:187], v[160:163], v[80:83]
    v_mfma_f32_16x16x32_bf16 v[100:103], v[184:187], v[164:167], v[100:103]
    s_waitcnt lgkmcnt(0)
    s_barrier
    ds_read_b128 v[160:163], v4
    v_mfma_f32_16x16x32_bf16 v[104:107], v[196:199], v[188:191], 0
    ds_read_b128 v[168:171], v5
    v_mfma_f32_16x16x32_bf16 v[124:127], v[196:199], v[192:195], 0
    ds_read_b128 v[164:167], v4 offset:2048
    v_mfma_f32_16x16x32_bf16 v[108:111], v[200:203], v[188:191], 0
    ds_read_b128 v[172:175], v5 offset:1024
    v_mfma_f32_16x16x32_bf16 v[128:131], v[200:203], v[192:195], 0
    ds_read_b128 v[176:179], v5 offset:2048
    v_mfma_f32_16x16x32_bf16 v[112:115], v[204:207], v[188:191], 0
    ds_read_b128 v[180:183], v5 offset:3072
    v_mfma_f32_16x16x32_bf16 v[132:135], v[204:207], v[192:195], 0
    ds_read_b128 v[184:187], v6 offset:4096
    v_mfma_f32_16x16x32_bf16 v[116:119], v[208:211], v[188:191], 0
    v_mfma_f32_16x16x32_bf16 v[136:139], v[208:211], v[192:195], 0
    v_add_u32 v4, s42, v1
    v_add_u32 v5, s42, v2
    v_add_u32 v6, s42, v3
    s_add_u32 s42, s42, 17408
    s_cmp_eq_u32 s42, 158720
    s_cselect_b32 s42, 2048, s42
    v_mfma_f32_16x16x32_bf16 v[120:123], v[212:215], v[188:191], 0
    v_mfma_f32_16x16x32_bf16 v[140:143], v[212:215], v[192:195], 0
    s_waitcnt lgkmcnt(0)
    s_barrier
    s_branch L_g1
L_gloop:
    ds_read_b128 v[160:163], v4
    v_mfma_f32_16x16x32_bf16 v[104:107], v[196:199], v[188:191], v[104:107]
    ds_read_b128 v[168:171], v5
    v_mfma_f32_16x16x32_bf16 v[124:127], v[196:199], v[192:195], v[124:127]
    ds_read_b128 v[164:167], v4 offset:2048
    v_mfma_f32_16x16x32_bf16 v[108:111], v[200:203], v[188:191], v[108:111]
    ds_read_b128 v[172:175], v5 offset:1024
    v_mfma_f32_16x16x32_bf16 v[128:131], v[200:203], v[192:195], v[128:131]
    ds_read_b128 v[176:179], v5 offset:2048
    v_mfma_f32_16x16x32_bf16 v[112:115], v[204:207], v[188:191], v[112:115]
    ds_read_b128 v[180:183], v5 offset:3072
    v_mfma_f32_16x16x32_bf16 v[132:135], v[204:207], v[192:195], v[132:135]
    ds_read_b128 v[184:187], v6 offset:4096
    v_mfma_f32_16x16x32_bf16 v[116:119], v[208:211], v[188:191], v[116:119]
    v_mfma_f32_16x16x32_bf16 v[136:139], v[208:211], v[192:195], v[136:139]
    v_add_u32 v4, s42, v1
    v_add_u32 v5, s42, v2
    v_add_u32 v6, s42, v3
    s_add_u32 s42, s42, 17408
    s_cmp_eq_u32 s42, 158720
    s_cselect_b32 s42, 2048, s42
    v_mfma_f32_16x16x32_bf16 v[120:123], v[212:215], v[188:191], v[120:123]
    v_mfma_f32_16x16x32_bf16 v[140:143], v[212:215], v[192:195], v[140:143]
    s_waitcnt lgkmcnt(0)
    s_barrier
L_g1:
    ds_read_b128 v[188:191], v4
    v_mfma_f32_16x16x32_bf16 v[104:107], v[168:171], v[160:163], v[104:107]
    ds_read_b128 v[196:199], v5
    v_mfma_f32_16x16x32_bf16 v[124:127], v[168:171], v[164:167], v[124:127]
    ds_read_b128 v[192:195], v4 offset:2048
    v_mfma_f32_16x16x32_bf16 v[108:111], v[172:175], v[160:163], v[108:111]
    ds_read_b128 v[200:203], v5 offset:1024
    v_mfma_f32_16x16x32_bf16 v[128:131], v[172:175], v[164:167], v[128:131]
    ds_read_b128 v[204:207], v5 offset:2048
    v_mfma_f32_16x16x32_bf16 v[112:115], v[176:179], v[160:163], v[112:115]
    ds_read_b128 v[208:211], v5 offset:3072
    v_mfma_f32_16x16x32_bf16 v[132:135], v[176:179], v[164:167], v[132:135]
    ds_read_b128 v[212:215], v6 offset:4096
    v_mfma_f32_16x16x32_bf16 v[116:119], v[180:183], v[160:163], v[116:119]
    v_mfma_f32_16x16x32_bf16 v[136:139], v[180:183], v[164:167], v[136:139]
    v_add_u32 v4, s42, v1
    v_add_u32 v5, s42, v2
    v_add_u32 v6, s42, v3
    s_add_u32 s42, s42, 17408
    s_cmp_eq_u32 s42, 158720
    s_cselect_b32 s42, 2048, s42
    s_add_u32 s43, s43, 1
    s_cmp_lt_u32 s43, 15
    v_mfma_f32_16x16x32_bf16 v[120:123], v[184:187], v[160:163], v[120:123]
    v_mfma_f32_16x16x32_bf16 v[140:143], v[184:187], v[164:167], v[140:143]
    s_waitcnt lgkmcnt(0)
    s_barrier
    s_cbranch_scc1 L_gloop
    v_mov_b32 v1, v157
    ds_read_b128 v[160:163], v4
    v_mfma_f32_16x16x32_bf16 v[104:107], v[196:199], v[188:191], v[104:107]
    ds_read_b128 v[168:171], v5
    v_mfma_f32_16x16x32_bf16 v[124:127], v[196:199], v[192:195], v[124:127]
    ds_read_b128 v[164:167], v4 offset:2048
    v_mfma_f32_16x16x32_bf16 v[108:111], v[200:203], v[188:191], v[108:111]
    ds_read_b128 v[172:175], v5 offset:1024
    v_mfma_f32_16x16x32_bf16 v[128:131], v[200:203], v[192:195], v[128:131]
    ds_read_b128 v[176:179], v5 offset:2048
    v_mfma_f32_16x16x32_bf16 v[112:115], v[204:207], v[188:191], v[112:115]
    ds_read_b128 v[180:183], v5 offset:3072
    v_mfma_f32_16x16x32_bf16 v[132:135], v[204:207], v[192:195], v[132:135]
    ds_read_b128 v[184:187], v6 offset:4096
    v_mfma_f32_16x16x32_bf16 v[116:119], v[208:211], v[188:191], v[116:119]
    v_mfma_f32_16x16x32_bf16 v[136:139], v[208:211], v[192:195], v[136:139]
    v_add_u32 v4, s42, v1
    v_add_u32 v5, s42, v2
    v_add_u32 v6, s42, v3
    s_add_u32 s42, s42, 17408
    s_cmp_eq_u32 s42, 158720
    s_cselect_b32 s42, 2048, s42
    v_mfma_f32_16x16x32_bf16 v[120:123], v[212:215], v[188:191], v[120:123]
    v_mfma_f32_16x16x32_bf16 v[140:143], v[212:215], v[192:195], v[140:143]
    s_waitcnt lgkmcnt(0)
    s_barrier
    ds_read2st64_b64 v[188:191], v4 offset0:0 offset1:1
    v_mfma_f32_16x16x32_bf16 v[104:107], v[168:171], v[160:163], v[104:107]
    ds_read_b128 v[196:199], v5
    v_mfma_f32_16x16x32_bf16 v[124:127], v[168:171], v[164:167], v[124:127]
    ds_read2st64_b64 v[192:195], v4 offset0:4 offset1:5
    v_mfma_f32_16x16x32_bf16 v[108:111], v[172:175], v[160:163], v[108:111]
    ds_read_b128 v[200:203], v5 offset:1024
    v_mfma_f32_16x16x32_bf16 v[128:131], v[172:175], v[164:167], v[128:131]
    ds_read_b128 v[204:207], v5 offset:2048
    v_mfma_f32_16x16x32_bf16 v[112:115], v[176:179], v[160:163], v[112:115]
    ds_read_b128 v[208:211], v5 offset:3072
    v_mfma_f32_16x16x32_bf16 v[132:135], v[176:179], v[164:167], v[132:135]
    ds_read_b128 v[212:215], v6 offset:4096
    v_mfma_f32_16x16x32_bf16 v[116:119], v[180:183], v[160:163], v[116:119]
    v_mfma_f32_16x16x32_bf16 v[136:139], v[180:183], v[164:167], v[136:139]
    v_add_u32 v4, s42, v1
    v_add_u32 v5, s42, v2
    v_add_u32 v6, s42, v3
    s_add_u32 s42, s42, 17408
    s_cmp_eq_u32 s42, 158720
    s_cselect_b32 s42, 2048, s42
    v_mfma_f32_16x16x32_bf16 v[120:123], v[184:187], v[160:163], v[120:123]
    v_mfma_f32_16x16x32_bf16 v[140:143], v[184:187], v[164:167], v[140:143]
    s_waitcnt lgkmcnt(0)
    s_barrier
    ds_read2st64_b64 v[160:163], v4 offset0:0 offset1:1
    v_mfma_f32_16x16x32_bf16 v[104:107], v[196:199], v[188:191], v[104:107]
    ds_read_b128 v[168:171], v5
    v_mfma_f32_16x16x32_bf16 v[124:127], v[196:199], v[192:195], v[124:127]
    ds_read2st64_b64 v[164:167], v4 offset0:4 offset1:5
    v_mfma_f32_16x16x32_bf16 v[108:111], v[200:203], v[188:191], v[108:111]
    ds_read_b128 v[172:175], v5 offset:1024
    v_mfma_f32_16x16x32_bf16 v[128:131], v[200:203], v[192:195], v[128:131]
    ds_read_b128 v[176:179], v5 offset:2048
    v_mfma_f32_16x16x32_bf16 v[112:115], v[204:207], v[188:191], v[112:115]
    ds_read_b128 v[180:183], v5 offset:3072
    v_mfma_f32_16x16x32_bf16 v[132:135], v[204:207], v[192:195], v[132:135]
    ds_read_b128 v[184:187], v6 offset:4096
    v_mfma_f32_16x16x32_bf16 v[116:119], v[208:211], v[188:191], v[116:119]
    v_mfma_f32_16x16x32_bf16 v[136:139], v[208:211], v[192:195], v[136:139]
    v_add_u32 v4, s42, v1
    v_add_u32 v5, s42, v2
    v_add_u32 v6, s42, v3
    s_add_u32 s42, s42, 17408
    s_cmp_eq_u32 s42, 158720
    s_cselect_b32 s42, 2048, s42
    v_mfma_f32_16x16x32_bf16 v[120:123], v[212:215], v[188:191], v[120:123]
    v_mfma_f32_16x16x32_bf16 v[140:143], v[212:215], v[192:195], v[140:143]
    s_waitcnt lgkmcnt(0)
    s_barrier
    ds_read2st64_b64 v[188:191], v4 offset0:0 offset1:1
    v_mfma_f32_16x16x32_bf16 v[104:107], v[168:171], v[160:163], v[104:107]
    ds_read_b128 v[196:199], v5
    v_mfma_f32_16x16x32_bf16 v[124:127], v[168:171], v[164:167], v[124:127]
    ds_read2st64_b64 v[192:195], v4 offset0:4 offset1:5
    v_mfma_f32_16x16x32_bf16 v[108:111], v[172:175], v[160:163], v[108:111]
    ds_read_b128 v[200:203], v5 offset:1024
    v_mfma_f32_16x16x32_bf16 v[128:131], v[172:175], v[164:167], v[128:131]
    ds_read_b128 v[204:207], v5 offset:2048
    v_mfma_f32_16x16x32_bf16 v[112:115], v[176:179], v[160:163], v[112:115]
    ds_read_b128 v[208:211], v5 offset:3072
    v_mfma_f32_16x16x32_bf16 v[132:135], v[176:179], v[164:167], v[132:135]
    ds_read_b128 v[212:215], v6 offset:4096
    v_mfma_f32_16x16x32_bf16 v[116:119], v[180:183], v[160:163], v[116:119]
    v_mfma_f32_16x16x32_bf16 v[136:139], v[180:183], v[164:167], v[136:139]
    v_add_u32 v4, s42, v1
    v_add_u32 v5, s42, v2
    v_add_u32 v6, s42, v3
    s_add_u32 s42, s42, 17408
    s_cmp_eq_u32 s42, 158720
    s_cselect_b32 s42, 2048, s42
    v_mfma_f32_16x16x32_bf16 v[120:123], v[184:187], v[160:163], v[120:123]
    v_mfma_f32_16x16x32_bf16 v[140:143], v[184:187], v[164:167], v[140:143]
    s_waitcnt lgkmcnt(0)
    s_barrier
    ds_read2st64_b64 v[160:163], v4 offset0:0 offset1:1
    v_mfma_f32_16x16x32_bf16 v[104:107], v[196:199], v[188:191], v[104:107]
    ds_read_b128 v[168:171], v5
    v_mfma_f32_16x16x32_bf16 v[124:127], v[196:199], v[192:195], v[124:127]
    ds_read2st64_b64 v[164:167], v4 offset0:4 offset1:5
    v_mfma_f32_16x16x32_bf16 v[108:111], v[200:203], v[188:191], v[108:111]
    ds_read_b128 v[172:175], v5 offset:1024
    v_mfma_f32_16x16x32_bf16 v[128:131], v[200:203], v[192:195], v[128:131]
    ds_read_b128 v[176:179], v5 offset:2048
    v_mfma_f32_16x16x32_bf16 v[112:115], v[204:207], v[188:191], v[112:115]
    ds_read_b128 v[180:183], v5 offset:3072
    v_mfma_f32_16x16x32_bf16 v[132:135], v[204:207], v[192:195], v[132:135]
    ds_read_b128 v[184:187], v6 offset:4096
    v_mfma_f32_16x16x32_bf16 v[116:119], v[208:211], v[188:191], v[116:119]
    v_mfma_f32_16x16x32_bf16 v[136:139], v[208:211], v[192:195], v[136:139]
    v_add_u32 v4, s42, v1
    v_add_u32 v5, s42, v2
    v_add_u32 v6, s42, v3
    s_add_u32 s42, s42, 17408
    s_cmp_eq_u32 s42, 158720
    s_cselect_b32 s42, 2048, s42
    v_mfma_f32_16x16x32_bf16 v[120:123], v[212:215], v[188:191], v[120:123]
    v_mfma_f32_16x16x32_bf16 v[140:143], v[212:215], v[192:195], v[140:143]
    s_waitcnt lgkmcnt(0)
    s_barrier
    ds_read2st64_b64 v[188:191], v4 offset0:0 offset1:1
    v_mfma_f32_16x16x32_bf16 v[104:107], v[168:171], v[160:163], v[104:107]
    ds_read_b128 v[196:199], v5
    v_mfma_f32_16x16x32_bf16 v[124:127], v[168:171], v[164:167], v[124:127]
    ds_read2st64_b64 v[192:195], v4 offset0:4 offset1:5
    v_mfma_f32_16x16x32_bf16 v[108:111], v[172:175], v[160:163], v[108:111]
    ds_read_b128 v[200:203], v5 offset:1024
    v_mfma_f32_16x16x32_bf16 v[128:131], v[172:175], v[164:167], v[128:131]
    ds_read_b128 v[204:207], v5 offset:2048
    v_mfma_f32_16x16x32_bf16 v[112:115], v[176:179], v[160:163], v[112:115]
    ds_read_b128 v[208:211], v5 offset:3072
    v_mfma_f32_16x16x32_bf16 v[132:135], v[176:179], v[164:167], v[132:135]
    ds_read_b128 v[212:215], v6 offset:4096
    v_mfma_f32_16x16x32_bf16 v[116:119], v[180:183], v[160:163], v[116:119]
    v_mfma_f32_16x16x32_bf16 v[136:139], v[180:183], v[164:167], v[136:139]
    v_add_u32 v4, s42, v1
    v_add_u32 v5, s42, v2
    v_add_u32 v6, s42, v3
    s_add_u32 s42, s42, 17408
    s_cmp_eq_u32 s42, 158720
    s_cselect_b32 s42, 2048, s42
    v_mfma_f32_16x16x32_bf16 v[120:123], v[184:187], v[160:163], v[120:123]
    v_mfma_f32_16x16x32_bf16 v[140:143], v[184:187], v[164:167], v[140:143]
    s_waitcnt lgkmcnt(0)
    s_barrier
    s_mul_i32 s40, s34, 10240
    v_lshlrev_b32 v1, 4, v0
    v_add_u32 v2, s40, v1
    s_xor_b32 s41, s34, 2
    s_mul_i32 s41, s41, 10240
    v_add_u32 v3, s41, v1
    s_cmp_eq_u32 s39, 0
    s_cbranch_scc0 L_h1
    s_nop 4
    ds_write_b128 v2, v[124:127] offset:0
    ds_write_b128 v2, v[128:131] offset:1024
    ds_write_b128 v2, v[132:135] offset:2048
    ds_write_b128 v2, v[136:139] offset:3072
    ds_write_b128 v2, v[140:143] offset:4096
    ds_write_b128 v2, v[84:87] offset:5120
    ds_write_b128 v2, v[88:91] offset:6144
    ds_write_b128 v2, v[92:95] offset:7168
    ds_write_b128 v2, v[96:99] offset:8192
    ds_write_b128 v2, v[100:103] offset:9216
    s_waitcnt lgkmcnt(0)
    s_barrier
    ds_read_b128 v[8:11], v3 offset:0
    ds_read_b128 v[12:15], v3 offset:1024
    ds_read_b128 v[16:19], v3 offset:2048
    ds_read_b128 v[20:23], v3 offset:3072
    ds_read_b128 v[24:27], v3 offset:4096
    ds_read_b128 v[28:31], v3 offset:5120
    ds_read_b128 v[32:35], v3 offset:6144
    ds_read_b128 v[36:39], v3 offset:7168
    ds_read_b128 v[40:43], v3 offset:8192
    ds_read_b128 v[44:47], v3 offset:9216
    s_mov_b32 s40, 0xbfb8aa3b
    s_mov_b32 s41, 0xffff0000
    s_waitcnt lgkmcnt(9)
    v_add_f32 v104, v104, v8
    v_add_f32 v105, v105, v9
    v_add_f32 v106, v106, v10
    v_add_f32 v107, v107, v11
    v_mul_f32 v124, s40, v104
    v_mul_f32 v125, s40, v105
    v_mul_f32 v126, s40, v106
    v_mul_f32 v127, s40, v107
    v_exp_f32 v124, v124
    v_exp_f32 v125, v125
    v_exp_f32 v126, v126
    v_exp_f32 v127, v127
    v_add_f32 v124, 1.0, v124
    v_add_f32 v125, 1.0, v125
    v_add_f32 v126, 1.0, v126
    v_add_f32 v127, 1.0, v127
    v_rcp_f32 v124, v124
    v_rcp_f32 v125, v125
    v_rcp_f32 v126, v126
    v_rcp_f32 v127, v127
    s_waitcnt lgkmcnt(8)
    v_add_f32 v108, v108, v12
    v_add_f32 v109, v109, v13
    v_add_f32 v110, v110, v14
    v_add_f32 v111, v111, v15
    v_mul_f32 v128, s40, v108
    v_mul_f32 v129, s40, v109
    v_mul_f32 v130, s40, v110
    v_mul_f32 v131, s40, v111
    v_exp_f32 v128, v128
    v_exp_f32 v129, v129
    v_exp_f32 v130, v130
    v_exp_f32 v131, v131
    v_add_f32 v128, 1.0, v128
    v_add_f32 v129, 1.0, v129
    v_add_f32 v130, 1.0, v130
    v_add_f32 v131, 1.0, v131
    v_rcp_f32 v128, v128
    v_rcp_f32 v129, v129
    v_rcp_f32 v130, v130
    v_rcp_f32 v131, v131
    s_waitcnt lgkmcnt(7)
    v_add_f32 v112, v112, v16
    v_add_f32 v113, v113, v17
    v_add_f32 v114, v114, v18
    v_add_f32 v115, v115, v19
    v_mul_f32 v132, s40, v112
    v_mul_f32 v133, s40, v113
    v_mul_f32 v134, s40, v114
    v_mul_f32 v135, s40, v115
    v_exp_f32 v132, v132
    v_exp_f32 v133, v133
    v_exp_f32 v134, v134
    v_exp_f32 v135, v135
    v_add_f32 v132, 1.0, v132
    v_add_f32 v133, 1.0, v133
    v_add_f32 v134, 1.0, v134
    v_add_f32 v135, 1.0, v135
    v_rcp_f32 v132, v132
    v_rcp_f32 v133, v133
    v_rcp_f32 v134, v134
    v_rcp_f32 v135, v135
    s_waitcnt lgkmcnt(6)
    v_add_f32 v116, v116, v20
    v_add_f32 v117, v117, v21
    v_add_f32 v118, v118, v22
    v_add_f32 v119, v119, v23
    v_mul_f32 v136, s40, v116
    v_mul_f32 v137, s40, v117
    v_mul_f32 v138, s40, v118
    v_mul_f32 v139, s40, v119
    v_exp_f32 v136, v136
    v_exp_f32 v137, v137
    v_exp_f32 v138, v138
    v_exp_f32 v139, v139
    v_add_f32 v136, 1.0, v136
    v_add_f32 v137, 1.0, v137
    v_add_f32 v138, 1.0, v138
    v_add_f32 v139, 1.0, v139
    v_rcp_f32 v136, v136
    v_rcp_f32 v137, v137
    v_rcp_f32 v138, v138
    v_rcp_f32 v139, v139
    s_waitcnt lgkmcnt(5)
    v_add_f32 v120, v120, v24
    v_add_f32 v121, v121, v25
    v_add_f32 v122, v122, v26
    v_add_f32 v123, v123, v27
    v_mul_f32 v140, s40, v120
    v_mul_f32 v141, s40, v121
    v_mul_f32 v142, s40, v122
    v_mul_f32 v143, s40, v123
    v_exp_f32 v140, v140
    v_exp_f32 v141, v141
    v_exp_f32 v142, v142
    v_exp_f32 v143, v143
    v_add_f32 v140, 1.0, v140
    v_add_f32 v141, 1.0, v141
    v_add_f32 v142, 1.0, v142
    v_add_f32 v143, 1.0, v143
    v_rcp_f32 v140, v140
    v_rcp_f32 v141, v141
    v_rcp_f32 v142, v142
    v_rcp_f32 v143, v143
    s_waitcnt vmcnt(0) lgkmcnt(0)
    v_add_f32 v64, v64, v28
    v_add_f32 v65, v65, v29
    v_add_f32 v66, v66, v30
    v_add_f32 v67, v67, v31
    v_lshlrev_b32 v52, 16, v144
    v_and_b32 v53, s41, v144
    v_lshlrev_b32 v54, 16, v145
    v_and_b32 v55, s41, v145
    v_mul_f32 v124, v124, v104
    v_mul_f32 v125, v125, v105
    v_mul_f32 v126, v126, v106
    v_mul_f32 v127, v127, v107
    v_fma_f32 v124, v124, v64, v52
    v_fma_f32 v125, v125, v65, v53
    v_fma_f32 v126, v126, v66, v54
    v_fma_f32 v127, v127, v67, v55
    v_cvt_pk_bf16_f32 v144, v124, v125
    v_cvt_pk_bf16_f32 v145, v126, v127
    buffer_store_dwordx2 v[144:145], v7, s[16:19], 0 offen offset:0
    v_add_f32 v68, v68, v32
    v_add_f32 v69, v69, v33
    v_add_f32 v70, v70, v34
    v_add_f32 v71, v71, v35
    v_lshlrev_b32 v52, 16, v146
    v_and_b32 v53, s41, v146
    v_lshlrev_b32 v54, 16, v147
    v_and_b32 v55, s41, v147
    v_mul_f32 v128, v128, v108
    v_mul_f32 v129, v129, v109
    v_mul_f32 v130, v130, v110
    v_mul_f32 v131, v131, v111
    v_fma_f32 v128, v128, v68, v52
    v_fma_f32 v129, v129, v69, v53
    v_fma_f32 v130, v130, v70, v54
    v_fma_f32 v131, v131, v71, v55
    v_cvt_pk_bf16_f32 v146, v128, v129
    v_cvt_pk_bf16_f32 v147, v130, v131
    buffer_store_dwordx2 v[146:147], v7, s[16:19], 0 offen offset:32
    v_add_f32 v72, v72, v36
    v_add_f32 v73, v73, v37
    v_add_f32 v74, v74, v38
    v_add_f32 v75, v75, v39
    v_lshlrev_b32 v52, 16, v148
    v_and_b32 v53, s41, v148
    v_lshlrev_b32 v54, 16, v149
    v_and_b32 v55, s41, v149
    v_mul_f32 v132, v132, v112
    v_mul_f32 v133, v133, v113
    v_mul_f32 v134, v134, v114
    v_mul_f32 v135, v135, v115
    v_fma_f32 v132, v132, v72, v52
    v_fma_f32 v133, v133, v73, v53
    v_fma_f32 v134, v134, v74, v54
    v_fma_f32 v135, v135, v75, v55
    v_cvt_pk_bf16_f32 v148, v132, v133
    v_cvt_pk_bf16_f32 v149, v134, v135
    buffer_store_dwordx2 v[148:149], v7, s[16:19], 0 offen offset:64
    v_add_f32 v76, v76, v40
    v_add_f32 v77, v77, v41
    v_add_f32 v78, v78, v42
    v_add_f32 v79, v79, v43
    v_lshlrev_b32 v52, 16, v150
    v_and_b32 v53, s41, v150
    v_lshlrev_b32 v54, 16, v151
    v_and_b32 v55, s41, v151
    v_mul_f32 v136, v136, v116
    v_mul_f32 v137, v137, v117
    v_mul_f32 v138, v138, v118
    v_mul_f32 v139, v139, v119
    v_fma_f32 v136, v136, v76, v52
    v_fma_f32 v137, v137, v77, v53
    v_fma_f32 v138, v138, v78, v54
    v_fma_f32 v139, v139, v79, v55
    v_cvt_pk_bf16_f32 v150, v136, v137
    v_cvt_pk_bf16_f32 v151, v138, v139
    buffer_store_dwordx2 v[150:151], v7, s[16:19], 0 offen offset:96
    v_add_f32 v80, v80, v44
    v_add_f32 v81, v81, v45
    v_add_f32 v82, v82, v46
    v_add_f32 v83, v83, v47
    v_lshlrev_b32 v52, 16, v152
    v_and_b32 v53, s41, v152
    v_lshlrev_b32 v54, 16, v153
    v_and_b32 v55, s41, v153
    v_mul_f32 v140, v140, v120
    v_mul_f32 v141, v141, v121
    v_mul_f32 v142, v142, v122
    v_mul_f32 v143, v143, v123
    v_fma_f32 v140, v140, v80, v52
    v_fma_f32 v141, v141, v81, v53
    v_fma_f32 v142, v142, v82, v54
    v_fma_f32 v143, v143, v83, v55
    v_cvt_pk_bf16_f32 v152, v140, v141
    v_cvt_pk_bf16_f32 v153, v142, v143
    s_mov_b32 exec_hi, 0
    buffer_store_dwordx2 v[152:153], v7, s[16:19], 0 offen offset:128
    s_endpgm
L_h1:
    s_nop 4
    ds_write_b128 v2, v[104:107] offset:0
    ds_write_b128 v2, v[108:111] offset:1024
    ds_write_b128 v2, v[112:115] offset:2048
    ds_write_b128 v2, v[116:119] offset:3072
    ds_write_b128 v2, v[120:123] offset:4096
    ds_write_b128 v2, v[64:67] offset:5120
    ds_write_b128 v2, v[68:71] offset:6144
    ds_write_b128 v2, v[72:75] offset:7168
    ds_write_b128 v2, v[76:79] offset:8192
    ds_write_b128 v2, v[80:83] offset:9216
    s_waitcnt lgkmcnt(0)
    s_barrier
    ds_read_b128 v[8:11], v3 offset:0
    ds_read_b128 v[12:15], v3 offset:1024
    ds_read_b128 v[16:19], v3 offset:2048
    ds_read_b128 v[20:23], v3 offset:3072
    ds_read_b128 v[24:27], v3 offset:4096
    ds_read_b128 v[28:31], v3 offset:5120
    ds_read_b128 v[32:35], v3 offset:6144
    ds_read_b128 v[36:39], v3 offset:7168
    ds_read_b128 v[40:43], v3 offset:8192
    ds_read_b128 v[44:47], v3 offset:9216
    s_mov_b32 s40, 0xbfb8aa3b
    s_mov_b32 s41, 0xffff0000
    s_waitcnt lgkmcnt(9)
    v_add_f32 v124, v124, v8
    v_add_f32 v125, v125, v9
    v_add_f32 v126, v126, v10
    v_add_f32 v127, v127, v11
    v_mul_f32 v104, s40, v124
    v_mul_f32 v105, s40, v125
    v_mul_f32 v106, s40, v126
    v_mul_f32 v107, s40, v127
    v_exp_f32 v104, v104
    v_exp_f32 v105, v105
    v_exp_f32 v106, v106
    v_exp_f32 v107, v107
    v_add_f32 v104, 1.0, v104
    v_add_f32 v105, 1.0, v105
    v_add_f32 v106, 1.0, v106
    v_add_f32 v107, 1.0, v107
    v_rcp_f32 v104, v104
    v_rcp_f32 v105, v105
    v_rcp_f32 v106, v106
    v_rcp_f32 v107, v107
    s_waitcnt lgkmcnt(8)
    v_add_f32 v128, v128, v12
    v_add_f32 v129, v129, v13
    v_add_f32 v130, v130, v14
    v_add_f32 v131, v131, v15
    v_mul_f32 v108, s40, v128
    v_mul_f32 v109, s40, v129
    v_mul_f32 v110, s40, v130
    v_mul_f32 v111, s40, v131
    v_exp_f32 v108, v108
    v_exp_f32 v109, v109
    v_exp_f32 v110, v110
    v_exp_f32 v111, v111
    v_add_f32 v108, 1.0, v108
    v_add_f32 v109, 1.0, v109
    v_add_f32 v110, 1.0, v110
    v_add_f32 v111, 1.0, v111
    v_rcp_f32 v108, v108
    v_rcp_f32 v109, v109
    v_rcp_f32 v110, v110
    v_rcp_f32 v111, v111
    s_waitcnt lgkmcnt(7)
    v_add_f32 v132, v132, v16
    v_add_f32 v133, v133, v17
    v_add_f32 v134, v134, v18
    v_add_f32 v135, v135, v19
    v_mul_f32 v112, s40, v132
    v_mul_f32 v113, s40, v133
    v_mul_f32 v114, s40, v134
    v_mul_f32 v115, s40, v135
    v_exp_f32 v112, v112
    v_exp_f32 v113, v113
    v_exp_f32 v114, v114
    v_exp_f32 v115, v115
    v_add_f32 v112, 1.0, v112
    v_add_f32 v113, 1.0, v113
    v_add_f32 v114, 1.0, v114
    v_add_f32 v115, 1.0, v115
    v_rcp_f32 v112, v112
    v_rcp_f32 v113, v113
    v_rcp_f32 v114, v114
    v_rcp_f32 v115, v115
    s_waitcnt lgkmcnt(6)
    v_add_f32 v136, v136, v20
    v_add_f32 v137, v137, v21
    v_add_f32 v138, v138, v22
    v_add_f32 v139, v139, v23
    v_mul_f32 v116, s40, v136
    v_mul_f32 v117, s40, v137
    v_mul_f32 v118, s40, v138
    v_mul_f32 v119, s40, v139
    v_exp_f32 v116, v116
    v_exp_f32 v117, v117
    v_exp_f32 v118, v118
    v_exp_f32 v119, v119
    v_add_f32 v116, 1.0, v116
    v_add_f32 v117, 1.0, v117
    v_add_f32 v118, 1.0, v118
    v_add_f32 v119, 1.0, v119
    v_rcp_f32 v116, v116
    v_rcp_f32 v117, v117
    v_rcp_f32 v118, v118
    v_rcp_f32 v119, v119
    s_waitcnt lgkmcnt(5)
    v_add_f32 v140, v140, v24
    v_add_f32 v141, v141, v25
    v_add_f32 v142, v142, v26
    v_add_f32 v143, v143, v27
    v_mul_f32 v120, s40, v140
    v_mul_f32 v121, s40, v141
    v_mul_f32 v122, s40, v142
    v_mul_f32 v123, s40, v143
    v_exp_f32 v120, v120
    v_exp_f32 v121, v121
    v_exp_f32 v122, v122
    v_exp_f32 v123, v123
    v_add_f32 v120, 1.0, v120
    v_add_f32 v121, 1.0, v121
    v_add_f32 v122, 1.0, v122
    v_add_f32 v123, 1.0, v123
    v_rcp_f32 v120, v120
    v_rcp_f32 v121, v121
    v_rcp_f32 v122, v122
    v_rcp_f32 v123, v123
    s_waitcnt vmcnt(0) lgkmcnt(0)
    v_add_f32 v84, v84, v28
    v_add_f32 v85, v85, v29
    v_add_f32 v86, v86, v30
    v_add_f32 v87, v87, v31
    v_lshlrev_b32 v52, 16, v144
    v_and_b32 v53, s41, v144
    v_lshlrev_b32 v54, 16, v145
    v_and_b32 v55, s41, v145
    v_mul_f32 v104, v104, v124
    v_mul_f32 v105, v105, v125
    v_mul_f32 v106, v106, v126
    v_mul_f32 v107, v107, v127
    v_fma_f32 v104, v104, v84, v52
    v_fma_f32 v105, v105, v85, v53
    v_fma_f32 v106, v106, v86, v54
    v_fma_f32 v107, v107, v87, v55
    v_cvt_pk_bf16_f32 v144, v104, v105
    v_cvt_pk_bf16_f32 v145, v106, v107
    buffer_store_dwordx2 v[144:145], v7, s[16:19], 0 offen offset:0
    v_add_f32 v88, v88, v32
    v_add_f32 v89, v89, v33
    v_add_f32 v90, v90, v34
    v_add_f32 v91, v91, v35
    v_lshlrev_b32 v52, 16, v146
    v_and_b32 v53, s41, v146
    v_lshlrev_b32 v54, 16, v147
    v_and_b32 v55, s41, v147
    v_mul_f32 v108, v108, v128
    v_mul_f32 v109, v109, v129
    v_mul_f32 v110, v110, v130
    v_mul_f32 v111, v111, v131
    v_fma_f32 v108, v108, v88, v52
    v_fma_f32 v109, v109, v89, v53
    v_fma_f32 v110, v110, v90, v54
    v_fma_f32 v111, v111, v91, v55
    v_cvt_pk_bf16_f32 v146, v108, v109
    v_cvt_pk_bf16_f32 v147, v110, v111
    buffer_store_dwordx2 v[146:147], v7, s[16:19], 0 offen offset:32
    v_add_f32 v92, v92, v36
    v_add_f32 v93, v93, v37
    v_add_f32 v94, v94, v38
    v_add_f32 v95, v95, v39
    v_lshlrev_b32 v52, 16, v148
    v_and_b32 v53, s41, v148
    v_lshlrev_b32 v54, 16, v149
    v_and_b32 v55, s41, v149
    v_mul_f32 v112, v112, v132
    v_mul_f32 v113, v113, v133
    v_mul_f32 v114, v114, v134
    v_mul_f32 v115, v115, v135
    v_fma_f32 v112, v112, v92, v52
    v_fma_f32 v113, v113, v93, v53
    v_fma_f32 v114, v114, v94, v54
    v_fma_f32 v115, v115, v95, v55
    v_cvt_pk_bf16_f32 v148, v112, v113
    v_cvt_pk_bf16_f32 v149, v114, v115
    buffer_store_dwordx2 v[148:149], v7, s[16:19], 0 offen offset:64
    v_add_f32 v96, v96, v40
    v_add_f32 v97, v97, v41
    v_add_f32 v98, v98, v42
    v_add_f32 v99, v99, v43
    v_lshlrev_b32 v52, 16, v150
    v_and_b32 v53, s41, v150
    v_lshlrev_b32 v54, 16, v151
    v_and_b32 v55, s41, v151
    v_mul_f32 v116, v116, v136
    v_mul_f32 v117, v117, v137
    v_mul_f32 v118, v118, v138
    v_mul_f32 v119, v119, v139
    v_fma_f32 v116, v116, v96, v52
    v_fma_f32 v117, v117, v97, v53
    v_fma_f32 v118, v118, v98, v54
    v_fma_f32 v119, v119, v99, v55
    v_cvt_pk_bf16_f32 v150, v116, v117
    v_cvt_pk_bf16_f32 v151, v118, v119
    buffer_store_dwordx2 v[150:151], v7, s[16:19], 0 offen offset:96
    v_add_f32 v100, v100, v44
    v_add_f32 v101, v101, v45
    v_add_f32 v102, v102, v46
    v_add_f32 v103, v103, v47
    v_lshlrev_b32 v52, 16, v152
    v_and_b32 v53, s41, v152
    v_lshlrev_b32 v54, 16, v153
    v_and_b32 v55, s41, v153
    v_mul_f32 v120, v120, v140
    v_mul_f32 v121, v121, v141
    v_mul_f32 v122, v122, v142
    v_mul_f32 v123, v123, v143
    v_fma_f32 v120, v120, v100, v52
    v_fma_f32 v121, v121, v101, v53
    v_fma_f32 v122, v122, v102, v54
    v_fma_f32 v123, v123, v103, v55
    v_cvt_pk_bf16_f32 v152, v120, v121
    v_cvt_pk_bf16_f32 v153, v122, v123
    s_mov_b32 exec_hi, 0
    buffer_store_dwordx2 v[152:153], v7, s[16:19], 0 offen offset:128
    s_endpgm
L_H:
    s_mul_i32 s54, s51, 5
    s_cmp_eq_u32 s51, 3
    s_mul_i32 s55, s51, 4
    s_cselect_b32 s54, 14, s54
    s_cselect_b32 s55, 11, s55
    s_lshl_b32 s54, s54, 6
    s_lshl_b32 s55, s55, 6
    s_mul_i32 s53, s49, 288
    v_add_u32 v15, s54, v0
    v_mul_u32_u24 v16, 3641, v15
    v_lshrrev_b32 v16, 16, v16
    v_mul_u32_u24 v17, 18, v16
    v_sub_u32 v15, v15, v17
    v_mul_u32_u24 v16, 9216, v16
    v_lshlrev_b32 v15, 4, v15
    v_add3_u32 v1, v16, v15, s53
    v_add_u32 v15, s54, v0
    v_add_u32 v15, 64, v15
    v_mul_u32_u24 v16, 3641, v15
    v_lshrrev_b32 v16, 16, v16
    v_mul_u32_u24 v17, 18, v16
    v_sub_u32 v15, v15, v17
    v_mul_u32_u24 v16, 9216, v16
    v_lshlrev_b32 v15, 4, v15
    v_add3_u32 v2, v16, v15, s53
    v_subrev_u32 v2, 1024, v2
    v_add_u32 v15, s54, v0
    v_add_u32 v15, 128, v15
    v_mul_u32_u24 v16, 3641, v15
    v_lshrrev_b32 v16, 16, v16
    v_mul_u32_u24 v17, 18, v16
    v_sub_u32 v15, v15, v17
    v_mul_u32_u24 v16, 9216, v16
    v_lshlrev_b32 v15, 4, v15
    v_add3_u32 v3, v16, v15, s53
    v_subrev_u32 v3, 2048, v3
    v_add_u32 v15, s54, v0
    v_add_u32 v15, 192, v15
    v_mul_u32_u24 v16, 3641, v15
    v_lshrrev_b32 v16, 16, v16
    v_mul_u32_u24 v17, 18, v16
    v_sub_u32 v15, v15, v17
    v_mul_u32_u24 v16, 9216, v16
    v_lshlrev_b32 v15, 4, v15
    v_add3_u32 v4, v16, v15, s53
    v_subrev_u32 v4, 3072, v4
    v_add_u32 v15, s54, v0
    v_add_u32 v15, 256, v15
    v_mul_u32_u24 v16, 3641, v15
    v_lshrrev_b32 v16, 16, v16
    v_mul_u32_u24 v17, 18, v16
    v_sub_u32 v15, v15, v17
    v_mul_u32_u24 v16, 9216, v16
    v_lshlrev_b32 v15, 4, v15
    v_add3_u32 v5, v16, v15, s53
    s_lshl_b32 s54, s54, 4
    s_mul_i32 s67, s49, 27
    s_lshr_b32 s67, s67, 2
    s_lshl_b32 s67, s67, 5
    v_add_u32 v15, s55, v0
    v_mul_u32_u24 v16, 4682, v15
    v_lshrrev_b32 v16, 16, v16
    v_mul_u32_u24 v17, 14, v16
    v_sub_u32 v15, v15, v17
    v_mul_u32_u24 v16, 3456, v16
    v_lshlrev_b32 v15, 4, v15
    v_add3_u32 v7, v16, v15, s67
    v_add_u32 v15, s55, v0
    v_add_u32 v15, 64, v15
    v_mul_u32_u24 v16, 4682, v15
    v_lshrrev_b32 v16, 16, v16
    v_mul_u32_u24 v17, 14, v16
    v_sub_u32 v15, v15, v17
    v_mul_u32_u24 v16, 3456, v16
    v_lshlrev_b32 v15, 4, v15
    v_add3_u32 v8, v16, v15, s67
    v_subrev_u32 v8, 1024, v8
    v_add_u32 v15, s55, v0
    v_add_u32 v15, 128, v15
    v_mul_u32_u24 v16, 4682, v15
    v_lshrrev_b32 v16, 16, v16
    v_mul_u32_u24 v17, 14, v16
    v_sub_u32 v15, v15, v17
    v_mul_u32_u24 v16, 3456, v16
    v_lshlrev_b32 v15, 4, v15
    v_add3_u32 v9, v16, v15, s67
    v_subrev_u32 v9, 2048, v9
    v_add_u32 v15, s55, v0
    v_add_u32 v15, 192, v15
    v_mul_u32_u24 v16, 4682, v15
    v_lshrrev_b32 v16, 16, v16
    v_mul_u32_u24 v17, 14, v16
    v_sub_u32 v15, v15, v17
    v_mul_u32_u24 v16, 3456, v16
    v_lshlrev_b32 v15, 4, v15
    v_add3_u32 v10, v16, v15, s67
    v_subrev_u32 v10, 3072, v10
    s_lshl_b32 s55, s55, 4
    v_lshrrev_b32 v14, 2, v0
    s_and_b32 s3, s49, 3
    s_mov_b32 s3, 0
    s_add_u32 s3, s3, s50
    s_and_b32 s3, s3, 7
    s_lshl_b32 s3, s3, 4
    s_lshl_b32 s52, s48, 7
    s_add_u32 s52, s52, s3
    v_add_u32 v14, s52, v14
    v_mul_u32_u24 v14, 1152, v14
    v_and_b32 v15, 3, v0
    v_lshl_add_u32 v14, v15, 4, v14
    s_waitcnt lgkmcnt(0)
    s_mov_b32 s12, s4
    s_mov_b32 s13, s5
    s_mov_b32 s14, 2359296
    s_mov_b32 s15, 0x00020000
    buffer_load_dwordx4 v[32:35], v14, s[12:15], 0 offen offset:0
    buffer_load_dwordx4 v[36:39], v14, s[12:15], 0 offen offset:64
    buffer_load_dwordx4 v[40:43], v14, s[12:15], 0 offen offset:128
    buffer_load_dwordx4 v[44:47], v14, s[12:15], 0 offen offset:192
    buffer_load_dwordx4 v[48:51], v14, s[12:15], 0 offen offset:256
    buffer_load_dwordx4 v[52:55], v14, s[12:15], 0 offen offset:320
    buffer_load_dwordx4 v[128:131], v14, s[12:15], 0 offen offset:384
    buffer_load_dwordx4 v[132:135], v14, s[12:15], 0 offen offset:448
    buffer_load_dwordx4 v[136:139], v14, s[12:15], 0 offen offset:512
    buffer_load_dwordx4 v[140:143], v14, s[12:15], 0 offen offset:576
    buffer_load_dwordx4 v[144:147], v14, s[12:15], 0 offen offset:640
    buffer_load_dwordx4 v[148:151], v14, s[12:15], 0 offen offset:704
    buffer_load_dwordx4 v[152:155], v14, s[12:15], 0 offen offset:768
    buffer_load_dwordx4 v[156:159], v14, s[12:15], 0 offen offset:832
    buffer_load_dwordx4 v[160:163], v14, s[12:15], 0 offen offset:896
    buffer_load_dwordx4 v[164:167], v14, s[12:15], 0 offen offset:960
    buffer_load_dwordx4 v[168:171], v14, s[12:15], 0 offen offset:1024
    buffer_load_dwordx4 v[172:175], v14, s[12:15], 0 offen offset:1088
    s_mov_b32 s16, s8
    s_mov_b32 s17, s9
    s_mov_b32 s18, 5308416
    s_mov_b32 s19, 0x00020000
    s_mov_b32 s20, s6
    s_mov_b32 s21, s7
    s_mov_b32 s22, 1990656
    s_mov_b32 s23, 0x00020000
    v_lshlrev_b32 v6, 4, v0
    v_lshrrev_b32 v11, 2, v0
    v_add_u32 v11, s3, v11
    v_mul_u32_u24 v11, 416, v11
    v_and_b32 v15, 1, v0
    v_lshlrev_b32 v15, 4, v15
    v_and_b32 v16, 2, v0
    v_lshlrev_b32 v16, 2, v16
    v_add3_u32 v11, v11, v15, v16
    v_add_u32 v11, 110592, v11
    s_mov_b32 s24, s46
    s_mov_b32 s25, s47
    s_mov_b32 s26, 9437184
    s_mov_b32 s27, 0x00020000
    s_add_u32 s32, s46, 30670848
    s_addc_u32 s33, s47, 0
    s_mov_b32 s34, 7077888
    s_mov_b32 s35, 0x00020000
    s_add_u32 s36, s46, 41066496
    s_addc_u32 s37, s47, 0
    s_mov_b32 s38, 524288
    s_mov_b32 s39, 0x00020000
    s_mov_b32 s40, s44
    s_mov_b32 s41, s45
    s_mov_b32 s42, 256
    s_mov_b32 s43, 0x00020000
    s_cmp_ge_u32 s51, 2
    s_cbranch_scc1 L_H4
    s_add_u32 m0, s54, 0
    s_mov_b32 s60, 4608
    buffer_load_dwordx4 v1, s[16:19], s60 offen offset:0 lds
    buffer_load_dwordx4 v2, s[16:19], s60 offen offset:1024 lds
    buffer_load_dwordx4 v3, s[16:19], s60 offen offset:2048 lds
    buffer_load_dwordx4 v4, s[16:19], s60 offen offset:3072 lds
    s_add_u32 m0, s54, 4096
    s_nop 0
    buffer_load_dwordx4 v5, s[16:19], s60 offen offset:0 lds
    s_add_u32 m0, s54, 18432
    s_mov_b32 s60, 594432
    buffer_load_dwordx4 v1, s[16:19], s60 offen offset:0 lds
    buffer_load_dwordx4 v2, s[16:19], s60 offen offset:1024 lds
    buffer_load_dwordx4 v3, s[16:19], s60 offen offset:2048 lds
    buffer_load_dwordx4 v4, s[16:19], s60 offen offset:3072 lds
    s_add_u32 m0, s54, 22528
    s_nop 0
    buffer_load_dwordx4 v5, s[16:19], s60 offen offset:0 lds
    s_mov_b32 s61, 0x3f803f80
    s_mov_b32 s62, 0xffff0000
    v_mov_b32 v14, 0
    v_mov_b32 v15, 0
    v_mov_b32 v16, 0
    v_mov_b32 v17, 0
    s_waitcnt vmcnt(27)
    v_dot2_f32_bf16 v14, v32, s61, v14
    v_dot2_f32_bf16 v15, v32, v32, v15
    v_dot2_f32_bf16 v16, v33, s61, v16
    v_dot2_f32_bf16 v17, v33, v33, v17
    v_dot2_f32_bf16 v14, v34, s61, v14
    v_dot2_f32_bf16 v15, v34, v34, v15
    v_dot2_f32_bf16 v16, v35, s61, v16
    v_dot2_f32_bf16 v17, v35, v35, v17
    s_waitcnt vmcnt(26)
    v_dot2_f32_bf16 v14, v36, s61, v14
    v_dot2_f32_bf16 v15, v36, v36, v15
    v_dot2_f32_bf16 v16, v37, s61, v16
    v_dot2_f32_bf16 v17, v37, v37, v17
    v_dot2_f32_bf16 v14, v38, s61, v14
    v_dot2_f32_bf16 v15, v38, v38, v15
    v_dot2_f32_bf16 v16, v39, s61, v16
    v_dot2_f32_bf16 v17, v39, v39, v17
    s_waitcnt vmcnt(25)
    v_dot2_f32_bf16 v14, v40, s61, v14
    v_dot2_f32_bf16 v15, v40, v40, v15
    v_dot2_f32_bf16 v16, v41, s61, v16
    v_dot2_f32_bf16 v17, v41, v41, v17
    v_dot2_f32_bf16 v14, v42, s61, v14
    v_dot2_f32_bf16 v15, v42, v42, v15
    v_dot2_f32_bf16 v16, v43, s61, v16
    v_dot2_f32_bf16 v17, v43, v43, v17
    s_waitcnt vmcnt(24)
    v_dot2_f32_bf16 v14, v44, s61, v14
    v_dot2_f32_bf16 v15, v44, v44, v15
    v_dot2_f32_bf16 v16, v45, s61, v16
    v_dot2_f32_bf16 v17, v45, v45, v17
    v_dot2_f32_bf16 v14, v46, s61, v14
    v_dot2_f32_bf16 v15, v46, v46, v15
    v_dot2_f32_bf16 v16, v47, s61, v16
    v_dot2_f32_bf16 v17, v47, v47, v17
    s_waitcnt vmcnt(23)
    v_dot2_f32_bf16 v14, v48, s61, v14
    v_dot2_f32_bf16 v15, v48, v48, v15
    v_dot2_f32_bf16 v16, v49, s61, v16
    v_dot2_f32_bf16 v17, v49, v49, v17
    v_dot2_f32_bf16 v14, v50, s61, v14
    v_dot2_f32_bf16 v15, v50, v50, v15
    v_dot2_f32_bf16 v16, v51, s61, v16
    v_dot2_f32_bf16 v17, v51, v51, v17
    s_waitcnt vmcnt(22)
    v_dot2_f32_bf16 v14, v52, s61, v14
    v_dot2_f32_bf16 v15, v52, v52, v15
    v_dot2_f32_bf16 v16, v53, s61, v16
    v_dot2_f32_bf16 v17, v53, v53, v17
    v_dot2_f32_bf16 v14, v54, s61, v14
    v_dot2_f32_bf16 v15, v54, v54, v15
    v_dot2_f32_bf16 v16, v55, s61, v16
    v_dot2_f32_bf16 v17, v55, v55, v17
    s_waitcnt vmcnt(21)
    v_dot2_f32_bf16 v14, v128, s61, v14
    v_dot2_f32_bf16 v15, v128, v128, v15
    v_dot2_f32_bf16 v16, v129, s61, v16
    v_dot2_f32_bf16 v17, v129, v129, v17
    v_dot2_f32_bf16 v14, v130, s61, v14
    v_dot2_f32_bf16 v15, v130, v130, v15
    v_dot2_f32_bf16 v16, v131, s61, v16
    v_dot2_f32_bf16 v17, v131, v131, v17
    s_waitcnt vmcnt(20)
    v_dot2_f32_bf16 v14, v132, s61, v14
    v_dot2_f32_bf16 v15, v132, v132, v15
    v_dot2_f32_bf16 v16, v133, s61, v16
    v_dot2_f32_bf16 v17, v133, v133, v17
    v_dot2_f32_bf16 v14, v134, s61, v14
    v_dot2_f32_bf16 v15, v134, v134, v15
    v_dot2_f32_bf16 v16, v135, s61, v16
    v_dot2_f32_bf16 v17, v135, v135, v17
    s_waitcnt vmcnt(19)
    v_dot2_f32_bf16 v14, v136, s61, v14
    v_dot2_f32_bf16 v15, v136, v136, v15
    v_dot2_f32_bf16 v16, v137, s61, v16
    v_dot2_f32_bf16 v17, v137, v137, v17
    v_dot2_f32_bf16 v14, v138, s61, v14
    v_dot2_f32_bf16 v15, v138, v138, v15
    v_dot2_f32_bf16 v16, v139, s61, v16
    v_dot2_f32_bf16 v17, v139, v139, v17
    s_waitcnt vmcnt(18)
    v_dot2_f32_bf16 v14, v140, s61, v14
    v_dot2_f32_bf16 v15, v140, v140, v15
    v_dot2_f32_bf16 v16, v141, s61, v16
    v_dot2_f32_bf16 v17, v141, v141, v17
    v_dot2_f32_bf16 v14, v142, s61, v14
    v_dot2_f32_bf16 v15, v142, v142, v15
    v_dot2_f32_bf16 v16, v143, s61, v16
    v_dot2_f32_bf16 v17, v143, v143, v17
    s_waitcnt vmcnt(17)
    v_dot2_f32_bf16 v14, v144, s61, v14
    v_dot2_f32_bf16 v15, v144, v144, v15
    v_dot2_f32_bf16 v16, v145, s61, v16
    v_dot2_f32_bf16 v17, v145, v145, v17
    v_dot2_f32_bf16 v14, v146, s61, v14
    v_dot2_f32_bf16 v15, v146, v146, v15
    v_dot2_f32_bf16 v16, v147, s61, v16
    v_dot2_f32_bf16 v17, v147, v147, v17
    s_waitcnt vmcnt(16)
    v_dot2_f32_bf16 v14, v148, s61, v14
    v_dot2_f32_bf16 v15, v148, v148, v15
    v_dot2_f32_bf16 v16, v149, s61, v16
    v_dot2_f32_bf16 v17, v149, v149, v17
    v_dot2_f32_bf16 v14, v150, s61, v14
    v_dot2_f32_bf16 v15, v150, v150, v15
    v_dot2_f32_bf16 v16, v151, s61, v16
    v_dot2_f32_bf16 v17, v151, v151, v17
    s_waitcnt vmcnt(15)
    v_dot2_f32_bf16 v14, v152, s61, v14
    v_dot2_f32_bf16 v15, v152, v152, v15
    v_dot2_f32_bf16 v16, v153, s61, v16
    v_dot2_f32_bf16 v17, v153, v153, v17
    v_dot2_f32_bf16 v14, v154, s61, v14
    v_dot2_f32_bf16 v15, v154, v154, v15
    v_dot2_f32_bf16 v16, v155, s61, v16
    v_dot2_f32_bf16 v17, v155, v155, v17
    s_waitcnt vmcnt(14)
    v_dot2_f32_bf16 v14, v156, s61, v14
    v_dot2_f32_bf16 v15, v156, v156, v15
    v_dot2_f32_bf16 v16, v157, s61, v16
    v_dot2_f32_bf16 v17, v157, v157, v17
    v_dot2_f32_bf16 v14, v158, s61, v14
    v_dot2_f32_bf16 v15, v158, v158, v15
    v_dot2_f32_bf16 v16, v159, s61, v16
    v_dot2_f32_bf16 v17, v159, v159, v17
    s_waitcnt vmcnt(13)
    v_dot2_f32_bf16 v14, v160, s61, v14
    v_dot2_f32_bf16 v15, v160, v160, v15
    v_dot2_f32_bf16 v16, v161, s61, v16
    v_dot2_f32_bf16 v17, v161, v161, v17
    v_dot2_f32_bf16 v14, v162, s61, v14
    v_dot2_f32_bf16 v15, v162, v162, v15
    v_dot2_f32_bf16 v16, v163, s61, v16
    v_dot2_f32_bf16 v17, v163, v163, v17
    s_waitcnt vmcnt(12)
    v_dot2_f32_bf16 v14, v164, s61, v14
    v_dot2_f32_bf16 v15, v164, v164, v15
    v_dot2_f32_bf16 v16, v165, s61, v16
    v_dot2_f32_bf16 v17, v165, v165, v17
    v_dot2_f32_bf16 v14, v166, s61, v14
    v_dot2_f32_bf16 v15, v166, v166, v15
    v_dot2_f32_bf16 v16, v167, s61, v16
    v_dot2_f32_bf16 v17, v167, v167, v17
    s_waitcnt vmcnt(11)
    v_dot2_f32_bf16 v14, v168, s61, v14
    v_dot2_f32_bf16 v15, v168, v168, v15
    v_dot2_f32_bf16 v16, v169, s61, v16
    v_dot2_f32_bf16 v17, v169, v169, v17
    v_dot2_f32_bf16 v14, v170, s61, v14
    v_dot2_f32_bf16 v15, v170, v170, v15
    v_dot2_f32_bf16 v16, v171, s61, v16
    v_dot2_f32_bf16 v17, v171, v171, v17
    s_waitcnt vmcnt(10)
    v_dot2_f32_bf16 v14, v172, s61, v14
    v_dot2_f32_bf16 v15, v172, v172, v15
    v_dot2_f32_bf16 v16, v173, s61, v16
    v_dot2_f32_bf16 v17, v173, v173, v17
    v_dot2_f32_bf16 v14, v174, s61, v14
    v_dot2_f32_bf16 v15, v174, v174, v15
    v_dot2_f32_bf16 v16, v175, s61, v16
    v_dot2_f32_bf16 v17, v175, v175, v17
    s_nop 1
    v_add_f32 v14, v14, v16
    v_add_f32 v15, v15, v17
    s_nop 0
    v_add_f32_dpp v14, v14, v14 quad_perm:[1,0,3,2] row_mask:0xf bank_mask:0xf
    v_add_f32_dpp v15, v15, v15 quad_perm:[1,0,3,2] row_mask:0xf bank_mask:0xf
    s_nop 0
    v_add_f32_dpp v14, v14, v14 quad_perm:[2,3,0,1] row_mask:0xf bank_mask:0xf
    v_add_f32_dpp v15, v15, v15 quad_perm:[2,3,0,1] row_mask:0xf bank_mask:0xf
    v_mul_f32 v14, 0x3ae38e39, v14
    v_mul_f32 v15, 0x3ae38e39, v15
    v_fma_f32 v15, -v14, v14, v15
    v_max_f32 v15, 0, v15
    v_add_f32 v15, 0x3727c5ac, v15
    v_rsq_f32 v16, v15
    s_nop 0
    v_mul_f32 v14, -v14, v16
    v_lshlrev_b32 v24, 16, v32
    v_and_b32 v25, s62, v32
    v_lshlrev_b32 v26, 16, v33
    v_and_b32 v27, s62, v33
    v_pk_fma_f32 v[24:25], v[24:25], v[16:17], v[14:15] op_sel_hi:[1,0,0]
    v_pk_fma_f32 v[26:27], v[26:27], v[16:17], v[14:15] op_sel_hi:[1,0,0]
    s_add_u32 m0, s54, 36864
    s_mov_b32 s60, 1184256
    buffer_load_dwordx4 v1, s[16:19], s60 offen offset:0 lds
    v_cvt_pk_bf16_f32 v32, v24, v25
    v_cvt_pk_bf16_f32 v33, v26, v27
    v_lshlrev_b32 v28, 16, v34
    v_and_b32 v29, s62, v34
    v_lshlrev_b32 v30, 16, v35
    v_and_b32 v31, s62, v35
    buffer_load_dwordx4 v2, s[16:19], s60 offen offset:1024 lds
    v_pk_fma_f32 v[28:29], v[28:29], v[16:17], v[14:15] op_sel_hi:[1,0,0]
    v_pk_fma_f32 v[30:31], v[30:31], v[16:17], v[14:15] op_sel_hi:[1,0,0]
    v_cvt_pk_bf16_f32 v34, v28, v29
    v_cvt_pk_bf16_f32 v35, v30, v31
    ds_write2_b64 v11, v[32:33], v[34:35] offset0:0 offset1:4
    v_lshlrev_b32 v24, 16, v36
    v_and_b32 v25, s62, v36
    v_lshlrev_b32 v26, 16, v37
    v_and_b32 v27, s62, v37
    v_pk_fma_f32 v[24:25], v[24:25], v[16:17], v[14:15] op_sel_hi:[1,0,0]
    v_pk_fma_f32 v[26:27], v[26:27], v[16:17], v[14:15] op_sel_hi:[1,0,0]
    buffer_load_dwordx4 v3, s[16:19], s60 offen offset:2048 lds
    v_cvt_pk_bf16_f32 v36, v24, v25
    v_cvt_pk_bf16_f32 v37, v26, v27
    v_lshlrev_b32 v28, 16, v38
    v_and_b32 v29, s62, v38
    v_lshlrev_b32 v30, 16, v39
    v_and_b32 v31, s62, v39
    buffer_load_dwordx4 v4, s[16:19], s60 offen offset:3072 lds
    v_pk_fma_f32 v[28:29], v[28:29], v[16:17], v[14:15] op_sel_hi:[1,0,0]
    v_pk_fma_f32 v[30:31], v[30:31], v[16:17], v[14:15] op_sel_hi:[1,0,0]
    v_cvt_pk_bf16_f32 v38, v28, v29
    v_cvt_pk_bf16_f32 v39, v30, v31
    ds_write2_b64 v11, v[36:37], v[38:39] offset0:8 offset1:12
    v_lshlrev_b32 v24, 16, v40
    v_and_b32 v25, s62, v40
    v_lshlrev_b32 v26, 16, v41
    v_and_b32 v27, s62, v41
    v_pk_fma_f32 v[24:25], v[24:25], v[16:17], v[14:15] op_sel_hi:[1,0,0]
    v_pk_fma_f32 v[26:27], v[26:27], v[16:17], v[14:15] op_sel_hi:[1,0,0]
    s_add_u32 m0, s54, 40960
    s_nop 0
    buffer_load_dwordx4 v5, s[16:19], s60 offen offset:0 lds
    v_cvt_pk_bf16_f32 v40, v24, v25
    v_cvt_pk_bf16_f32 v41, v26, v27
    v_lshlrev_b32 v28, 16, v42
    v_and_b32 v29, s62, v42
    v_lshlrev_b32 v30, 16, v43
    v_and_b32 v31, s62, v43
    s_add_u32 m0, s54, 55296
    s_mov_b32 s60, 1774080
    buffer_load_dwordx4 v1, s[16:19], s60 offen offset:0 lds
    v_pk_fma_f32 v[28:29], v[28:29], v[16:17], v[14:15] op_sel_hi:[1,0,0]
    v_pk_fma_f32 v[30:31], v[30:31], v[16:17], v[14:15] op_sel_hi:[1,0,0]
    v_cvt_pk_bf16_f32 v42, v28, v29
    v_cvt_pk_bf16_f32 v43, v30, v31
    ds_write2_b64 v11, v[40:41], v[42:43] offset0:16 offset1:20
    v_lshlrev_b32 v24, 16, v44
    v_and_b32 v25, s62, v44
    v_lshlrev_b32 v26, 16, v45
    v_and_b32 v27, s62, v45
    v_pk_fma_f32 v[24:25], v[24:25], v[16:17], v[14:15] op_sel_hi:[1,0,0]
    v_pk_fma_f32 v[26:27], v[26:27], v[16:17], v[14:15] op_sel_hi:[1,0,0]
    buffer_load_dwordx4 v2, s[16:19], s60 offen offset:1024 lds
    v_cvt_pk_bf16_f32 v44, v24, v25
    v_cvt_pk_bf16_f32 v45, v26, v27
    v_lshlrev_b32 v28, 16, v46
    v_and_b32 v29, s62, v46
    v_lshlrev_b32 v30, 16, v47
    v_and_b32 v31, s62, v47
    buffer_load_dwordx4 v3, s[16:19], s60 offen offset:2048 lds
    v_pk_fma_f32 v[28:29], v[28:29], v[16:17], v[14:15] op_sel_hi:[1,0,0]
    v_pk_fma_f32 v[30:31], v[30:31], v[16:17], v[14:15] op_sel_hi:[1,0,0]
    v_cvt_pk_bf16_f32 v46, v28, v29
    v_cvt_pk_bf16_f32 v47, v30, v31
    ds_write2_b64 v11, v[44:45], v[46:47] offset0:24 offset1:28
    v_lshlrev_b32 v24, 16, v48
    v_and_b32 v25, s62, v48
    v_lshlrev_b32 v26, 16, v49
    v_and_b32 v27, s62, v49
    v_pk_fma_f32 v[24:25], v[24:25], v[16:17], v[14:15] op_sel_hi:[1,0,0]
    v_pk_fma_f32 v[26:27], v[26:27], v[16:17], v[14:15] op_sel_hi:[1,0,0]
    buffer_load_dwordx4 v4, s[16:19], s60 offen offset:3072 lds
    v_cvt_pk_bf16_f32 v48, v24, v25
    v_cvt_pk_bf16_f32 v49, v26, v27
    v_lshlrev_b32 v28, 16, v50
    v_and_b32 v29, s62, v50
    v_lshlrev_b32 v30, 16, v51
    v_and_b32 v31, s62, v51
    s_add_u32 m0, s54, 59392
    s_nop 0
    buffer_load_dwordx4 v5, s[16:19], s60 offen offset:0 lds
    v_pk_fma_f32 v[28:29], v[28:29], v[16:17], v[14:15] op_sel_hi:[1,0,0]
    v_pk_fma_f32 v[30:31], v[30:31], v[16:17], v[14:15] op_sel_hi:[1,0,0]
    v_cvt_pk_bf16_f32 v50, v28, v29
    v_cvt_pk_bf16_f32 v51, v30, v31
    ds_write2_b64 v11, v[48:49], v[50:51] offset0:32 offset1:36
    v_lshlrev_b32 v24, 16, v52
    v_and_b32 v25, s62, v52
    v_lshlrev_b32 v26, 16, v53
    v_and_b32 v27, s62, v53
    v_pk_fma_f32 v[24:25], v[24:25], v[16:17], v[14:15] op_sel_hi:[1,0,0]
    v_pk_fma_f32 v[26:27], v[26:27], v[16:17], v[14:15] op_sel_hi:[1,0,0]
    s_add_u32 m0, s54, 73728
    s_mov_b32 s60, 2363904
    buffer_load_dwordx4 v1, s[16:19], s60 offen offset:0 lds
    v_cvt_pk_bf16_f32 v52, v24, v25
    v_cvt_pk_bf16_f32 v53, v26, v27
    v_lshlrev_b32 v28, 16, v54
    v_and_b32 v29, s62, v54
    v_lshlrev_b32 v30, 16, v55
    v_and_b32 v31, s62, v55
    buffer_load_dwordx4 v2, s[16:19], s60 offen offset:1024 lds
    v_pk_fma_f32 v[28:29], v[28:29], v[16:17], v[14:15] op_sel_hi:[1,0,0]
    v_pk_fma_f32 v[30:31], v[30:31], v[16:17], v[14:15] op_sel_hi:[1,0,0]
    v_cvt_pk_bf16_f32 v54, v28, v29
    v_cvt_pk_bf16_f32 v55, v30, v31
    ds_write2_b64 v11, v[52:53], v[54:55] offset0:40 offset1:44
    s_waitcnt lgkmcnt(0)
    s_barrier
    buffer_load_dwordx4 v3, s[16:19], s60 offen offset:2048 lds
    buffer_load_dwordx4 v4, s[16:19], s60 offen offset:3072 lds
    s_add_u32 m0, s54, 77824
    s_nop 0
    buffer_load_dwordx4 v5, s[16:19], s60 offen offset:0 lds
    s_add_u32 m0, s54, 92160
    s_mov_b32 s60, 2953728
    buffer_load_dwordx4 v1, s[16:19], s60 offen offset:0 lds
    buffer_load_dwordx4 v2, s[16:19], s60 offen offset:1024 lds
    buffer_load_dwordx4 v3, s[16:19], s60 offen offset:2048 lds
    buffer_load_dwordx4 v4, s[16:19], s60 offen offset:3072 lds
    s_add_u32 m0, s54, 96256
    s_nop 0
    buffer_load_dwordx4 v5, s[16:19], s60 offen offset:0 lds
    v_mov_b32 v36, 0xc0135761
    s_or_b32 s71, s80, 1
    s_lshl_b32 s52, s2, 2
    s_add_u32 s52, s52, s51
    s_cmp_eq_u32 s52, 0
    s_cbranch_scc0 L_nn_1
    v_mov_b32 v24, s71
    s_mov_b64 exec, 1
    buffer_store_dword v24, off, s[40:43], 0 sc1
    s_mov_b64 exec, -1
L_nn_1:
    s_lshl_b32 s52, s2, 2
    s_add_u32 s52, s52, s51
    s_mul_i32 s4, s52, 1944
    s_add_u32 s53, s52, 0
    s_mul_i32 s63, s53, 13108
    s_lshr_b32 s63, s63, 16
    s_mul_i32 s64, s63, 5
    s_sub_u32 s53, s53, s64
    s_mul_i32 s53, s53, 896
    s_mul_i32 s63, s63, 9216
    s_add_u32 s5, s53, s63
    s_add_u32 s53, s52, 1024
    s_mul_i32 s63, s53, 13108
    s_lshr_b32 s63, s63, 16
    s_mul_i32 s64, s63, 5
    s_sub_u32 s53, s53, s64
    s_mul_i32 s53, s53, 896
    s_mul_i32 s63, s63, 9216
    s_add_u32 s6, s53, s63
    s_add_u32 s53, s52, 2048
    s_mul_i32 s63, s53, 13108
    s_lshr_b32 s63, s63, 16
    s_mul_i32 s64, s63, 5
    s_sub_u32 s53, s53, s64
    s_mul_i32 s53, s53, 896
    s_mul_i32 s63, s63, 9216
    s_add_u32 s7, s53, s63
    s_lshl_b32 s8, s52, 13
    s_add_u32 s9, s8, 4096
    s_mul_i32 s65, s52, 648
    s_mul_i32 s66, s52, 2592
    s_mov_b32 s12, s10
    s_mov_b32 s13, s11
    s_mov_b32 s14, 8388608
    s_mov_b32 s15, 0x00020000
    s_mov_b32 s28, s76
    s_mov_b32 s29, s77
    s_mov_b32 s30, 2654208
    s_mov_b32 s31, 0x00020000
    s_waitcnt vmcnt(20)
    s_barrier
    buffer_load_dwordx4 v[48:51], v6, s[20:23], s4 offen offset:0
    v_lshlrev_b32 v24, 16, v128
    v_and_b32 v25, s62, v128
    v_lshlrev_b32 v26, 16, v129
    v_and_b32 v27, s62, v129
    v_fma_f32 v24, v24, v16, v14
    v_fma_f32 v25, v25, v16, v14
    v_fma_f32 v26, v26, v16, v14
    v_fma_f32 v27, v27, v16, v14
    v_cvt_pk_bf16_f32 v128, v24, v25
    v_cvt_pk_bf16_f32 v129, v26, v27
    v_lshlrev_b32 v28, 16, v130
    v_and_b32 v29, s62, v130
    buffer_load_dwordx4 v[48:51], v6, s[20:23], s4 offen offset:1024
    v_lshlrev_b32 v30, 16, v131
    v_and_b32 v31, s62, v131
    v_fma_f32 v28, v28, v16, v14
    v_fma_f32 v29, v29, v16, v14
    v_fma_f32 v30, v30, v16, v14
    v_fma_f32 v31, v31, v16, v14
    v_cvt_pk_bf16_f32 v130, v28, v29
    v_cvt_pk_bf16_f32 v131, v30, v31
    ds_write2_b64 v11, v[128:129], v[130:131] offset0:0 offset1:4
    v_lshlrev_b32 v24, 16, v132
    v_and_b32 v25, s62, v132
    v_lshlrev_b32 v26, 16, v133
    v_and_b32 v27, s62, v133
    v_fma_f32 v24, v24, v16, v14
    v_fma_f32 v25, v25, v16, v14
    v_fma_f32 v26, v26, v16, v14
    v_fma_f32 v27, v27, v16, v14
    v_cvt_pk_bf16_f32 v132, v24, v25
    v_cvt_pk_bf16_f32 v133, v26, v27
    v_lshlrev_b32 v28, 16, v134
    v_and_b32 v29, s62, v134
    v_lshlrev_b32 v30, 16, v135
    s_waitcnt vmcnt(17)
    s_barrier
    s_add_u32 m0, s54, 0
    s_mov_b32 s60, 3543552
    buffer_load_dwordx4 v1, s[16:19], s60 offen offset:0 lds
    v_and_b32 v31, s62, v135
    v_fma_f32 v28, v28, v16, v14
    v_fma_f32 v29, v29, v16, v14
    v_fma_f32 v30, v30, v16, v14
    v_fma_f32 v31, v31, v16, v14
    buffer_load_dwordx4 v2, s[16:19], s60 offen offset:1024 lds
    v_cvt_pk_bf16_f32 v134, v28, v29
    v_cvt_pk_bf16_f32 v135, v30, v31
    ds_write2_b64 v11, v[132:133], v[134:135] offset0:8 offset1:12
    buffer_load_dwordx4 v3, s[16:19], s60 offen offset:2048 lds
    v_lshlrev_b32 v24, 16, v136
    v_and_b32 v25, s62, v136
    v_lshlrev_b32 v26, 16, v137
    v_and_b32 v27, s62, v137
    v_fma_f32 v24, v24, v16, v14
    buffer_load_dwordx4 v4, s[16:19], s60 offen offset:3072 lds
    v_fma_f32 v25, v25, v16, v14
    v_fma_f32 v26, v26, v16, v14
    v_fma_f32 v27, v27, v16, v14
    v_cvt_pk_bf16_f32 v136, v24, v25
    v_cvt_pk_bf16_f32 v137, v26, v27
    s_add_u32 m0, s54, 4096
    s_nop 0
    buffer_load_dwordx4 v5, s[16:19], s60 offen offset:0 lds
    v_lshlrev_b32 v28, 16, v138
    v_and_b32 v29, s62, v138
    v_lshlrev_b32 v30, 16, v139
    v_and_b32 v31, s62, v139
    v_fma_f32 v28, v28, v16, v14
    buffer_load_dwordx4 v[48:51], v6, s[16:19], s5 offen
    v_fma_f32 v29, v29, v16, v14
    v_fma_f32 v30, v30, v16, v14
    v_fma_f32 v31, v31, v16, v14
    v_cvt_pk_bf16_f32 v138, v28, v29
    v_cvt_pk_bf16_f32 v139, v30, v31
    buffer_load_dwordx4 v[48:51], v6, s[16:19], s6 offen
    ds_write2_b64 v11, v[136:137], v[138:139] offset0:16 offset1:20
    v_lshlrev_b32 v24, 16, v140
    v_and_b32 v25, s62, v140
    v_lshlrev_b32 v26, 16, v141
    v_and_b32 v27, s62, v141
    v_fma_f32 v24, v24, v16, v14
    v_fma_f32 v25, v25, v16, v14
    v_fma_f32 v26, v26, v16, v14
    s_waitcnt lgkmcnt(0)
    s_waitcnt vmcnt(19)
    s_barrier
    s_add_u32 m0, s54, 18432
    s_mov_b32 s60, 4133376
    buffer_load_dwordx4 v1, s[16:19], s60 offen offset:0 lds
    v_fma_f32 v27, v27, v16, v14
    v_cvt_pk_bf16_f32 v140, v24, v25
    v_cvt_pk_bf16_f32 v141, v26, v27
    v_lshlrev_b32 v28, 16, v142
    v_and_b32 v29, s62, v142
    buffer_load_dwordx4 v2, s[16:19], s60 offen offset:1024 lds
    v_lshlrev_b32 v30, 16, v143
    v_and_b32 v31, s62, v143
    v_fma_f32 v28, v28, v16, v14
    v_fma_f32 v29, v29, v16, v14
    v_fma_f32 v30, v30, v16, v14
    buffer_load_dwordx4 v3, s[16:19], s60 offen offset:2048 lds
    v_fma_f32 v31, v31, v16, v14
    v_cvt_pk_bf16_f32 v142, v28, v29
    v_cvt_pk_bf16_f32 v143, v30, v31
    ds_write2_b64 v11, v[140:141], v[142:143] offset0:24 offset1:28
    buffer_load_dwordx4 v4, s[16:19], s60 offen offset:3072 lds
    v_lshlrev_b32 v24, 16, v144
    v_and_b32 v25, s62, v144
    v_lshlrev_b32 v26, 16, v145
    v_and_b32 v27, s62, v145
    v_fma_f32 v24, v24, v16, v14
    s_add_u32 m0, s54, 22528
    s_nop 0
    buffer_load_dwordx4 v5, s[16:19], s60 offen offset:0 lds
    v_fma_f32 v25, v25, v16, v14
    v_fma_f32 v26, v26, v16, v14
    v_fma_f32 v27, v27, v16, v14
    v_cvt_pk_bf16_f32 v144, v24, v25
    v_cvt_pk_bf16_f32 v145, v26, v27
    buffer_load_dwordx4 v[48:51], v6, s[16:19], s7 offen
    v_lshlrev_b32 v28, 16, v146
    v_and_b32 v29, s62, v146
    v_lshlrev_b32 v30, 16, v147
    v_and_b32 v31, s62, v147
    v_fma_f32 v28, v28, v16, v14
    buffer_load_dwordx4 v[48:51], v6, s[28:31], s66 offen offset:0
    v_fma_f32 v29, v29, v16, v14
    v_fma_f32 v30, v30, v16, v14
    v_fma_f32 v31, v31, v16, v14
    v_cvt_pk_bf16_f32 v146, v28, v29
    v_cvt_pk_bf16_f32 v147, v30, v31
    ds_write2_b64 v11, v[144:145], v[146:147] offset0:32 offset1:36
    v_lshlrev_b32 v24, 16, v148
    v_and_b32 v25, s62, v148
    s_waitcnt lgkmcnt(0)
    s_waitcnt vmcnt(21)
    s_barrier
    s_add_u32 m0, s54, 36864
    s_mov_b32 s60, 4723200
    buffer_load_dwordx4 v1, s[16:19], s60 offen offset:0 lds
    v_lshlrev_b32 v26, 16, v149
    v_and_b32 v27, s62, v149
    v_fma_f32 v24, v24, v16, v14
    v_fma_f32 v25, v25, v16, v14
    v_fma_f32 v26, v26, v16, v14
    buffer_load_dwordx4 v2, s[16:19], s60 offen offset:1024 lds
    v_fma_f32 v27, v27, v16, v14
    v_cvt_pk_bf16_f32 v148, v24, v25
    v_cvt_pk_bf16_f32 v149, v26, v27
    v_lshlrev_b32 v28, 16, v150
    v_and_b32 v29, s62, v150
    buffer_load_dwordx4 v3, s[16:19], s60 offen offset:2048 lds
    v_lshlrev_b32 v30, 16, v151
    v_and_b32 v31, s62, v151
    v_fma_f32 v28, v28, v16, v14
    v_fma_f32 v29, v29, v16, v14
    v_fma_f32 v30, v30, v16, v14
    buffer_load_dwordx4 v4, s[16:19], s60 offen offset:3072 lds
    v_fma_f32 v31, v31, v16, v14
    v_cvt_pk_bf16_f32 v150, v28, v29
    v_cvt_pk_bf16_f32 v151, v30, v31
    ds_write2_b64 v11, v[148:149], v[150:151] offset0:40 offset1:44
    s_add_u32 m0, s54, 40960
    s_nop 0
    buffer_load_dwordx4 v5, s[16:19], s60 offen offset:0 lds
    v_lshlrev_b32 v24, 16, v152
    v_and_b32 v25, s62, v152
    v_lshlrev_b32 v26, 16, v153
    v_and_b32 v27, s62, v153
    v_fma_f32 v24, v24, v16, v14
    buffer_load_dwordx4 v[48:51], v6, s[28:31], s66 offen offset:784
    v_fma_f32 v25, v25, v16, v14
    v_fma_f32 v26, v26, v16, v14
    v_fma_f32 v27, v27, v16, v14
    v_cvt_pk_bf16_f32 v152, v24, v25
    v_cvt_pk_bf16_f32 v153, v26, v27
    buffer_load_dwordx4 v[48:51], v6, s[28:31], s66 offen offset:1568
    v_lshlrev_b32 v28, 16, v154
    v_and_b32 v29, s62, v154
    v_lshlrev_b32 v30, 16, v155
    v_and_b32 v31, s62, v155
    v_fma_f32 v28, v28, v16, v14
    v_fma_f32 v29, v29, v16, v14
    v_fma_f32 v30, v30, v16, v14
    v_fma_f32 v31, v31, v16, v14
    v_cvt_pk_bf16_f32 v154, v28, v29
    v_cvt_pk_bf16_f32 v155, v30, v31
    s_waitcnt lgkmcnt(0)
    s_waitcnt vmcnt(23)
    s_barrier
    s_add_u32 m0, s55, 55296
    s_mov_b32 s60, 0
    buffer_load_dwordx4 v7, s[20:23], s60 offen offset:0 lds
    ds_write2_b64 v11, v[152:153], v[154:155] offset0:0 offset1:4
    v_lshlrev_b32 v24, 16, v156
    v_and_b32 v25, s62, v156
    v_lshlrev_b32 v26, 16, v157
    buffer_load_dwordx4 v8, s[20:23], s60 offen offset:1024 lds
    v_and_b32 v27, s62, v157
    v_fma_f32 v24, v24, v16, v14
    v_fma_f32 v25, v25, v16, v14
    v_fma_f32 v26, v26, v16, v14
    v_fma_f32 v27, v27, v16, v14
    v_cvt_pk_bf16_f32 v156, v24, v25
    buffer_load_dwordx4 v9, s[20:23], s60 offen offset:2048 lds
    v_cvt_pk_bf16_f32 v157, v26, v27
    v_lshlrev_b32 v28, 16, v158
    v_and_b32 v29, s62, v158
    v_lshlrev_b32 v30, 16, v159
    v_and_b32 v31, s62, v159
    v_fma_f32 v28, v28, v16, v14
    buffer_load_dwordx4 v10, s[20:23], s60 offen offset:3072 lds
    v_fma_f32 v29, v29, v16, v14
    v_fma_f32 v30, v30, v16, v14
    v_fma_f32 v31, v31, v16, v14
    v_cvt_pk_bf16_f32 v158, v28, v29
    v_cvt_pk_bf16_f32 v159, v30, v31
    ds_write2_b64 v11, v[156:157], v[158:159] offset0:8 offset1:12
    s_mov_b32 s28, s72
    s_mov_b32 s29, s73
    s_mov_b32 s30, 663552
    s_mov_b32 s31, 0x00020000
    buffer_load_dwordx4 v[48:51], v6, s[28:31], s65 offen
    v_lshlrev_b32 v24, 16, v160
    v_and_b32 v25, s62, v160
    v_lshlrev_b32 v26, 16, v161
    v_and_b32 v27, s62, v161
    v_fma_f32 v24, v24, v16, v14
    v_fma_f32 v25, v25, v16, v14
    buffer_load_dwordx4 v[48:51], v6, s[12:15], s8 offen offset:0
    v_fma_f32 v26, v26, v16, v14
    v_fma_f32 v27, v27, v16, v14
    v_cvt_pk_bf16_f32 v160, v24, v25
    v_cvt_pk_bf16_f32 v161, v26, v27
    v_lshlrev_b32 v28, 16, v162
    v_and_b32 v29, s62, v162
    v_lshlrev_b32 v30, 16, v163
    v_and_b32 v31, s62, v163
    v_fma_f32 v28, v28, v16, v14
    v_fma_f32 v29, v29, v16, v14
    v_fma_f32 v30, v30, v16, v14
    v_fma_f32 v31, v31, v16, v14
    s_waitcnt lgkmcnt(0)
    s_waitcnt vmcnt(22)
    s_barrier
    s_add_u32 m0, s55, 73728
    s_mov_b32 s60, 221184
    buffer_load_dwordx4 v7, s[20:23], s60 offen offset:0 lds
    v_cvt_pk_bf16_f32 v162, v28, v29
    v_cvt_pk_bf16_f32 v163, v30, v31
    ds_write2_b64 v11, v[160:161], v[162:163] offset0:16 offset1:20
    v_lshlrev_b32 v24, 16, v164
    buffer_load_dwordx4 v8, s[20:23], s60 offen offset:1024 lds
    v_and_b32 v25, s62, v164
    v_lshlrev_b32 v26, 16, v165
    v_and_b32 v27, s62, v165
    v_fma_f32 v24, v24, v16, v14
    v_fma_f32 v25, v25, v16, v14
    v_fma_f32 v26, v26, v16, v14
    buffer_load_dwordx4 v9, s[20:23], s60 offen offset:2048 lds
    v_fma_f32 v27, v27, v16, v14
    v_cvt_pk_bf16_f32 v164, v24, v25
    v_cvt_pk_bf16_f32 v165, v26, v27
    v_lshlrev_b32 v28, 16, v166
    v_and_b32 v29, s62, v166
    v_lshlrev_b32 v30, 16, v167
    buffer_load_dwordx4 v10, s[20:23], s60 offen offset:3072 lds
    v_and_b32 v31, s62, v167
    v_fma_f32 v28, v28, v16, v14
    v_fma_f32 v29, v29, v16, v14
    v_fma_f32 v30, v30, v16, v14
    v_fma_f32 v31, v31, v16, v14
    v_cvt_pk_bf16_f32 v166, v28, v29
    buffer_load_dwordx4 v[48:51], v6, s[12:15], s8 offen offset:1024
    v_cvt_pk_bf16_f32 v167, v30, v31
    ds_write2_b64 v11, v[164:165], v[166:167] offset0:24 offset1:28
    v_lshlrev_b32 v24, 16, v168
    v_and_b32 v25, s62, v168
    buffer_load_dwordx4 v[48:51], v6, s[12:15], s8 offen offset:2048
    v_lshlrev_b32 v26, 16, v169
    v_and_b32 v27, s62, v169
    v_fma_f32 v24, v24, v16, v14
    v_fma_f32 v25, v25, v16, v14
    v_fma_f32 v26, v26, v16, v14
    v_fma_f32 v27, v27, v16, v14
    v_cvt_pk_bf16_f32 v168, v24, v25
    v_cvt_pk_bf16_f32 v169, v26, v27
    v_lshlrev_b32 v28, 16, v170
    v_and_b32 v29, s62, v170
    v_lshlrev_b32 v30, 16, v171
    v_and_b32 v31, s62, v171
    s_waitcnt lgkmcnt(0)
    s_waitcnt vmcnt(21)
    s_barrier
    s_add_u32 m0, s55, 92160
    s_mov_b32 s60, 442368
    buffer_load_dwordx4 v7, s[20:23], s60 offen offset:0 lds
    v_fma_f32 v28, v28, v16, v14
    v_fma_f32 v29, v29, v16, v14
    v_fma_f32 v30, v30, v16, v14
    v_fma_f32 v31, v31, v16, v14
    v_cvt_pk_bf16_f32 v170, v28, v29
    buffer_load_dwordx4 v8, s[20:23], s60 offen offset:1024 lds
    v_cvt_pk_bf16_f32 v171, v30, v31
    ds_write2_b64 v11, v[168:169], v[170:171] offset0:32 offset1:36
    v_lshlrev_b32 v24, 16, v172
    buffer_load_dwordx4 v9, s[20:23], s60 offen offset:2048 lds
    v_and_b32 v25, s62, v172
    v_lshlrev_b32 v26, 16, v173
    v_and_b32 v27, s62, v173
    v_fma_f32 v24, v24, v16, v14
    v_fma_f32 v25, v25, v16, v14
    buffer_load_dwordx4 v10, s[20:23], s60 offen offset:3072 lds
    v_fma_f32 v26, v26, v16, v14
    v_fma_f32 v27, v27, v16, v14
    v_cvt_pk_bf16_f32 v172, v24, v25
    v_cvt_pk_bf16_f32 v173, v26, v27
    v_lshlrev_b32 v28, 16, v174
    buffer_load_dwordx4 v[48:51], v6, s[12:15], s8 offen offset:3072
    v_and_b32 v29, s62, v174
    v_lshlrev_b32 v30, 16, v175
    v_and_b32 v31, s62, v175
    v_fma_f32 v28, v28, v16, v14
    v_fma_f32 v29, v29, v16, v14
    buffer_load_dwordx4 v[48:51], v6, s[12:15], s9 offen offset:0
    v_fma_f32 v30, v30, v16, v14
    v_fma_f32 v31, v31, v16, v14
    v_cvt_pk_bf16_f32 v174, v28, v29
    v_cvt_pk_bf16_f32 v175, v30, v31
    ds_write2_b64 v11, v[172:173], v[174:175] offset0:40 offset1:44
    buffer_load_dword v40, off, s[40:43], 0 sc1
    s_waitcnt lgkmcnt(0)
    s_waitcnt vmcnt(21)
    s_barrier
    s_add_u32 m0, s55, 0
    s_mov_b32 s60, 663552
    buffer_load_dwordx4 v7, s[20:23], s60 offen offset:0 lds
    buffer_load_dwordx4 v8, s[20:23], s60 offen offset:1024 lds
    buffer_load_dwordx4 v9, s[20:23], s60 offen offset:2048 lds
    buffer_load_dwordx4 v10, s[20:23], s60 offen offset:3072 lds
    buffer_load_dwordx4 v[48:51], v6, s[12:15], s9 offen offset:1024
    s_waitcnt vmcnt(20)
    s_barrier
    s_add_u32 m0, s55, 18432
    s_mov_b32 s60, 884736
    buffer_load_dwordx4 v7, s[20:23], s60 offen offset:0 lds
    buffer_load_dwordx4 v8, s[20:23], s60 offen offset:1024 lds
    buffer_load_dwordx4 v9, s[20:23], s60 offen offset:2048 lds
    buffer_load_dwordx4 v10, s[20:23], s60 offen offset:3072 lds
    s_add_u32 m0, s55, 110592
    s_mov_b32 s60, 1105920
    buffer_load_dwordx4 v7, s[20:23], s60 offen offset:0 lds
    buffer_load_dwordx4 v8, s[20:23], s60 offen offset:1024 lds
    buffer_load_dwordx4 v9, s[20:23], s60 offen offset:2048 lds
    buffer_load_dwordx4 v10, s[20:23], s60 offen offset:3072 lds
    s_waitcnt vmcnt(22)
    s_barrier
    buffer_load_dwordx4 v[48:51], v6, s[12:15], s9 offen offset:2048
    s_waitcnt vmcnt(14)
    s_mov_b32 s64, 0
L_nspin_1:
    v_readfirstlane_b32 s71, v40
    s_add_u32 s64, s64, 1
    s_cmp_gt_u32 s64, 50000
    s_cbranch_scc1 L_nok_1
    s_cmp_lg_u32 s71, 0
    s_cbranch_scc1 L_nok_1
    s_sleep 8
    buffer_load_dword v40, off, s[40:43], 0 sc1
    s_waitcnt vmcnt(0)
    s_branch L_nspin_1
L_nok_1:
    buffer_load_dwordx4 v[48:51], v6, s[12:15], s9 offen offset:3072
    s_barrier
    s_add_u32 m0, s55, 55296
    s_mov_b32 s60, 1327104
    buffer_load_dwordx4 v7, s[20:23], s60 offen offset:0 lds
    s_and_b32 s63, s51, 1
    s_mul_i32 s63, s63, 9216
    s_add_u32 s63, s63, 129024
    v_add_u32 v24, s63, v6
    ds_read_b128 v[100:103], v24 offset:0
    ds_read_b128 v[104:107], v24 offset:1024
    ds_read_b128 v[108:111], v24 offset:2048
    ds_read_b128 v[112:115], v24 offset:3072
    ds_read_b128 v[116:119], v24 offset:4096
    ds_read_b128 v[120:123], v24 offset:5120
    ds_read_b128 v[124:127], v24 offset:6144
    s_waitcnt lgkmcnt(0)
    v_lshlrev_b32 v24, 16, v100
    v_and_b32 v25, s62, v100
    v_lshlrev_b32 v26, 16, v101
    v_and_b32 v27, s62, v101
    v_mul_f32 v28, v24, v24
    v_mul_f32 v29, v25, v25
    v_mul_f32 v30, v26, v26
    v_mul_f32 v31, v27, v27
    v_fmamk_f32 v28, v28, 0xbdd2d3e8, v36
    v_fmamk_f32 v29, v29, 0xbdd2d3e8, v36
    v_fmamk_f32 v30, v30, 0xbdd2d3e8, v36
    v_fmamk_f32 v31, v31, 0xbdd2d3e8, v36
    v_mul_f32 v28, v28, v24
    v_mul_f32 v29, v29, v25
    v_mul_f32 v30, v30, v26
    v_mul_f32 v31, v31, v27
    v_exp_f32 v28, v28
    v_exp_f32 v29, v29
    buffer_load_dwordx4 v8, s[20:23], s60 offen offset:1024 lds
    v_exp_f32 v30, v30
    v_exp_f32 v31, v31
    v_add_f32 v28, 1.0, v28
    v_add_f32 v29, 1.0, v29
    v_add_f32 v30, 1.0, v30
    v_add_f32 v31, 1.0, v31
    v_rcp_f32 v28, v28
    v_rcp_f32 v29, v29
    v_rcp_f32 v30, v30
    v_rcp_f32 v31, v31
    v_mul_f32 v24, v24, v28
    v_mul_f32 v25, v25, v29
    v_mul_f32 v26, v26, v30
    v_mul_f32 v27, v27, v31
    v_cvt_pk_bf16_f32 v100, v24, v25
    v_cvt_pk_bf16_f32 v101, v26, v27
    v_add_f32 v14, v24, v25
    v_mul_f32 v16, v24, v24
    v_mul_f32 v17, v26, v26
    v_add_f32 v15, v26, v27
    v_fmac_f32 v16, v25, v25
    v_fmac_f32 v17, v27, v27
    v_lshlrev_b32 v24, 16, v102
    buffer_load_dwordx4 v9, s[20:23], s60 offen offset:2048 lds
    v_and_b32 v25, s62, v102
    v_lshlrev_b32 v26, 16, v103
    v_and_b32 v27, s62, v103
    v_mul_f32 v28, v24, v24
    v_mul_f32 v29, v25, v25
    v_mul_f32 v30, v26, v26
    v_mul_f32 v31, v27, v27
    v_fmamk_f32 v28, v28, 0xbdd2d3e8, v36
    v_fmamk_f32 v29, v29, 0xbdd2d3e8, v36
    v_fmamk_f32 v30, v30, 0xbdd2d3e8, v36
    v_fmamk_f32 v31, v31, 0xbdd2d3e8, v36
    v_mul_f32 v28, v28, v24
    v_mul_f32 v29, v29, v25
    v_mul_f32 v30, v30, v26
    v_mul_f32 v31, v31, v27
    v_exp_f32 v28, v28
    v_exp_f32 v29, v29
    v_exp_f32 v30, v30
    v_exp_f32 v31, v31
    v_add_f32 v28, 1.0, v28
    v_add_f32 v29, 1.0, v29
    v_add_f32 v30, 1.0, v30
    v_add_f32 v31, 1.0, v31
    v_rcp_f32 v28, v28
    buffer_load_dwordx4 v10, s[20:23], s60 offen offset:3072 lds
    v_rcp_f32 v29, v29
    v_rcp_f32 v30, v30
    v_rcp_f32 v31, v31
    v_mul_f32 v24, v24, v28
    v_mul_f32 v25, v25, v29
    v_mul_f32 v26, v26, v30
    v_mul_f32 v27, v27, v31
    v_cvt_pk_bf16_f32 v102, v24, v25
    v_cvt_pk_bf16_f32 v103, v26, v27
    v_add_f32 v18, v24, v25
    v_mul_f32 v20, v24, v24
    v_mul_f32 v21, v26, v26
    v_add_f32 v19, v26, v27
    v_fmac_f32 v20, v25, v25
    v_fmac_f32 v21, v27, v27
    v_lshlrev_b32 v24, 16, v104
    v_and_b32 v25, s62, v104
    v_lshlrev_b32 v26, 16, v105
    v_and_b32 v27, s62, v105
    v_mul_f32 v28, v24, v24
    v_mul_f32 v29, v25, v25
    v_mul_f32 v30, v26, v26
    v_mul_f32 v31, v27, v27
    v_fmamk_f32 v28, v28, 0xbdd2d3e8, v36
    v_fmamk_f32 v29, v29, 0xbdd2d3e8, v36
    v_fmamk_f32 v30, v30, 0xbdd2d3e8, v36
    v_fmamk_f32 v31, v31, 0xbdd2d3e8, v36
    v_mul_f32 v28, v28, v24
    v_mul_f32 v29, v29, v25
    v_mul_f32 v30, v30, v26
    v_mul_f32 v31, v31, v27
    v_exp_f32 v28, v28
    v_exp_f32 v29, v29
    v_exp_f32 v30, v30
    v_exp_f32 v31, v31
    v_add_f32 v28, 1.0, v28
    v_add_f32 v29, 1.0, v29
    v_add_f32 v30, 1.0, v30
    v_add_f32 v31, 1.0, v31
    v_rcp_f32 v28, v28
    v_rcp_f32 v29, v29
    v_rcp_f32 v30, v30
    v_rcp_f32 v31, v31
    v_mul_f32 v24, v24, v28
    v_mul_f32 v25, v25, v29
    v_mul_f32 v26, v26, v30
    v_mul_f32 v27, v27, v31
    s_waitcnt vmcnt(15)
    s_barrier
    s_add_u32 m0, s55, 73728
    s_mov_b32 s60, 1548288
    buffer_load_dwordx4 v7, s[20:23], s60 offen offset:0 lds
    v_cvt_pk_bf16_f32 v104, v24, v25
    v_cvt_pk_bf16_f32 v105, v26, v27
    v_add_f32 v14, v14, v24
    v_fmac_f32 v16, v24, v24
    v_add_f32 v15, v15, v26
    v_fmac_f32 v17, v26, v26
    v_add_f32 v14, v14, v25
    v_add_f32 v15, v15, v27
    v_fmac_f32 v16, v25, v25
    v_fmac_f32 v17, v27, v27
    v_lshlrev_b32 v24, 16, v106
    v_and_b32 v25, s62, v106
    v_lshlrev_b32 v26, 16, v107
    v_and_b32 v27, s62, v107
    v_mul_f32 v28, v24, v24
    v_mul_f32 v29, v25, v25
    buffer_load_dwordx4 v8, s[20:23], s60 offen offset:1024 lds
    v_mul_f32 v30, v26, v26
    v_mul_f32 v31, v27, v27
    v_fmamk_f32 v28, v28, 0xbdd2d3e8, v36
    v_fmamk_f32 v29, v29, 0xbdd2d3e8, v36
    v_fmamk_f32 v30, v30, 0xbdd2d3e8, v36
    v_fmamk_f32 v31, v31, 0xbdd2d3e8, v36
    v_mul_f32 v28, v28, v24
    v_mul_f32 v29, v29, v25
    v_mul_f32 v30, v30, v26
    v_mul_f32 v31, v31, v27
    v_exp_f32 v28, v28
    v_exp_f32 v29, v29
    v_exp_f32 v30, v30
    buffer_load_dwordx4 v9, s[20:23], s60 offen offset:2048 lds
    v_exp_f32 v31, v31
    v_add_f32 v28, 1.0, v28
    v_add_f32 v29, 1.0, v29
    v_add_f32 v30, 1.0, v30
    v_add_f32 v31, 1.0, v31
    v_rcp_f32 v28, v28
    v_rcp_f32 v29, v29
    v_rcp_f32 v30, v30
    v_rcp_f32 v31, v31
    v_mul_f32 v24, v24, v28
    v_mul_f32 v25, v25, v29
    buffer_load_dwordx4 v10, s[20:23], s60 offen offset:3072 lds
    v_mul_f32 v26, v26, v30
    v_mul_f32 v27, v27, v31
    v_cvt_pk_bf16_f32 v106, v24, v25
    v_cvt_pk_bf16_f32 v107, v26, v27
    v_add_f32 v18, v18, v24
    v_fmac_f32 v20, v24, v24
    v_add_f32 v19, v19, v26
    v_fmac_f32 v21, v26, v26
    v_add_f32 v18, v18, v25
    v_add_f32 v19, v19, v27
    v_fmac_f32 v20, v25, v25
    v_fmac_f32 v21, v27, v27
    v_lshlrev_b32 v24, 16, v108
    v_and_b32 v25, s62, v108
    v_lshlrev_b32 v26, 16, v109
    v_and_b32 v27, s62, v109
    s_add_u32 m0, s55, 129024
    s_mov_b32 s60, 1769472
    buffer_load_dwordx4 v7, s[20:23], s60 offen offset:0 lds
    v_mul_f32 v28, v24, v24
    v_mul_f32 v29, v25, v25
    v_mul_f32 v30, v26, v26
    v_mul_f32 v31, v27, v27
    v_fmamk_f32 v28, v28, 0xbdd2d3e8, v36
    v_fmamk_f32 v29, v29, 0xbdd2d3e8, v36
    v_fmamk_f32 v30, v30, 0xbdd2d3e8, v36
    v_fmamk_f32 v31, v31, 0xbdd2d3e8, v36
    v_mul_f32 v28, v28, v24
    v_mul_f32 v29, v29, v25
    v_mul_f32 v30, v30, v26
    v_mul_f32 v31, v31, v27
    v_exp_f32 v28, v28
    v_exp_f32 v29, v29
    buffer_load_dwordx4 v8, s[20:23], s60 offen offset:1024 lds
    v_exp_f32 v30, v30
    v_exp_f32 v31, v31
    v_add_f32 v28, 1.0, v28
    v_add_f32 v29, 1.0, v29
    v_add_f32 v30, 1.0, v30
    v_add_f32 v31, 1.0, v31
    v_rcp_f32 v28, v28
    v_rcp_f32 v29, v29
    v_rcp_f32 v30, v30
    v_rcp_f32 v31, v31
    buffer_load_dwordx4 v9, s[20:23], s60 offen offset:2048 lds
    v_mul_f32 v24, v24, v28
    v_mul_f32 v25, v25, v29
    v_mul_f32 v26, v26, v30
    v_mul_f32 v27, v27, v31
    v_cvt_pk_bf16_f32 v108, v24, v25
    v_cvt_pk_bf16_f32 v109, v26, v27
    v_add_f32 v14, v14, v24
    v_fmac_f32 v16, v24, v24
    v_add_f32 v15, v15, v26
    v_fmac_f32 v17, v26, v26
    v_add_f32 v14, v14, v25
    v_add_f32 v15, v15, v27
    v_fmac_f32 v16, v25, v25
    v_fmac_f32 v17, v27, v27
    v_lshlrev_b32 v24, 16, v110
    v_and_b32 v25, s62, v110
    buffer_load_dwordx4 v10, s[20:23], s60 offen offset:3072 lds
    v_lshlrev_b32 v26, 16, v111
    v_and_b32 v27, s62, v111
    v_mul_f32 v28, v24, v24
    v_mul_f32 v29, v25, v25
    v_mul_f32 v30, v26, v26
    v_mul_f32 v31, v27, v27
    v_fmamk_f32 v28, v28, 0xbdd2d3e8, v36
    v_fmamk_f32 v29, v29, 0xbdd2d3e8, v36
    v_fmamk_f32 v30, v30, 0xbdd2d3e8, v36
    v_fmamk_f32 v31, v31, 0xbdd2d3e8, v36
    v_mul_f32 v28, v28, v24
    v_mul_f32 v29, v29, v25
    v_mul_f32 v30, v30, v26
    v_mul_f32 v31, v31, v27
    v_exp_f32 v28, v28
    v_exp_f32 v29, v29
    v_exp_f32 v30, v30
    v_exp_f32 v31, v31
    v_add_f32 v28, 1.0, v28
    v_add_f32 v29, 1.0, v29
    v_add_f32 v30, 1.0, v30
    v_add_f32 v31, 1.0, v31
    v_rcp_f32 v28, v28
    v_rcp_f32 v29, v29
    v_rcp_f32 v30, v30
    s_waitcnt vmcnt(18)
    s_barrier
    s_add_u32 m0, s54, 36864
    s_mov_b32 s60, 0
    buffer_load_dwordx4 v1, s[16:19], s60 offen offset:0 lds
    v_rcp_f32 v31, v31
    v_mul_f32 v24, v24, v28
    v_mul_f32 v25, v25, v29
    v_mul_f32 v26, v26, v30
    v_mul_f32 v27, v27, v31
    v_cvt_pk_bf16_f32 v110, v24, v25
    v_cvt_pk_bf16_f32 v111, v26, v27
    v_add_f32 v18, v18, v24
    v_fmac_f32 v20, v24, v24
    v_add_f32 v19, v19, v26
    v_fmac_f32 v21, v26, v26
    v_add_f32 v18, v18, v25
    buffer_load_dwordx4 v2, s[16:19], s60 offen offset:1024 lds
    v_add_f32 v19, v19, v27
    v_fmac_f32 v20, v25, v25
    v_fmac_f32 v21, v27, v27
    v_lshlrev_b32 v24, 16, v112
    v_and_b32 v25, s62, v112
    v_lshlrev_b32 v26, 16, v113
    v_and_b32 v27, s62, v113
    v_mul_f32 v28, v24, v24
    v_mul_f32 v29, v25, v25
    v_mul_f32 v30, v26, v26
    v_mul_f32 v31, v27, v27
    v_fmamk_f32 v28, v28, 0xbdd2d3e8, v36
    v_fmamk_f32 v29, v29, 0xbdd2d3e8, v36
    buffer_load_dwordx4 v3, s[16:19], s60 offen offset:2048 lds
    v_fmamk_f32 v30, v30, 0xbdd2d3e8, v36
    v_fmamk_f32 v31, v31, 0xbdd2d3e8, v36
    v_mul_f32 v28, v28, v24
    v_mul_f32 v29, v29, v25
    v_mul_f32 v30, v30, v26
    v_mul_f32 v31, v31, v27
    v_exp_f32 v28, v28
    v_exp_f32 v29, v29
    v_exp_f32 v30, v30
    v_exp_f32 v31, v31
    buffer_load_dwordx4 v4, s[16:19], s60 offen offset:3072 lds
    v_add_f32 v28, 1.0, v28
    v_add_f32 v29, 1.0, v29
    v_add_f32 v30, 1.0, v30
    v_add_f32 v31, 1.0, v31
    v_rcp_f32 v28, v28
    v_rcp_f32 v29, v29
    v_rcp_f32 v30, v30
    v_rcp_f32 v31, v31
    v_mul_f32 v24, v24, v28
    s_add_u32 m0, s54, 40960
    s_nop 0
    buffer_load_dwordx4 v5, s[16:19], s60 offen offset:0 lds
    v_mul_f32 v25, v25, v29
    v_mul_f32 v26, v26, v30
    v_mul_f32 v27, v27, v31
    v_cvt_pk_bf16_f32 v112, v24, v25
    v_cvt_pk_bf16_f32 v113, v26, v27
    v_add_f32 v14, v14, v24
    v_fmac_f32 v16, v24, v24
    v_add_f32 v15, v15, v26
    v_fmac_f32 v17, v26, v26
    v_add_f32 v14, v14, v25
    v_add_f32 v15, v15, v27
    v_fmac_f32 v16, v25, v25
    v_fmac_f32 v17, v27, v27
    s_add_u32 m0, s54, 92160
    s_mov_b32 s60, 589824
    buffer_load_dwordx4 v1, s[16:19], s60 offen offset:0 lds
    v_lshlrev_b32 v24, 16, v114
    v_and_b32 v25, s62, v114
    v_lshlrev_b32 v26, 16, v115
    v_and_b32 v27, s62, v115
    v_mul_f32 v28, v24, v24
    v_mul_f32 v29, v25, v25
    v_mul_f32 v30, v26, v26
    v_mul_f32 v31, v27, v27
    v_fmamk_f32 v28, v28, 0xbdd2d3e8, v36
    v_fmamk_f32 v29, v29, 0xbdd2d3e8, v36
    v_fmamk_f32 v30, v30, 0xbdd2d3e8, v36
    v_fmamk_f32 v31, v31, 0xbdd2d3e8, v36
    v_mul_f32 v28, v28, v24
    buffer_load_dwordx4 v2, s[16:19], s60 offen offset:1024 lds
    v_mul_f32 v29, v29, v25
    v_mul_f32 v30, v30, v26
    v_mul_f32 v31, v31, v27
    v_exp_f32 v28, v28
    v_exp_f32 v29, v29
    v_exp_f32 v30, v30
    v_exp_f32 v31, v31
    v_add_f32 v28, 1.0, v28
    v_add_f32 v29, 1.0, v29
    buffer_load_dwordx4 v3, s[16:19], s60 offen offset:2048 lds
    v_add_f32 v30, 1.0, v30
    v_add_f32 v31, 1.0, v31
    v_rcp_f32 v28, v28
    v_rcp_f32 v29, v29
    v_rcp_f32 v30, v30
    v_rcp_f32 v31, v31
    v_mul_f32 v24, v24, v28
    v_mul_f32 v25, v25, v29
    v_mul_f32 v26, v26, v30
    buffer_load_dwordx4 v4, s[16:19], s60 offen offset:3072 lds
    v_mul_f32 v27, v27, v31
    v_cvt_pk_bf16_f32 v114, v24, v25
    v_cvt_pk_bf16_f32 v115, v26, v27
    v_add_f32 v18, v18, v24
    v_fmac_f32 v20, v24, v24
    v_add_f32 v19, v19, v26
    v_fmac_f32 v21, v26, v26
    v_add_f32 v18, v18, v25
    v_add_f32 v19, v19, v27
    v_fmac_f32 v20, v25, v25
    v_fmac_f32 v21, v27, v27
    v_lshlrev_b32 v24, 16, v116
    v_and_b32 v25, s62, v116
    s_add_u32 m0, s54, 96256
    s_nop 0
    buffer_load_dwordx4 v5, s[16:19], s60 offen offset:0 lds
    v_lshlrev_b32 v26, 16, v117
    v_and_b32 v27, s62, v117
    v_mul_f32 v28, v24, v24
    v_mul_f32 v29, v25, v25
    v_mul_f32 v30, v26, v26
    v_mul_f32 v31, v27, v27
    v_fmamk_f32 v28, v28, 0xbdd2d3e8, v36
    v_fmamk_f32 v29, v29, 0xbdd2d3e8, v36
    v_fmamk_f32 v30, v30, 0xbdd2d3e8, v36
    v_fmamk_f32 v31, v31, 0xbdd2d3e8, v36
    v_mul_f32 v28, v28, v24
    v_mul_f32 v29, v29, v25
    v_mul_f32 v30, v30, v26
    v_mul_f32 v31, v31, v27
    v_exp_f32 v28, v28
    v_exp_f32 v29, v29
    v_exp_f32 v30, v30
    v_exp_f32 v31, v31
    v_add_f32 v28, 1.0, v28
    v_add_f32 v29, 1.0, v29
    v_add_f32 v30, 1.0, v30
    v_add_f32 v31, 1.0, v31
    s_waitcnt vmcnt(24)
    s_barrier
    s_add_u32 m0, s54, 0
    s_mov_b32 s60, 1179648
    buffer_load_dwordx4 v1, s[16:19], s60 offen offset:0 lds
    v_rcp_f32 v28, v28
    v_rcp_f32 v29, v29
    v_rcp_f32 v30, v30
    v_rcp_f32 v31, v31
    v_mul_f32 v24, v24, v28
    v_mul_f32 v25, v25, v29
    v_mul_f32 v26, v26, v30
    v_mul_f32 v27, v27, v31
    v_cvt_pk_bf16_f32 v116, v24, v25
    v_cvt_pk_bf16_f32 v117, v26, v27
    v_add_f32 v14, v14, v24
    v_fmac_f32 v16, v24, v24
    v_add_f32 v15, v15, v26
    v_fmac_f32 v17, v26, v26
    v_add_f32 v14, v14, v25
    v_add_f32 v15, v15, v27
    v_fmac_f32 v16, v25, v25
    v_fmac_f32 v17, v27, v27
    s_lshl_b32 s63, s51, 12
    s_add_u32 s63, s63, 147456
    v_add_u32 v40, s63, v6
    ds_read_b128 v[128:131], v40
    ds_read_b128 v[132:135], v40 offset:1024
    ds_read_b128 v[44:47], v40 offset:2048
    ds_read_b128 v[52:55], v40 offset:3072
    buffer_load_dwordx4 v2, s[16:19], s60 offen offset:1024 lds
    v_lshlrev_b32 v24, 16, v118
    v_and_b32 v25, s62, v118
    v_lshlrev_b32 v26, 16, v119
    v_and_b32 v27, s62, v119
    v_mul_f32 v28, v24, v24
    v_mul_f32 v29, v25, v25
    v_mul_f32 v30, v26, v26
    v_mul_f32 v31, v27, v27
    v_fmamk_f32 v28, v28, 0xbdd2d3e8, v36
    v_fmamk_f32 v29, v29, 0xbdd2d3e8, v36
    v_fmamk_f32 v30, v30, 0xbdd2d3e8, v36
    v_fmamk_f32 v31, v31, 0xbdd2d3e8, v36
    v_mul_f32 v28, v28, v24
    v_mul_f32 v29, v29, v25
    v_mul_f32 v30, v30, v26
    v_mul_f32 v31, v31, v27
    v_exp_f32 v28, v28
    v_exp_f32 v29, v29
    v_exp_f32 v30, v30
    v_exp_f32 v31, v31
    v_add_f32 v28, 1.0, v28
    v_add_f32 v29, 1.0, v29
    v_add_f32 v30, 1.0, v30
    v_add_f32 v31, 1.0, v31
    buffer_load_dwordx4 v3, s[16:19], s60 offen offset:2048 lds
    v_rcp_f32 v28, v28
    v_rcp_f32 v29, v29
    v_rcp_f32 v30, v30
    v_rcp_f32 v31, v31
    v_mul_f32 v24, v24, v28
    v_mul_f32 v25, v25, v29
    v_mul_f32 v26, v26, v30
    v_mul_f32 v27, v27, v31
    v_cvt_pk_bf16_f32 v118, v24, v25
    v_cvt_pk_bf16_f32 v119, v26, v27
    v_add_f32 v18, v18, v24
    v_fmac_f32 v20, v24, v24
    v_add_f32 v19, v19, v26
    v_fmac_f32 v21, v26, v26
    v_add_f32 v18, v18, v25
    v_add_f32 v19, v19, v27
    v_fmac_f32 v20, v25, v25
    v_fmac_f32 v21, v27, v27
    v_lshlrev_b32 v24, 16, v120
    v_and_b32 v25, s62, v120
    v_lshlrev_b32 v26, 16, v121
    v_and_b32 v27, s62, v121
    v_mul_f32 v28, v24, v24
    v_mul_f32 v29, v25, v25
    buffer_load_dwordx4 v4, s[16:19], s60 offen offset:3072 lds
    v_mul_f32 v30, v26, v26
    v_mul_f32 v31, v27, v27
    v_fmamk_f32 v28, v28, 0xbdd2d3e8, v36
    v_fmamk_f32 v29, v29, 0xbdd2d3e8, v36
    v_fmamk_f32 v30, v30, 0xbdd2d3e8, v36
    v_fmamk_f32 v31, v31, 0xbdd2d3e8, v36
    v_mul_f32 v28, v28, v24
    v_mul_f32 v29, v29, v25
    v_mul_f32 v30, v30, v26
    v_mul_f32 v31, v31, v27
    v_exp_f32 v28, v28
    v_exp_f32 v29, v29
    v_exp_f32 v30, v30
    v_exp_f32 v31, v31
    v_add_f32 v28, 1.0, v28
    v_add_f32 v29, 1.0, v29
    v_add_f32 v30, 1.0, v30
    v_add_f32 v31, 1.0, v31
    v_rcp_f32 v28, v28
    v_rcp_f32 v29, v29
    v_rcp_f32 v30, v30
    s_add_u32 m0, s54, 4096
    s_nop 0
    buffer_load_dwordx4 v5, s[16:19], s60 offen offset:0 lds
    v_rcp_f32 v31, v31
    v_mul_f32 v24, v24, v28
    v_mul_f32 v25, v25, v29
    v_mul_f32 v26, v26, v30
    v_mul_f32 v27, v27, v31
    v_cvt_pk_bf16_f32 v120, v24, v25
    v_cvt_pk_bf16_f32 v121, v26, v27
    v_add_f32 v14, v14, v24
    v_fmac_f32 v16, v24, v24
    v_add_f32 v15, v15, v26
    v_fmac_f32 v17, v26, v26
    v_add_f32 v14, v14, v25
    v_add_f32 v15, v15, v27
    v_fmac_f32 v16, v25, v25
    v_fmac_f32 v17, v27, v27
    v_lshlrev_b32 v24, 16, v122
    v_and_b32 v25, s62, v122
    v_lshlrev_b32 v26, 16, v123
    v_and_b32 v27, s62, v123
    v_mul_f32 v28, v24, v24
    v_mul_f32 v29, v25, v25
    v_mul_f32 v30, v26, v26
    v_mul_f32 v31, v27, v27
    v_fmamk_f32 v28, v28, 0xbdd2d3e8, v36
    v_fmamk_f32 v29, v29, 0xbdd2d3e8, v36
    v_fmamk_f32 v30, v30, 0xbdd2d3e8, v36
    v_fmamk_f32 v31, v31, 0xbdd2d3e8, v36
    v_mul_f32 v28, v28, v24
    v_mul_f32 v29, v29, v25
    v_mul_f32 v30, v30, v26
    v_mul_f32 v31, v31, v27
    v_exp_f32 v28, v28
    v_exp_f32 v29, v29
    v_exp_f32 v30, v30
    v_exp_f32 v31, v31
    v_add_f32 v28, 1.0, v28
    v_add_f32 v29, 1.0, v29
    v_add_f32 v30, 1.0, v30
    v_add_f32 v31, 1.0, v31
    v_rcp_f32 v28, v28
    v_rcp_f32 v29, v29
    v_rcp_f32 v30, v30
    v_rcp_f32 v31, v31
    v_mul_f32 v24, v24, v28
    v_mul_f32 v25, v25, v29
    v_mul_f32 v26, v26, v30
    v_mul_f32 v27, v27, v31
    s_waitcnt vmcnt(23)
    s_barrier
    s_add_u32 m0, s54, 18432
    s_mov_b32 s60, 1769472
    buffer_load_dwordx4 v1, s[16:19], s60 offen offset:0 lds
    v_cvt_pk_bf16_f32 v122, v24, v25
    v_cvt_pk_bf16_f32 v123, v26, v27
    v_add_f32 v18, v18, v24
    v_fmac_f32 v20, v24, v24
    v_add_f32 v19, v19, v26
    v_fmac_f32 v21, v26, v26
    v_add_f32 v18, v18, v25
    v_add_f32 v19, v19, v27
    v_fmac_f32 v20, v25, v25
    v_fmac_f32 v21, v27, v27
    v_lshlrev_b32 v24, 16, v124
    v_and_b32 v25, s62, v124
    v_lshlrev_b32 v26, 16, v125
    v_and_b32 v27, s62, v125
    v_mul_f32 v28, v24, v24
    v_mul_f32 v29, v25, v25
    v_mul_f32 v30, v26, v26
    v_mul_f32 v31, v27, v27
    v_fmamk_f32 v28, v28, 0xbdd2d3e8, v36
    v_fmamk_f32 v29, v29, 0xbdd2d3e8, v36
    v_fmamk_f32 v30, v30, 0xbdd2d3e8, v36
    v_fmamk_f32 v31, v31, 0xbdd2d3e8, v36
    v_mul_f32 v28, v28, v24
    v_mul_f32 v29, v29, v25
    v_mul_f32 v30, v30, v26
    v_mul_f32 v31, v31, v27
    v_exp_f32 v28, v28
    buffer_load_dwordx4 v2, s[16:19], s60 offen offset:1024 lds
    v_exp_f32 v29, v29
    v_exp_f32 v30, v30
    v_exp_f32 v31, v31
    v_add_f32 v28, 1.0, v28
    v_add_f32 v29, 1.0, v29
    v_add_f32 v30, 1.0, v30
    v_add_f32 v31, 1.0, v31
    v_rcp_f32 v28, v28
    v_rcp_f32 v29, v29
    v_rcp_f32 v30, v30
    v_rcp_f32 v31, v31
    v_mul_f32 v24, v24, v28
    v_mul_f32 v25, v25, v29
    v_mul_f32 v26, v26, v30
    v_mul_f32 v27, v27, v31
    v_cvt_pk_bf16_f32 v124, v24, v25
    v_cvt_pk_bf16_f32 v125, v26, v27
    v_add_f32 v14, v14, v24
    v_fmac_f32 v16, v24, v24
    v_add_f32 v15, v15, v26
    buffer_load_dwordx4 v3, s[16:19], s60 offen offset:2048 lds
    v_fmac_f32 v17, v26, v26
    v_add_f32 v14, v14, v25
    v_add_f32 v15, v15, v27
    v_fmac_f32 v16, v25, v25
    v_fmac_f32 v17, v27, v27
    v_lshlrev_b32 v24, 16, v126
    v_and_b32 v25, s62, v126
    v_lshlrev_b32 v26, 16, v127
    v_and_b32 v27, s62, v127
    v_mul_f32 v28, v24, v24
    v_mul_f32 v29, v25, v25
    v_mul_f32 v30, v26, v26
    v_mul_f32 v31, v27, v27
    v_fmamk_f32 v28, v28, 0xbdd2d3e8, v36
    v_fmamk_f32 v29, v29, 0xbdd2d3e8, v36
    v_fmamk_f32 v30, v30, 0xbdd2d3e8, v36
    v_fmamk_f32 v31, v31, 0xbdd2d3e8, v36
    v_mul_f32 v28, v28, v24
    v_mul_f32 v29, v29, v25
    v_mul_f32 v30, v30, v26
    v_mul_f32 v31, v31, v27
    v_exp_f32 v28, v28
    v_exp_f32 v29, v29
    v_exp_f32 v30, v30
    buffer_load_dwordx4 v4, s[16:19], s60 offen offset:3072 lds
    v_exp_f32 v31, v31
    v_add_f32 v28, 1.0, v28
    v_add_f32 v29, 1.0, v29
    v_add_f32 v30, 1.0, v30
    v_add_f32 v31, 1.0, v31
    v_rcp_f32 v28, v28
    v_rcp_f32 v29, v29
    v_rcp_f32 v30, v30
    v_rcp_f32 v31, v31
    v_mul_f32 v24, v24, v28
    v_mul_f32 v25, v25, v29
    v_mul_f32 v26, v26, v30
    v_mul_f32 v27, v27, v31
    v_cvt_pk_bf16_f32 v126, v24, v25
    v_cvt_pk_bf16_f32 v127, v26, v27
    v_add_f32 v18, v18, v24
    v_fmac_f32 v20, v24, v24
    v_add_f32 v19, v19, v26
    v_fmac_f32 v21, v26, v26
    v_add_f32 v18, v18, v25
    v_add_f32 v19, v19, v27
    v_fmac_f32 v20, v25, v25
    s_add_u32 m0, s54, 22528
    s_nop 0
    buffer_load_dwordx4 v5, s[16:19], s60 offen offset:0 lds
    v_fmac_f32 v21, v27, v27
    s_waitcnt lgkmcnt(0)
    v_add_f32 v14, v14, v44
    v_add_f32 v15, v15, v45
    v_add_f32 v16, v16, v46
    v_add_f32 v17, v17, v47
    v_add_f32 v18, v18, v52
    v_add_f32 v19, v19, v53
    v_add_f32 v20, v20, v54
    v_add_f32 v21, v21, v55
    v_add_f32 v14, v14, v15
    v_add_f32 v16, v16, v17
    v_add_f32 v18, v18, v19
    v_add_f32 v20, v20, v21
    v_mov_b32 v24, v14
    v_mov_b32 v25, v16
    v_mov_b32 v26, v18
    v_mov_b32 v27, v20
    v_permlane32_swap_b32 v14, v24
    v_permlane32_swap_b32 v16, v25
    v_permlane32_swap_b32 v18, v26
    v_permlane32_swap_b32 v20, v27
    v_add_f32 v14, v14, v24
    v_add_f32 v16, v16, v25
    v_add_f32 v18, v18, v26
    v_add_f32 v20, v20, v27
    v_mov_b32 v24, v14
    v_mov_b32 v25, v16
    v_mov_b32 v26, v18
    v_mov_b32 v27, v20
    v_permlane16_swap_b32 v14, v24
    v_permlane16_swap_b32 v16, v25
    v_permlane16_swap_b32 v18, v26
    v_permlane16_swap_b32 v20, v27
    v_add_f32 v14, v14, v24
    v_add_f32 v16, v16, v25
    v_add_f32 v18, v18, v26
    v_add_f32 v20, v20, v27
    s_mov_b32 s64, 0xffff0000
    s_mov_b32 s65, 0
    v_cndmask_b32 v24, v14, v18, s[64:65]
    v_cndmask_b32 v26, v16, v20, s[64:65]
    v_mov_b32 v25, s71
    v_mov_b32 v27, s71
    s_lshl_b32 s63, s48, 4
    s_add_u32 s63, s63, s49
    s_lshl_b32 s63, s63, 2
    s_add_u32 s63, s63, s51
    s_lshl_b32 s63, s63, 9
    s_mov_b32 exec_hi, 0
    buffer_store_dwordx4 v[24:27], v6, s[36:39], s63 offen sc1
    s_mov_b64 exec, -1
    s_waitcnt vmcnt(25)
    s_barrier
    s_add_u32 m0, s54, 110592
    s_mov_b32 s60, 2359296
    buffer_load_dwordx4 v1, s[16:19], s60 offen offset:0 lds
    buffer_load_dwordx4 v2, s[16:19], s60 offen offset:1024 lds
    buffer_load_dwordx4 v3, s[16:19], s60 offen offset:2048 lds
    buffer_load_dwordx4 v4, s[16:19], s60 offen offset:3072 lds
    s_add_u32 m0, s54, 114688
    s_nop 0
    buffer_load_dwordx4 v5, s[16:19], s60 offen offset:0 lds
    s_waitcnt vmcnt(26)
    s_barrier
    s_add_u32 m0, s54, 55296
    s_mov_b32 s60, 2949120
    buffer_load_dwordx4 v1, s[16:19], s60 offen offset:0 lds
    buffer_load_dwordx4 v2, s[16:19], s60 offen offset:1024 lds
    buffer_load_dwordx4 v3, s[16:19], s60 offen offset:2048 lds
    buffer_load_dwordx4 v4, s[16:19], s60 offen offset:3072 lds
    s_add_u32 m0, s54, 59392
    s_nop 0
    buffer_load_dwordx4 v5, s[16:19], s60 offen offset:0 lds
    s_waitcnt vmcnt(26)
    s_barrier
    s_waitcnt vmcnt(21)
    s_barrier
    v_lshrrev_b32 v32, 4, v0
    v_lshlrev_b32 v32, 13, v32
    v_and_b32 v33, 15, v0
    v_lshl_add_u32 v32, v33, 4, v32
    s_lshl_b32 s64, s48, 15
    s_lshl_b32 s65, s51, 9
    s_add_u32 s64, s64, s65
    s_add_u32 s65, s64, 4096
    buffer_load_dwordx4 v[40:43], v32, s[36:39], s64 offen offset:0 sc1
    buffer_load_dwordx4 v[44:47], v32, s[36:39], s64 offen offset:2048 sc1
    buffer_load_dwordx4 v[48:51], v32, s[36:39], s65 offen offset:0 sc1
    buffer_load_dwordx4 v[52:55], v32, s[36:39], s65 offen offset:2048 sc1
    buffer_load_dwordx4 v[56:59], v32, s[36:39], s64 offen offset:256 sc1
    buffer_load_dwordx4 v[60:63], v32, s[36:39], s64 offen offset:2304 sc1
    buffer_load_dwordx4 v[64:67], v32, s[36:39], s65 offen offset:256 sc1
    buffer_load_dwordx4 v[68:71], v32, s[36:39], s65 offen offset:2304 sc1
    s_waitcnt vmcnt(24)
    s_barrier
    s_add_u32 m0, s54, 36864
    s_mov_b32 s60, 3538944
    buffer_load_dwordx4 v1, s[16:19], s60 offen offset:0 lds
    s_and_b32 s63, s51, 1
    s_mul_i32 s63, s63, 9216
    s_add_u32 s63, s63, 73728
    v_add_u32 v24, s63, v6
    ds_read_b128 v[140:143], v24 offset:0
    ds_read_b128 v[144:147], v24 offset:1024
    ds_read_b128 v[148:151], v24 offset:2048
    ds_read_b128 v[152:155], v24 offset:3072
    ds_read_b128 v[156:159], v24 offset:4096
    ds_read_b128 v[196:199], v24 offset:5120
    ds_read_b128 v[200:203], v24 offset:6144
    s_waitcnt lgkmcnt(0)
    buffer_load_dwordx4 v2, s[16:19], s60 offen offset:1024 lds
    s_lshl_b32 s61, s48, 2
    s_add_u32 s61, s61, s51
    s_mul_i32 s61, s61, 110592
    s_lshl_b32 s63, s67, 5
    s_add_u32 s61, s61, s63
    s_add_u32 s70, s61, 4096
    v_permlane16_swap_b32 v140, v142
    v_permlane16_swap_b32 v141, v143
    v_permlane16_swap_b32 v144, v146
    v_permlane16_swap_b32 v145, v147
    v_permlane16_swap_b32 v148, v150
    v_permlane16_swap_b32 v149, v151
    v_permlane16_swap_b32 v152, v154
    buffer_load_dwordx4 v3, s[16:19], s60 offen offset:2048 lds
    v_permlane16_swap_b32 v153, v155
    v_permlane16_swap_b32 v156, v158
    v_permlane16_swap_b32 v157, v159
    v_permlane16_swap_b32 v196, v198
    v_permlane16_swap_b32 v197, v199
    v_permlane16_swap_b32 v200, v202
    v_permlane16_swap_b32 v201, v203
    buffer_load_dwordx4 v4, s[16:19], s60 offen offset:3072 lds
    s_add_u32 m0, s54, 40960
    s_nop 0
    buffer_load_dwordx4 v5, s[16:19], s60 offen offset:0 lds
    s_waitcnt vmcnt(24)
    s_barrier
    s_add_u32 m0, s54, 92160
    s_mov_b32 s60, 4128768
    buffer_load_dwordx4 v1, s[16:19], s60 offen offset:0 lds
    s_waitcnt vmcnt(6)
    v_xor_b32 v24, s71, v41
    v_xor_b32 v25, s71, v43
    v_xor_b32 v26, s71, v45
    v_xor_b32 v27, s71, v47
    v_or3_b32 v25, v25, v26, v27
    v_xor_b32 v26, s71, v49
    v_xor_b32 v27, s71, v51
    v_or3_b32 v24, v24, v26, v27
    v_xor_b32 v26, s71, v53
    v_xor_b32 v27, s71, v55
    buffer_load_dwordx4 v2, s[16:19], s60 offen offset:1024 lds
    v_or3_b32 v25, v25, v26, v27
    v_xor_b32 v26, s71, v57
    v_xor_b32 v27, s71, v59
    v_or3_b32 v24, v24, v26, v27
    v_xor_b32 v26, s71, v61
    v_xor_b32 v27, s71, v63
    v_or3_b32 v25, v25, v26, v27
    v_xor_b32 v26, s71, v65
    v_xor_b32 v27, s71, v67
    v_or3_b32 v24, v24, v26, v27
    buffer_load_dwordx4 v3, s[16:19], s60 offen offset:2048 lds
    v_xor_b32 v26, s71, v69
    v_xor_b32 v27, s71, v71
    v_or3_b32 v25, v25, v26, v27
    v_or_b32 v24, v24, v25
    v_cmp_ne_u32 vcc, 0, v24
    s_nop 4
    s_cbranch_vccz L_pok_1
    s_mov_b32 s63, 0
L_pspin_1:
    s_sleep 4
    buffer_load_dwordx4 v[40:43], v32, s[36:39], s64 offen offset:0 sc1
    buffer_load_dwordx4 v[44:47], v32, s[36:39], s64 offen offset:2048 sc1
    buffer_load_dwordx4 v[48:51], v32, s[36:39], s65 offen offset:0 sc1
    buffer_load_dwordx4 v[52:55], v32, s[36:39], s65 offen offset:2048 sc1
    buffer_load_dwordx4 v[56:59], v32, s[36:39], s64 offen offset:256 sc1
    buffer_load_dwordx4 v[60:63], v32, s[36:39], s64 offen offset:2304 sc1
    buffer_load_dwordx4 v[64:67], v32, s[36:39], s65 offen offset:256 sc1
    buffer_load_dwordx4 v[68:71], v32, s[36:39], s65 offen offset:2304 sc1
    s_add_u32 s63, s63, 1
    s_cmp_gt_u32 s63, 50000
    s_cbranch_scc1 L_pok_1
    s_waitcnt vmcnt(0)
    v_xor_b32 v24, s71, v41
    v_xor_b32 v25, s71, v43
    v_xor_b32 v26, s71, v45
    v_xor_b32 v27, s71, v47
    v_or3_b32 v25, v25, v26, v27
    v_xor_b32 v26, s71, v49
    v_xor_b32 v27, s71, v51
    v_or3_b32 v24, v24, v26, v27
    v_xor_b32 v26, s71, v53
    v_xor_b32 v27, s71, v55
    v_or3_b32 v25, v25, v26, v27
    v_xor_b32 v26, s71, v57
    v_xor_b32 v27, s71, v59
    v_or3_b32 v24, v24, v26, v27
    v_xor_b32 v26, s71, v61
    v_xor_b32 v27, s71, v63
    v_or3_b32 v25, v25, v26, v27
    v_xor_b32 v26, s71, v65
    v_xor_b32 v27, s71, v67
    v_or3_b32 v24, v24, v26, v27
    v_xor_b32 v26, s71, v69
    v_xor_b32 v27, s71, v71
    v_or3_b32 v25, v25, v26, v27
    v_or_b32 v24, v24, v25
    v_cmp_ne_u32 vcc, 0, v24
    s_nop 4
    s_cbranch_vccnz L_pspin_1
L_pok_1:
    v_add_f32 v40, v40, v44
    v_add_f32 v48, v48, v52
    v_add_f32 v42, v42, v46
    v_add_f32 v50, v50, v54
    buffer_load_dwordx4 v4, s[16:19], s60 offen offset:3072 lds
    v_add_f32 v56, v56, v60
    v_add_f32 v64, v64, v68
    v_add_f32 v58, v58, v62
    v_add_f32 v66, v66, v70
    v_add_f32 v14, v40, v48
    v_add_f32 v15, v42, v50
    v_add_f32 v18, v56, v64
    v_add_f32 v19, v58, v66
    v_mov_b32 v24, v14
    v_mov_b32 v25, v15
    s_add_u32 m0, s54, 96256
    s_nop 0
    buffer_load_dwordx4 v5, s[16:19], s60 offen offset:0 lds
    v_mov_b32 v26, v18
    v_mov_b32 v27, v19
    v_permlane32_swap_b32 v14, v24
    v_permlane32_swap_b32 v15, v25
    v_permlane32_swap_b32 v18, v26
    v_permlane32_swap_b32 v19, v27
    v_add_f32 v14, v14, v24
    v_add_f32 v15, v15, v25
    v_add_f32 v18, v18, v26
    v_add_f32 v19, v19, v27
    s_add_u32 m0, s54, 73728
    s_mov_b32 s60, 4718592
    buffer_load_dwordx4 v1, s[16:19], s60 offen offset:0 lds
    v_mov_b32 v24, v14
    v_mov_b32 v25, v15
    v_mov_b32 v26, v18
    v_mov_b32 v27, v19
    v_permlane16_swap_b32 v14, v24
    v_permlane16_swap_b32 v15, v25
    v_permlane16_swap_b32 v18, v26
    v_permlane16_swap_b32 v19, v27
    v_add_f32 v14, v14, v24
    v_add_f32 v15, v15, v25
    buffer_load_dwordx4 v2, s[16:19], s60 offen offset:1024 lds
    v_add_f32 v18, v18, v26
    v_add_f32 v19, v19, v27
    v_mul_f32 v14, 0x39e38e39, v14
    v_mul_f32 v18, 0x39e38e39, v18
    v_mul_f32 v15, 0x39e38e39, v15
    v_mul_f32 v19, 0x39e38e39, v19
    v_fma_f32 v15, -v14, v14, v15
    v_fma_f32 v19, -v18, v18, v19
    v_max_f32 v15, 0, v15
    v_max_f32 v19, 0, v19
    buffer_load_dwordx4 v3, s[16:19], s60 offen offset:2048 lds
    v_add_f32 v15, 0x3727c5ac, v15
    v_add_f32 v19, 0x3727c5ac, v19
    v_rsq_f32 v16, v15
    v_rsq_f32 v20, v19
    v_mul_f32 v14, -v14, v16
    v_mul_f32 v18, -v18, v20
    v_bfe_u32 v33, v0, 4, 1
    v_lshlrev_b32 v33, 2, v33
    buffer_load_dwordx4 v4, s[16:19], s60 offen offset:3072 lds
    v_xor_b32 v33, v0, v33
    v_lshlrev_b32 v33, 4, v33
    s_lshl_b32 s66, s49, 6
    s_lshl_b32 s63, s48, 2
    s_add_u32 s66, s66, s63
    s_add_u32 s66, s66, s51
    s_mul_i32 s66, s66, 9216
    s_mov_b32 s14, 0
    s_mov_b32 s15, -1
    v_lshlrev_b32 v24, 16, v100
    v_and_b32 v25, s62, v100
    v_lshlrev_b32 v26, 16, v101
    v_and_b32 v27, s62, v101
    v_fma_f32 v24, v24, v16, v14
    s_add_u32 m0, s54, 77824
    s_nop 0
    buffer_load_dwordx4 v5, s[16:19], s60 offen offset:0 lds
    v_fma_f32 v25, v25, v16, v14
    v_fma_f32 v26, v26, v16, v14
    v_fma_f32 v27, v27, v16, v14
    v_cvt_pk_bf16_f32 v100, v24, v25
    v_cvt_pk_bf16_f32 v101, v26, v27
    v_lshlrev_b32 v28, 16, v102
    v_and_b32 v29, s62, v102
    v_lshlrev_b32 v30, 16, v103
    v_and_b32 v31, s62, v103
    v_fma_f32 v28, v28, v20, v18
    v_fma_f32 v29, v29, v20, v18
    v_fma_f32 v30, v30, v20, v18
    v_fma_f32 v31, v31, v20, v18
    v_cvt_pk_bf16_f32 v102, v28, v29
    v_cvt_pk_bf16_f32 v103, v30, v31
    v_cndmask_b32 v40, v100, v102, s[14:15]
    v_cndmask_b32 v41, v101, v103, s[14:15]
    v_cndmask_b32 v42, v102, v100, s[14:15]
    v_cndmask_b32 v43, v103, v101, s[14:15]
    s_add_u32 s63, s66, 0
    buffer_store_dwordx4 v[40:43], v33, s[24:27], s63 offen sc1
    s_barrier
    buffer_store_dwordx4 v[140:143], v6, s[32:35], s61 offen offset:0 sc1
    v_lshlrev_b32 v24, 16, v104
    v_and_b32 v25, s62, v104
    v_lshlrev_b32 v26, 16, v105
    v_and_b32 v27, s62, v105
    v_fma_f32 v24, v24, v16, v14
    v_fma_f32 v25, v25, v16, v14
    v_fma_f32 v26, v26, v16, v14
    v_fma_f32 v27, v27, v16, v14
    v_cvt_pk_bf16_f32 v104, v24, v25
    v_cvt_pk_bf16_f32 v105, v26, v27
    v_lshlrev_b32 v28, 16, v106
    v_and_b32 v29, s62, v106
    v_lshlrev_b32 v30, 16, v107
    v_and_b32 v31, s62, v107
    v_fma_f32 v28, v28, v20, v18
    v_fma_f32 v29, v29, v20, v18
    v_fma_f32 v30, v30, v20, v18
    v_fma_f32 v31, v31, v20, v18
    v_cvt_pk_bf16_f32 v106, v28, v29
    v_cvt_pk_bf16_f32 v107, v30, v31
    v_cndmask_b32 v44, v104, v106, s[14:15]
    v_cndmask_b32 v45, v105, v107, s[14:15]
    v_cndmask_b32 v46, v106, v104, s[14:15]
    v_cndmask_b32 v47, v107, v105, s[14:15]
    s_add_u32 s63, s66, 1024
    buffer_store_dwordx4 v[44:47], v33, s[24:27], s63 offen sc1
    v_lshlrev_b32 v24, 16, v108
    v_and_b32 v25, s62, v108
    v_lshlrev_b32 v26, 16, v109
    v_and_b32 v27, s62, v109
    v_fma_f32 v24, v24, v16, v14
    v_fma_f32 v25, v25, v16, v14
    v_fma_f32 v26, v26, v16, v14
    v_fma_f32 v27, v27, v16, v14
    v_cvt_pk_bf16_f32 v108, v24, v25
    v_cvt_pk_bf16_f32 v109, v26, v27
    v_lshlrev_b32 v28, 16, v110
    v_and_b32 v29, s62, v110
    v_lshlrev_b32 v30, 16, v111
    v_and_b32 v31, s62, v111
    v_fma_f32 v28, v28, v20, v18
    v_fma_f32 v29, v29, v20, v18
    v_fma_f32 v30, v30, v20, v18
    v_fma_f32 v31, v31, v20, v18
    v_cvt_pk_bf16_f32 v110, v28, v29
    v_cvt_pk_bf16_f32 v111, v30, v31
    v_cndmask_b32 v48, v108, v110, s[14:15]
    v_cndmask_b32 v49, v109, v111, s[14:15]
    v_cndmask_b32 v50, v110, v108, s[14:15]
    v_cndmask_b32 v51, v111, v109, s[14:15]
    s_add_u32 s63, s66, 2048
    buffer_store_dwordx4 v[48:51], v33, s[24:27], s63 offen sc1
    v_lshlrev_b32 v24, 16, v112
    v_and_b32 v25, s62, v112
    v_lshlrev_b32 v26, 16, v113
    v_and_b32 v27, s62, v113
    v_fma_f32 v24, v24, v16, v14
    v_fma_f32 v25, v25, v16, v14
    v_fma_f32 v26, v26, v16, v14
    v_fma_f32 v27, v27, v16, v14
    v_cvt_pk_bf16_f32 v112, v24, v25
    v_cvt_pk_bf16_f32 v113, v26, v27
    v_lshlrev_b32 v28, 16, v114
    v_and_b32 v29, s62, v114
    v_lshlrev_b32 v30, 16, v115
    v_and_b32 v31, s62, v115
    v_fma_f32 v28, v28, v20, v18
    v_fma_f32 v29, v29, v20, v18
    v_fma_f32 v30, v30, v20, v18
    v_fma_f32 v31, v31, v20, v18
    v_cvt_pk_bf16_f32 v114, v28, v29
    v_cvt_pk_bf16_f32 v115, v30, v31
    v_cndmask_b32 v52, v112, v114, s[14:15]
    v_cndmask_b32 v53, v113, v115, s[14:15]
    v_cndmask_b32 v54, v114, v112, s[14:15]
    v_cndmask_b32 v55, v115, v113, s[14:15]
    s_add_u32 s63, s66, 3072
    buffer_store_dwordx4 v[52:55], v33, s[24:27], s63 offen sc1
    v_lshlrev_b32 v24, 16, v116
    v_and_b32 v25, s62, v116
    v_lshlrev_b32 v26, 16, v117
    v_and_b32 v27, s62, v117
    v_fma_f32 v24, v24, v16, v14
    v_fma_f32 v25, v25, v16, v14
    v_fma_f32 v26, v26, v16, v14
    v_fma_f32 v27, v27, v16, v14
    v_cvt_pk_bf16_f32 v116, v24, v25
    v_cvt_pk_bf16_f32 v117, v26, v27
    v_lshlrev_b32 v28, 16, v118
    v_and_b32 v29, s62, v118
    v_lshlrev_b32 v30, 16, v119
    v_and_b32 v31, s62, v119
    v_fma_f32 v28, v28, v20, v18
    v_fma_f32 v29, v29, v20, v18
    v_fma_f32 v30, v30, v20, v18
    v_fma_f32 v31, v31, v20, v18
    v_cvt_pk_bf16_f32 v118, v28, v29
    v_cvt_pk_bf16_f32 v119, v30, v31
    v_cndmask_b32 v56, v116, v118, s[14:15]
    s_barrier
    buffer_store_dwordx4 v[144:147], v6, s[32:35], s61 offen offset:1024 sc1
    v_cndmask_b32 v57, v117, v119, s[14:15]
    v_cndmask_b32 v58, v118, v116, s[14:15]
    v_cndmask_b32 v59, v119, v117, s[14:15]
    v_lshlrev_b32 v24, 16, v120
    v_and_b32 v25, s62, v120
    v_lshlrev_b32 v26, 16, v121
    v_and_b32 v27, s62, v121
    v_fma_f32 v24, v24, v16, v14
    v_fma_f32 v25, v25, v16, v14
    v_fma_f32 v26, v26, v16, v14
    v_fma_f32 v27, v27, v16, v14
    v_cvt_pk_bf16_f32 v120, v24, v25
    v_cvt_pk_bf16_f32 v121, v26, v27
    v_lshlrev_b32 v28, 16, v122
    v_and_b32 v29, s62, v122
    v_lshlrev_b32 v30, 16, v123
    v_and_b32 v31, s62, v123
    v_fma_f32 v28, v28, v20, v18
    v_fma_f32 v29, v29, v20, v18
    v_fma_f32 v30, v30, v20, v18
    v_fma_f32 v31, v31, v20, v18
    v_cvt_pk_bf16_f32 v122, v28, v29
    v_cvt_pk_bf16_f32 v123, v30, v31
    v_cndmask_b32 v60, v120, v122, s[14:15]
    v_cndmask_b32 v61, v121, v123, s[14:15]
    v_cndmask_b32 v62, v122, v120, s[14:15]
    v_cndmask_b32 v63, v123, v121, s[14:15]
    v_lshlrev_b32 v24, 16, v124
    v_and_b32 v25, s62, v124
    v_lshlrev_b32 v26, 16, v125
    v_and_b32 v27, s62, v125
    v_fma_f32 v24, v24, v16, v14
    v_fma_f32 v25, v25, v16, v14
    v_fma_f32 v26, v26, v16, v14
    v_fma_f32 v27, v27, v16, v14
    v_cvt_pk_bf16_f32 v124, v24, v25
    v_cvt_pk_bf16_f32 v125, v26, v27
    v_lshlrev_b32 v28, 16, v126
    v_and_b32 v29, s62, v126
    v_lshlrev_b32 v30, 16, v127
    v_and_b32 v31, s62, v127
    v_fma_f32 v28, v28, v20, v18
    v_fma_f32 v29, v29, v20, v18
    v_fma_f32 v30, v30, v20, v18
    v_fma_f32 v31, v31, v20, v18
    v_cvt_pk_bf16_f32 v126, v28, v29
    v_cvt_pk_bf16_f32 v127, v30, v31
    v_cndmask_b32 v64, v124, v126, s[14:15]
    v_cndmask_b32 v65, v125, v127, s[14:15]
    v_cndmask_b32 v66, v126, v124, s[14:15]
    v_cndmask_b32 v67, v127, v125, s[14:15]
    v_lshlrev_b32 v24, 16, v128
    v_and_b32 v25, s62, v128
    v_lshlrev_b32 v26, 16, v129
    v_and_b32 v27, s62, v129
    v_fma_f32 v24, v24, v16, v14
    v_fma_f32 v25, v25, v16, v14
    v_fma_f32 v26, v26, v16, v14
    v_fma_f32 v27, v27, v16, v14
    v_cvt_pk_bf16_f32 v128, v24, v25
    v_cvt_pk_bf16_f32 v129, v26, v27
    v_lshlrev_b32 v28, 16, v130
    v_and_b32 v29, s62, v130
    v_lshlrev_b32 v30, 16, v131
    v_and_b32 v31, s62, v131
    v_fma_f32 v28, v28, v20, v18
    v_fma_f32 v29, v29, v20, v18
    v_fma_f32 v30, v30, v20, v18
    v_fma_f32 v31, v31, v20, v18
    v_cvt_pk_bf16_f32 v130, v28, v29
    v_cvt_pk_bf16_f32 v131, v30, v31
    v_cndmask_b32 v68, v128, v130, s[14:15]
    v_cndmask_b32 v69, v129, v131, s[14:15]
    v_cndmask_b32 v70, v130, v128, s[14:15]
    v_cndmask_b32 v71, v131, v129, s[14:15]
    v_lshlrev_b32 v24, 16, v132
    v_and_b32 v25, s62, v132
    v_lshlrev_b32 v26, 16, v133
    v_and_b32 v27, s62, v133
    v_fma_f32 v24, v24, v16, v14
    v_fma_f32 v25, v25, v16, v14
    v_fma_f32 v26, v26, v16, v14
    v_fma_f32 v27, v27, v16, v14
    v_cvt_pk_bf16_f32 v132, v24, v25
    v_cvt_pk_bf16_f32 v133, v26, v27
    v_lshlrev_b32 v28, 16, v134
    v_and_b32 v29, s62, v134
    v_lshlrev_b32 v30, 16, v135
    v_and_b32 v31, s62, v135
    v_fma_f32 v28, v28, v20, v18
    v_fma_f32 v29, v29, v20, v18
    v_fma_f32 v30, v30, v20, v18
    v_fma_f32 v31, v31, v20, v18
    v_cvt_pk_bf16_f32 v134, v28, v29
    v_cvt_pk_bf16_f32 v135, v30, v31
    v_cndmask_b32 v72, v132, v134, s[14:15]
    v_cndmask_b32 v73, v133, v135, s[14:15]
    v_cndmask_b32 v74, v134, v132, s[14:15]
    v_cndmask_b32 v75, v135, v133, s[14:15]
    s_lshr_b32 s4, s49, 3
    s_lshl_b32 s4, s4, 4
    s_add_u32 s4, s4, s48
    s_lshl_b32 s4, s4, 2
    s_add_u32 s68, s4, s51
    s_and_b32 s59, s49, 7
    s_sub_u32 s4, s68, 18
    s_lshr_b32 s12, s4, 3
    s_and_b32 s13, s4, 7
    s_mul_i32 s12, s12, 288
    s_lshl_b32 s9, s13, 5
    s_add_u32 s12, s12, s9
    s_mul_i32 s4, s4, 288
    s_sub_u32 s4, s4, 18304
    s_cmp_ge_u32 s13, 4
    s_cselect_b32 s9, 16, 0
    s_add_u32 s12, s12, s9
    s_cmp_ge_u32 s68, 82
    s_cselect_b32 s4, s4, s12
    s_cselect_b32 s5, 144, 16
    s_mov_b32 s6, 8
    s_mov_b32 s7, 4
    s_mov_b32 s8, 2
    s_lshr_b32 s9, s68, 1
    s_mul_i32 s9, s9, 72
    s_and_b32 s12, s68, 1
    s_lshl_b32 s12, s12, 3
    s_add_u32 s9, s9, s12
    s_cmp_lt_u32 s68, 16
    s_cselect_b32 s4, s9, s4
    s_cselect_b32 s5, 4, s5
    s_cselect_b32 s6, 36, s6
    s_cselect_b32 s7, 18, s7
    s_mul_i32 s9, s68, 288
    s_sub_u32 s9, s9, 4592
    s_and_b32 s12, s68, 0xfffffffe
    s_cmp_eq_u32 s12, 16
    s_cselect_b32 s4, s9, s4
    s_cselect_b32 s5, 36, s5
    s_cselect_b32 s6, 144, s6
    s_cselect_b32 s7, 72, s7
    s_cselect_b32 s8, 18, s8
    s_mov_b32 s30, 663552
    s_cmp_lt_u32 s68, 18
    s_cselect_b32 s28, s72, s76
    s_cselect_b32 s29, s73, s77
    s_cselect_b32 s30, s30, 2654208
    s_mul_i32 s4, s4, 1152
    s_mul_i32 s9, s59, 144
    s_add_u32 s4, s4, s9
    s_mul_i32 s9, s51, 4608
    s_add_u32 s9, s9, 129024
    s_waitcnt vmcnt(16)
    s_waitcnt vmcnt(6)
    s_barrier
    s_add_u32 s63, s66, 4096
    buffer_store_dwordx4 v[56:59], v33, s[24:27], s63 offen sc1
    s_add_u32 s63, s66, 5120
    buffer_store_dwordx4 v[60:63], v33, s[24:27], s63 offen sc1
    s_add_u32 s63, s66, 6144
    buffer_store_dwordx4 v[64:67], v33, s[24:27], s63 offen sc1
    s_add_u32 s63, s66, 7168
    buffer_store_dwordx4 v[68:71], v33, s[24:27], s63 offen sc1
    s_add_u32 s63, s66, 8192
    buffer_store_dwordx4 v[72:75], v33, s[24:27], s63 offen sc1
    v_mul_u32_u24 v1, 7282, v0
    v_lshrrev_b32 v1, 16, v1
    v_mul_u32_u24 v2, 9, v1
    v_sub_u32 v2, v0, v2
    v_lshlrev_b32 v2, 4, v2
    v_add_u32 v3, 0, v1
    v_and_b32 v4, 1, v3
    v_bfe_u32 v5, v3, 1, 1
    v_mad_u32_u24 v4, v5, s8, v4
    v_bfe_u32 v5, v3, 2, 1
    v_mad_u32_u24 v4, v5, s7, v4
    v_bfe_u32 v5, v3, 3, 1
    v_mad_u32_u24 v4, v5, s6, v4
    v_bfe_u32 v5, v3, 4, 1
    v_mad_u32_u24 v4, v5, s5, v4
    v_mul_u32_u24 v4, 1152, v4
    v_add_u32 v4, v4, v2
    s_add_u32 m0, s9, 0
    s_mov_b32 exec_hi, 0x7fffffff
    buffer_load_dwordx4 v4, s[28:31], s4 offen lds
    s_mov_b64 exec, -1
    v_add_u32 v3, 7, v1
    v_and_b32 v4, 1, v3
    v_bfe_u32 v5, v3, 1, 1
    v_mad_u32_u24 v4, v5, s8, v4
    v_bfe_u32 v5, v3, 2, 1
    v_mad_u32_u24 v4, v5, s7, v4
    v_bfe_u32 v5, v3, 3, 1
    v_mad_u32_u24 v4, v5, s6, v4
    v_bfe_u32 v5, v3, 4, 1
    v_mad_u32_u24 v4, v5, s5, v4
    v_mul_u32_u24 v4, 1152, v4
    v_add_u32 v4, v4, v2
    s_add_u32 m0, s9, 1008
    s_mov_b32 exec_hi, 0x7fffffff
    buffer_load_dwordx4 v4, s[28:31], s4 offen lds
    s_mov_b64 exec, -1
    v_add_u32 v3, 14, v1
    v_and_b32 v4, 1, v3
    v_bfe_u32 v5, v3, 1, 1
    v_mad_u32_u24 v4, v5, s8, v4
    v_bfe_u32 v5, v3, 2, 1
    v_mad_u32_u24 v4, v5, s7, v4
    v_bfe_u32 v5, v3, 3, 1
    v_mad_u32_u24 v4, v5, s6, v4
    v_bfe_u32 v5, v3, 4, 1
    v_mad_u32_u24 v4, v5, s5, v4
    v_mul_u32_u24 v4, 1152, v4
    v_add_u32 v4, v4, v2
    s_add_u32 m0, s9, 2016
    s_mov_b32 exec_hi, 0x7fffffff
    buffer_load_dwordx4 v4, s[28:31], s4 offen lds
    s_mov_b64 exec, -1
    v_add_u32 v3, 21, v1
    v_and_b32 v4, 1, v3
    v_bfe_u32 v5, v3, 1, 1
    v_mad_u32_u24 v4, v5, s8, v4
    v_bfe_u32 v5, v3, 2, 1
    v_mad_u32_u24 v4, v5, s7, v4
    v_bfe_u32 v5, v3, 3, 1
    v_mad_u32_u24 v4, v5, s6, v4
    v_bfe_u32 v5, v3, 4, 1
    v_mad_u32_u24 v4, v5, s5, v4
    v_mul_u32_u24 v4, 1152, v4
    v_add_u32 v4, v4, v2
    s_add_u32 m0, s9, 3024
    s_mov_b32 exec_hi, 0x7fffffff
    buffer_load_dwordx4 v4, s[28:31], s4 offen lds
    s_mov_b64 exec, -1
    v_add_u32 v3, 28, v1
    v_and_b32 v4, 1, v3
    v_bfe_u32 v5, v3, 1, 1
    v_mad_u32_u24 v4, v5, s8, v4
    v_bfe_u32 v5, v3, 2, 1
    v_mad_u32_u24 v4, v5, s7, v4
    v_bfe_u32 v5, v3, 3, 1
    v_mad_u32_u24 v4, v5, s6, v4
    v_bfe_u32 v5, v3, 4, 1
    v_mad_u32_u24 v4, v5, s5, v4
    v_mul_u32_u24 v4, 1152, v4
    v_add_u32 v4, v4, v2
    s_add_u32 m0, s9, 4032
    s_mov_b32 exec_hi, 0xf
    buffer_load_dwordx4 v4, s[28:31], s4 offen lds
    s_mov_b64 exec, -1
    v_lshrrev_b32 v241, 2, v0
    v_mul_u32_u24 v241, 144, v241
    v_and_b32 v242, 3, v0
    v_lshl_add_u32 v241, v242, 3, v241
    v_add_u32 v241, s9, v241
    v_lshrrev_b32 v240, 4, v0
    v_lshlrev_b32 v240, 7, v240
    v_and_b32 v242, 7, v0
    v_lshl_add_u32 v240, v242, 4, v240
    v_and_b32 v242, 8, v0
    v_lshl_add_u32 v240, v242, 24, v240
    v_add_u32 v240, 4096, v240
    s_waitcnt vmcnt(5)
    s_add_u32 s40, s46, 41590784
    s_addc_u32 s41, s47, 0
    s_mov_b32 s42, 15360
    s_mov_b32 s43, 0x00020000
    s_lshl_b32 s63, s49, 4
    s_add_u32 s63, s63, s48
    s_lshl_b32 s63, s63, 2
    s_add_u32 s63, s63, s51
    s_lshl_b32 s63, s63, 2
    v_mov_b32 v13, s71
    s_mov_b64 exec, 1
    buffer_store_dword v13, off, s[40:43], s63 offset:3072 sc1
    s_mov_b64 exec, -1
    s_waitcnt vmcnt(1)
    ds_read_b64_tr_b16 v[220:221], v241 offset:0
    ds_read_b64_tr_b16 v[222:223], v241 offset:2304
    ds_read_b64_tr_b16 v[224:225], v241 offset:32
    ds_read_b64_tr_b16 v[226:227], v241 offset:2336
    ds_read_b64_tr_b16 v[228:229], v241 offset:64
    ds_read_b64_tr_b16 v[230:231], v241 offset:2368
    ds_read_b64_tr_b16 v[232:233], v241 offset:96
    ds_read_b64_tr_b16 v[234:235], v241 offset:2400
    ds_read_b64_tr_b16 v[236:237], v241 offset:128
    ds_read_b64_tr_b16 v[238:239], v241 offset:2432
    s_waitcnt lgkmcnt(0)
    s_barrier
    s_add_u32 s20, s46, 37748736
    s_addc_u32 s21, s47, 0
    s_mov_b32 s22, 3317760
    s_mul_i32 s4, s59, 90
    s_add_u32 s4, s4, s68
    s_mul_i32 s4, s4, 4608
    s_cmp_lt_u32 s68, 90
    s_cselect_b32 s4, s4, 3317760
    s_mov_b32 s32, s48
    s_mov_b32 s33, s49
    s_mov_b32 s34, s50
    s_add_u32 s72, s46, 41590784
    s_addc_u32 s73, s47, 0
    s_mov_b32 s74, 15360
    s_mov_b32 s75, 0x00020000
    s_sub_u32 s38, s34, 4
    v_lshrrev_b32 v5, 3, v0
    v_and_b32 v6, 7, v0
    v_xor_b32 v6, v6, v5
    v_lshlrev_b32 v6, 4, v6
    s_lshl_b32 s40, s32, 7
    s_lshl_b32 s41, s38, 5
    s_add_u32 s40, s40, s41
    v_add_u32 v5, s40, v5
    v_lshlrev_b32 v5, 12, v5
    v_add_u32 v1, v5, v6
    v_add_u32 v2, 31744, v1
    v_add_u32 v3, 63488, v1
    v_add_u32 v4, 95232, v1
    s_mul_i32 s41, s38, 5
    s_cmp_eq_u32 s38, 3
    s_cselect_b32 s41, 14, s41
    s_lshl_b32 s41, s41, 10
    v_lshlrev_b32 v6, 4, v0
    v_add_u32 v5, s41, v6
    s_lshl_b32 s40, s38, 12
    s_add_u32 s41, s41, 16384
    s_mov_b32 s12, s10
    s_mov_b32 s13, s11
    s_mov_b32 s14, 8388608
    s_mov_b32 s15, 0x00020000
    s_mul_i32 s37, s33, 589824
    s_add_u32 s16, s46, s37
    s_addc_u32 s17, s47, 0
    s_mov_b32 s18, 589824
    s_mov_b32 s19, 0x00020000
    s_add_u32 s24, s46, 18874368
    s_addc_u32 s25, s47, 0
    s_mov_b32 s26, 11796480
    s_mov_b32 s27, 0x00020000
    s_add_u32 s28, s46, 30670848
    s_addc_u32 s29, s47, 0
    s_mov_b32 s30, 7077888
    s_mov_b32 s31, 0x00020000
    s_add_u32 m0, s40, 0
    s_movk_i32 s42, 0
    buffer_load_dwordx4 v1, s[12:15], s42 offen offset:0  lds
    buffer_load_dwordx4 v2, s[12:15], s42 offen offset:1024  lds
    buffer_load_dwordx4 v3, s[12:15], s42 offen offset:2048  lds
    buffer_load_dwordx4 v4, s[12:15], s42 offen offset:3072  lds
    s_add_u32 m0, s40, 34816
    s_movk_i32 s42, 128
    buffer_load_dwordx4 v1, s[12:15], s42 offen offset:0  lds
    buffer_load_dwordx4 v2, s[12:15], s42 offen offset:1024  lds
    buffer_load_dwordx4 v3, s[12:15], s42 offen offset:2048  lds
    buffer_load_dwordx4 v4, s[12:15], s42 offen offset:3072  lds
    s_add_u32 m0, s40, 69632
    s_movk_i32 s42, 256
    buffer_load_dwordx4 v1, s[12:15], s42 offen offset:0  lds
    buffer_load_dwordx4 v2, s[12:15], s42 offen offset:1024  lds
    buffer_load_dwordx4 v3, s[12:15], s42 offen offset:2048  lds
    buffer_load_dwordx4 v4, s[12:15], s42 offen offset:3072  lds
    s_add_u32 m0, s40, 104448
    s_movk_i32 s42, 384
    buffer_load_dwordx4 v1, s[12:15], s42 offen offset:0  lds
    buffer_load_dwordx4 v2, s[12:15], s42 offen offset:1024  lds
    buffer_load_dwordx4 v3, s[12:15], s42 offen offset:2048  lds
    buffer_load_dwordx4 v4, s[12:15], s42 offen offset:3072  lds
    v_lshlrev_b32 v7, 2, v0
    s_lshl_b32 s57, s33, 8
    s_mov_b32 s69, 0
L_pf1_1:
    buffer_load_dword v244, v7, s[72:75], s57 offen offset:3072 sc1
    s_add_u32 s69, s69, 1
    s_cmp_gt_u32 s69, 50000
    s_cbranch_scc1 L_pf1ok_1
    s_waitcnt vmcnt(0)
    v_xor_b32 v244, s71, v244
    v_cmp_ne_u32 vcc, 0, v244
    s_nop 4
    s_cbranch_vccz L_pf1ok_1
    s_sleep 2
    s_branch L_pf1_1
L_pf1ok_1:
    s_add_u32 m0, s41, 0
    s_mov_b32 s43, 0
    buffer_load_dwordx4 v5, s[16:19], s43 offen offset:0 sc1 lds
    buffer_load_dwordx4 v5, s[16:19], s43 offen offset:1024 sc1 lds
    buffer_load_dwordx4 v5, s[16:19], s43 offen offset:2048 sc1 lds
    buffer_load_dwordx4 v5, s[16:19], s43 offen offset:3072 sc1 lds
    s_add_u32 m0, s41, 4096
    s_add_u32 s43, s43, 4096
    buffer_load_dwordx4 v5, s[16:19], s43 offen sc1 lds
    s_add_u32 m0, s41, 34816
    s_mov_b32 s43, 18432
    buffer_load_dwordx4 v5, s[16:19], s43 offen offset:0 sc1 lds
    buffer_load_dwordx4 v5, s[16:19], s43 offen offset:1024 sc1 lds
    buffer_load_dwordx4 v5, s[16:19], s43 offen offset:2048 sc1 lds
    buffer_load_dwordx4 v5, s[16:19], s43 offen offset:3072 sc1 lds
    s_add_u32 m0, s41, 38912
    s_add_u32 s43, s43, 4096
    buffer_load_dwordx4 v5, s[16:19], s43 offen sc1 lds
    s_add_u32 m0, s41, 69632
    s_mov_b32 s43, 36864
    buffer_load_dwordx4 v5, s[16:19], s43 offen offset:0 sc1 lds
    buffer_load_dwordx4 v5, s[16:19], s43 offen offset:1024 sc1 lds
    buffer_load_dwordx4 v5, s[16:19], s43 offen offset:2048 sc1 lds
    buffer_load_dwordx4 v5, s[16:19], s43 offen offset:3072 sc1 lds
    s_add_u32 m0, s41, 73728
    s_add_u32 s43, s43, 4096
    buffer_load_dwordx4 v5, s[16:19], s43 offen sc1 lds
    s_lshr_b32 s50, s2, 3
    s_and_b32 s51, s2, 7
    s_mul_i32 s52, s51, 4608
    s_lshl_b32 s53, s50, 1
    s_mul_i32 s53, s53, 110592
    v_lshrrev_b32 v216, 5, v0
    v_mul_u32_u24 v216, 110592, v216
    v_and_b32 v8, 31, v0
    v_lshl_add_u32 v216, v8, 4, v216
    v_add_u32 v216, s53, v216
    s_mul_i32 s54, s38, 192
    s_sub_u32 s53, s53, 110592
    v_add_u32 v7, s54, v0
    v_mul_u32_u24 v8, 820, v7
    v_lshrrev_b32 v8, 16, v8
    v_mul_u32_u24 v9, 80, v8
    v_sub_u32 v7, v7, v9
    v_add_u32 v7, 16, v7
    v_lshrrev_b32 v9, 5, v7
    v_mul_u32_u24 v9, 110592, v9
    v_lshl_add_u32 v9, v8, 9, v9
    v_and_b32 v7, 31, v7
    v_lshl_add_u32 v9, v7, 4, v9
    v_add_u32 v213, s53, v9
    v_add_u32 v7, s54, v0
    v_add_u32 v7, 64, v7
    v_mul_u32_u24 v8, 820, v7
    v_lshrrev_b32 v8, 16, v8
    v_mul_u32_u24 v9, 80, v8
    v_sub_u32 v7, v7, v9
    v_add_u32 v7, 16, v7
    v_lshrrev_b32 v9, 5, v7
    v_mul_u32_u24 v9, 110592, v9
    v_lshl_add_u32 v9, v8, 9, v9
    v_and_b32 v7, 31, v7
    v_lshl_add_u32 v9, v7, 4, v9
    v_add_u32 v214, s53, v9
    v_add_u32 v7, s54, v0
    v_add_u32 v7, 128, v7
    v_mul_u32_u24 v8, 820, v7
    v_lshrrev_b32 v8, 16, v8
    v_mul_u32_u24 v9, 80, v8
    v_sub_u32 v7, v7, v9
    v_add_u32 v7, 16, v7
    v_lshrrev_b32 v9, 5, v7
    v_mul_u32_u24 v9, 110592, v9
    v_lshl_add_u32 v9, v8, 9, v9
    v_and_b32 v7, 31, v7
    v_lshl_add_u32 v9, v7, 4, v9
    v_add_u32 v215, s53, v9
    s_mul_i32 s53, s38, 3072
    v_lshrrev_b32 v9, 2, v0
    s_lshl_b32 s54, s38, 4
    v_add_u32 v9, s54, v9
    s_lshl_b32 s54, s50, 6
    v_add_u32 v10, s54, v9
    v_and_b32 v11, 3, v0
    v_mul_u32_u24 v12, 36, v11
    v_lshlrev_b32 v13, 4, v9
    v_add_u32 v13, 139296, v13
    s_movk_i32 s55, 1280
    v_add_u32 v14, 0, v12
    v_lshrrev_b32 v15, 4, v14
    v_mad_u32_u24 v204, v15, s55, v13
    v_and_b32 v14, 15, v14
    v_add_u32 v204, v204, v14
    v_add_u32 v14, 4, v12
    v_lshrrev_b32 v15, 4, v14
    v_mad_u32_u24 v205, v15, s55, v13
    v_and_b32 v14, 15, v14
    v_add_u32 v205, v205, v14
    v_add_u32 v14, 8, v12
    v_lshrrev_b32 v15, 4, v14
    v_mad_u32_u24 v206, v15, s55, v13
    v_and_b32 v14, 15, v14
    v_add_u32 v206, v206, v14
    v_add_u32 v14, 12, v12
    v_lshrrev_b32 v15, 4, v14
    v_mad_u32_u24 v207, v15, s55, v13
    v_and_b32 v14, 15, v14
    v_add_u32 v207, v207, v14
    v_add_u32 v14, 16, v12
    v_lshrrev_b32 v15, 4, v14
    v_mad_u32_u24 v208, v15, s55, v13
    v_and_b32 v14, 15, v14
    v_add_u32 v208, v208, v14
    v_add_u32 v14, 20, v12
    v_lshrrev_b32 v15, 4, v14
    v_mad_u32_u24 v209, v15, s55, v13
    v_and_b32 v14, 15, v14
    v_add_u32 v209, v209, v14
    v_add_u32 v14, 24, v12
    v_lshrrev_b32 v15, 4, v14
    v_mad_u32_u24 v210, v15, s55, v13
    v_and_b32 v14, 15, v14
    v_add_u32 v210, v210, v14
    v_add_u32 v14, 28, v12
    v_lshrrev_b32 v15, 4, v14
    v_mad_u32_u24 v211, v15, s55, v13
    v_and_b32 v14, 15, v14
    v_add_u32 v211, v211, v14
    v_add_u32 v14, 32, v12
    v_lshrrev_b32 v15, 4, v14
    v_mad_u32_u24 v212, v15, s55, v13
    v_and_b32 v14, 15, v14
    v_add_u32 v212, v212, v14
    s_mov_b32 s56, 0xffff0000
    v_mov_b32 v138, 0xc0135761
    s_lshr_b32 s54, s50, 1
    s_lshl_b32 s54, s54, 7
    s_max_u32 s57, s50, 1
    s_sub_u32 s57, s57, 1
    s_lshr_b32 s57, s57, 1
    s_lshl_b32 s57, s57, 7
    v_mov_b32 v248, s54
    v_mov_b32 v249, s57
    v_cmp_lt_u32 vcc, 31, v0
    s_nop 1
    v_cndmask_b32 v248, v248, v249, vcc
    v_and_b32 v249, 15, v0
    v_lshl_add_u32 v248, v249, 2, v248
    v_add_u32 v248, 7168, v248
    s_waitcnt vmcnt(10)
    s_barrier
    s_mul_i32 s37, s38, 9216
    s_add_u32 s37, s37, 126976
    v_add_u32 v7, s37, v6
    ds_read_b128 v[160:163], v7 offset:0
    ds_read_b128 v[164:167], v7 offset:1024
    ds_read_b128 v[168:171], v7 offset:2048
    ds_read_b128 v[172:175], v7 offset:3072
    ds_read_b128 v[176:179], v7 offset:4096
    ds_read_b128 v[180:183], v7 offset:5120
    ds_read_b128 v[184:187], v7 offset:6144
    ds_read_b128 v[188:191], v7 offset:7168
    ds_read_b128 v[192:195], v7 offset:8192
    s_waitcnt vmcnt(5)
    s_waitcnt lgkmcnt(0)
    s_barrier
    s_add_u32 m0, s41, 104448
    s_mov_b32 s43, 55296
    buffer_load_dwordx4 v5, s[16:19], s43 offen offset:0 sc1 lds
    buffer_load_dwordx4 v5, s[16:19], s43 offen offset:1024 sc1 lds
    buffer_load_dwordx4 v5, s[16:19], s43 offen offset:2048 sc1 lds
    buffer_load_dwordx4 v5, s[16:19], s43 offen offset:3072 sc1 lds
    s_add_u32 m0, s41, 108544
    s_add_u32 s43, s43, 4096
    buffer_load_dwordx4 v5, s[16:19], s43 offen sc1 lds
    s_add_u32 m0, s40, 0
    s_movk_i32 s42, 512
    buffer_load_dwordx4 v1, s[12:15], s42 offen offset:0  lds
    buffer_load_dwordx4 v2, s[12:15], s42 offen offset:1024  lds
    buffer_load_dwordx4 v3, s[12:15], s42 offen offset:2048  lds
    buffer_load_dwordx4 v4, s[12:15], s42 offen offset:3072  lds
    s_add_u32 m0, s41, 0
    s_mov_b32 s43, 73728
    buffer_load_dwordx4 v5, s[16:19], s43 offen offset:0 sc1 lds
    buffer_load_dwordx4 v5, s[16:19], s43 offen offset:1024 sc1 lds
    buffer_load_dwordx4 v5, s[16:19], s43 offen offset:2048 sc1 lds
    buffer_load_dwordx4 v5, s[16:19], s43 offen offset:3072 sc1 lds
    s_add_u32 m0, s41, 4096
    s_add_u32 s43, s43, 4096
    buffer_load_dwordx4 v5, s[16:19], s43 offen sc1 lds
    buffer_store_dwordx4 v[148:151], v6, s[28:31], s61 offen offset:2048 sc1
    buffer_store_dwordx4 v[152:155], v6, s[28:31], s61 offen offset:3072 sc1
    s_waitcnt vmcnt(16)
    s_barrier
    s_add_u32 m0, s40, 34816
    s_movk_i32 s42, 640
    buffer_load_dwordx4 v1, s[12:15], s42 offen offset:0  lds
    buffer_load_dwordx4 v2, s[12:15], s42 offen offset:1024  lds
    buffer_load_dwordx4 v3, s[12:15], s42 offen offset:2048  lds
    buffer_load_dwordx4 v4, s[12:15], s42 offen offset:3072  lds
    s_add_u32 m0, s41, 34816
    s_mov_b32 s43, 92160
    buffer_load_dwordx4 v5, s[16:19], s43 offen offset:0 sc1 lds
    buffer_load_dwordx4 v5, s[16:19], s43 offen offset:1024 sc1 lds
    buffer_load_dwordx4 v5, s[16:19], s43 offen offset:2048 sc1 lds
    buffer_load_dwordx4 v5, s[16:19], s43 offen offset:3072 sc1 lds
    s_add_u32 m0, s41, 38912
    s_add_u32 s43, s43, 4096
    buffer_load_dwordx4 v5, s[16:19], s43 offen sc1 lds
    buffer_store_dwordx4 v[156:159], v6, s[28:31], s70 offen offset:0 sc1
    buffer_store_dwordx4 v[196:199], v6, s[28:31], s70 offen offset:1024 sc1
    s_waitcnt vmcnt(22)
    s_barrier
    s_add_u32 m0, s40, 69632
    s_movk_i32 s42, 768
    buffer_load_dwordx4 v1, s[12:15], s42 offen offset:0  lds
    buffer_load_dwordx4 v2, s[12:15], s42 offen offset:1024  lds
    buffer_load_dwordx4 v3, s[12:15], s42 offen offset:2048  lds
    buffer_load_dwordx4 v4, s[12:15], s42 offen offset:3072  lds
    s_add_u32 m0, s41, 69632
    s_mov_b32 s43, 110592
    buffer_load_dwordx4 v5, s[16:19], s43 offen offset:0 sc1 lds
    buffer_load_dwordx4 v5, s[16:19], s43 offen offset:1024 sc1 lds
    buffer_load_dwordx4 v5, s[16:19], s43 offen offset:2048 sc1 lds
    buffer_load_dwordx4 v5, s[16:19], s43 offen offset:3072 sc1 lds
    s_add_u32 m0, s41, 73728
    s_add_u32 s43, s43, 4096
    buffer_load_dwordx4 v5, s[16:19], s43 offen sc1 lds
    buffer_store_dwordx4 v[200:203], v6, s[28:31], s70 offen offset:2048 sc1
    s_waitcnt vmcnt(23)
    s_barrier
    s_add_u32 m0, s40, 104448
    s_movk_i32 s42, 896
    buffer_load_dwordx4 v1, s[12:15], s42 offen offset:0  lds
    buffer_load_dwordx4 v2, s[12:15], s42 offen offset:1024  lds
    buffer_load_dwordx4 v3, s[12:15], s42 offen offset:2048  lds
    buffer_load_dwordx4 v4, s[12:15], s42 offen offset:3072  lds
    s_add_u32 m0, s41, 104448
    s_mov_b32 s43, 129024
    buffer_load_dwordx4 v5, s[16:19], s43 offen offset:0 sc1 lds
    buffer_load_dwordx4 v5, s[16:19], s43 offen offset:1024 sc1 lds
    buffer_load_dwordx4 v5, s[16:19], s43 offen offset:2048 sc1 lds
    buffer_load_dwordx4 v5, s[16:19], s43 offen offset:3072 sc1 lds
    s_add_u32 m0, s41, 108544
    s_add_u32 s43, s43, 4096
    buffer_load_dwordx4 v5, s[16:19], s43 offen sc1 lds
    s_waitcnt vmcnt(21)
    s_barrier
    s_add_u32 m0, s40, 0
    s_movk_i32 s42, 1024
    buffer_load_dwordx4 v1, s[12:15], s42 offen offset:0  lds
    buffer_load_dwordx4 v2, s[12:15], s42 offen offset:1024  lds
    buffer_load_dwordx4 v3, s[12:15], s42 offen offset:2048  lds
    buffer_load_dwordx4 v4, s[12:15], s42 offen offset:3072  lds
    s_add_u32 m0, s41, 0
    s_mov_b32 s43, 147456
    buffer_load_dwordx4 v5, s[16:19], s43 offen offset:0 sc1 lds
    buffer_load_dwordx4 v5, s[16:19], s43 offen offset:1024 sc1 lds
    buffer_load_dwordx4 v5, s[16:19], s43 offen offset:2048 sc1 lds
    buffer_load_dwordx4 v5, s[16:19], s43 offen offset:3072 sc1 lds
    s_add_u32 m0, s41, 4096
    s_add_u32 s43, s43, 4096
    buffer_load_dwordx4 v5, s[16:19], s43 offen sc1 lds
    s_waitcnt vmcnt(18)
    s_barrier
    s_cmp_eq_u32 s34, 4
    s_cbranch_scc0 L_f1_1
    s_lshl_b32 s68, s48, 7
    s_lshl_b32 s69, s49, 2
    s_add_u32 s68, s68, s69
    s_add_u32 s68, s68, 7168
    v_mov_b32 v253, s68
    v_mov_b32 v254, s71
    s_mov_b64 exec, 1
    buffer_store_dword v254, v253, s[72:75], 0 offen sc1
    s_mov_b64 exec, -1
L_f1_1:
    s_add_u32 m0, s40, 34816
    s_movk_i32 s42, 1152
    buffer_load_dwordx4 v1, s[12:15], s42 offen offset:0  lds
    buffer_load_dwordx4 v2, s[12:15], s42 offen offset:1024  lds
    buffer_load_dwordx4 v3, s[12:15], s42 offen offset:2048  lds
    buffer_load_dwordx4 v4, s[12:15], s42 offen offset:3072  lds
    s_add_u32 m0, s41, 34816
    s_mov_b32 s43, 165888
    buffer_load_dwordx4 v5, s[16:19], s43 offen offset:0 sc1 lds
    buffer_load_dwordx4 v5, s[16:19], s43 offen offset:1024 sc1 lds
    buffer_load_dwordx4 v5, s[16:19], s43 offen offset:2048 sc1 lds
    buffer_load_dwordx4 v5, s[16:19], s43 offen offset:3072 sc1 lds
    s_add_u32 m0, s41, 38912
    s_add_u32 s43, s43, 4096
    buffer_load_dwordx4 v5, s[16:19], s43 offen sc1 lds
    buffer_store_dwordx4 v[220:223], v6, s[20:23], s4 offen offset:0 sc1
    s_waitcnt vmcnt(19)
    s_barrier
    s_add_u32 m0, s40, 69632
    s_movk_i32 s42, 1280
    buffer_load_dwordx4 v1, s[12:15], s42 offen offset:0  lds
    buffer_load_dwordx4 v2, s[12:15], s42 offen offset:1024  lds
    buffer_load_dwordx4 v3, s[12:15], s42 offen offset:2048  lds
    buffer_load_dwordx4 v4, s[12:15], s42 offen offset:3072  lds
    s_add_u32 m0, s41, 69632
    s_mov_b32 s43, 184320
    buffer_load_dwordx4 v5, s[16:19], s43 offen offset:0 sc1 lds
    buffer_load_dwordx4 v5, s[16:19], s43 offen offset:1024 sc1 lds
    buffer_load_dwordx4 v5, s[16:19], s43 offen offset:2048 sc1 lds
    buffer_load_dwordx4 v5, s[16:19], s43 offen offset:3072 sc1 lds
    s_add_u32 m0, s41, 73728
    s_add_u32 s43, s43, 4096
    buffer_load_dwordx4 v5, s[16:19], s43 offen sc1 lds
    buffer_store_dwordx4 v[224:227], v6, s[20:23], s4 offen offset:1024 sc1
    s_waitcnt vmcnt(20)
    s_barrier
    s_add_u32 m0, s40, 104448
    s_movk_i32 s42, 1408
    buffer_load_dwordx4 v1, s[12:15], s42 offen offset:0  lds
    buffer_load_dwordx4 v2, s[12:15], s42 offen offset:1024  lds
    buffer_load_dwordx4 v3, s[12:15], s42 offen offset:2048  lds
    buffer_load_dwordx4 v4, s[12:15], s42 offen offset:3072  lds
    s_add_u32 m0, s41, 104448
    s_mov_b32 s43, 202752
    buffer_load_dwordx4 v5, s[16:19], s43 offen offset:0 sc1 lds
    buffer_load_dwordx4 v5, s[16:19], s43 offen offset:1024 sc1 lds
    buffer_load_dwordx4 v5, s[16:19], s43 offen offset:2048 sc1 lds
    buffer_load_dwordx4 v5, s[16:19], s43 offen offset:3072 sc1 lds
    s_add_u32 m0, s41, 108544
    s_add_u32 s43, s43, 4096
    buffer_load_dwordx4 v5, s[16:19], s43 offen sc1 lds
    buffer_store_dwordx4 v[228:231], v6, s[20:23], s4 offen offset:2048 sc1
    s_waitcnt vmcnt(21)
    s_barrier
    s_add_u32 m0, s40, 0
    s_movk_i32 s42, 1536
    buffer_load_dwordx4 v1, s[12:15], s42 offen offset:0  lds
    buffer_load_dwordx4 v2, s[12:15], s42 offen offset:1024  lds
    buffer_load_dwordx4 v3, s[12:15], s42 offen offset:2048  lds
    buffer_load_dwordx4 v4, s[12:15], s42 offen offset:3072  lds
    s_add_u32 m0, s41, 0
    s_mov_b32 s43, 221184
    buffer_load_dwordx4 v5, s[16:19], s43 offen offset:0 sc1 lds
    buffer_load_dwordx4 v5, s[16:19], s43 offen offset:1024 sc1 lds
    buffer_load_dwordx4 v5, s[16:19], s43 offen offset:2048 sc1 lds
    buffer_load_dwordx4 v5, s[16:19], s43 offen offset:3072 sc1 lds
    s_add_u32 m0, s41, 4096
    s_add_u32 s43, s43, 4096
    buffer_load_dwordx4 v5, s[16:19], s43 offen sc1 lds
    buffer_load_dword v244, v248, s[72:75], 0 offen offset:0 sc1
    s_waitcnt vmcnt(21)
    s_barrier
    s_waitcnt vmcnt(0)
    v_xor_b32 v244, s71, v244
    v_cmp_ne_u32 vcc, 0, v244
    s_nop 4
    s_cbranch_vccz L_pfaok_1
    s_mov_b32 s69, 0
L_pfa_1:
    buffer_load_dword v244, v248, s[72:75], 0 offen offset:0 sc1
    s_add_u32 s69, s69, 1
    s_cmp_gt_u32 s69, 50000
    s_cbranch_scc1 L_pfaok_1
    s_waitcnt vmcnt(0)
    v_xor_b32 v244, s71, v244
    v_cmp_ne_u32 vcc, 0, v244
    s_nop 4
    s_cbranch_vccz L_pfaok_1
    s_sleep 2
    s_branch L_pfa_1
L_pfaok_1:
    s_add_u32 s54, s38, 0
    s_min_u32 s54, s54, 8
    s_mul_i32 s57, s54, 1280
    s_add_u32 m0, s57, 151808
    s_lshl_b32 s54, s54, 9
    s_add_u32 s54, s54, s52
    buffer_load_dwordx4 v216, s[28:31], s54 offen sc1 lds
    s_add_u32 s54, s38, 4
    s_min_u32 s54, s54, 8
    s_mul_i32 s57, s54, 1280
    s_add_u32 m0, s57, 151808
    s_lshl_b32 s54, s54, 9
    s_add_u32 s54, s54, s52
    buffer_load_dwordx4 v216, s[28:31], s54 offen sc1 lds
    s_add_u32 s54, s38, 8
    s_min_u32 s54, s54, 8
    s_mul_i32 s57, s54, 1280
    s_add_u32 m0, s57, 151808
    s_lshl_b32 s54, s54, 9
    s_add_u32 s54, s54, s52
    buffer_load_dwordx4 v216, s[28:31], s54 offen sc1 lds
    s_add_u32 m0, s40, 34816
    s_movk_i32 s42, 1664
    buffer_load_dwordx4 v1, s[12:15], s42 offen offset:0  lds
    buffer_load_dwordx4 v2, s[12:15], s42 offen offset:1024  lds
    buffer_load_dwordx4 v3, s[12:15], s42 offen offset:2048  lds
    buffer_load_dwordx4 v4, s[12:15], s42 offen offset:3072  lds
    s_add_u32 m0, s41, 34816
    s_mov_b32 s43, 239616
    buffer_load_dwordx4 v5, s[16:19], s43 offen offset:0 sc1 lds
    buffer_load_dwordx4 v5, s[16:19], s43 offen offset:1024 sc1 lds
    buffer_load_dwordx4 v5, s[16:19], s43 offen offset:2048 sc1 lds
    buffer_load_dwordx4 v5, s[16:19], s43 offen offset:3072 sc1 lds
    s_add_u32 m0, s41, 38912
    s_add_u32 s43, s43, 4096
    buffer_load_dwordx4 v5, s[16:19], s43 offen sc1 lds
    s_barrier
    s_add_u32 s54, s52, 36864
    s_add_u32 m0, s53, 139264
    s_nop 0
    buffer_load_dwordx4 v213, s[28:31], s54 offen sc1 lds
    s_add_u32 m0, s53, 140288
    s_nop 0
    buffer_load_dwordx4 v214, s[28:31], s54 offen sc1 lds
    s_add_u32 m0, s53, 141312
    s_nop 0
    buffer_load_dwordx4 v215, s[28:31], s54 offen sc1 lds
    s_add_u32 m0, s40, 69632
    s_movk_i32 s42, 1792
    buffer_load_dwordx4 v1, s[12:15], s42 offen offset:0  lds
    buffer_load_dwordx4 v2, s[12:15], s42 offen offset:1024  lds
    buffer_load_dwordx4 v3, s[12:15], s42 offen offset:2048  lds
    buffer_load_dwordx4 v4, s[12:15], s42 offen offset:3072  lds
    s_add_u32 m0, s41, 69632
    s_mov_b32 s43, 258048
    buffer_load_dwordx4 v5, s[16:19], s43 offen offset:0 sc1 lds
    buffer_load_dwordx4 v5, s[16:19], s43 offen offset:1024 sc1 lds
    buffer_load_dwordx4 v5, s[16:19], s43 offen offset:2048 sc1 lds
    buffer_load_dwordx4 v5, s[16:19], s43 offen offset:3072 sc1 lds
    s_add_u32 m0, s41, 73728
    s_add_u32 s43, s43, 4096
    buffer_load_dwordx4 v5, s[16:19], s43 offen sc1 lds
    s_barrier
    s_add_u32 m0, s40, 104448
    s_movk_i32 s42, 1920
    buffer_load_dwordx4 v1, s[12:15], s42 offen offset:0  lds
    buffer_load_dwordx4 v2, s[12:15], s42 offen offset:1024  lds
    buffer_load_dwordx4 v3, s[12:15], s42 offen offset:2048  lds
    buffer_load_dwordx4 v4, s[12:15], s42 offen offset:3072  lds
    s_add_u32 m0, s41, 104448
    s_mov_b32 s43, 276480
    buffer_load_dwordx4 v5, s[16:19], s43 offen offset:0 sc1 lds
    buffer_load_dwordx4 v5, s[16:19], s43 offen offset:1024 sc1 lds
    buffer_load_dwordx4 v5, s[16:19], s43 offen offset:2048 sc1 lds
    buffer_load_dwordx4 v5, s[16:19], s43 offen offset:3072 sc1 lds
    s_add_u32 m0, s41, 108544
    s_add_u32 s43, s43, 4096
    buffer_load_dwordx4 v5, s[16:19], s43 offen sc1 lds
    s_waitcnt vmcnt(21)
    s_waitcnt vmcnt(18)
    s_barrier
    s_add_u32 m0, s40, 0
    s_movk_i32 s42, 2048
    buffer_load_dwordx4 v1, s[12:15], s42 offen offset:0  lds
    ds_read_b32 v16, v204 offset:12512
    ds_read_b32 v17, v205 offset:12512
    ds_read_b32 v18, v206 offset:12512
    ds_read_b32 v19, v207 offset:12512
    ds_read_b32 v20, v208 offset:12512
    buffer_load_dwordx4 v2, s[12:15], s42 offen offset:1024  lds
    ds_read_b32 v21, v209 offset:12512
    ds_read_b32 v22, v210 offset:12512
    ds_read_b32 v23, v211 offset:12512
    ds_read_b32 v24, v212 offset:12512
    buffer_load_dwordx4 v3, s[12:15], s42 offen offset:2048  lds
    buffer_load_dwordx4 v4, s[12:15], s42 offen offset:3072  lds
    s_waitcnt lgkmcnt(0)
    v_lshlrev_b32 v140, 16, v16
    v_and_b32 v141, s56, v16
    v_lshlrev_b32 v142, 16, v17
    v_and_b32 v143, s56, v17
    v_lshlrev_b32 v144, 16, v18
    s_add_u32 m0, s41, 0
    s_mov_b32 s43, 294912
    buffer_load_dwordx4 v5, s[16:19], s43 offen offset:0 sc1 lds
    v_and_b32 v145, s56, v18
    v_lshlrev_b32 v146, 16, v19
    v_and_b32 v147, s56, v19
    v_lshlrev_b32 v148, 16, v20
    v_and_b32 v149, s56, v20
    v_lshlrev_b32 v150, 16, v21
    v_and_b32 v151, s56, v21
    buffer_load_dwordx4 v5, s[16:19], s43 offen offset:1024 sc1 lds
    v_lshlrev_b32 v152, 16, v22
    v_and_b32 v153, s56, v22
    v_lshlrev_b32 v154, 16, v23
    v_and_b32 v155, s56, v23
    v_lshlrev_b32 v156, 16, v24
    v_and_b32 v157, s56, v24
    ds_read2_b32 v[28:29], v204 offset0:56 offset1:48
    buffer_load_dwordx4 v5, s[16:19], s43 offen offset:2048 sc1 lds
    ds_read2_b32 v[30:31], v205 offset0:56 offset1:48
    ds_read2_b32 v[32:33], v206 offset0:56 offset1:48
    ds_read2_b32 v[34:35], v207 offset0:56 offset1:48
    ds_read2_b32 v[36:37], v208 offset0:56 offset1:48
    ds_read2_b32 v[38:39], v209 offset0:56 offset1:48
    buffer_load_dwordx4 v5, s[16:19], s43 offen offset:3072 sc1 lds
    ds_read2_b32 v[40:41], v210 offset0:56 offset1:48
    ds_read2_b32 v[42:43], v211 offset0:56 offset1:48
    ds_read2_b32 v[44:45], v212 offset0:56 offset1:48
    ds_read2_b32 v[46:47], v204 offset0:40 offset1:32
    ds_read2_b32 v[48:49], v205 offset0:40 offset1:32
    s_add_u32 m0, s41, 4096
    s_add_u32 s43, s43, 4096
    buffer_load_dwordx4 v5, s[16:19], s43 offen sc1 lds
    ds_read2_b32 v[50:51], v206 offset0:40 offset1:32
    ds_read2_b32 v[52:53], v207 offset0:40 offset1:32
    s_waitcnt vmcnt(18)
    s_barrier
    s_add_u32 s54, s52, 73728
    s_add_u32 m0, s53, 151552
    s_nop 0
    buffer_load_dwordx4 v213, s[28:31], s54 offen sc1 lds
    s_add_u32 m0, s53, 152576
    s_nop 0
    buffer_load_dwordx4 v214, s[28:31], s54 offen sc1 lds
    s_add_u32 m0, s53, 153600
    s_nop 0
    buffer_load_dwordx4 v215, s[28:31], s54 offen sc1 lds
    s_add_u32 m0, s40, 34816
    s_movk_i32 s42, 2176
    buffer_load_dwordx4 v1, s[12:15], s42 offen offset:0  lds
    ds_read2_b32 v[54:55], v208 offset0:40 offset1:32
    ds_read2_b32 v[56:57], v209 offset0:40 offset1:32
    ds_read2_b32 v[58:59], v210 offset0:40 offset1:32
    ds_read2_b32 v[60:61], v211 offset0:40 offset1:32
    ds_read2_b32 v[62:63], v212 offset0:40 offset1:32
    buffer_load_dwordx4 v2, s[12:15], s42 offen offset:1024  lds
    s_waitcnt lgkmcnt(9)
    v_lshlrev_b32 v126, 16, v28
    v_and_b32 v127, s56, v28
    v_mul_f32 v130, v126, v140
    v_mul_f32 v131, v127, v141
    v_lshlrev_b32 v128, 16, v30
    v_and_b32 v129, s56, v30
    v_mul_f32 v132, v128, v142
    buffer_load_dwordx4 v3, s[12:15], s42 offen offset:2048  lds
    v_mul_f32 v133, v129, v143
    v_lshlrev_b32 v126, 16, v32
    v_and_b32 v127, s56, v32
    v_fmac_f32 v130, v126, v144
    v_fmac_f32 v131, v127, v145
    v_lshlrev_b32 v128, 16, v34
    v_and_b32 v129, s56, v34
    buffer_load_dwordx4 v4, s[12:15], s42 offen offset:3072  lds
    v_fmac_f32 v132, v128, v146
    v_fmac_f32 v133, v129, v147
    v_lshlrev_b32 v126, 16, v36
    v_and_b32 v127, s56, v36
    v_fmac_f32 v130, v126, v148
    v_fmac_f32 v131, v127, v149
    v_lshlrev_b32 v128, 16, v38
    s_add_u32 m0, s41, 34816
    s_mov_b32 s43, 313344
    buffer_load_dwordx4 v5, s[16:19], s43 offen offset:0 sc1 lds
    v_and_b32 v129, s56, v38
    v_fmac_f32 v132, v128, v150
    v_fmac_f32 v133, v129, v151
    v_lshlrev_b32 v126, 16, v40
    v_and_b32 v127, s56, v40
    v_fmac_f32 v130, v126, v152
    v_fmac_f32 v131, v127, v153
    buffer_load_dwordx4 v5, s[16:19], s43 offen offset:1024 sc1 lds
    v_lshlrev_b32 v128, 16, v42
    v_and_b32 v129, s56, v42
    v_fmac_f32 v132, v128, v154
    v_fmac_f32 v133, v129, v155
    v_lshlrev_b32 v126, 16, v44
    v_and_b32 v127, s56, v44
    v_fmac_f32 v130, v126, v156
    buffer_load_dwordx4 v5, s[16:19], s43 offen offset:2048 sc1 lds
    v_fmac_f32 v131, v127, v157
    v_add_f32 v130, v130, v131
    v_add_f32 v132, v132, v133
    v_add_f32 v100, v130, v132
    ds_read2_b32 v[64:65], v204 offset0:24 offset1:16
    ds_read2_b32 v[66:67], v205 offset0:24 offset1:16
    buffer_load_dwordx4 v5, s[16:19], s43 offen offset:3072 sc1 lds
    ds_read2_b32 v[68:69], v206 offset0:24 offset1:16
    ds_read2_b32 v[70:71], v207 offset0:24 offset1:16
    ds_read2_b32 v[72:73], v208 offset0:24 offset1:16
    ds_read2_b32 v[74:75], v209 offset0:24 offset1:16
    ds_read2_b32 v[76:77], v210 offset0:24 offset1:16
    s_add_u32 m0, s41, 38912
    s_add_u32 s43, s43, 4096
    buffer_load_dwordx4 v5, s[16:19], s43 offen sc1 lds
    ds_read2_b32 v[78:79], v211 offset0:24 offset1:16
    ds_read2_b32 v[80:81], v212 offset0:24 offset1:16
    v_lshlrev_b32 v126, 16, v29
    s_waitcnt vmcnt(21)
    s_barrier
    s_add_u32 m0, s40, 69632
    s_movk_i32 s42, 2304
    buffer_load_dwordx4 v1, s[12:15], s42 offen offset:0  lds
    v_and_b32 v127, s56, v29
    v_mul_f32 v130, v126, v140
    v_mul_f32 v131, v127, v141
    v_lshlrev_b32 v128, 16, v31
    v_and_b32 v129, s56, v31
    v_mul_f32 v132, v128, v142
    v_mul_f32 v133, v129, v143
    buffer_load_dwordx4 v2, s[12:15], s42 offen offset:1024  lds
    v_lshlrev_b32 v126, 16, v33
    v_and_b32 v127, s56, v33
    v_fmac_f32 v130, v126, v144
    v_fmac_f32 v131, v127, v145
    v_lshlrev_b32 v128, 16, v35
    v_and_b32 v129, s56, v35
    v_fmac_f32 v132, v128, v146
    buffer_load_dwordx4 v3, s[12:15], s42 offen offset:2048  lds
    v_fmac_f32 v133, v129, v147
    v_lshlrev_b32 v126, 16, v37
    v_and_b32 v127, s56, v37
    v_fmac_f32 v130, v126, v148
    v_fmac_f32 v131, v127, v149
    v_lshlrev_b32 v128, 16, v39
    v_and_b32 v129, s56, v39
    buffer_load_dwordx4 v4, s[12:15], s42 offen offset:3072  lds
    v_fmac_f32 v132, v128, v150
    v_fmac_f32 v133, v129, v151
    v_lshlrev_b32 v126, 16, v41
    v_and_b32 v127, s56, v41
    v_fmac_f32 v130, v126, v152
    v_fmac_f32 v131, v127, v153
    v_lshlrev_b32 v128, 16, v43
    s_add_u32 m0, s41, 69632
    s_mov_b32 s43, 331776
    buffer_load_dwordx4 v5, s[16:19], s43 offen offset:0 sc1 lds
    v_and_b32 v129, s56, v43
    v_fmac_f32 v132, v128, v154
    v_fmac_f32 v133, v129, v155
    v_lshlrev_b32 v126, 16, v45
    v_and_b32 v127, s56, v45
    v_fmac_f32 v130, v126, v156
    v_fmac_f32 v131, v127, v157
    buffer_load_dwordx4 v5, s[16:19], s43 offen offset:1024 sc1 lds
    v_add_f32 v130, v130, v131
    v_add_f32 v132, v132, v133
    v_add_f32 v101, v130, v132
    s_waitcnt lgkmcnt(9)
    v_lshlrev_b32 v126, 16, v46
    v_and_b32 v127, s56, v46
    v_mul_f32 v130, v126, v140
    v_mul_f32 v131, v127, v141
    buffer_load_dwordx4 v5, s[16:19], s43 offen offset:2048 sc1 lds
    v_lshlrev_b32 v128, 16, v48
    v_and_b32 v129, s56, v48
    v_mul_f32 v132, v128, v142
    v_mul_f32 v133, v129, v143
    v_lshlrev_b32 v126, 16, v50
    v_and_b32 v127, s56, v50
    v_fmac_f32 v130, v126, v144
    buffer_load_dwordx4 v5, s[16:19], s43 offen offset:3072 sc1 lds
    v_fmac_f32 v131, v127, v145
    v_lshlrev_b32 v128, 16, v52
    v_and_b32 v129, s56, v52
    v_fmac_f32 v132, v128, v146
    v_fmac_f32 v133, v129, v147
    v_lshlrev_b32 v126, 16, v54
    v_and_b32 v127, s56, v54
    s_add_u32 m0, s41, 73728
    s_add_u32 s43, s43, 4096
    buffer_load_dwordx4 v5, s[16:19], s43 offen sc1 lds
    buffer_store_dwordx4 v[232:235], v6, s[20:23], s4 offen offset:3072 sc1
    v_fmac_f32 v130, v126, v148
    v_fmac_f32 v131, v127, v149
    v_lshlrev_b32 v128, 16, v56
    v_and_b32 v129, s56, v56
    v_fmac_f32 v132, v128, v150
    s_waitcnt vmcnt(22)
    s_waitcnt vmcnt(19)
    s_barrier
    s_add_u32 m0, s40, 104448
    s_movk_i32 s42, 2432
    buffer_load_dwordx4 v1, s[12:15], s42 offen offset:0  lds
    v_fmac_f32 v133, v129, v151
    v_lshlrev_b32 v126, 16, v58
    v_and_b32 v127, s56, v58
    v_fmac_f32 v130, v126, v152
    v_fmac_f32 v131, v127, v153
    v_lshlrev_b32 v128, 16, v60
    v_and_b32 v129, s56, v60
    buffer_load_dwordx4 v2, s[12:15], s42 offen offset:1024  lds
    v_fmac_f32 v132, v128, v154
    v_fmac_f32 v133, v129, v155
    v_lshlrev_b32 v126, 16, v62
    v_and_b32 v127, s56, v62
    v_fmac_f32 v130, v126, v156
    v_fmac_f32 v131, v127, v157
    v_add_f32 v130, v130, v131
    buffer_load_dwordx4 v3, s[12:15], s42 offen offset:2048  lds
    v_add_f32 v132, v132, v133
    v_add_f32 v102, v130, v132
    ds_read2_b32 v[82:83], v204 offset0:8 offset1:0
    ds_read2_b32 v[84:85], v205 offset0:8 offset1:0
    ds_read2_b32 v[86:87], v206 offset0:8 offset1:0
    ds_read2_b32 v[88:89], v207 offset0:8 offset1:0
    buffer_load_dwordx4 v4, s[12:15], s42 offen offset:3072  lds
    ds_read2_b32 v[90:91], v208 offset0:8 offset1:0
    ds_read2_b32 v[92:93], v209 offset0:8 offset1:0
    ds_read2_b32 v[94:95], v210 offset0:8 offset1:0
    ds_read2_b32 v[96:97], v211 offset0:8 offset1:0
    ds_read2_b32 v[98:99], v212 offset0:8 offset1:0
    s_add_u32 m0, s41, 104448
    s_mov_b32 s43, 350208
    buffer_load_dwordx4 v5, s[16:19], s43 offen offset:0 sc1 lds
    v_lshlrev_b32 v126, 16, v47
    v_and_b32 v127, s56, v47
    v_mul_f32 v130, v126, v140
    v_mul_f32 v131, v127, v141
    v_lshlrev_b32 v128, 16, v49
    v_and_b32 v129, s56, v49
    v_mul_f32 v132, v128, v142
    buffer_load_dwordx4 v5, s[16:19], s43 offen offset:1024 sc1 lds
    v_mul_f32 v133, v129, v143
    v_lshlrev_b32 v126, 16, v51
    v_and_b32 v127, s56, v51
    v_fmac_f32 v130, v126, v144
    v_fmac_f32 v131, v127, v145
    v_lshlrev_b32 v128, 16, v53
    v_and_b32 v129, s56, v53
    buffer_load_dwordx4 v5, s[16:19], s43 offen offset:2048 sc1 lds
    v_fmac_f32 v132, v128, v146
    v_fmac_f32 v133, v129, v147
    v_lshlrev_b32 v126, 16, v55
    v_and_b32 v127, s56, v55
    v_fmac_f32 v130, v126, v148
    v_fmac_f32 v131, v127, v149
    v_lshlrev_b32 v128, 16, v57
    buffer_load_dwordx4 v5, s[16:19], s43 offen offset:3072 sc1 lds
    v_and_b32 v129, s56, v57
    v_fmac_f32 v132, v128, v150
    v_fmac_f32 v133, v129, v151
    v_lshlrev_b32 v126, 16, v59
    v_and_b32 v127, s56, v59
    v_fmac_f32 v130, v126, v152
    v_fmac_f32 v131, v127, v153
    s_add_u32 m0, s41, 108544
    s_add_u32 s43, s43, 4096
    buffer_load_dwordx4 v5, s[16:19], s43 offen sc1 lds
    v_lshlrev_b32 v128, 16, v61
    v_and_b32 v129, s56, v61
    v_fmac_f32 v132, v128, v154
    v_fmac_f32 v133, v129, v155
    s_waitcnt vmcnt(19)
    s_barrier
    s_add_u32 m0, s40, 0
    s_movk_i32 s42, 2560
    buffer_load_dwordx4 v1, s[12:15], s42 offen offset:0  lds
    v_lshlrev_b32 v126, 16, v63
    v_and_b32 v127, s56, v63
    v_fmac_f32 v130, v126, v156
    v_fmac_f32 v131, v127, v157
    v_add_f32 v130, v130, v131
    v_add_f32 v132, v132, v133
    v_add_f32 v103, v130, v132
    buffer_load_dwordx4 v2, s[12:15], s42 offen offset:1024  lds
    v_add_u32 v204, 12288, v204
    v_add_u32 v205, 12288, v205
    v_add_u32 v206, 12288, v206
    v_add_u32 v207, 12288, v207
    v_add_u32 v208, 12288, v208
    v_add_u32 v209, 12288, v209
    v_add_u32 v210, 12288, v210
    buffer_load_dwordx4 v3, s[12:15], s42 offen offset:2048  lds
    v_add_u32 v211, 12288, v211
    v_add_u32 v212, 12288, v212
    ds_read2_b32 v[28:29], v204 offset0:56 offset1:48
    ds_read2_b32 v[30:31], v205 offset0:56 offset1:48
    ds_read2_b32 v[32:33], v206 offset0:56 offset1:48
    ds_read2_b32 v[34:35], v207 offset0:56 offset1:48
    buffer_load_dwordx4 v4, s[12:15], s42 offen offset:3072  lds
    ds_read2_b32 v[36:37], v208 offset0:56 offset1:48
    ds_read2_b32 v[38:39], v209 offset0:56 offset1:48
    ds_read2_b32 v[40:41], v210 offset0:56 offset1:48
    ds_read2_b32 v[42:43], v211 offset0:56 offset1:48
    ds_read2_b32 v[44:45], v212 offset0:56 offset1:48
    s_add_u32 m0, s41, 0
    s_mov_b32 s43, 368640
    buffer_load_dwordx4 v5, s[16:19], s43 offen offset:0 sc1 lds
    s_waitcnt lgkmcnt(15)
    v_lshlrev_b32 v126, 16, v64
    v_and_b32 v127, s56, v64
    v_mul_f32 v130, v126, v140
    v_mul_f32 v131, v127, v141
    v_lshlrev_b32 v128, 16, v66
    v_and_b32 v129, s56, v66
    v_mul_f32 v132, v128, v142
    buffer_load_dwordx4 v5, s[16:19], s43 offen offset:1024 sc1 lds
    v_mul_f32 v133, v129, v143
    v_lshlrev_b32 v126, 16, v68
    v_and_b32 v127, s56, v68
    v_fmac_f32 v130, v126, v144
    v_fmac_f32 v131, v127, v145
    v_lshlrev_b32 v128, 16, v70
    v_and_b32 v129, s56, v70
    buffer_load_dwordx4 v5, s[16:19], s43 offen offset:2048 sc1 lds
    v_fmac_f32 v132, v128, v146
    v_fmac_f32 v133, v129, v147
    v_lshlrev_b32 v126, 16, v72
    v_and_b32 v127, s56, v72
    v_fmac_f32 v130, v126, v148
    v_fmac_f32 v131, v127, v149
    v_lshlrev_b32 v128, 16, v74
    buffer_load_dwordx4 v5, s[16:19], s43 offen offset:3072 sc1 lds
    v_and_b32 v129, s56, v74
    v_fmac_f32 v132, v128, v150
    v_fmac_f32 v133, v129, v151
    v_lshlrev_b32 v126, 16, v76
    v_and_b32 v127, s56, v76
    v_fmac_f32 v130, v126, v152
    v_fmac_f32 v131, v127, v153
    s_add_u32 m0, s41, 4096
    s_add_u32 s43, s43, 4096
    buffer_load_dwordx4 v5, s[16:19], s43 offen sc1 lds
    buffer_store_dwordx4 v[236:239], v240, s[20:23], s4 offen sc1
    v_lshlrev_b32 v128, 16, v78
    v_and_b32 v129, s56, v78
    v_fmac_f32 v132, v128, v154
    v_fmac_f32 v133, v129, v155
    s_waitcnt vmcnt(20)
    s_barrier
    s_add_u32 m0, s40, 34816
    s_movk_i32 s42, 2688
    buffer_load_dwordx4 v1, s[12:15], s42 offen offset:0  lds
    v_lshlrev_b32 v126, 16, v80
    v_and_b32 v127, s56, v80
    v_fmac_f32 v130, v126, v156
    v_fmac_f32 v131, v127, v157
    v_add_f32 v130, v130, v131
    v_add_f32 v132, v132, v133
    v_add_f32 v104, v130, v132
    buffer_load_dwordx4 v2, s[12:15], s42 offen offset:1024  lds
    v_lshlrev_b32 v126, 16, v65
    v_and_b32 v127, s56, v65
    v_mul_f32 v130, v126, v140
    v_mul_f32 v131, v127, v141
    v_lshlrev_b32 v128, 16, v67
    v_and_b32 v129, s56, v67
    v_mul_f32 v132, v128, v142
    buffer_load_dwordx4 v3, s[12:15], s42 offen offset:2048  lds
    v_mul_f32 v133, v129, v143
    v_lshlrev_b32 v126, 16, v69
    v_and_b32 v127, s56, v69
    v_fmac_f32 v130, v126, v144
    v_fmac_f32 v131, v127, v145
    v_lshlrev_b32 v128, 16, v71
    v_and_b32 v129, s56, v71
    buffer_load_dwordx4 v4, s[12:15], s42 offen offset:3072  lds
    v_fmac_f32 v132, v128, v146
    v_fmac_f32 v133, v129, v147
    v_lshlrev_b32 v126, 16, v73
    v_and_b32 v127, s56, v73
    v_fmac_f32 v130, v126, v148
    v_fmac_f32 v131, v127, v149
    v_lshlrev_b32 v128, 16, v75
    s_add_u32 m0, s41, 34816
    s_mov_b32 s43, 387072
    buffer_load_dwordx4 v5, s[16:19], s43 offen offset:0 sc1 lds
    v_and_b32 v129, s56, v75
    v_fmac_f32 v132, v128, v150
    v_fmac_f32 v133, v129, v151
    v_lshlrev_b32 v126, 16, v77
    v_and_b32 v127, s56, v77
    v_fmac_f32 v130, v126, v152
    v_fmac_f32 v131, v127, v153
    buffer_load_dwordx4 v5, s[16:19], s43 offen offset:1024 sc1 lds
    v_lshlrev_b32 v128, 16, v79
    v_and_b32 v129, s56, v79
    v_fmac_f32 v132, v128, v154
    v_fmac_f32 v133, v129, v155
    v_lshlrev_b32 v126, 16, v81
    v_and_b32 v127, s56, v81
    v_fmac_f32 v130, v126, v156
    buffer_load_dwordx4 v5, s[16:19], s43 offen offset:2048 sc1 lds
    v_fmac_f32 v131, v127, v157
    v_add_f32 v130, v130, v131
    v_add_f32 v132, v132, v133
    v_add_f32 v105, v130, v132
    ds_read2_b32 v[46:47], v204 offset0:40 offset1:32
    ds_read2_b32 v[48:49], v205 offset0:40 offset1:32
    buffer_load_dwordx4 v5, s[16:19], s43 offen offset:3072 sc1 lds
    ds_read2_b32 v[50:51], v206 offset0:40 offset1:32
    ds_read2_b32 v[52:53], v207 offset0:40 offset1:32
    ds_read2_b32 v[54:55], v208 offset0:40 offset1:32
    ds_read2_b32 v[56:57], v209 offset0:40 offset1:32
    ds_read2_b32 v[58:59], v210 offset0:40 offset1:32
    s_add_u32 m0, s41, 38912
    s_add_u32 s43, s43, 4096
    buffer_load_dwordx4 v5, s[16:19], s43 offen sc1 lds
    ds_read2_b32 v[60:61], v211 offset0:40 offset1:32
    ds_read2_b32 v[62:63], v212 offset0:40 offset1:32
    s_waitcnt lgkmcnt(15)
    v_lshlrev_b32 v126, 16, v82
    v_and_b32 v127, s56, v82
    s_waitcnt vmcnt(19)
    s_barrier
    s_add_u32 m0, s40, 69632
    s_movk_i32 s42, 2816
    buffer_load_dwordx4 v1, s[12:15], s42 offen offset:0  lds
    v_mul_f32 v130, v126, v140
    v_mul_f32 v131, v127, v141
    v_lshlrev_b32 v128, 16, v84
    v_and_b32 v129, s56, v84
    v_mul_f32 v132, v128, v142
    v_mul_f32 v133, v129, v143
    v_lshlrev_b32 v126, 16, v86
    buffer_load_dwordx4 v2, s[12:15], s42 offen offset:1024  lds
    v_and_b32 v127, s56, v86
    v_fmac_f32 v130, v126, v144
    v_fmac_f32 v131, v127, v145
    v_lshlrev_b32 v128, 16, v88
    v_and_b32 v129, s56, v88
    v_fmac_f32 v132, v128, v146
    v_fmac_f32 v133, v129, v147
    buffer_load_dwordx4 v3, s[12:15], s42 offen offset:2048  lds
    v_lshlrev_b32 v126, 16, v90
    v_and_b32 v127, s56, v90
    v_fmac_f32 v130, v126, v148
    v_fmac_f32 v131, v127, v149
    v_lshlrev_b32 v128, 16, v92
    v_and_b32 v129, s56, v92
    v_fmac_f32 v132, v128, v150
    buffer_load_dwordx4 v4, s[12:15], s42 offen offset:3072  lds
    v_fmac_f32 v133, v129, v151
    v_lshlrev_b32 v126, 16, v94
    v_and_b32 v127, s56, v94
    v_fmac_f32 v130, v126, v152
    v_fmac_f32 v131, v127, v153
    v_lshlrev_b32 v128, 16, v96
    v_and_b32 v129, s56, v96
    s_add_u32 m0, s41, 69632
    s_mov_b32 s43, 405504
    buffer_load_dwordx4 v5, s[16:19], s43 offen offset:0 sc1 lds
    v_fmac_f32 v132, v128, v154
    v_fmac_f32 v133, v129, v155
    v_lshlrev_b32 v126, 16, v98
    v_and_b32 v127, s56, v98
    v_fmac_f32 v130, v126, v156
    v_fmac_f32 v131, v127, v157
    v_add_f32 v130, v130, v131
    buffer_load_dwordx4 v5, s[16:19], s43 offen offset:1024 sc1 lds
    v_add_f32 v132, v132, v133
    v_add_f32 v106, v130, v132
    v_lshlrev_b32 v126, 16, v83
    v_and_b32 v127, s56, v83
    v_mul_f32 v130, v126, v140
    v_mul_f32 v131, v127, v141
    v_lshlrev_b32 v128, 16, v85
    buffer_load_dwordx4 v5, s[16:19], s43 offen offset:2048 sc1 lds
    v_and_b32 v129, s56, v85
    v_mul_f32 v132, v128, v142
    v_mul_f32 v133, v129, v143
    v_lshlrev_b32 v126, 16, v87
    v_and_b32 v127, s56, v87
    v_fmac_f32 v130, v126, v144
    v_fmac_f32 v131, v127, v145
    buffer_load_dwordx4 v5, s[16:19], s43 offen offset:3072 sc1 lds
    v_lshlrev_b32 v128, 16, v89
    v_and_b32 v129, s56, v89
    v_fmac_f32 v132, v128, v146
    v_fmac_f32 v133, v129, v147
    v_lshlrev_b32 v126, 16, v91
    v_and_b32 v127, s56, v91
    v_fmac_f32 v130, v126, v148
    s_add_u32 m0, s41, 73728
    s_add_u32 s43, s43, 4096
    buffer_load_dwordx4 v5, s[16:19], s43 offen sc1 lds
    v_fmac_f32 v131, v127, v149
    v_lshlrev_b32 v128, 16, v93
    v_and_b32 v129, s56, v93
    v_fmac_f32 v132, v128, v150
    v_fmac_f32 v133, v129, v151
    s_waitcnt vmcnt(19)
    s_barrier
    s_add_u32 m0, s40, 104448
    s_movk_i32 s42, 2944
    buffer_load_dwordx4 v1, s[12:15], s42 offen offset:0  lds
    v_lshlrev_b32 v126, 16, v95
    v_and_b32 v127, s56, v95
    v_fmac_f32 v130, v126, v152
    v_fmac_f32 v131, v127, v153
    v_lshlrev_b32 v128, 16, v97
    v_and_b32 v129, s56, v97
    v_fmac_f32 v132, v128, v154
    buffer_load_dwordx4 v2, s[12:15], s42 offen offset:1024  lds
    v_fmac_f32 v133, v129, v155
    v_lshlrev_b32 v126, 16, v99
    v_and_b32 v127, s56, v99
    v_fmac_f32 v130, v126, v156
    v_fmac_f32 v131, v127, v157
    v_add_f32 v130, v130, v131
    v_add_f32 v132, v132, v133
    buffer_load_dwordx4 v3, s[12:15], s42 offen offset:2048  lds
    v_add_f32 v107, v130, v132
    ds_read2_b32 v[64:65], v204 offset0:24 offset1:16
    ds_read2_b32 v[66:67], v205 offset0:24 offset1:16
    ds_read2_b32 v[68:69], v206 offset0:24 offset1:16
    ds_read2_b32 v[70:71], v207 offset0:24 offset1:16
    buffer_load_dwordx4 v4, s[12:15], s42 offen offset:3072  lds
    ds_read2_b32 v[72:73], v208 offset0:24 offset1:16
    ds_read2_b32 v[74:75], v209 offset0:24 offset1:16
    ds_read2_b32 v[76:77], v210 offset0:24 offset1:16
    ds_read2_b32 v[78:79], v211 offset0:24 offset1:16
    ds_read2_b32 v[80:81], v212 offset0:24 offset1:16
    s_add_u32 m0, s41, 104448
    s_mov_b32 s43, 423936
    buffer_load_dwordx4 v5, s[16:19], s43 offen offset:0 sc1 lds
    ds_read2_b32 v[82:83], v204 offset0:8 offset1:0
    ds_read2_b32 v[84:85], v205 offset0:8 offset1:0
    ds_read2_b32 v[86:87], v206 offset0:8 offset1:0
    ds_read2_b32 v[88:89], v207 offset0:8 offset1:0
    ds_read2_b32 v[90:91], v208 offset0:8 offset1:0
    buffer_load_dwordx4 v5, s[16:19], s43 offen offset:1024 sc1 lds
    ds_read2_b32 v[92:93], v209 offset0:8 offset1:0
    ds_read2_b32 v[94:95], v210 offset0:8 offset1:0
    ds_read2_b32 v[96:97], v211 offset0:8 offset1:0
    ds_read2_b32 v[98:99], v212 offset0:8 offset1:0
    v_mov_b32 v126, 0xce6e6b28
    buffer_load_dwordx4 v5, s[16:19], s43 offen offset:2048 sc1 lds
    v_mul_f32 v100, 0x3eae1a93, v100
    v_mul_f32 v101, 0x3eae1a93, v101
    v_mul_f32 v102, 0x3eae1a93, v102
    v_mul_f32 v103, 0x3eae1a93, v103
    v_mul_f32 v104, 0x3eae1a93, v104
    v_mul_f32 v105, 0x3eae1a93, v105
    v_mul_f32 v106, 0x3eae1a93, v106
    buffer_load_dwordx4 v5, s[16:19], s43 offen offset:3072 sc1 lds
    v_mul_f32 v107, 0x3eae1a93, v107
    v_cmp_gt_u32 vcc, 2, v10
    s_nop 1
    v_cndmask_b32 v101, v101, v126, vcc
    v_cmp_gt_u32 vcc, 4, v10
    s_nop 1
    v_cndmask_b32 v102, v102, v126, vcc
    v_cmp_gt_u32 vcc, 6, v10
    s_nop 1
    v_cndmask_b32 v103, v103, v126, vcc
    s_add_u32 m0, s41, 108544
    s_add_u32 s43, s43, 4096
    buffer_load_dwordx4 v5, s[16:19], s43 offen sc1 lds
    v_cmp_gt_u32 vcc, 8, v10
    s_nop 1
    v_cndmask_b32 v104, v104, v126, vcc
    v_cmp_gt_u32 vcc, 10, v10
    s_nop 1
    v_cndmask_b32 v105, v105, v126, vcc
    s_waitcnt vmcnt(18)
    s_barrier
    s_add_u32 m0, s40, 0
    s_movk_i32 s42, 3072
    buffer_load_dwordx4 v1, s[12:15], s42 offen offset:0  lds
    v_cmp_gt_u32 vcc, 12, v10
    s_nop 1
    v_cndmask_b32 v106, v106, v126, vcc
    v_cmp_gt_u32 vcc, 14, v10
    s_nop 1
    v_cndmask_b32 v107, v107, v126, vcc
    v_max3_f32 v127, v100, v101, v102
    v_max3_f32 v128, v103, v104, v105
    v_max3_f32 v127, v127, v106, v107
    buffer_load_dwordx4 v2, s[12:15], s42 offen offset:1024  lds
    v_max_f32 v127, v127, v128
    v_sub_f32 v100, v100, v127
    v_sub_f32 v101, v101, v127
    v_sub_f32 v102, v102, v127
    v_sub_f32 v103, v103, v127
    v_sub_f32 v104, v104, v127
    v_sub_f32 v105, v105, v127
    buffer_load_dwordx4 v3, s[12:15], s42 offen offset:2048  lds
    v_sub_f32 v106, v106, v127
    v_sub_f32 v107, v107, v127
    v_exp_f32 v100, v100
    v_exp_f32 v101, v101
    v_exp_f32 v102, v102
    buffer_load_dwordx4 v4, s[12:15], s42 offen offset:3072  lds
    v_exp_f32 v103, v103
    v_exp_f32 v104, v104
    v_exp_f32 v105, v105
    v_exp_f32 v106, v106
    s_add_u32 m0, s41, 0
    s_mov_b32 s43, 442368
    buffer_load_dwordx4 v5, s[16:19], s43 offen offset:0 sc1 lds
    v_exp_f32 v107, v107
    v_add_f32 v127, v100, v101
    v_add_f32 v128, v102, v103
    v_add_f32 v129, v104, v105
    v_add_f32 v130, v106, v107
    v_add_f32 v127, v127, v128
    buffer_load_dwordx4 v5, s[16:19], s43 offen offset:1024 sc1 lds
    v_add_f32 v129, v129, v130
    v_add_f32 v127, v127, v129
    v_rcp_f32 v134, v127
    s_nop 0
    v_mul_f32 v100, v100, v134
    v_mul_f32 v101, v101, v134
    buffer_load_dwordx4 v5, s[16:19], s43 offen offset:2048 sc1 lds
    v_mul_f32 v102, v102, v134
    v_mul_f32 v103, v103, v134
    v_mul_f32 v104, v104, v134
    v_mul_f32 v105, v105, v134
    v_mul_f32 v106, v106, v134
    v_mul_f32 v107, v107, v134
    s_waitcnt lgkmcnt(15)
    v_lshlrev_b32 v126, 16, v28
    buffer_load_dwordx4 v5, s[16:19], s43 offen offset:3072 sc1 lds
    v_and_b32 v127, s56, v28
    v_mul_f32 v108, v126, v100
    v_mul_f32 v109, v127, v100
    v_lshlrev_b32 v128, 16, v30
    v_and_b32 v129, s56, v30
    v_mul_f32 v110, v128, v100
    v_mul_f32 v111, v129, v100
    s_add_u32 m0, s41, 4096
    s_add_u32 s43, s43, 4096
    buffer_load_dwordx4 v5, s[16:19], s43 offen sc1 lds
    v_lshlrev_b32 v126, 16, v32
    v_and_b32 v127, s56, v32
    v_mul_f32 v112, v126, v100
    s_waitcnt vmcnt(18)
    s_barrier
    s_cmp_eq_u32 s34, 4
    s_cbranch_scc0 L_fw_1
    s_lshl_b32 s68, s49, 7
    s_lshl_b32 s69, s48, 2
    s_add_u32 s68, s68, s69
    s_add_u32 s68, s68, 9216
    v_mov_b32 v253, s68
    v_mov_b32 v254, s71
    s_mov_b64 exec, 1
    buffer_store_dword v254, v253, s[72:75], 0 offen sc1
    s_mov_b64 exec, -1
L_fw_1:
    s_add_u32 m0, s40, 34816
    s_movk_i32 s42, 3200
    buffer_load_dwordx4 v1, s[12:15], s42 offen offset:0  lds
    v_mul_f32 v113, v127, v100
    v_lshlrev_b32 v128, 16, v34
    v_and_b32 v129, s56, v34
    v_mul_f32 v114, v128, v100
    v_mul_f32 v115, v129, v100
    v_lshlrev_b32 v126, 16, v36
    v_and_b32 v127, s56, v36
    buffer_load_dwordx4 v2, s[12:15], s42 offen offset:1024  lds
    v_mul_f32 v116, v126, v100
    v_mul_f32 v117, v127, v100
    v_lshlrev_b32 v128, 16, v38
    v_and_b32 v129, s56, v38
    v_mul_f32 v118, v128, v100
    v_mul_f32 v119, v129, v100
    v_lshlrev_b32 v126, 16, v40
    buffer_load_dwordx4 v3, s[12:15], s42 offen offset:2048  lds
    v_and_b32 v127, s56, v40
    v_mul_f32 v120, v126, v100
    v_mul_f32 v121, v127, v100
    v_lshlrev_b32 v128, 16, v42
    v_and_b32 v129, s56, v42
    v_mul_f32 v122, v128, v100
    v_mul_f32 v123, v129, v100
    buffer_load_dwordx4 v4, s[12:15], s42 offen offset:3072  lds
    v_lshlrev_b32 v126, 16, v44
    v_and_b32 v127, s56, v44
    v_mul_f32 v124, v126, v100
    v_mul_f32 v125, v127, v100
    v_lshlrev_b32 v126, 16, v29
    v_and_b32 v127, s56, v29
    v_fmac_f32 v108, v126, v101
    s_add_u32 m0, s41, 34816
    s_mov_b32 s43, 460800
    buffer_load_dwordx4 v5, s[16:19], s43 offen offset:0 sc1 lds
    v_fmac_f32 v109, v127, v101
    v_lshlrev_b32 v128, 16, v31
    v_and_b32 v129, s56, v31
    v_fmac_f32 v110, v128, v101
    v_fmac_f32 v111, v129, v101
    v_lshlrev_b32 v126, 16, v33
    v_and_b32 v127, s56, v33
    buffer_load_dwordx4 v5, s[16:19], s43 offen offset:1024 sc1 lds
    v_fmac_f32 v112, v126, v101
    v_fmac_f32 v113, v127, v101
    v_lshlrev_b32 v128, 16, v35
    v_and_b32 v129, s56, v35
    v_fmac_f32 v114, v128, v101
    v_fmac_f32 v115, v129, v101
    v_lshlrev_b32 v126, 16, v37
    buffer_load_dwordx4 v5, s[16:19], s43 offen offset:2048 sc1 lds
    v_and_b32 v127, s56, v37
    v_fmac_f32 v116, v126, v101
    v_fmac_f32 v117, v127, v101
    v_lshlrev_b32 v128, 16, v39
    v_and_b32 v129, s56, v39
    v_fmac_f32 v118, v128, v101
    v_fmac_f32 v119, v129, v101
    buffer_load_dwordx4 v5, s[16:19], s43 offen offset:3072 sc1 lds
    v_lshlrev_b32 v126, 16, v41
    v_and_b32 v127, s56, v41
    v_fmac_f32 v120, v126, v101
    v_fmac_f32 v121, v127, v101
    v_lshlrev_b32 v128, 16, v43
    v_and_b32 v129, s56, v43
    v_fmac_f32 v122, v128, v101
    s_add_u32 m0, s41, 38912
    s_add_u32 s43, s43, 4096
    buffer_load_dwordx4 v5, s[16:19], s43 offen sc1 lds
    v_fmac_f32 v123, v129, v101
    v_lshlrev_b32 v126, 16, v45
    v_and_b32 v127, s56, v45
    v_fmac_f32 v124, v126, v101
    v_fmac_f32 v125, v127, v101
    s_waitcnt vmcnt(18)
    s_barrier
    s_add_u32 m0, s40, 69632
    s_movk_i32 s42, 3328
    buffer_load_dwordx4 v1, s[12:15], s42 offen offset:0  lds
    v_lshlrev_b32 v126, 16, v46
    v_and_b32 v127, s56, v46
    v_fmac_f32 v108, v126, v102
    v_fmac_f32 v109, v127, v102
    v_lshlrev_b32 v128, 16, v48
    v_and_b32 v129, s56, v48
    v_fmac_f32 v110, v128, v102
    buffer_load_dwordx4 v2, s[12:15], s42 offen offset:1024  lds
    v_fmac_f32 v111, v129, v102
    v_lshlrev_b32 v126, 16, v50
    v_and_b32 v127, s56, v50
    v_fmac_f32 v112, v126, v102
    v_fmac_f32 v113, v127, v102
    v_lshlrev_b32 v128, 16, v52
    v_and_b32 v129, s56, v52
    buffer_load_dwordx4 v3, s[12:15], s42 offen offset:2048  lds
    v_fmac_f32 v114, v128, v102
    v_fmac_f32 v115, v129, v102
    v_lshlrev_b32 v126, 16, v54
    v_and_b32 v127, s56, v54
    v_fmac_f32 v116, v126, v102
    v_fmac_f32 v117, v127, v102
    v_lshlrev_b32 v128, 16, v56
    buffer_load_dwordx4 v4, s[12:15], s42 offen offset:3072  lds
    v_and_b32 v129, s56, v56
    v_fmac_f32 v118, v128, v102
    v_fmac_f32 v119, v129, v102
    v_lshlrev_b32 v126, 16, v58
    v_and_b32 v127, s56, v58
    v_fmac_f32 v120, v126, v102
    v_fmac_f32 v121, v127, v102
    s_add_u32 m0, s41, 69632
    s_mov_b32 s43, 479232
    buffer_load_dwordx4 v5, s[16:19], s43 offen offset:0 sc1 lds
    v_lshlrev_b32 v128, 16, v60
    v_and_b32 v129, s56, v60
    v_fmac_f32 v122, v128, v102
    v_fmac_f32 v123, v129, v102
    v_lshlrev_b32 v126, 16, v62
    v_and_b32 v127, s56, v62
    v_fmac_f32 v124, v126, v102
    buffer_load_dwordx4 v5, s[16:19], s43 offen offset:1024 sc1 lds
    v_fmac_f32 v125, v127, v102
    v_lshlrev_b32 v126, 16, v47
    v_and_b32 v127, s56, v47
    v_fmac_f32 v108, v126, v103
    v_fmac_f32 v109, v127, v103
    v_lshlrev_b32 v128, 16, v49
    v_and_b32 v129, s56, v49
    buffer_load_dwordx4 v5, s[16:19], s43 offen offset:2048 sc1 lds
    v_fmac_f32 v110, v128, v103
    v_fmac_f32 v111, v129, v103
    v_lshlrev_b32 v126, 16, v51
    v_and_b32 v127, s56, v51
    v_fmac_f32 v112, v126, v103
    v_fmac_f32 v113, v127, v103
    v_lshlrev_b32 v128, 16, v53
    buffer_load_dwordx4 v5, s[16:19], s43 offen offset:3072 sc1 lds
    v_and_b32 v129, s56, v53
    v_fmac_f32 v114, v128, v103
    v_fmac_f32 v115, v129, v103
    v_lshlrev_b32 v126, 16, v55
    v_and_b32 v127, s56, v55
    v_fmac_f32 v116, v126, v103
    v_fmac_f32 v117, v127, v103
    s_add_u32 m0, s41, 73728
    s_add_u32 s43, s43, 4096
    buffer_load_dwordx4 v5, s[16:19], s43 offen sc1 lds
    v_lshlrev_b32 v128, 16, v57
    v_and_b32 v129, s56, v57
    v_fmac_f32 v118, v128, v103
    v_fmac_f32 v119, v129, v103
    v_lshlrev_b32 v126, 16, v59
    s_waitcnt vmcnt(18)
    s_barrier
    s_add_u32 m0, s40, 104448
    s_movk_i32 s42, 3456
    buffer_load_dwordx4 v1, s[12:15], s42 offen offset:0  lds
    v_and_b32 v127, s56, v59
    v_fmac_f32 v120, v126, v103
    v_fmac_f32 v121, v127, v103
    v_lshlrev_b32 v128, 16, v61
    v_and_b32 v129, s56, v61
    v_fmac_f32 v122, v128, v103
    v_fmac_f32 v123, v129, v103
    buffer_load_dwordx4 v2, s[12:15], s42 offen offset:1024  lds
    v_lshlrev_b32 v126, 16, v63
    v_and_b32 v127, s56, v63
    v_fmac_f32 v124, v126, v103
    v_fmac_f32 v125, v127, v103
    s_waitcnt lgkmcnt(9)
    v_lshlrev_b32 v126, 16, v64
    v_and_b32 v127, s56, v64
    v_fmac_f32 v108, v126, v104
    buffer_load_dwordx4 v3, s[12:15], s42 offen offset:2048  lds
    v_fmac_f32 v109, v127, v104
    v_lshlrev_b32 v128, 16, v66
    v_and_b32 v129, s56, v66
    v_fmac_f32 v110, v128, v104
    v_fmac_f32 v111, v129, v104
    v_lshlrev_b32 v126, 16, v68
    v_and_b32 v127, s56, v68
    buffer_load_dwordx4 v4, s[12:15], s42 offen offset:3072  lds
    v_fmac_f32 v112, v126, v104
    v_fmac_f32 v113, v127, v104
    v_lshlrev_b32 v128, 16, v70
    v_and_b32 v129, s56, v70
    v_fmac_f32 v114, v128, v104
    v_fmac_f32 v115, v129, v104
    v_lshlrev_b32 v126, 16, v72
    s_add_u32 m0, s41, 104448
    s_mov_b32 s43, 497664
    buffer_load_dwordx4 v5, s[16:19], s43 offen offset:0 sc1 lds
    v_and_b32 v127, s56, v72
    v_fmac_f32 v116, v126, v104
    v_fmac_f32 v117, v127, v104
    v_lshlrev_b32 v128, 16, v74
    v_and_b32 v129, s56, v74
    v_fmac_f32 v118, v128, v104
    v_fmac_f32 v119, v129, v104
    buffer_load_dwordx4 v5, s[16:19], s43 offen offset:1024 sc1 lds
    v_lshlrev_b32 v126, 16, v76
    v_and_b32 v127, s56, v76
    v_fmac_f32 v120, v126, v104
    v_fmac_f32 v121, v127, v104
    v_lshlrev_b32 v128, 16, v78
    v_and_b32 v129, s56, v78
    v_fmac_f32 v122, v128, v104
    buffer_load_dwordx4 v5, s[16:19], s43 offen offset:2048 sc1 lds
    v_fmac_f32 v123, v129, v104
    v_lshlrev_b32 v126, 16, v80
    v_and_b32 v127, s56, v80
    v_fmac_f32 v124, v126, v104
    v_fmac_f32 v125, v127, v104
    v_lshlrev_b32 v126, 16, v65
    v_and_b32 v127, s56, v65
    buffer_load_dwordx4 v5, s[16:19], s43 offen offset:3072 sc1 lds
    v_fmac_f32 v108, v126, v105
    v_fmac_f32 v109, v127, v105
    v_lshlrev_b32 v128, 16, v67
    v_and_b32 v129, s56, v67
    v_fmac_f32 v110, v128, v105
    v_fmac_f32 v111, v129, v105
    v_lshlrev_b32 v126, 16, v69
    s_add_u32 m0, s41, 108544
    s_add_u32 s43, s43, 4096
    buffer_load_dwordx4 v5, s[16:19], s43 offen sc1 lds
    v_and_b32 v127, s56, v69
    v_fmac_f32 v112, v126, v105
    v_fmac_f32 v113, v127, v105
    v_lshlrev_b32 v128, 16, v71
    v_and_b32 v129, s56, v71
    s_waitcnt vmcnt(18)
    s_barrier
    s_add_u32 m0, s40, 0
    s_movk_i32 s42, 3584
    buffer_load_dwordx4 v1, s[12:15], s42 offen offset:0  lds
    v_fmac_f32 v114, v128, v105
    v_fmac_f32 v115, v129, v105
    v_lshlrev_b32 v126, 16, v73
    v_and_b32 v127, s56, v73
    v_fmac_f32 v116, v126, v105
    v_fmac_f32 v117, v127, v105
    v_lshlrev_b32 v128, 16, v75
    buffer_load_dwordx4 v2, s[12:15], s42 offen offset:1024  lds
    v_and_b32 v129, s56, v75
    v_fmac_f32 v118, v128, v105
    v_fmac_f32 v119, v129, v105
    v_lshlrev_b32 v126, 16, v77
    v_and_b32 v127, s56, v77
    v_fmac_f32 v120, v126, v105
    v_fmac_f32 v121, v127, v105
    buffer_load_dwordx4 v3, s[12:15], s42 offen offset:2048  lds
    v_lshlrev_b32 v128, 16, v79
    v_and_b32 v129, s56, v79
    v_fmac_f32 v122, v128, v105
    v_fmac_f32 v123, v129, v105
    v_lshlrev_b32 v126, 16, v81
    v_and_b32 v127, s56, v81
    v_fmac_f32 v124, v126, v105
    buffer_load_dwordx4 v4, s[12:15], s42 offen offset:3072  lds
    v_fmac_f32 v125, v127, v105
    s_waitcnt lgkmcnt(0)
    v_lshlrev_b32 v126, 16, v82
    v_and_b32 v127, s56, v82
    v_fmac_f32 v108, v126, v106
    v_fmac_f32 v109, v127, v106
    v_lshlrev_b32 v128, 16, v84
    v_and_b32 v129, s56, v84
    s_add_u32 m0, s41, 0
    s_mov_b32 s43, 516096
    buffer_load_dwordx4 v5, s[16:19], s43 offen offset:0 sc1 lds
    v_fmac_f32 v110, v128, v106
    v_fmac_f32 v111, v129, v106
    v_lshlrev_b32 v126, 16, v86
    v_and_b32 v127, s56, v86
    v_fmac_f32 v112, v126, v106
    v_fmac_f32 v113, v127, v106
    v_lshlrev_b32 v128, 16, v88
    buffer_load_dwordx4 v5, s[16:19], s43 offen offset:1024 sc1 lds
    v_and_b32 v129, s56, v88
    v_fmac_f32 v114, v128, v106
    v_fmac_f32 v115, v129, v106
    v_lshlrev_b32 v126, 16, v90
    v_and_b32 v127, s56, v90
    v_fmac_f32 v116, v126, v106
    v_fmac_f32 v117, v127, v106
    buffer_load_dwordx4 v5, s[16:19], s43 offen offset:2048 sc1 lds
    v_lshlrev_b32 v128, 16, v92
    v_and_b32 v129, s56, v92
    v_fmac_f32 v118, v128, v106
    v_fmac_f32 v119, v129, v106
    v_lshlrev_b32 v126, 16, v94
    v_and_b32 v127, s56, v94
    v_fmac_f32 v120, v126, v106
    buffer_load_dwordx4 v5, s[16:19], s43 offen offset:3072 sc1 lds
    v_fmac_f32 v121, v127, v106
    v_lshlrev_b32 v128, 16, v96
    v_and_b32 v129, s56, v96
    v_fmac_f32 v122, v128, v106
    v_fmac_f32 v123, v129, v106
    v_lshlrev_b32 v126, 16, v98
    v_and_b32 v127, s56, v98
    s_add_u32 m0, s41, 4096
    s_add_u32 s43, s43, 4096
    buffer_load_dwordx4 v5, s[16:19], s43 offen sc1 lds
    v_fmac_f32 v124, v126, v106
    v_fmac_f32 v125, v127, v106
    v_lshlrev_b32 v126, 16, v83
    v_and_b32 v127, s56, v83
    s_waitcnt vmcnt(18)
    s_barrier
    s_add_u32 m0, s40, 34816
    s_movk_i32 s42, 3712
    buffer_load_dwordx4 v1, s[12:15], s42 offen offset:0  lds
    v_fmac_f32 v108, v126, v107
    v_fmac_f32 v109, v127, v107
    v_lshlrev_b32 v128, 16, v85
    v_and_b32 v129, s56, v85
    v_fmac_f32 v110, v128, v107
    v_fmac_f32 v111, v129, v107
    v_lshlrev_b32 v126, 16, v87
    buffer_load_dwordx4 v2, s[12:15], s42 offen offset:1024  lds
    v_and_b32 v127, s56, v87
    v_fmac_f32 v112, v126, v107
    v_fmac_f32 v113, v127, v107
    v_lshlrev_b32 v128, 16, v89
    v_and_b32 v129, s56, v89
    v_fmac_f32 v114, v128, v107
    v_fmac_f32 v115, v129, v107
    buffer_load_dwordx4 v3, s[12:15], s42 offen offset:2048  lds
    v_lshlrev_b32 v126, 16, v91
    v_and_b32 v127, s56, v91
    v_fmac_f32 v116, v126, v107
    v_fmac_f32 v117, v127, v107
    v_lshlrev_b32 v128, 16, v93
    v_and_b32 v129, s56, v93
    v_fmac_f32 v118, v128, v107
    buffer_load_dwordx4 v4, s[12:15], s42 offen offset:3072  lds
    v_fmac_f32 v119, v129, v107
    v_lshlrev_b32 v126, 16, v95
    v_and_b32 v127, s56, v95
    v_fmac_f32 v120, v126, v107
    v_fmac_f32 v121, v127, v107
    v_lshlrev_b32 v128, 16, v97
    v_and_b32 v129, s56, v97
    s_add_u32 m0, s41, 34816
    s_mov_b32 s43, 534528
    buffer_load_dwordx4 v5, s[16:19], s43 offen offset:0 sc1 lds
    v_fmac_f32 v122, v128, v107
    v_fmac_f32 v123, v129, v107
    v_lshlrev_b32 v126, 16, v99
    v_and_b32 v127, s56, v99
    v_fmac_f32 v124, v126, v107
    v_fmac_f32 v125, v127, v107
    s_lshl_b32 s54, s50, 2
    s_add_u32 s54, s54, s38
    s_mul_i32 s54, s54, 92160
    buffer_load_dwordx4 v5, s[16:19], s43 offen offset:1024 sc1 lds
    s_lshl_b32 s58, s51, 11
    s_add_u32 s58, s58, s54
    s_lshr_b32 s59, s51, 2
    s_lshl_b32 s59, s59, 10
    s_add_u32 s54, s54, s59
    s_and_b32 s59, s51, 3
    s_lshl_b32 s59, s59, 8
    s_add_u32 s54, s54, s59
    s_add_u32 s54, s54, 16384
    v_lshlrev_b32 v140, 2, v0
    v_cvt_pk_bf16_f32 v28, v108, v109
    v_cvt_pk_bf16_f32 v29, v110, v111
    v_cvt_pk_bf16_f32 v30, v112, v113
    buffer_load_dwordx4 v5, s[16:19], s43 offen offset:2048 sc1 lds
    v_cvt_pk_bf16_f32 v31, v114, v115
    v_cvt_pk_bf16_f32 v32, v116, v117
    v_cvt_pk_bf16_f32 v33, v118, v119
    v_cvt_pk_bf16_f32 v34, v120, v121
    v_cvt_pk_bf16_f32 v35, v122, v123
    v_cvt_pk_bf16_f32 v36, v124, v125
    buffer_store_dwordx4 v[28:31], v6, s[24:27], s58 offen sc1
    buffer_load_dwordx4 v5, s[16:19], s43 offen offset:3072 sc1 lds
    buffer_store_dwordx4 v[32:35], v6, s[24:27], s58 offen offset:1024 sc1
    buffer_store_dword v36, v140, s[24:27], s54 offen sc1
    s_add_u32 m0, s41, 38912
    s_add_u32 s43, s43, 4096
    buffer_load_dwordx4 v5, s[16:19], s43 offen sc1 lds
    s_waitcnt vmcnt(21)
    s_barrier
    s_add_u32 m0, s40, 69632
    s_movk_i32 s42, 3840
    buffer_load_dwordx4 v1, s[12:15], s42 offen offset:0  lds
    buffer_load_dwordx4 v2, s[12:15], s42 offen offset:1024  lds
    buffer_load_dwordx4 v3, s[12:15], s42 offen offset:2048  lds
    buffer_load_dwordx4 v4, s[12:15], s42 offen offset:3072  lds
    s_add_u32 m0, s41, 69632
    s_mov_b32 s43, 552960
    buffer_load_dwordx4 v5, s[16:19], s43 offen offset:0 sc1 lds
    buffer_load_dwordx4 v5, s[16:19], s43 offen offset:1024 sc1 lds
    buffer_load_dwordx4 v5, s[16:19], s43 offen offset:2048 sc1 lds
    buffer_load_dwordx4 v5, s[16:19], s43 offen offset:3072 sc1 lds
    s_add_u32 m0, s41, 73728
    s_add_u32 s43, s43, 4096
    buffer_load_dwordx4 v5, s[16:19], s43 offen sc1 lds
    s_waitcnt vmcnt(21)
    s_barrier
    s_add_u32 m0, s40, 104448
    s_movk_i32 s42, 3968
    buffer_load_dwordx4 v1, s[12:15], s42 offen offset:0  lds
    buffer_load_dwordx4 v2, s[12:15], s42 offen offset:1024  lds
    buffer_load_dwordx4 v3, s[12:15], s42 offen offset:2048  lds
    buffer_load_dwordx4 v4, s[12:15], s42 offen offset:3072  lds
    s_add_u32 m0, s41, 104448
    s_mov_b32 s43, 571392
    buffer_load_dwordx4 v5, s[16:19], s43 offen offset:0 sc1 lds
    buffer_load_dwordx4 v5, s[16:19], s43 offen offset:1024 sc1 lds
    buffer_load_dwordx4 v5, s[16:19], s43 offen offset:2048 sc1 lds
    buffer_load_dwordx4 v5, s[16:19], s43 offen offset:3072 sc1 lds
    s_add_u32 m0, s41, 108544
    s_add_u32 s43, s43, 4096
    buffer_load_dwordx4 v5, s[16:19], s43 offen sc1 lds
    s_and_b32 s40, s2, 7
    s_lshr_b32 s41, s2, 3
    s_lshr_b32 s32, s40, 1
    s_lshl_b32 s32, s32, 3
    s_lshr_b32 s42, s41, 2
    s_add_u32 s32, s32, s42
    s_and_b32 s33, s40, 1
    s_lshl_b32 s33, s33, 2
    s_and_b32 s42, s41, 3
    s_add_u32 s33, s33, s42
    s_lshl_b32 s40, s32, 2
    s_add_u32 s40, s40, s38
    s_mul_i32 s41, s40, 92160
    v_add_u32 v1, s41, v6
    s_mul_i32 s41, s33, 414720
    s_lshl_b32 s40, s38, 11
    s_add_u32 s41, s41, s40
    v_add_u32 v2, s41, v6
    s_add_u32 s40, s40, 2048
    s_add_u32 s41, s40, 8192
    s_add_u32 s16, s46, 37748736
    s_addc_u32 s17, s47, 0
    s_mov_b32 s18, 3317760
    s_mov_b32 s19, 0x00020000
    v_and_b32 v4, 15, v0
    v_lshlrev_b32 v4, 2, v4
    s_lshl_b32 s54, s49, 7
    s_xor_b32 s58, s54, 1024
    v_mov_b32 v249, s54
    v_mov_b32 v248, s58
    v_cmp_lt_u32 vcc, 31, v0
    s_nop 1
    v_cndmask_b32 v249, v249, v248, vcc
    v_add_u32 v249, 9216, v249
    v_add_u32 v249, v4, v249
    s_lshl_b32 s54, s32, 5
    s_add_u32 s54, s54, 1024
    v_and_b32 v248, 28, v4
    v_add_u32 v248, s54, v248
    v_lshrrev_b32 v4, 1, v0
    v_and_b32 v4, 15, v4
    v_lshlrev_b32 v4, 4, v4
    v_and_b32 v3, 1, v0
    v_lshl_add_u32 v4, v3, 2, v4
    s_lshr_b32 s58, s32, 1
    s_lshl_b32 s58, s58, 8
    s_and_b32 s54, s32, 1
    s_lshl_b32 s54, s54, 3
    s_add_u32 s58, s58, s54
    s_add_u32 s58, s58, 11264
    s_waitcnt vmcnt(18)
    s_barrier
    s_cmp_eq_u32 s34, 4
    s_cbranch_scc0 L_fo_1
    s_lshl_b32 s68, s2, 2
    v_mov_b32 v254, s71
    s_mov_b64 exec, 1
    buffer_store_dword v254, off, s[72:75], s68 offset:1024 sc1
    s_mov_b64 exec, -1
L_fo_1:
    s_mul_i32 s37, s38, 9216
    v_add_u32 v7, s37, v6
    v_mov_b32 v8, 163832
    v_mov_b32 v9, s71
    ds_write_b32 v8, v9
    ds_write_b128 v7, v[160:163] offset:0
    ds_write_b128 v7, v[164:167] offset:1024
    ds_write_b128 v7, v[168:171] offset:2048
    buffer_load_dword v245, v249, s[72:75], 0 offen offset:0 sc1
    s_waitcnt vmcnt(10)
    s_barrier
    ds_write_b128 v7, v[172:175] offset:3072
    ds_write_b128 v7, v[176:179] offset:4096
    ds_write_b128 v7, v[180:183] offset:5120
    s_waitcnt vmcnt(0)
    v_xor_b32 v245, s71, v245
    v_cmp_ne_u32 vcc, 0, v245
    s_nop 4
    s_cbranch_vccz L_pfwok_1
    s_mov_b32 s69, 0
L_pfw_1:
    buffer_load_dword v245, v249, s[72:75], 0 offen offset:0 sc1
    s_add_u32 s69, s69, 1
    s_cmp_gt_u32 s69, 50000
    s_cbranch_scc1 L_pfwok_1
    s_waitcnt vmcnt(0)
    v_xor_b32 v245, s71, v245
    v_cmp_ne_u32 vcc, 0, v245
    s_nop 4
    s_cbranch_vccz L_pfwok_1
    s_sleep 2
    s_branch L_pfw_1
L_pfwok_1:
    s_add_u32 m0, s41, 34816
    s_mov_b32 s43, 0
    buffer_load_dwordx4 v2, s[16:19], s43 offen sc1 lds
    buffer_load_dwordx4 v2, s[16:19], s43 offen offset:1024 sc1 lds
    s_barrier
    ds_write_b128 v7, v[184:187] offset:6144
    ds_write_b128 v7, v[188:191] offset:7168
    ds_write_b128 v7, v[192:195] offset:8192
    s_add_u32 m0, s41, 52224
    s_mov_b32 s43, 9216
    buffer_load_dwordx4 v2, s[16:19], s43 offen sc1 lds
    buffer_load_dwordx4 v2, s[16:19], s43 offen offset:1024 sc1 lds
    s_add_u32 m0, s41, 69632
    s_mov_b32 s43, 18432
    buffer_load_dwordx4 v2, s[16:19], s43 offen sc1 lds
    buffer_load_dwordx4 v2, s[16:19], s43 offen offset:1024 sc1 lds
    buffer_load_dword v244, v248, s[72:75], 0 offen offset:0 sc1
    s_waitcnt lgkmcnt(0)
    s_barrier
    s_add_u32 m0, s41, 87040
    s_mov_b32 s43, 27648
    buffer_load_dwordx4 v2, s[16:19], s43 offen sc1 lds
    buffer_load_dwordx4 v2, s[16:19], s43 offen offset:1024 sc1 lds
    s_add_u32 m0, s41, 104448
    s_mov_b32 s43, 36864
    buffer_load_dwordx4 v2, s[16:19], s43 offen sc1 lds
    buffer_load_dwordx4 v2, s[16:19], s43 offen offset:1024 sc1 lds
    s_waitcnt vmcnt(4)
    v_xor_b32 v244, s71, v244
    v_cmp_ne_u32 vcc, 0, v244
    s_nop 4
    s_cbranch_vccz L_pfook_1
    s_mov_b32 s69, 0
L_pfo_1:
    buffer_load_dword v244, v248, s[72:75], 0 offen offset:0 sc1
    s_add_u32 s69, s69, 1
    s_cmp_gt_u32 s69, 50000
    s_cbranch_scc1 L_pfook_1
    s_waitcnt vmcnt(0)
    v_xor_b32 v244, s71, v244
    v_cmp_ne_u32 vcc, 0, v244
    s_nop 4
    s_cbranch_vccz L_pfook_1
    s_sleep 2
    s_branch L_pfo_1
L_pfook_1:
    s_add_u32 m0, s40, 34816
    s_mov_b32 s42, 0
    buffer_load_dwordx4 v1, s[24:27], s42 offen sc1 lds
    buffer_load_dwordx4 v1, s[24:27], s42 offen offset:1024 sc1 lds
    s_add_u32 m0, s40, 52224
    s_mov_b32 s42, 2048
    buffer_load_dwordx4 v1, s[24:27], s42 offen sc1 lds
    buffer_load_dwordx4 v1, s[24:27], s42 offen offset:1024 sc1 lds
    s_add_u32 m0, s40, 69632
    s_mov_b32 s42, 4096
    buffer_load_dwordx4 v1, s[24:27], s42 offen sc1 lds
    buffer_load_dwordx4 v1, s[24:27], s42 offen offset:1024 sc1 lds
    s_add_u32 m0, s40, 87040
    s_mov_b32 s42, 6144
    buffer_load_dwordx4 v1, s[24:27], s42 offen sc1 lds
    buffer_load_dwordx4 v1, s[24:27], s42 offen offset:1024 sc1 lds
    s_add_u32 m0, s40, 104448
    s_mov_b32 s42, 8192
    buffer_load_dwordx4 v1, s[24:27], s42 offen sc1 lds
    buffer_load_dwordx4 v1, s[24:27], s42 offen offset:1024 sc1 lds
    s_add_u32 m0, s41, 121856
    s_mov_b32 s43, 46080
    buffer_load_dwordx4 v2, s[16:19], s43 offen sc1 lds
    buffer_load_dwordx4 v2, s[16:19], s43 offen offset:1024 sc1 lds
    s_add_u32 m0, s40, 121856
    s_mov_b32 s42, 10240
    buffer_load_dwordx4 v1, s[24:27], s42 offen sc1 lds
    buffer_load_dwordx4 v1, s[24:27], s42 offen offset:1024 sc1 lds
    s_add_u32 m0, s41, 139264
    s_mov_b32 s43, 55296
    buffer_load_dwordx4 v2, s[16:19], s43 offen sc1 lds
    buffer_load_dwordx4 v2, s[16:19], s43 offen offset:1024 sc1 lds
    s_add_u32 m0, s40, 139264
    s_mov_b32 s42, 12288
    buffer_load_dwordx4 v1, s[24:27], s42 offen sc1 lds
    buffer_load_dwordx4 v1, s[24:27], s42 offen offset:1024 sc1 lds
    s_waitcnt vmcnt(16)
    s_barrier
    s_add_u32 m0, s41, 0
    s_mov_b32 s43, 64512
    buffer_load_dwordx4 v2, s[16:19], s43 offen sc1 lds
    buffer_load_dwordx4 v2, s[16:19], s43 offen offset:1024 sc1 lds
    s_add_u32 m0, s40, 0
    s_mov_b32 s42, 14336
    buffer_load_dwordx4 v1, s[24:27], s42 offen sc1 lds
    buffer_load_dwordx4 v1, s[24:27], s42 offen offset:1024 sc1 lds
    s_add_u32 m0, s41, 17408
    s_mov_b32 s43, 73728
    buffer_load_dwordx4 v2, s[16:19], s43 offen sc1 lds
    buffer_load_dwordx4 v2, s[16:19], s43 offen offset:1024 sc1 lds
    s_add_u32 m0, s40, 17408
    s_mov_b32 s42, 16384
    buffer_load_dwordx4 v1, s[24:27], s42 offen sc1 lds
    buffer_load_dwordx4 v1, s[24:27], s42 offen offset:1024 sc1 lds
    s_waitcnt vmcnt(22)
    s_barrier
    s_add_u32 m0, s41, 34816
    s_mov_b32 s43, 82944
    buffer_load_dwordx4 v2, s[16:19], s43 offen sc1 lds
    buffer_load_dwordx4 v2, s[16:19], s43 offen offset:1024 sc1 lds
    s_waitcnt vmcnt(22)
    s_barrier
    s_add_u32 m0, s41, 52224
    s_mov_b32 s43, 92160
    buffer_load_dwordx4 v2, s[16:19], s43 offen sc1 lds
    buffer_load_dwordx4 v2, s[16:19], s43 offen offset:1024 sc1 lds
    s_waitcnt vmcnt(22)
    s_barrier
    s_add_u32 m0, s41, 69632
    s_mov_b32 s43, 101376
    buffer_load_dwordx4 v2, s[16:19], s43 offen sc1 lds
    buffer_load_dwordx4 v2, s[16:19], s43 offen offset:1024 sc1 lds
    s_waitcnt vmcnt(22)
    s_barrier
    s_add_u32 m0, s41, 87040
    s_mov_b32 s43, 110592
    buffer_load_dwordx4 v2, s[16:19], s43 offen sc1 lds
    buffer_load_dwordx4 v2, s[16:19], s43 offen offset:1024 sc1 lds
    s_waitcnt vmcnt(20)
    s_barrier
    s_add_u32 m0, s41, 104448
    s_mov_b32 s43, 119808
    buffer_load_dwordx4 v2, s[16:19], s43 offen sc1 lds
    buffer_load_dwordx4 v2, s[16:19], s43 offen offset:1024 sc1 lds
    s_waitcnt vmcnt(18)
    s_barrier
    s_add_u32 m0, s41, 121856
    s_mov_b32 s43, 129024
    buffer_load_dwordx4 v2, s[16:19], s43 offen sc1 lds
    buffer_load_dwordx4 v2, s[16:19], s43 offen offset:1024 sc1 lds
    s_waitcnt vmcnt(16)
    s_barrier
    s_add_u32 m0, s41, 139264
    s_mov_b32 s43, 138240
    buffer_load_dwordx4 v2, s[16:19], s43 offen sc1 lds
    buffer_load_dwordx4 v2, s[16:19], s43 offen offset:1024 sc1 lds
    s_waitcnt vmcnt(14)
    s_barrier
    s_add_u32 m0, s41, 0
    s_mov_b32 s43, 147456
    buffer_load_dwordx4 v2, s[16:19], s43 offen sc1 lds
    buffer_load_dwordx4 v2, s[16:19], s43 offen offset:1024 sc1 lds
    v_add_u32 v5, s41, v6
    s_mov_b32 s69, 0
L_pfy_1:
    buffer_load_dword v244, v4, s[72:75], s58 offen offset:0 sc1
    s_add_u32 s69, s69, 1
    s_cmp_gt_u32 s69, 50000
    s_cbranch_scc1 L_pfyok_1
    s_waitcnt vmcnt(0)
    v_xor_b32 v244, s71, v244
    v_cmp_ne_u32 vcc, 0, v244
    s_nop 4
    s_cbranch_vccz L_pfyok_1
    s_sleep 1
    s_branch L_pfy_1
L_pfyok_1:
    s_add_u32 m0, s40, 34816
    s_mov_b32 s42, 18432
    buffer_load_dwordx4 v1, s[24:27], s42 offen sc1 lds
    buffer_load_dwordx4 v1, s[24:27], s42 offen offset:1024 sc1 lds
    s_add_u32 m0, s40, 52224
    s_mov_b32 s42, 20480
    buffer_load_dwordx4 v1, s[24:27], s42 offen sc1 lds
    buffer_load_dwordx4 v1, s[24:27], s42 offen offset:1024 sc1 lds
    s_add_u32 m0, s40, 69632
    s_mov_b32 s42, 22528
    buffer_load_dwordx4 v1, s[24:27], s42 offen sc1 lds
    buffer_load_dwordx4 v1, s[24:27], s42 offen offset:1024 sc1 lds
    s_add_u32 m0, s40, 87040
    s_mov_b32 s42, 24576
    buffer_load_dwordx4 v1, s[24:27], s42 offen sc1 lds
    buffer_load_dwordx4 v1, s[24:27], s42 offen offset:1024 sc1 lds
    s_add_u32 m0, s40, 104448
    s_mov_b32 s42, 26624
    buffer_load_dwordx4 v1, s[24:27], s42 offen sc1 lds
    buffer_load_dwordx4 v1, s[24:27], s42 offen offset:1024 sc1 lds
    s_add_u32 m0, s40, 121856
    s_mov_b32 s42, 28672
    buffer_load_dwordx4 v1, s[24:27], s42 offen sc1 lds
    buffer_load_dwordx4 v1, s[24:27], s42 offen offset:1024 sc1 lds
    s_add_u32 m0, s40, 139264
    s_mov_b32 s42, 30720
    buffer_load_dwordx4 v1, s[24:27], s42 offen sc1 lds
    buffer_load_dwordx4 v1, s[24:27], s42 offen offset:1024 sc1 lds
    s_add_u32 m0, s40, 0
    s_mov_b32 s42, 32768
    buffer_load_dwordx4 v1, s[24:27], s42 offen sc1 lds
    buffer_load_dwordx4 v1, s[24:27], s42 offen offset:1024 sc1 lds
    s_waitcnt vmcnt(14)
    s_barrier
    s_add_u32 m0, s40, 17408
    s_mov_b32 s42, 34816
    buffer_load_dwordx4 v1, s[24:27], s42 offen sc1 lds
    buffer_load_dwordx4 v1, s[24:27], s42 offen offset:1024 sc1 lds
    s_add_u32 m0, s41, 17408
    s_mov_b32 s43, 156672
    buffer_load_dwordx4 v2, s[16:19], s43 offen sc1 lds
    buffer_load_dwordx4 v2, s[16:19], s43 offen offset:1024 sc1 lds
    s_waitcnt vmcnt(16)
    s_barrier
    s_add_u32 m0, s40, 34816
    s_mov_b32 s42, 36864
    buffer_load_dwordx4 v1, s[24:27], s42 offen sc1 lds
    buffer_load_dwordx4 v1, s[24:27], s42 offen offset:1024 sc1 lds
    s_add_u32 m0, s41, 34816
    s_mov_b32 s43, 165888
    buffer_load_dwordx4 v2, s[16:19], s43 offen sc1 lds
    buffer_load_dwordx4 v2, s[16:19], s43 offen offset:1024 sc1 lds
    s_waitcnt vmcnt(18)
    s_barrier
    s_add_u32 m0, s40, 52224
    s_mov_b32 s42, 38912
    buffer_load_dwordx4 v1, s[24:27], s42 offen sc1 lds
    buffer_load_dwordx4 v1, s[24:27], s42 offen offset:1024 sc1 lds
    s_add_u32 m0, s41, 52224
    s_mov_b32 s43, 175104
    buffer_load_dwordx4 v2, s[16:19], s43 offen sc1 lds
    buffer_load_dwordx4 v2, s[16:19], s43 offen offset:1024 sc1 lds
    s_waitcnt vmcnt(20)
    s_barrier
    s_add_u32 m0, s40, 69632
    s_mov_b32 s42, 40960
    buffer_load_dwordx4 v1, s[24:27], s42 offen sc1 lds
    buffer_load_dwordx4 v1, s[24:27], s42 offen offset:1024 sc1 lds
    s_add_u32 m0, s41, 69632
    s_mov_b32 s43, 184320
    buffer_load_dwordx4 v2, s[16:19], s43 offen sc1 lds
    buffer_load_dwordx4 v2, s[16:19], s43 offen offset:1024 sc1 lds
    s_waitcnt vmcnt(22)
    s_barrier
    s_add_u32 m0, s40, 87040
    s_mov_b32 s42, 43008
    buffer_load_dwordx4 v1, s[24:27], s42 offen sc1 lds
    buffer_load_dwordx4 v1, s[24:27], s42 offen offset:1024 sc1 lds
    s_add_u32 m0, s41, 87040
    s_mov_b32 s43, 193536
    buffer_load_dwordx4 v2, s[16:19], s43 offen sc1 lds
    buffer_load_dwordx4 v2, s[16:19], s43 offen offset:1024 sc1 lds
    s_waitcnt vmcnt(24)
    s_barrier
    s_add_u32 m0, s40, 104448
    s_mov_b32 s42, 45056
    buffer_load_dwordx4 v1, s[24:27], s42 offen sc1 lds
    buffer_load_dwordx4 v1, s[24:27], s42 offen offset:1024 sc1 lds
    s_add_u32 m0, s41, 104448
    s_mov_b32 s43, 202752
    buffer_load_dwordx4 v2, s[16:19], s43 offen sc1 lds
    buffer_load_dwordx4 v2, s[16:19], s43 offen offset:1024 sc1 lds
    s_waitcnt vmcnt(26)
    s_barrier
    s_add_u32 m0, s40, 121856
    s_mov_b32 s42, 47104
    buffer_load_dwordx4 v1, s[24:27], s42 offen sc1 lds
    buffer_load_dwordx4 v1, s[24:27], s42 offen offset:1024 sc1 lds
    s_add_u32 m0, s41, 121856
    s_mov_b32 s43, 211968
    buffer_load_dwordx4 v2, s[16:19], s43 offen sc1 lds
    buffer_load_dwordx4 v2, s[16:19], s43 offen offset:1024 sc1 lds
    s_waitcnt vmcnt(28)
    s_barrier
    s_mov_b32 s42, 49152
    s_mov_b32 s43, 221184
    s_mov_b32 s57, 139264
    s_mov_b32 s59, 0
    s_cmp_eq_u32 s38, 3
    s_cbranch_scc1 L_q5
    s_branch L_q4
L_H4:
    s_add_u32 m0, s54, 0
    s_mov_b32 s60, 4608
    buffer_load_dwordx4 v1, s[16:19], s60 offen offset:0 lds
    buffer_load_dwordx4 v2, s[16:19], s60 offen offset:1024 lds
    buffer_load_dwordx4 v3, s[16:19], s60 offen offset:2048 lds
    buffer_load_dwordx4 v4, s[16:19], s60 offen offset:3072 lds
    s_add_u32 m0, s54, 18432
    s_mov_b32 s60, 594432
    buffer_load_dwordx4 v1, s[16:19], s60 offen offset:0 lds
    buffer_load_dwordx4 v2, s[16:19], s60 offen offset:1024 lds
    buffer_load_dwordx4 v3, s[16:19], s60 offen offset:2048 lds
    buffer_load_dwordx4 v4, s[16:19], s60 offen offset:3072 lds
    s_mov_b32 s61, 0x3f803f80
    s_mov_b32 s62, 0xffff0000
    v_mov_b32 v14, 0
    v_mov_b32 v15, 0
    v_mov_b32 v16, 0
    v_mov_b32 v17, 0
    s_waitcnt vmcnt(25)
    v_dot2_f32_bf16 v14, v32, s61, v14
    v_dot2_f32_bf16 v15, v32, v32, v15
    v_dot2_f32_bf16 v16, v33, s61, v16
    v_dot2_f32_bf16 v17, v33, v33, v17
    v_dot2_f32_bf16 v14, v34, s61, v14
    v_dot2_f32_bf16 v15, v34, v34, v15
    v_dot2_f32_bf16 v16, v35, s61, v16
    v_dot2_f32_bf16 v17, v35, v35, v17
    s_waitcnt vmcnt(24)
    v_dot2_f32_bf16 v14, v36, s61, v14
    v_dot2_f32_bf16 v15, v36, v36, v15
    v_dot2_f32_bf16 v16, v37, s61, v16
    v_dot2_f32_bf16 v17, v37, v37, v17
    v_dot2_f32_bf16 v14, v38, s61, v14
    v_dot2_f32_bf16 v15, v38, v38, v15
    v_dot2_f32_bf16 v16, v39, s61, v16
    v_dot2_f32_bf16 v17, v39, v39, v17
    s_waitcnt vmcnt(23)
    v_dot2_f32_bf16 v14, v40, s61, v14
    v_dot2_f32_bf16 v15, v40, v40, v15
    v_dot2_f32_bf16 v16, v41, s61, v16
    v_dot2_f32_bf16 v17, v41, v41, v17
    v_dot2_f32_bf16 v14, v42, s61, v14
    v_dot2_f32_bf16 v15, v42, v42, v15
    v_dot2_f32_bf16 v16, v43, s61, v16
    v_dot2_f32_bf16 v17, v43, v43, v17
    s_waitcnt vmcnt(22)
    v_dot2_f32_bf16 v14, v44, s61, v14
    v_dot2_f32_bf16 v15, v44, v44, v15
    v_dot2_f32_bf16 v16, v45, s61, v16
    v_dot2_f32_bf16 v17, v45, v45, v17
    v_dot2_f32_bf16 v14, v46, s61, v14
    v_dot2_f32_bf16 v15, v46, v46, v15
    v_dot2_f32_bf16 v16, v47, s61, v16
    v_dot2_f32_bf16 v17, v47, v47, v17
    s_waitcnt vmcnt(21)
    v_dot2_f32_bf16 v14, v48, s61, v14
    v_dot2_f32_bf16 v15, v48, v48, v15
    v_dot2_f32_bf16 v16, v49, s61, v16
    v_dot2_f32_bf16 v17, v49, v49, v17
    v_dot2_f32_bf16 v14, v50, s61, v14
    v_dot2_f32_bf16 v15, v50, v50, v15
    v_dot2_f32_bf16 v16, v51, s61, v16
    v_dot2_f32_bf16 v17, v51, v51, v17
    s_waitcnt vmcnt(20)
    v_dot2_f32_bf16 v14, v52, s61, v14
    v_dot2_f32_bf16 v15, v52, v52, v15
    v_dot2_f32_bf16 v16, v53, s61, v16
    v_dot2_f32_bf16 v17, v53, v53, v17
    v_dot2_f32_bf16 v14, v54, s61, v14
    v_dot2_f32_bf16 v15, v54, v54, v15
    v_dot2_f32_bf16 v16, v55, s61, v16
    v_dot2_f32_bf16 v17, v55, v55, v17
    s_waitcnt vmcnt(19)
    v_dot2_f32_bf16 v14, v128, s61, v14
    v_dot2_f32_bf16 v15, v128, v128, v15
    v_dot2_f32_bf16 v16, v129, s61, v16
    v_dot2_f32_bf16 v17, v129, v129, v17
    v_dot2_f32_bf16 v14, v130, s61, v14
    v_dot2_f32_bf16 v15, v130, v130, v15
    v_dot2_f32_bf16 v16, v131, s61, v16
    v_dot2_f32_bf16 v17, v131, v131, v17
    s_waitcnt vmcnt(18)
    v_dot2_f32_bf16 v14, v132, s61, v14
    v_dot2_f32_bf16 v15, v132, v132, v15
    v_dot2_f32_bf16 v16, v133, s61, v16
    v_dot2_f32_bf16 v17, v133, v133, v17
    v_dot2_f32_bf16 v14, v134, s61, v14
    v_dot2_f32_bf16 v15, v134, v134, v15
    v_dot2_f32_bf16 v16, v135, s61, v16
    v_dot2_f32_bf16 v17, v135, v135, v17
    s_waitcnt vmcnt(17)
    v_dot2_f32_bf16 v14, v136, s61, v14
    v_dot2_f32_bf16 v15, v136, v136, v15
    v_dot2_f32_bf16 v16, v137, s61, v16
    v_dot2_f32_bf16 v17, v137, v137, v17
    v_dot2_f32_bf16 v14, v138, s61, v14
    v_dot2_f32_bf16 v15, v138, v138, v15
    v_dot2_f32_bf16 v16, v139, s61, v16
    v_dot2_f32_bf16 v17, v139, v139, v17
    s_waitcnt vmcnt(16)
    v_dot2_f32_bf16 v14, v140, s61, v14
    v_dot2_f32_bf16 v15, v140, v140, v15
    v_dot2_f32_bf16 v16, v141, s61, v16
    v_dot2_f32_bf16 v17, v141, v141, v17
    v_dot2_f32_bf16 v14, v142, s61, v14
    v_dot2_f32_bf16 v15, v142, v142, v15
    v_dot2_f32_bf16 v16, v143, s61, v16
    v_dot2_f32_bf16 v17, v143, v143, v17
    s_waitcnt vmcnt(15)
    v_dot2_f32_bf16 v14, v144, s61, v14
    v_dot2_f32_bf16 v15, v144, v144, v15
    v_dot2_f32_bf16 v16, v145, s61, v16
    v_dot2_f32_bf16 v17, v145, v145, v17
    v_dot2_f32_bf16 v14, v146, s61, v14
    v_dot2_f32_bf16 v15, v146, v146, v15
    v_dot2_f32_bf16 v16, v147, s61, v16
    v_dot2_f32_bf16 v17, v147, v147, v17
    s_waitcnt vmcnt(14)
    v_dot2_f32_bf16 v14, v148, s61, v14
    v_dot2_f32_bf16 v15, v148, v148, v15
    v_dot2_f32_bf16 v16, v149, s61, v16
    v_dot2_f32_bf16 v17, v149, v149, v17
    v_dot2_f32_bf16 v14, v150, s61, v14
    v_dot2_f32_bf16 v15, v150, v150, v15
    v_dot2_f32_bf16 v16, v151, s61, v16
    v_dot2_f32_bf16 v17, v151, v151, v17
    s_waitcnt vmcnt(13)
    v_dot2_f32_bf16 v14, v152, s61, v14
    v_dot2_f32_bf16 v15, v152, v152, v15
    v_dot2_f32_bf16 v16, v153, s61, v16
    v_dot2_f32_bf16 v17, v153, v153, v17
    v_dot2_f32_bf16 v14, v154, s61, v14
    v_dot2_f32_bf16 v15, v154, v154, v15
    v_dot2_f32_bf16 v16, v155, s61, v16
    v_dot2_f32_bf16 v17, v155, v155, v17
    s_waitcnt vmcnt(12)
    v_dot2_f32_bf16 v14, v156, s61, v14
    v_dot2_f32_bf16 v15, v156, v156, v15
    v_dot2_f32_bf16 v16, v157, s61, v16
    v_dot2_f32_bf16 v17, v157, v157, v17
    v_dot2_f32_bf16 v14, v158, s61, v14
    v_dot2_f32_bf16 v15, v158, v158, v15
    v_dot2_f32_bf16 v16, v159, s61, v16
    v_dot2_f32_bf16 v17, v159, v159, v17
    s_waitcnt vmcnt(11)
    v_dot2_f32_bf16 v14, v160, s61, v14
    v_dot2_f32_bf16 v15, v160, v160, v15
    v_dot2_f32_bf16 v16, v161, s61, v16
    v_dot2_f32_bf16 v17, v161, v161, v17
    v_dot2_f32_bf16 v14, v162, s61, v14
    v_dot2_f32_bf16 v15, v162, v162, v15
    v_dot2_f32_bf16 v16, v163, s61, v16
    v_dot2_f32_bf16 v17, v163, v163, v17
    s_waitcnt vmcnt(10)
    v_dot2_f32_bf16 v14, v164, s61, v14
    v_dot2_f32_bf16 v15, v164, v164, v15
    v_dot2_f32_bf16 v16, v165, s61, v16
    v_dot2_f32_bf16 v17, v165, v165, v17
    v_dot2_f32_bf16 v14, v166, s61, v14
    v_dot2_f32_bf16 v15, v166, v166, v15
    v_dot2_f32_bf16 v16, v167, s61, v16
    v_dot2_f32_bf16 v17, v167, v167, v17
    s_waitcnt vmcnt(9)
    v_dot2_f32_bf16 v14, v168, s61, v14
    v_dot2_f32_bf16 v15, v168, v168, v15
    v_dot2_f32_bf16 v16, v169, s61, v16
    v_dot2_f32_bf16 v17, v169, v169, v17
    v_dot2_f32_bf16 v14, v170, s61, v14
    v_dot2_f32_bf16 v15, v170, v170, v15
    v_dot2_f32_bf16 v16, v171, s61, v16
    v_dot2_f32_bf16 v17, v171, v171, v17
    s_waitcnt vmcnt(8)
    v_dot2_f32_bf16 v14, v172, s61, v14
    v_dot2_f32_bf16 v15, v172, v172, v15
    v_dot2_f32_bf16 v16, v173, s61, v16
    v_dot2_f32_bf16 v17, v173, v173, v17
    v_dot2_f32_bf16 v14, v174, s61, v14
    v_dot2_f32_bf16 v15, v174, v174, v15
    v_dot2_f32_bf16 v16, v175, s61, v16
    v_dot2_f32_bf16 v17, v175, v175, v17
    s_nop 1
    v_add_f32 v14, v14, v16
    v_add_f32 v15, v15, v17
    s_nop 0
    v_add_f32_dpp v14, v14, v14 quad_perm:[1,0,3,2] row_mask:0xf bank_mask:0xf
    v_add_f32_dpp v15, v15, v15 quad_perm:[1,0,3,2] row_mask:0xf bank_mask:0xf
    s_nop 0
    v_add_f32_dpp v14, v14, v14 quad_perm:[2,3,0,1] row_mask:0xf bank_mask:0xf
    v_add_f32_dpp v15, v15, v15 quad_perm:[2,3,0,1] row_mask:0xf bank_mask:0xf
    v_mul_f32 v14, 0x3ae38e39, v14
    v_mul_f32 v15, 0x3ae38e39, v15
    v_fma_f32 v15, -v14, v14, v15
    v_max_f32 v15, 0, v15
    v_add_f32 v15, 0x3727c5ac, v15
    v_rsq_f32 v16, v15
    s_nop 0
    v_mul_f32 v14, -v14, v16
    v_lshlrev_b32 v24, 16, v32
    v_and_b32 v25, s62, v32
    v_lshlrev_b32 v26, 16, v33
    v_and_b32 v27, s62, v33
    v_pk_fma_f32 v[24:25], v[24:25], v[16:17], v[14:15] op_sel_hi:[1,0,0]
    v_pk_fma_f32 v[26:27], v[26:27], v[16:17], v[14:15] op_sel_hi:[1,0,0]
    s_add_u32 m0, s54, 36864
    s_mov_b32 s60, 1184256
    buffer_load_dwordx4 v1, s[16:19], s60 offen offset:0 lds
    v_cvt_pk_bf16_f32 v32, v24, v25
    v_cvt_pk_bf16_f32 v33, v26, v27
    v_lshlrev_b32 v28, 16, v34
    v_and_b32 v29, s62, v34
    v_lshlrev_b32 v30, 16, v35
    v_and_b32 v31, s62, v35
    buffer_load_dwordx4 v2, s[16:19], s60 offen offset:1024 lds
    v_pk_fma_f32 v[28:29], v[28:29], v[16:17], v[14:15] op_sel_hi:[1,0,0]
    v_pk_fma_f32 v[30:31], v[30:31], v[16:17], v[14:15] op_sel_hi:[1,0,0]
    v_cvt_pk_bf16_f32 v34, v28, v29
    v_cvt_pk_bf16_f32 v35, v30, v31
    ds_write2_b64 v11, v[32:33], v[34:35] offset0:0 offset1:4
    v_lshlrev_b32 v24, 16, v36
    v_and_b32 v25, s62, v36
    v_lshlrev_b32 v26, 16, v37
    v_and_b32 v27, s62, v37
    v_pk_fma_f32 v[24:25], v[24:25], v[16:17], v[14:15] op_sel_hi:[1,0,0]
    v_pk_fma_f32 v[26:27], v[26:27], v[16:17], v[14:15] op_sel_hi:[1,0,0]
    buffer_load_dwordx4 v3, s[16:19], s60 offen offset:2048 lds
    v_cvt_pk_bf16_f32 v36, v24, v25
    v_cvt_pk_bf16_f32 v37, v26, v27
    v_lshlrev_b32 v28, 16, v38
    v_and_b32 v29, s62, v38
    v_lshlrev_b32 v30, 16, v39
    v_and_b32 v31, s62, v39
    buffer_load_dwordx4 v4, s[16:19], s60 offen offset:3072 lds
    v_pk_fma_f32 v[28:29], v[28:29], v[16:17], v[14:15] op_sel_hi:[1,0,0]
    v_pk_fma_f32 v[30:31], v[30:31], v[16:17], v[14:15] op_sel_hi:[1,0,0]
    v_cvt_pk_bf16_f32 v38, v28, v29
    v_cvt_pk_bf16_f32 v39, v30, v31
    ds_write2_b64 v11, v[36:37], v[38:39] offset0:8 offset1:12
    v_lshlrev_b32 v24, 16, v40
    v_and_b32 v25, s62, v40
    v_lshlrev_b32 v26, 16, v41
    v_and_b32 v27, s62, v41
    v_pk_fma_f32 v[24:25], v[24:25], v[16:17], v[14:15] op_sel_hi:[1,0,0]
    v_pk_fma_f32 v[26:27], v[26:27], v[16:17], v[14:15] op_sel_hi:[1,0,0]
    s_add_u32 m0, s54, 55296
    s_mov_b32 s60, 1774080
    buffer_load_dwordx4 v1, s[16:19], s60 offen offset:0 lds
    v_cvt_pk_bf16_f32 v40, v24, v25
    v_cvt_pk_bf16_f32 v41, v26, v27
    v_lshlrev_b32 v28, 16, v42
    v_and_b32 v29, s62, v42
    v_lshlrev_b32 v30, 16, v43
    v_and_b32 v31, s62, v43
    buffer_load_dwordx4 v2, s[16:19], s60 offen offset:1024 lds
    v_pk_fma_f32 v[28:29], v[28:29], v[16:17], v[14:15] op_sel_hi:[1,0,0]
    v_pk_fma_f32 v[30:31], v[30:31], v[16:17], v[14:15] op_sel_hi:[1,0,0]
    v_cvt_pk_bf16_f32 v42, v28, v29
    v_cvt_pk_bf16_f32 v43, v30, v31
    ds_write2_b64 v11, v[40:41], v[42:43] offset0:16 offset1:20
    v_lshlrev_b32 v24, 16, v44
    v_and_b32 v25, s62, v44
    v_lshlrev_b32 v26, 16, v45
    v_and_b32 v27, s62, v45
    v_pk_fma_f32 v[24:25], v[24:25], v[16:17], v[14:15] op_sel_hi:[1,0,0]
    v_pk_fma_f32 v[26:27], v[26:27], v[16:17], v[14:15] op_sel_hi:[1,0,0]
    buffer_load_dwordx4 v3, s[16:19], s60 offen offset:2048 lds
    v_cvt_pk_bf16_f32 v44, v24, v25
    v_cvt_pk_bf16_f32 v45, v26, v27
    v_lshlrev_b32 v28, 16, v46
    v_and_b32 v29, s62, v46
    v_lshlrev_b32 v30, 16, v47
    v_and_b32 v31, s62, v47
    buffer_load_dwordx4 v4, s[16:19], s60 offen offset:3072 lds
    v_pk_fma_f32 v[28:29], v[28:29], v[16:17], v[14:15] op_sel_hi:[1,0,0]
    v_pk_fma_f32 v[30:31], v[30:31], v[16:17], v[14:15] op_sel_hi:[1,0,0]
    v_cvt_pk_bf16_f32 v46, v28, v29
    v_cvt_pk_bf16_f32 v47, v30, v31
    ds_write2_b64 v11, v[44:45], v[46:47] offset0:24 offset1:28
    v_lshlrev_b32 v24, 16, v48
    v_and_b32 v25, s62, v48
    v_lshlrev_b32 v26, 16, v49
    v_and_b32 v27, s62, v49
    v_pk_fma_f32 v[24:25], v[24:25], v[16:17], v[14:15] op_sel_hi:[1,0,0]
    v_pk_fma_f32 v[26:27], v[26:27], v[16:17], v[14:15] op_sel_hi:[1,0,0]
    s_add_u32 m0, s54, 73728
    s_mov_b32 s60, 2363904
    buffer_load_dwordx4 v1, s[16:19], s60 offen offset:0 lds
    v_cvt_pk_bf16_f32 v48, v24, v25
    v_cvt_pk_bf16_f32 v49, v26, v27
    v_lshlrev_b32 v28, 16, v50
    v_and_b32 v29, s62, v50
    v_lshlrev_b32 v30, 16, v51
    v_and_b32 v31, s62, v51
    buffer_load_dwordx4 v2, s[16:19], s60 offen offset:1024 lds
    v_pk_fma_f32 v[28:29], v[28:29], v[16:17], v[14:15] op_sel_hi:[1,0,0]
    v_pk_fma_f32 v[30:31], v[30:31], v[16:17], v[14:15] op_sel_hi:[1,0,0]
    v_cvt_pk_bf16_f32 v50, v28, v29
    v_cvt_pk_bf16_f32 v51, v30, v31
    ds_write2_b64 v11, v[48:49], v[50:51] offset0:32 offset1:36
    v_lshlrev_b32 v24, 16, v52
    v_and_b32 v25, s62, v52
    v_lshlrev_b32 v26, 16, v53
    v_and_b32 v27, s62, v53
    v_pk_fma_f32 v[24:25], v[24:25], v[16:17], v[14:15] op_sel_hi:[1,0,0]
    v_pk_fma_f32 v[26:27], v[26:27], v[16:17], v[14:15] op_sel_hi:[1,0,0]
    buffer_load_dwordx4 v3, s[16:19], s60 offen offset:2048 lds
    v_cvt_pk_bf16_f32 v52, v24, v25
    v_cvt_pk_bf16_f32 v53, v26, v27
    v_lshlrev_b32 v28, 16, v54
    v_and_b32 v29, s62, v54
    v_lshlrev_b32 v30, 16, v55
    v_and_b32 v31, s62, v55
    buffer_load_dwordx4 v4, s[16:19], s60 offen offset:3072 lds
    v_pk_fma_f32 v[28:29], v[28:29], v[16:17], v[14:15] op_sel_hi:[1,0,0]
    v_pk_fma_f32 v[30:31], v[30:31], v[16:17], v[14:15] op_sel_hi:[1,0,0]
    v_cvt_pk_bf16_f32 v54, v28, v29
    v_cvt_pk_bf16_f32 v55, v30, v31
    ds_write2_b64 v11, v[52:53], v[54:55] offset0:40 offset1:44
    s_waitcnt lgkmcnt(0)
    s_barrier
    s_add_u32 m0, s54, 92160
    s_mov_b32 s60, 2953728
    buffer_load_dwordx4 v1, s[16:19], s60 offen offset:0 lds
    buffer_load_dwordx4 v2, s[16:19], s60 offen offset:1024 lds
    buffer_load_dwordx4 v3, s[16:19], s60 offen offset:2048 lds
    buffer_load_dwordx4 v4, s[16:19], s60 offen offset:3072 lds
    v_mov_b32 v36, 0xc0135761
    s_lshl_b32 s52, s2, 2
    s_add_u32 s52, s52, s51
    s_mul_i32 s4, s52, 1944
    s_add_u32 s53, s52, 0
    s_mul_i32 s63, s53, 13108
    s_lshr_b32 s63, s63, 16
    s_mul_i32 s64, s63, 5
    s_sub_u32 s53, s53, s64
    s_mul_i32 s53, s53, 896
    s_mul_i32 s63, s63, 9216
    s_add_u32 s5, s53, s63
    s_add_u32 s53, s52, 1024
    s_mul_i32 s63, s53, 13108
    s_lshr_b32 s63, s63, 16
    s_mul_i32 s64, s63, 5
    s_sub_u32 s53, s53, s64
    s_mul_i32 s53, s53, 896
    s_mul_i32 s63, s63, 9216
    s_add_u32 s6, s53, s63
    s_add_u32 s53, s52, 2048
    s_mul_i32 s63, s53, 13108
    s_lshr_b32 s63, s63, 16
    s_mul_i32 s64, s63, 5
    s_sub_u32 s53, s53, s64
    s_mul_i32 s53, s53, 896
    s_mul_i32 s63, s63, 9216
    s_add_u32 s7, s53, s63
    s_lshl_b32 s8, s52, 13
    s_add_u32 s9, s8, 4096
    s_mul_i32 s65, s52, 648
    s_mul_i32 s66, s52, 2592
    s_mov_b32 s12, s10
    s_mov_b32 s13, s11
    s_mov_b32 s14, 8388608
    s_mov_b32 s15, 0x00020000
    s_mov_b32 s28, s76
    s_mov_b32 s29, s77
    s_mov_b32 s30, 2654208
    s_mov_b32 s31, 0x00020000
    s_waitcnt vmcnt(16)
    s_barrier
    buffer_load_dwordx4 v[48:51], v6, s[20:23], s4 offen offset:0
    v_lshlrev_b32 v24, 16, v128
    v_and_b32 v25, s62, v128
    v_lshlrev_b32 v26, 16, v129
    v_and_b32 v27, s62, v129
    v_fma_f32 v24, v24, v16, v14
    v_fma_f32 v25, v25, v16, v14
    v_fma_f32 v26, v26, v16, v14
    v_fma_f32 v27, v27, v16, v14
    v_cvt_pk_bf16_f32 v128, v24, v25
    v_cvt_pk_bf16_f32 v129, v26, v27
    v_lshlrev_b32 v28, 16, v130
    v_and_b32 v29, s62, v130
    buffer_load_dwordx4 v[48:51], v6, s[20:23], s4 offen offset:1024
    v_lshlrev_b32 v30, 16, v131
    v_and_b32 v31, s62, v131
    v_fma_f32 v28, v28, v16, v14
    v_fma_f32 v29, v29, v16, v14
    v_fma_f32 v30, v30, v16, v14
    v_fma_f32 v31, v31, v16, v14
    v_cvt_pk_bf16_f32 v130, v28, v29
    v_cvt_pk_bf16_f32 v131, v30, v31
    ds_write2_b64 v11, v[128:129], v[130:131] offset0:0 offset1:4
    v_lshlrev_b32 v24, 16, v132
    v_and_b32 v25, s62, v132
    v_lshlrev_b32 v26, 16, v133
    v_and_b32 v27, s62, v133
    v_fma_f32 v24, v24, v16, v14
    v_fma_f32 v25, v25, v16, v14
    v_fma_f32 v26, v26, v16, v14
    v_fma_f32 v27, v27, v16, v14
    v_cvt_pk_bf16_f32 v132, v24, v25
    v_cvt_pk_bf16_f32 v133, v26, v27
    v_lshlrev_b32 v28, 16, v134
    v_and_b32 v29, s62, v134
    v_lshlrev_b32 v30, 16, v135
    s_waitcnt vmcnt(14)
    s_barrier
    s_add_u32 m0, s54, 0
    s_mov_b32 s60, 3543552
    buffer_load_dwordx4 v1, s[16:19], s60 offen offset:0 lds
    v_and_b32 v31, s62, v135
    v_fma_f32 v28, v28, v16, v14
    v_fma_f32 v29, v29, v16, v14
    v_fma_f32 v30, v30, v16, v14
    v_fma_f32 v31, v31, v16, v14
    buffer_load_dwordx4 v2, s[16:19], s60 offen offset:1024 lds
    v_cvt_pk_bf16_f32 v134, v28, v29
    v_cvt_pk_bf16_f32 v135, v30, v31
    ds_write2_b64 v11, v[132:133], v[134:135] offset0:8 offset1:12
    buffer_load_dwordx4 v3, s[16:19], s60 offen offset:2048 lds
    v_lshlrev_b32 v24, 16, v136
    v_and_b32 v25, s62, v136
    v_lshlrev_b32 v26, 16, v137
    v_and_b32 v27, s62, v137
    v_fma_f32 v24, v24, v16, v14
    buffer_load_dwordx4 v4, s[16:19], s60 offen offset:3072 lds
    v_fma_f32 v25, v25, v16, v14
    v_fma_f32 v26, v26, v16, v14
    v_fma_f32 v27, v27, v16, v14
    v_cvt_pk_bf16_f32 v136, v24, v25
    v_cvt_pk_bf16_f32 v137, v26, v27
    buffer_load_dwordx4 v[48:51], v6, s[16:19], s5 offen
    v_lshlrev_b32 v28, 16, v138
    v_and_b32 v29, s62, v138
    v_lshlrev_b32 v30, 16, v139
    v_and_b32 v31, s62, v139
    v_fma_f32 v28, v28, v16, v14
    buffer_load_dwordx4 v[48:51], v6, s[16:19], s6 offen
    v_fma_f32 v29, v29, v16, v14
    v_fma_f32 v30, v30, v16, v14
    v_fma_f32 v31, v31, v16, v14
    v_cvt_pk_bf16_f32 v138, v28, v29
    v_cvt_pk_bf16_f32 v139, v30, v31
    ds_write2_b64 v11, v[136:137], v[138:139] offset0:16 offset1:20
    v_lshlrev_b32 v24, 16, v140
    v_and_b32 v25, s62, v140
    s_waitcnt lgkmcnt(0)
    s_waitcnt vmcnt(16)
    s_barrier
    s_add_u32 m0, s54, 18432
    s_mov_b32 s60, 4133376
    buffer_load_dwordx4 v1, s[16:19], s60 offen offset:0 lds
    v_lshlrev_b32 v26, 16, v141
    v_and_b32 v27, s62, v141
    v_fma_f32 v24, v24, v16, v14
    v_fma_f32 v25, v25, v16, v14
    v_fma_f32 v26, v26, v16, v14
    buffer_load_dwordx4 v2, s[16:19], s60 offen offset:1024 lds
    v_fma_f32 v27, v27, v16, v14
    v_cvt_pk_bf16_f32 v140, v24, v25
    v_cvt_pk_bf16_f32 v141, v26, v27
    v_lshlrev_b32 v28, 16, v142
    v_and_b32 v29, s62, v142
    buffer_load_dwordx4 v3, s[16:19], s60 offen offset:2048 lds
    v_lshlrev_b32 v30, 16, v143
    v_and_b32 v31, s62, v143
    v_fma_f32 v28, v28, v16, v14
    v_fma_f32 v29, v29, v16, v14
    v_fma_f32 v30, v30, v16, v14
    buffer_load_dwordx4 v4, s[16:19], s60 offen offset:3072 lds
    v_fma_f32 v31, v31, v16, v14
    v_cvt_pk_bf16_f32 v142, v28, v29
    v_cvt_pk_bf16_f32 v143, v30, v31
    ds_write2_b64 v11, v[140:141], v[142:143] offset0:24 offset1:28
    buffer_load_dwordx4 v[48:51], v6, s[16:19], s7 offen
    v_lshlrev_b32 v24, 16, v144
    v_and_b32 v25, s62, v144
    v_lshlrev_b32 v26, 16, v145
    v_and_b32 v27, s62, v145
    v_fma_f32 v24, v24, v16, v14
    buffer_load_dwordx4 v[48:51], v6, s[28:31], s66 offen offset:0
    v_fma_f32 v25, v25, v16, v14
    v_fma_f32 v26, v26, v16, v14
    v_fma_f32 v27, v27, v16, v14
    v_cvt_pk_bf16_f32 v144, v24, v25
    v_cvt_pk_bf16_f32 v145, v26, v27
    v_lshlrev_b32 v28, 16, v146
    v_and_b32 v29, s62, v146
    v_lshlrev_b32 v30, 16, v147
    v_and_b32 v31, s62, v147
    v_fma_f32 v28, v28, v16, v14
    s_waitcnt lgkmcnt(0)
    s_waitcnt vmcnt(18)
    s_barrier
    s_add_u32 m0, s54, 36864
    s_mov_b32 s60, 4723200
    buffer_load_dwordx4 v1, s[16:19], s60 offen offset:0 lds
    v_fma_f32 v29, v29, v16, v14
    v_fma_f32 v30, v30, v16, v14
    v_fma_f32 v31, v31, v16, v14
    v_cvt_pk_bf16_f32 v146, v28, v29
    v_cvt_pk_bf16_f32 v147, v30, v31
    ds_write2_b64 v11, v[144:145], v[146:147] offset0:32 offset1:36
    buffer_load_dwordx4 v2, s[16:19], s60 offen offset:1024 lds
    v_lshlrev_b32 v24, 16, v148
    v_and_b32 v25, s62, v148
    v_lshlrev_b32 v26, 16, v149
    v_and_b32 v27, s62, v149
    v_fma_f32 v24, v24, v16, v14
    v_fma_f32 v25, v25, v16, v14
    buffer_load_dwordx4 v3, s[16:19], s60 offen offset:2048 lds
    v_fma_f32 v26, v26, v16, v14
    v_fma_f32 v27, v27, v16, v14
    v_cvt_pk_bf16_f32 v148, v24, v25
    v_cvt_pk_bf16_f32 v149, v26, v27
    v_lshlrev_b32 v28, 16, v150
    v_and_b32 v29, s62, v150
    buffer_load_dwordx4 v4, s[16:19], s60 offen offset:3072 lds
    v_lshlrev_b32 v30, 16, v151
    v_and_b32 v31, s62, v151
    v_fma_f32 v28, v28, v16, v14
    v_fma_f32 v29, v29, v16, v14
    v_fma_f32 v30, v30, v16, v14
    v_fma_f32 v31, v31, v16, v14
    buffer_load_dwordx4 v[48:51], v6, s[28:31], s66 offen offset:784
    v_cvt_pk_bf16_f32 v150, v28, v29
    v_cvt_pk_bf16_f32 v151, v30, v31
    ds_write2_b64 v11, v[148:149], v[150:151] offset0:40 offset1:44
    v_lshlrev_b32 v24, 16, v152
    buffer_load_dwordx4 v[48:51], v6, s[28:31], s66 offen offset:1568
    v_and_b32 v25, s62, v152
    v_lshlrev_b32 v26, 16, v153
    v_and_b32 v27, s62, v153
    v_fma_f32 v24, v24, v16, v14
    v_fma_f32 v25, v25, v16, v14
    v_fma_f32 v26, v26, v16, v14
    v_fma_f32 v27, v27, v16, v14
    v_cvt_pk_bf16_f32 v152, v24, v25
    v_cvt_pk_bf16_f32 v153, v26, v27
    v_lshlrev_b32 v28, 16, v154
    v_and_b32 v29, s62, v154
    v_lshlrev_b32 v30, 16, v155
    s_waitcnt lgkmcnt(0)
    s_waitcnt vmcnt(20)
    s_barrier
    s_add_u32 m0, s55, 55296
    s_mov_b32 s60, 0
    buffer_load_dwordx4 v7, s[20:23], s60 offen offset:0 lds
    v_and_b32 v31, s62, v155
    v_fma_f32 v28, v28, v16, v14
    v_fma_f32 v29, v29, v16, v14
    v_fma_f32 v30, v30, v16, v14
    v_fma_f32 v31, v31, v16, v14
    v_cvt_pk_bf16_f32 v154, v28, v29
    v_cvt_pk_bf16_f32 v155, v30, v31
    buffer_load_dwordx4 v8, s[20:23], s60 offen offset:1024 lds
    ds_write2_b64 v11, v[152:153], v[154:155] offset0:0 offset1:4
    v_lshlrev_b32 v24, 16, v156
    v_and_b32 v25, s62, v156
    v_lshlrev_b32 v26, 16, v157
    v_and_b32 v27, s62, v157
    buffer_load_dwordx4 v9, s[20:23], s60 offen offset:2048 lds
    v_fma_f32 v24, v24, v16, v14
    v_fma_f32 v25, v25, v16, v14
    v_fma_f32 v26, v26, v16, v14
    v_fma_f32 v27, v27, v16, v14
    v_cvt_pk_bf16_f32 v156, v24, v25
    v_cvt_pk_bf16_f32 v157, v26, v27
    v_lshlrev_b32 v28, 16, v158
    s_mov_b32 s28, s72
    s_mov_b32 s29, s73
    s_mov_b32 s30, 663552
    s_mov_b32 s31, 0x00020000
    buffer_load_dwordx4 v[48:51], v6, s[28:31], s65 offen
    v_and_b32 v29, s62, v158
    v_lshlrev_b32 v30, 16, v159
    v_and_b32 v31, s62, v159
    v_fma_f32 v28, v28, v16, v14
    v_fma_f32 v29, v29, v16, v14
    v_fma_f32 v30, v30, v16, v14
    v_fma_f32 v31, v31, v16, v14
    buffer_load_dwordx4 v[48:51], v6, s[12:15], s8 offen offset:0
    v_cvt_pk_bf16_f32 v158, v28, v29
    v_cvt_pk_bf16_f32 v159, v30, v31
    ds_write2_b64 v11, v[156:157], v[158:159] offset0:8 offset1:12
    v_lshlrev_b32 v24, 16, v160
    v_and_b32 v25, s62, v160
    v_lshlrev_b32 v26, 16, v161
    v_and_b32 v27, s62, v161
    v_fma_f32 v24, v24, v16, v14
    v_fma_f32 v25, v25, v16, v14
    v_fma_f32 v26, v26, v16, v14
    v_fma_f32 v27, v27, v16, v14
    v_cvt_pk_bf16_f32 v160, v24, v25
    s_waitcnt lgkmcnt(0)
    s_waitcnt vmcnt(19)
    s_barrier
    s_add_u32 m0, s55, 73728
    s_mov_b32 s60, 221184
    buffer_load_dwordx4 v7, s[20:23], s60 offen offset:0 lds
    v_cvt_pk_bf16_f32 v161, v26, v27
    v_lshlrev_b32 v28, 16, v162
    v_and_b32 v29, s62, v162
    v_lshlrev_b32 v30, 16, v163
    v_and_b32 v31, s62, v163
    v_fma_f32 v28, v28, v16, v14
    v_fma_f32 v29, v29, v16, v14
    buffer_load_dwordx4 v8, s[20:23], s60 offen offset:1024 lds
    v_fma_f32 v30, v30, v16, v14
    v_fma_f32 v31, v31, v16, v14
    v_cvt_pk_bf16_f32 v162, v28, v29
    v_cvt_pk_bf16_f32 v163, v30, v31
    ds_write2_b64 v11, v[160:161], v[162:163] offset0:16 offset1:20
    buffer_load_dwordx4 v9, s[20:23], s60 offen offset:2048 lds
    v_lshlrev_b32 v24, 16, v164
    v_and_b32 v25, s62, v164
    v_lshlrev_b32 v26, 16, v165
    v_and_b32 v27, s62, v165
    v_fma_f32 v24, v24, v16, v14
    v_fma_f32 v25, v25, v16, v14
    v_fma_f32 v26, v26, v16, v14
    buffer_load_dwordx4 v[48:51], v6, s[12:15], s8 offen offset:1024
    v_fma_f32 v27, v27, v16, v14
    v_cvt_pk_bf16_f32 v164, v24, v25
    v_cvt_pk_bf16_f32 v165, v26, v27
    v_lshlrev_b32 v28, 16, v166
    v_and_b32 v29, s62, v166
    v_lshlrev_b32 v30, 16, v167
    v_and_b32 v31, s62, v167
    buffer_load_dwordx4 v[48:51], v6, s[12:15], s8 offen offset:2048
    v_fma_f32 v28, v28, v16, v14
    v_fma_f32 v29, v29, v16, v14
    v_fma_f32 v30, v30, v16, v14
    v_fma_f32 v31, v31, v16, v14
    v_cvt_pk_bf16_f32 v166, v28, v29
    v_cvt_pk_bf16_f32 v167, v30, v31
    ds_write2_b64 v11, v[164:165], v[166:167] offset0:24 offset1:28
    v_lshlrev_b32 v24, 16, v168
    v_and_b32 v25, s62, v168
    v_lshlrev_b32 v26, 16, v169
    v_and_b32 v27, s62, v169
    v_fma_f32 v24, v24, v16, v14
    v_fma_f32 v25, v25, v16, v14
    v_fma_f32 v26, v26, v16, v14
    s_waitcnt lgkmcnt(0)
    s_waitcnt vmcnt(18)
    s_barrier
    s_add_u32 m0, s55, 92160
    s_mov_b32 s60, 442368
    buffer_load_dwordx4 v7, s[20:23], s60 offen offset:0 lds
    v_fma_f32 v27, v27, v16, v14
    v_cvt_pk_bf16_f32 v168, v24, v25
    v_cvt_pk_bf16_f32 v169, v26, v27
    v_lshlrev_b32 v28, 16, v170
    v_and_b32 v29, s62, v170
    v_lshlrev_b32 v30, 16, v171
    v_and_b32 v31, s62, v171
    buffer_load_dwordx4 v8, s[20:23], s60 offen offset:1024 lds
    v_fma_f32 v28, v28, v16, v14
    v_fma_f32 v29, v29, v16, v14
    v_fma_f32 v30, v30, v16, v14
    v_fma_f32 v31, v31, v16, v14
    v_cvt_pk_bf16_f32 v170, v28, v29
    v_cvt_pk_bf16_f32 v171, v30, v31
    ds_write2_b64 v11, v[168:169], v[170:171] offset0:32 offset1:36
    buffer_load_dwordx4 v9, s[20:23], s60 offen offset:2048 lds
    v_lshlrev_b32 v24, 16, v172
    v_and_b32 v25, s62, v172
    v_lshlrev_b32 v26, 16, v173
    v_and_b32 v27, s62, v173
    v_fma_f32 v24, v24, v16, v14
    v_fma_f32 v25, v25, v16, v14
    v_fma_f32 v26, v26, v16, v14
    buffer_load_dwordx4 v[48:51], v6, s[12:15], s8 offen offset:3072
    v_fma_f32 v27, v27, v16, v14
    v_cvt_pk_bf16_f32 v172, v24, v25
    v_cvt_pk_bf16_f32 v173, v26, v27
    v_lshlrev_b32 v28, 16, v174
    v_and_b32 v29, s62, v174
    v_lshlrev_b32 v30, 16, v175
    v_and_b32 v31, s62, v175
    buffer_load_dwordx4 v[48:51], v6, s[12:15], s9 offen offset:0
    v_fma_f32 v28, v28, v16, v14
    v_fma_f32 v29, v29, v16, v14
    v_fma_f32 v30, v30, v16, v14
    v_fma_f32 v31, v31, v16, v14
    v_cvt_pk_bf16_f32 v174, v28, v29
    v_cvt_pk_bf16_f32 v175, v30, v31
    ds_write2_b64 v11, v[172:173], v[174:175] offset0:40 offset1:44
    buffer_load_dword v40, off, s[40:43], 0 sc1
    s_waitcnt lgkmcnt(0)
    s_waitcnt vmcnt(18)
    s_barrier
    s_add_u32 m0, s55, 0
    s_mov_b32 s60, 663552
    buffer_load_dwordx4 v7, s[20:23], s60 offen offset:0 lds
    buffer_load_dwordx4 v8, s[20:23], s60 offen offset:1024 lds
    buffer_load_dwordx4 v9, s[20:23], s60 offen offset:2048 lds
    buffer_load_dwordx4 v[48:51], v6, s[12:15], s9 offen offset:1024
    s_waitcnt vmcnt(17)
    s_barrier
    s_add_u32 m0, s55, 18432
    s_mov_b32 s60, 884736
    buffer_load_dwordx4 v7, s[20:23], s60 offen offset:0 lds
    buffer_load_dwordx4 v8, s[20:23], s60 offen offset:1024 lds
    buffer_load_dwordx4 v9, s[20:23], s60 offen offset:2048 lds
    s_add_u32 m0, s55, 110592
    s_mov_b32 s60, 1105920
    buffer_load_dwordx4 v7, s[20:23], s60 offen offset:0 lds
    buffer_load_dwordx4 v8, s[20:23], s60 offen offset:1024 lds
    buffer_load_dwordx4 v9, s[20:23], s60 offen offset:2048 lds
    s_waitcnt vmcnt(18)
    s_barrier
    buffer_load_dwordx4 v[48:51], v6, s[12:15], s9 offen offset:2048
    s_waitcnt vmcnt(11)
    s_mov_b32 s64, 0
L_nspin_0:
    v_readfirstlane_b32 s71, v40
    s_add_u32 s64, s64, 1
    s_cmp_gt_u32 s64, 50000
    s_cbranch_scc1 L_nok_0
    s_cmp_lg_u32 s71, 0
    s_cbranch_scc1 L_nok_0
    s_sleep 8
    buffer_load_dword v40, off, s[40:43], 0 sc1
    s_waitcnt vmcnt(0)
    s_branch L_nspin_0
L_nok_0:
    buffer_load_dwordx4 v[48:51], v6, s[12:15], s9 offen offset:3072
    s_barrier
    s_add_u32 m0, s55, 55296
    s_mov_b32 s60, 1327104
    buffer_load_dwordx4 v7, s[20:23], s60 offen offset:0 lds
    s_and_b32 s63, s51, 1
    s_mul_i32 s63, s63, 9216
    s_add_u32 s63, s63, 36864
    v_add_u32 v24, s63, v6
    ds_read_b128 v[100:103], v24 offset:0
    ds_read_b128 v[104:107], v24 offset:1024
    ds_read_b128 v[108:111], v24 offset:2048
    ds_read_b128 v[112:115], v24 offset:3072
    ds_read_b128 v[116:119], v24 offset:4096
    ds_read_b128 v[120:123], v24 offset:5120
    ds_read_b128 v[124:127], v24 offset:6144
    s_waitcnt lgkmcnt(0)
    v_lshlrev_b32 v24, 16, v100
    v_and_b32 v25, s62, v100
    v_lshlrev_b32 v26, 16, v101
    v_and_b32 v27, s62, v101
    v_mul_f32 v28, v24, v24
    v_mul_f32 v29, v25, v25
    v_mul_f32 v30, v26, v26
    v_mul_f32 v31, v27, v27
    v_fmamk_f32 v28, v28, 0xbdd2d3e8, v36
    v_fmamk_f32 v29, v29, 0xbdd2d3e8, v36
    v_fmamk_f32 v30, v30, 0xbdd2d3e8, v36
    v_fmamk_f32 v31, v31, 0xbdd2d3e8, v36
    v_mul_f32 v28, v28, v24
    v_mul_f32 v29, v29, v25
    v_mul_f32 v30, v30, v26
    v_mul_f32 v31, v31, v27
    v_exp_f32 v28, v28
    v_exp_f32 v29, v29
    v_exp_f32 v30, v30
    v_exp_f32 v31, v31
    v_add_f32 v28, 1.0, v28
    v_add_f32 v29, 1.0, v29
    buffer_load_dwordx4 v8, s[20:23], s60 offen offset:1024 lds
    v_add_f32 v30, 1.0, v30
    v_add_f32 v31, 1.0, v31
    v_rcp_f32 v28, v28
    v_rcp_f32 v29, v29
    v_rcp_f32 v30, v30
    v_rcp_f32 v31, v31
    v_mul_f32 v24, v24, v28
    v_mul_f32 v25, v25, v29
    v_mul_f32 v26, v26, v30
    v_mul_f32 v27, v27, v31
    v_cvt_pk_bf16_f32 v100, v24, v25
    v_cvt_pk_bf16_f32 v101, v26, v27
    v_add_f32 v14, v24, v25
    v_mul_f32 v16, v24, v24
    v_mul_f32 v17, v26, v26
    v_add_f32 v15, v26, v27
    v_fmac_f32 v16, v25, v25
    v_fmac_f32 v17, v27, v27
    v_lshlrev_b32 v24, 16, v102
    v_and_b32 v25, s62, v102
    v_lshlrev_b32 v26, 16, v103
    v_and_b32 v27, s62, v103
    v_mul_f32 v28, v24, v24
    v_mul_f32 v29, v25, v25
    v_mul_f32 v30, v26, v26
    v_mul_f32 v31, v27, v27
    v_fmamk_f32 v28, v28, 0xbdd2d3e8, v36
    v_fmamk_f32 v29, v29, 0xbdd2d3e8, v36
    v_fmamk_f32 v30, v30, 0xbdd2d3e8, v36
    v_fmamk_f32 v31, v31, 0xbdd2d3e8, v36
    v_mul_f32 v28, v28, v24
    v_mul_f32 v29, v29, v25
    buffer_load_dwordx4 v9, s[20:23], s60 offen offset:2048 lds
    v_mul_f32 v30, v30, v26
    v_mul_f32 v31, v31, v27
    v_exp_f32 v28, v28
    v_exp_f32 v29, v29
    v_exp_f32 v30, v30
    v_exp_f32 v31, v31
    v_add_f32 v28, 1.0, v28
    v_add_f32 v29, 1.0, v29
    v_add_f32 v30, 1.0, v30
    v_add_f32 v31, 1.0, v31
    v_rcp_f32 v28, v28
    v_rcp_f32 v29, v29
    v_rcp_f32 v30, v30
    v_rcp_f32 v31, v31
    v_mul_f32 v24, v24, v28
    v_mul_f32 v25, v25, v29
    v_mul_f32 v26, v26, v30
    v_mul_f32 v27, v27, v31
    v_cvt_pk_bf16_f32 v102, v24, v25
    v_cvt_pk_bf16_f32 v103, v26, v27
    v_add_f32 v18, v24, v25
    v_mul_f32 v20, v24, v24
    v_mul_f32 v21, v26, v26
    v_add_f32 v19, v26, v27
    v_fmac_f32 v20, v25, v25
    v_fmac_f32 v21, v27, v27
    v_lshlrev_b32 v24, 16, v104
    v_and_b32 v25, s62, v104
    v_lshlrev_b32 v26, 16, v105
    v_and_b32 v27, s62, v105
    v_mul_f32 v28, v24, v24
    v_mul_f32 v29, v25, v25
    v_mul_f32 v30, v26, v26
    v_mul_f32 v31, v27, v27
    v_fmamk_f32 v28, v28, 0xbdd2d3e8, v36
    v_fmamk_f32 v29, v29, 0xbdd2d3e8, v36
    v_fmamk_f32 v30, v30, 0xbdd2d3e8, v36
    v_fmamk_f32 v31, v31, 0xbdd2d3e8, v36
    v_mul_f32 v28, v28, v24
    v_mul_f32 v29, v29, v25
    v_mul_f32 v30, v30, v26
    v_mul_f32 v31, v31, v27
    v_exp_f32 v28, v28
    v_exp_f32 v29, v29
    v_exp_f32 v30, v30
    v_exp_f32 v31, v31
    v_add_f32 v28, 1.0, v28
    v_add_f32 v29, 1.0, v29
    v_add_f32 v30, 1.0, v30
    v_add_f32 v31, 1.0, v31
    v_rcp_f32 v28, v28
    v_rcp_f32 v29, v29
    v_rcp_f32 v30, v30
    v_rcp_f32 v31, v31
    v_mul_f32 v24, v24, v28
    v_mul_f32 v25, v25, v29
    s_waitcnt vmcnt(12)
    s_barrier
    s_add_u32 m0, s55, 73728
    s_mov_b32 s60, 1548288
    buffer_load_dwordx4 v7, s[20:23], s60 offen offset:0 lds
    v_mul_f32 v26, v26, v30
    v_mul_f32 v27, v27, v31
    v_cvt_pk_bf16_f32 v104, v24, v25
    v_cvt_pk_bf16_f32 v105, v26, v27
    v_add_f32 v14, v14, v24
    v_fmac_f32 v16, v24, v24
    v_add_f32 v15, v15, v26
    v_fmac_f32 v17, v26, v26
    v_add_f32 v14, v14, v25
    v_add_f32 v15, v15, v27
    v_fmac_f32 v16, v25, v25
    v_fmac_f32 v17, v27, v27
    v_lshlrev_b32 v24, 16, v106
    v_and_b32 v25, s62, v106
    v_lshlrev_b32 v26, 16, v107
    v_and_b32 v27, s62, v107
    v_mul_f32 v28, v24, v24
    v_mul_f32 v29, v25, v25
    v_mul_f32 v30, v26, v26
    v_mul_f32 v31, v27, v27
    v_fmamk_f32 v28, v28, 0xbdd2d3e8, v36
    buffer_load_dwordx4 v8, s[20:23], s60 offen offset:1024 lds
    v_fmamk_f32 v29, v29, 0xbdd2d3e8, v36
    v_fmamk_f32 v30, v30, 0xbdd2d3e8, v36
    v_fmamk_f32 v31, v31, 0xbdd2d3e8, v36
    v_mul_f32 v28, v28, v24
    v_mul_f32 v29, v29, v25
    v_mul_f32 v30, v30, v26
    v_mul_f32 v31, v31, v27
    v_exp_f32 v28, v28
    v_exp_f32 v29, v29
    v_exp_f32 v30, v30
    v_exp_f32 v31, v31
    v_add_f32 v28, 1.0, v28
    v_add_f32 v29, 1.0, v29
    v_add_f32 v30, 1.0, v30
    v_add_f32 v31, 1.0, v31
    v_rcp_f32 v28, v28
    buffer_load_dwordx4 v9, s[20:23], s60 offen offset:2048 lds
    v_rcp_f32 v29, v29
    v_rcp_f32 v30, v30
    v_rcp_f32 v31, v31
    v_mul_f32 v24, v24, v28
    v_mul_f32 v25, v25, v29
    v_mul_f32 v26, v26, v30
    v_mul_f32 v27, v27, v31
    v_cvt_pk_bf16_f32 v106, v24, v25
    v_cvt_pk_bf16_f32 v107, v26, v27
    v_add_f32 v18, v18, v24
    v_fmac_f32 v20, v24, v24
    v_add_f32 v19, v19, v26
    v_fmac_f32 v21, v26, v26
    v_add_f32 v18, v18, v25
    v_add_f32 v19, v19, v27
    v_fmac_f32 v20, v25, v25
    v_fmac_f32 v21, v27, v27
    v_lshlrev_b32 v24, 16, v108
    s_add_u32 m0, s55, 129024
    s_mov_b32 s60, 1769472
    buffer_load_dwordx4 v7, s[20:23], s60 offen offset:0 lds
    v_and_b32 v25, s62, v108
    v_lshlrev_b32 v26, 16, v109
    v_and_b32 v27, s62, v109
    v_mul_f32 v28, v24, v24
    v_mul_f32 v29, v25, v25
    v_mul_f32 v30, v26, v26
    v_mul_f32 v31, v27, v27
    v_fmamk_f32 v28, v28, 0xbdd2d3e8, v36
    v_fmamk_f32 v29, v29, 0xbdd2d3e8, v36
    v_fmamk_f32 v30, v30, 0xbdd2d3e8, v36
    v_fmamk_f32 v31, v31, 0xbdd2d3e8, v36
    v_mul_f32 v28, v28, v24
    v_mul_f32 v29, v29, v25
    v_mul_f32 v30, v30, v26
    v_mul_f32 v31, v31, v27
    v_exp_f32 v28, v28
    v_exp_f32 v29, v29
    v_exp_f32 v30, v30
    buffer_load_dwordx4 v8, s[20:23], s60 offen offset:1024 lds
    v_exp_f32 v31, v31
    v_add_f32 v28, 1.0, v28
    v_add_f32 v29, 1.0, v29
    v_add_f32 v30, 1.0, v30
    v_add_f32 v31, 1.0, v31
    v_rcp_f32 v28, v28
    v_rcp_f32 v29, v29
    v_rcp_f32 v30, v30
    v_rcp_f32 v31, v31
    v_mul_f32 v24, v24, v28
    v_mul_f32 v25, v25, v29
    v_mul_f32 v26, v26, v30
    v_mul_f32 v27, v27, v31
    v_cvt_pk_bf16_f32 v108, v24, v25
    v_cvt_pk_bf16_f32 v109, v26, v27
    v_add_f32 v14, v14, v24
    buffer_load_dwordx4 v9, s[20:23], s60 offen offset:2048 lds
    v_fmac_f32 v16, v24, v24
    v_add_f32 v15, v15, v26
    v_fmac_f32 v17, v26, v26
    v_add_f32 v14, v14, v25
    v_add_f32 v15, v15, v27
    v_fmac_f32 v16, v25, v25
    v_fmac_f32 v17, v27, v27
    v_lshlrev_b32 v24, 16, v110
    v_and_b32 v25, s62, v110
    v_lshlrev_b32 v26, 16, v111
    v_and_b32 v27, s62, v111
    v_mul_f32 v28, v24, v24
    v_mul_f32 v29, v25, v25
    v_mul_f32 v30, v26, v26
    v_mul_f32 v31, v27, v27
    v_fmamk_f32 v28, v28, 0xbdd2d3e8, v36
    v_fmamk_f32 v29, v29, 0xbdd2d3e8, v36
    v_fmamk_f32 v30, v30, 0xbdd2d3e8, v36
    v_fmamk_f32 v31, v31, 0xbdd2d3e8, v36
    v_mul_f32 v28, v28, v24
    v_mul_f32 v29, v29, v25
    v_mul_f32 v30, v30, v26
    v_mul_f32 v31, v31, v27
    v_exp_f32 v28, v28
    v_exp_f32 v29, v29
    v_exp_f32 v30, v30
    v_exp_f32 v31, v31
    v_add_f32 v28, 1.0, v28
    v_add_f32 v29, 1.0, v29
    v_add_f32 v30, 1.0, v30
    v_add_f32 v31, 1.0, v31
    v_rcp_f32 v28, v28
    v_rcp_f32 v29, v29
    v_rcp_f32 v30, v30
    v_rcp_f32 v31, v31
    s_waitcnt vmcnt(14)
    s_barrier
    s_add_u32 m0, s54, 36864
    s_mov_b32 s60, 0
    buffer_load_dwordx4 v1, s[16:19], s60 offen offset:0 lds
    v_mul_f32 v24, v24, v28
    v_mul_f32 v25, v25, v29
    v_mul_f32 v26, v26, v30
    v_mul_f32 v27, v27, v31
    v_cvt_pk_bf16_f32 v110, v24, v25
    v_cvt_pk_bf16_f32 v111, v26, v27
    v_add_f32 v18, v18, v24
    v_fmac_f32 v20, v24, v24
    v_add_f32 v19, v19, v26
    v_fmac_f32 v21, v26, v26
    v_add_f32 v18, v18, v25
    v_add_f32 v19, v19, v27
    v_fmac_f32 v20, v25, v25
    v_fmac_f32 v21, v27, v27
    v_lshlrev_b32 v24, 16, v112
    v_and_b32 v25, s62, v112
    buffer_load_dwordx4 v2, s[16:19], s60 offen offset:1024 lds
    v_lshlrev_b32 v26, 16, v113
    v_and_b32 v27, s62, v113
    v_mul_f32 v28, v24, v24
    v_mul_f32 v29, v25, v25
    v_mul_f32 v30, v26, v26
    v_mul_f32 v31, v27, v27
    v_fmamk_f32 v28, v28, 0xbdd2d3e8, v36
    v_fmamk_f32 v29, v29, 0xbdd2d3e8, v36
    v_fmamk_f32 v30, v30, 0xbdd2d3e8, v36
    v_fmamk_f32 v31, v31, 0xbdd2d3e8, v36
    v_mul_f32 v28, v28, v24
    v_mul_f32 v29, v29, v25
    v_mul_f32 v30, v30, v26
    v_mul_f32 v31, v31, v27
    v_exp_f32 v28, v28
    buffer_load_dwordx4 v3, s[16:19], s60 offen offset:2048 lds
    v_exp_f32 v29, v29
    v_exp_f32 v30, v30
    v_exp_f32 v31, v31
    v_add_f32 v28, 1.0, v28
    v_add_f32 v29, 1.0, v29
    v_add_f32 v30, 1.0, v30
    v_add_f32 v31, 1.0, v31
    v_rcp_f32 v28, v28
    v_rcp_f32 v29, v29
    v_rcp_f32 v30, v30
    buffer_load_dwordx4 v4, s[16:19], s60 offen offset:3072 lds
    v_rcp_f32 v31, v31
    v_mul_f32 v24, v24, v28
    v_mul_f32 v25, v25, v29
    v_mul_f32 v26, v26, v30
    v_mul_f32 v27, v27, v31
    v_cvt_pk_bf16_f32 v112, v24, v25
    v_cvt_pk_bf16_f32 v113, v26, v27
    v_add_f32 v14, v14, v24
    v_fmac_f32 v16, v24, v24
    v_add_f32 v15, v15, v26
    v_fmac_f32 v17, v26, v26
    v_add_f32 v14, v14, v25
    v_add_f32 v15, v15, v27
    v_fmac_f32 v16, v25, v25
    v_fmac_f32 v17, v27, v27
    s_add_u32 m0, s54, 92160
    s_mov_b32 s60, 589824
    buffer_load_dwordx4 v1, s[16:19], s60 offen offset:0 lds
    v_lshlrev_b32 v24, 16, v114
    v_and_b32 v25, s62, v114
    v_lshlrev_b32 v26, 16, v115
    v_and_b32 v27, s62, v115
    v_mul_f32 v28, v24, v24
    v_mul_f32 v29, v25, v25
    v_mul_f32 v30, v26, v26
    v_mul_f32 v31, v27, v27
    v_fmamk_f32 v28, v28, 0xbdd2d3e8, v36
    v_fmamk_f32 v29, v29, 0xbdd2d3e8, v36
    v_fmamk_f32 v30, v30, 0xbdd2d3e8, v36
    v_fmamk_f32 v31, v31, 0xbdd2d3e8, v36
    v_mul_f32 v28, v28, v24
    v_mul_f32 v29, v29, v25
    v_mul_f32 v30, v30, v26
    v_mul_f32 v31, v31, v27
    buffer_load_dwordx4 v2, s[16:19], s60 offen offset:1024 lds
    v_exp_f32 v28, v28
    v_exp_f32 v29, v29
    v_exp_f32 v30, v30
    v_exp_f32 v31, v31
    v_add_f32 v28, 1.0, v28
    v_add_f32 v29, 1.0, v29
    v_add_f32 v30, 1.0, v30
    v_add_f32 v31, 1.0, v31
    v_rcp_f32 v28, v28
    v_rcp_f32 v29, v29
    buffer_load_dwordx4 v3, s[16:19], s60 offen offset:2048 lds
    v_rcp_f32 v30, v30
    v_rcp_f32 v31, v31
    v_mul_f32 v24, v24, v28
    v_mul_f32 v25, v25, v29
    v_mul_f32 v26, v26, v30
    v_mul_f32 v27, v27, v31
    v_cvt_pk_bf16_f32 v114, v24, v25
    v_cvt_pk_bf16_f32 v115, v26, v27
    v_add_f32 v18, v18, v24
    v_fmac_f32 v20, v24, v24
    v_add_f32 v19, v19, v26
    v_fmac_f32 v21, v26, v26
    v_add_f32 v18, v18, v25
    v_add_f32 v19, v19, v27
    buffer_load_dwordx4 v4, s[16:19], s60 offen offset:3072 lds
    v_fmac_f32 v20, v25, v25
    v_fmac_f32 v21, v27, v27
    v_lshlrev_b32 v24, 16, v116
    v_and_b32 v25, s62, v116
    v_lshlrev_b32 v26, 16, v117
    v_and_b32 v27, s62, v117
    v_mul_f32 v28, v24, v24
    v_mul_f32 v29, v25, v25
    v_mul_f32 v30, v26, v26
    v_mul_f32 v31, v27, v27
    v_fmamk_f32 v28, v28, 0xbdd2d3e8, v36
    v_fmamk_f32 v29, v29, 0xbdd2d3e8, v36
    v_fmamk_f32 v30, v30, 0xbdd2d3e8, v36
    v_fmamk_f32 v31, v31, 0xbdd2d3e8, v36
    v_mul_f32 v28, v28, v24
    v_mul_f32 v29, v29, v25
    v_mul_f32 v30, v30, v26
    v_mul_f32 v31, v31, v27
    v_exp_f32 v28, v28
    v_exp_f32 v29, v29
    v_exp_f32 v30, v30
    v_exp_f32 v31, v31
    v_add_f32 v28, 1.0, v28
    v_add_f32 v29, 1.0, v29
    v_add_f32 v30, 1.0, v30
    v_add_f32 v31, 1.0, v31
    v_rcp_f32 v28, v28
    s_waitcnt vmcnt(19)
    s_barrier
    s_add_u32 m0, s54, 0
    s_mov_b32 s60, 1179648
    buffer_load_dwordx4 v1, s[16:19], s60 offen offset:0 lds
    v_rcp_f32 v29, v29
    v_rcp_f32 v30, v30
    v_rcp_f32 v31, v31
    v_mul_f32 v24, v24, v28
    v_mul_f32 v25, v25, v29
    v_mul_f32 v26, v26, v30
    v_mul_f32 v27, v27, v31
    v_cvt_pk_bf16_f32 v116, v24, v25
    v_cvt_pk_bf16_f32 v117, v26, v27
    v_add_f32 v14, v14, v24
    v_fmac_f32 v16, v24, v24
    v_add_f32 v15, v15, v26
    v_fmac_f32 v17, v26, v26
    v_add_f32 v14, v14, v25
    v_add_f32 v15, v15, v27
    v_fmac_f32 v16, v25, v25
    v_fmac_f32 v17, v27, v27
    s_lshl_b32 s63, s51, 12
    s_add_u32 s63, s63, 147456
    v_add_u32 v40, s63, v6
    ds_read_b128 v[128:131], v40
    ds_read_b128 v[132:135], v40 offset:1024
    ds_read_b128 v[44:47], v40 offset:2048
    ds_read_b128 v[52:55], v40 offset:3072
    v_lshlrev_b32 v24, 16, v118
    v_and_b32 v25, s62, v118
    v_lshlrev_b32 v26, 16, v119
    v_and_b32 v27, s62, v119
    v_mul_f32 v28, v24, v24
    v_mul_f32 v29, v25, v25
    v_mul_f32 v30, v26, v26
    buffer_load_dwordx4 v2, s[16:19], s60 offen offset:1024 lds
    v_mul_f32 v31, v27, v27
    v_fmamk_f32 v28, v28, 0xbdd2d3e8, v36
    v_fmamk_f32 v29, v29, 0xbdd2d3e8, v36
    v_fmamk_f32 v30, v30, 0xbdd2d3e8, v36
    v_fmamk_f32 v31, v31, 0xbdd2d3e8, v36
    v_mul_f32 v28, v28, v24
    v_mul_f32 v29, v29, v25
    v_mul_f32 v30, v30, v26
    v_mul_f32 v31, v31, v27
    v_exp_f32 v28, v28
    v_exp_f32 v29, v29
    v_exp_f32 v30, v30
    v_exp_f32 v31, v31
    v_add_f32 v28, 1.0, v28
    v_add_f32 v29, 1.0, v29
    v_add_f32 v30, 1.0, v30
    v_add_f32 v31, 1.0, v31
    v_rcp_f32 v28, v28
    v_rcp_f32 v29, v29
    v_rcp_f32 v30, v30
    v_rcp_f32 v31, v31
    v_mul_f32 v24, v24, v28
    v_mul_f32 v25, v25, v29
    v_mul_f32 v26, v26, v30
    v_mul_f32 v27, v27, v31
    buffer_load_dwordx4 v3, s[16:19], s60 offen offset:2048 lds
    v_cvt_pk_bf16_f32 v118, v24, v25
    v_cvt_pk_bf16_f32 v119, v26, v27
    v_add_f32 v18, v18, v24
    v_fmac_f32 v20, v24, v24
    v_add_f32 v19, v19, v26
    v_fmac_f32 v21, v26, v26
    v_add_f32 v18, v18, v25
    v_add_f32 v19, v19, v27
    v_fmac_f32 v20, v25, v25
    v_fmac_f32 v21, v27, v27
    v_lshlrev_b32 v24, 16, v120
    v_and_b32 v25, s62, v120
    v_lshlrev_b32 v26, 16, v121
    v_and_b32 v27, s62, v121
    v_mul_f32 v28, v24, v24
    v_mul_f32 v29, v25, v25
    v_mul_f32 v30, v26, v26
    v_mul_f32 v31, v27, v27
    v_fmamk_f32 v28, v28, 0xbdd2d3e8, v36
    v_fmamk_f32 v29, v29, 0xbdd2d3e8, v36
    v_fmamk_f32 v30, v30, 0xbdd2d3e8, v36
    v_fmamk_f32 v31, v31, 0xbdd2d3e8, v36
    v_mul_f32 v28, v28, v24
    v_mul_f32 v29, v29, v25
    v_mul_f32 v30, v30, v26
    v_mul_f32 v31, v31, v27
    v_exp_f32 v28, v28
    v_exp_f32 v29, v29
    v_exp_f32 v30, v30
    v_exp_f32 v31, v31
    buffer_load_dwordx4 v4, s[16:19], s60 offen offset:3072 lds
    v_add_f32 v28, 1.0, v28
    v_add_f32 v29, 1.0, v29
    v_add_f32 v30, 1.0, v30
    v_add_f32 v31, 1.0, v31
    v_rcp_f32 v28, v28
    v_rcp_f32 v29, v29
    v_rcp_f32 v30, v30
    v_rcp_f32 v31, v31
    v_mul_f32 v24, v24, v28
    v_mul_f32 v25, v25, v29
    v_mul_f32 v26, v26, v30
    v_mul_f32 v27, v27, v31
    v_cvt_pk_bf16_f32 v120, v24, v25
    v_cvt_pk_bf16_f32 v121, v26, v27
    v_add_f32 v14, v14, v24
    v_fmac_f32 v16, v24, v24
    v_add_f32 v15, v15, v26
    v_fmac_f32 v17, v26, v26
    v_add_f32 v14, v14, v25
    v_add_f32 v15, v15, v27
    v_fmac_f32 v16, v25, v25
    v_fmac_f32 v17, v27, v27
    v_lshlrev_b32 v24, 16, v122
    v_and_b32 v25, s62, v122
    v_lshlrev_b32 v26, 16, v123
    v_and_b32 v27, s62, v123
    v_mul_f32 v28, v24, v24
    v_mul_f32 v29, v25, v25
    v_mul_f32 v30, v26, v26
    v_mul_f32 v31, v27, v27
    v_fmamk_f32 v28, v28, 0xbdd2d3e8, v36
    v_fmamk_f32 v29, v29, 0xbdd2d3e8, v36
    v_fmamk_f32 v30, v30, 0xbdd2d3e8, v36
    v_fmamk_f32 v31, v31, 0xbdd2d3e8, v36
    v_mul_f32 v28, v28, v24
    v_mul_f32 v29, v29, v25
    v_mul_f32 v30, v30, v26
    v_mul_f32 v31, v31, v27
    v_exp_f32 v28, v28
    v_exp_f32 v29, v29
    v_exp_f32 v30, v30
    v_exp_f32 v31, v31
    v_add_f32 v28, 1.0, v28
    v_add_f32 v29, 1.0, v29
    v_add_f32 v30, 1.0, v30
    v_add_f32 v31, 1.0, v31
    v_rcp_f32 v28, v28
    v_rcp_f32 v29, v29
    v_rcp_f32 v30, v30
    v_rcp_f32 v31, v31
    v_mul_f32 v24, v24, v28
    v_mul_f32 v25, v25, v29
    v_mul_f32 v26, v26, v30
    v_mul_f32 v27, v27, v31
    s_waitcnt vmcnt(18)
    s_barrier
    s_add_u32 m0, s54, 18432
    s_mov_b32 s60, 1769472
    buffer_load_dwordx4 v1, s[16:19], s60 offen offset:0 lds
    v_cvt_pk_bf16_f32 v122, v24, v25
    v_cvt_pk_bf16_f32 v123, v26, v27
    v_add_f32 v18, v18, v24
    v_fmac_f32 v20, v24, v24
    v_add_f32 v19, v19, v26
    v_fmac_f32 v21, v26, v26
    v_add_f32 v18, v18, v25
    v_add_f32 v19, v19, v27
    v_fmac_f32 v20, v25, v25
    v_fmac_f32 v21, v27, v27
    v_lshlrev_b32 v24, 16, v124
    v_and_b32 v25, s62, v124
    v_lshlrev_b32 v26, 16, v125
    v_and_b32 v27, s62, v125
    v_mul_f32 v28, v24, v24
    v_mul_f32 v29, v25, v25
    v_mul_f32 v30, v26, v26
    v_mul_f32 v31, v27, v27
    v_fmamk_f32 v28, v28, 0xbdd2d3e8, v36
    v_fmamk_f32 v29, v29, 0xbdd2d3e8, v36
    v_fmamk_f32 v30, v30, 0xbdd2d3e8, v36
    v_fmamk_f32 v31, v31, 0xbdd2d3e8, v36
    v_mul_f32 v28, v28, v24
    v_mul_f32 v29, v29, v25
    v_mul_f32 v30, v30, v26
    v_mul_f32 v31, v31, v27
    v_exp_f32 v28, v28
    v_exp_f32 v29, v29
    v_exp_f32 v30, v30
    buffer_load_dwordx4 v2, s[16:19], s60 offen offset:1024 lds
    v_exp_f32 v31, v31
    v_add_f32 v28, 1.0, v28
    v_add_f32 v29, 1.0, v29
    v_add_f32 v30, 1.0, v30
    v_add_f32 v31, 1.0, v31
    v_rcp_f32 v28, v28
    v_rcp_f32 v29, v29
    v_rcp_f32 v30, v30
    v_rcp_f32 v31, v31
    v_mul_f32 v24, v24, v28
    v_mul_f32 v25, v25, v29
    v_mul_f32 v26, v26, v30
    v_mul_f32 v27, v27, v31
    v_cvt_pk_bf16_f32 v124, v24, v25
    v_cvt_pk_bf16_f32 v125, v26, v27
    v_add_f32 v14, v14, v24
    v_fmac_f32 v16, v24, v24
    v_add_f32 v15, v15, v26
    v_fmac_f32 v17, v26, v26
    v_add_f32 v14, v14, v25
    v_add_f32 v15, v15, v27
    v_fmac_f32 v16, v25, v25
    v_fmac_f32 v17, v27, v27
    v_lshlrev_b32 v24, 16, v126
    v_and_b32 v25, s62, v126
    v_lshlrev_b32 v26, 16, v127
    v_and_b32 v27, s62, v127
    buffer_load_dwordx4 v3, s[16:19], s60 offen offset:2048 lds
    v_mul_f32 v28, v24, v24
    v_mul_f32 v29, v25, v25
    v_mul_f32 v30, v26, v26
    v_mul_f32 v31, v27, v27
    v_fmamk_f32 v28, v28, 0xbdd2d3e8, v36
    v_fmamk_f32 v29, v29, 0xbdd2d3e8, v36
    v_fmamk_f32 v30, v30, 0xbdd2d3e8, v36
    v_fmamk_f32 v31, v31, 0xbdd2d3e8, v36
    v_mul_f32 v28, v28, v24
    v_mul_f32 v29, v29, v25
    v_mul_f32 v30, v30, v26
    v_mul_f32 v31, v31, v27
    v_exp_f32 v28, v28
    v_exp_f32 v29, v29
    v_exp_f32 v30, v30
    v_exp_f32 v31, v31
    v_add_f32 v28, 1.0, v28
    v_add_f32 v29, 1.0, v29
    v_add_f32 v30, 1.0, v30
    v_add_f32 v31, 1.0, v31
    v_rcp_f32 v28, v28
    v_rcp_f32 v29, v29
    v_rcp_f32 v30, v30
    v_rcp_f32 v31, v31
    buffer_load_dwordx4 v4, s[16:19], s60 offen offset:3072 lds
    v_mul_f32 v24, v24, v28
    v_mul_f32 v25, v25, v29
    v_mul_f32 v26, v26, v30
    v_mul_f32 v27, v27, v31
    v_cvt_pk_bf16_f32 v126, v24, v25
    v_cvt_pk_bf16_f32 v127, v26, v27
    v_add_f32 v18, v18, v24
    v_fmac_f32 v20, v24, v24
    v_add_f32 v19, v19, v26
    v_fmac_f32 v21, v26, v26
    v_add_f32 v18, v18, v25
    v_add_f32 v19, v19, v27
    v_fmac_f32 v20, v25, v25
    v_fmac_f32 v21, v27, v27
    s_waitcnt lgkmcnt(0)
    v_add_f32 v14, v14, v44
    v_add_f32 v15, v15, v45
    v_add_f32 v16, v16, v46
    v_add_f32 v17, v17, v47
    v_add_f32 v18, v18, v52
    v_add_f32 v19, v19, v53
    v_add_f32 v20, v20, v54
    v_add_f32 v21, v21, v55
    v_add_f32 v14, v14, v15
    v_add_f32 v16, v16, v17
    v_add_f32 v18, v18, v19
    v_add_f32 v20, v20, v21
    v_mov_b32 v24, v14
    v_mov_b32 v25, v16
    v_mov_b32 v26, v18
    v_mov_b32 v27, v20
    v_permlane32_swap_b32 v14, v24
    v_permlane32_swap_b32 v16, v25
    v_permlane32_swap_b32 v18, v26
    v_permlane32_swap_b32 v20, v27
    v_add_f32 v14, v14, v24
    v_add_f32 v16, v16, v25
    v_add_f32 v18, v18, v26
    v_add_f32 v20, v20, v27
    v_mov_b32 v24, v14
    v_mov_b32 v25, v16
    v_mov_b32 v26, v18
    v_mov_b32 v27, v20
    v_permlane16_swap_b32 v14, v24
    v_permlane16_swap_b32 v16, v25
    v_permlane16_swap_b32 v18, v26
    v_permlane16_swap_b32 v20, v27
    v_add_f32 v14, v14, v24
    v_add_f32 v16, v16, v25
    v_add_f32 v18, v18, v26
    v_add_f32 v20, v20, v27
    s_mov_b32 s64, 0xffff0000
    s_mov_b32 s65, 0
    v_cndmask_b32 v24, v14, v18, s[64:65]
    v_cndmask_b32 v26, v16, v20, s[64:65]
    v_mov_b32 v25, s71
    v_mov_b32 v27, s71
    s_lshl_b32 s63, s48, 4
    s_add_u32 s63, s63, s49
    s_lshl_b32 s63, s63, 2
    s_add_u32 s63, s63, s51
    s_lshl_b32 s63, s63, 9
    s_mov_b32 exec_hi, 0
    buffer_store_dwordx4 v[24:27], v6, s[36:39], s63 offen sc1
    s_mov_b64 exec, -1
    s_waitcnt vmcnt(20)
    s_barrier
    s_add_u32 m0, s54, 110592
    s_mov_b32 s60, 2359296
    buffer_load_dwordx4 v1, s[16:19], s60 offen offset:0 lds
    buffer_load_dwordx4 v2, s[16:19], s60 offen offset:1024 lds
    buffer_load_dwordx4 v3, s[16:19], s60 offen offset:2048 lds
    buffer_load_dwordx4 v4, s[16:19], s60 offen offset:3072 lds
    s_waitcnt vmcnt(21)
    s_barrier
    s_add_u32 m0, s54, 55296
    s_mov_b32 s60, 2949120
    buffer_load_dwordx4 v1, s[16:19], s60 offen offset:0 lds
    buffer_load_dwordx4 v2, s[16:19], s60 offen offset:1024 lds
    buffer_load_dwordx4 v3, s[16:19], s60 offen offset:2048 lds
    buffer_load_dwordx4 v4, s[16:19], s60 offen offset:3072 lds
    s_waitcnt vmcnt(21)
    s_barrier
    s_waitcnt vmcnt(17)
    s_barrier
    v_lshrrev_b32 v32, 4, v0
    v_lshlrev_b32 v32, 13, v32
    v_and_b32 v33, 15, v0
    v_lshl_add_u32 v32, v33, 4, v32
    s_lshl_b32 s64, s48, 15
    s_lshl_b32 s65, s51, 9
    s_add_u32 s64, s64, s65
    s_add_u32 s65, s64, 4096
    buffer_load_dwordx4 v[40:43], v32, s[36:39], s64 offen offset:0 sc1
    buffer_load_dwordx4 v[44:47], v32, s[36:39], s64 offen offset:2048 sc1
    buffer_load_dwordx4 v[48:51], v32, s[36:39], s65 offen offset:0 sc1
    buffer_load_dwordx4 v[52:55], v32, s[36:39], s65 offen offset:2048 sc1
    buffer_load_dwordx4 v[56:59], v32, s[36:39], s64 offen offset:256 sc1
    buffer_load_dwordx4 v[60:63], v32, s[36:39], s64 offen offset:2304 sc1
    buffer_load_dwordx4 v[64:67], v32, s[36:39], s65 offen offset:256 sc1
    buffer_load_dwordx4 v[68:71], v32, s[36:39], s65 offen offset:2304 sc1
    s_waitcnt vmcnt(21)
    s_barrier
    s_add_u32 m0, s54, 36864
    s_mov_b32 s60, 3538944
    buffer_load_dwordx4 v1, s[16:19], s60 offen offset:0 lds
    s_and_b32 s63, s51, 1
    s_mul_i32 s63, s63, 9216
    s_add_u32 s63, s63, 129024
    v_add_u32 v24, s63, v6
    ds_read_b128 v[140:143], v24 offset:0
    ds_read_b128 v[144:147], v24 offset:1024
    ds_read_b128 v[148:151], v24 offset:2048
    ds_read_b128 v[152:155], v24 offset:3072
    ds_read_b128 v[156:159], v24 offset:4096
    ds_read_b128 v[196:199], v24 offset:5120
    ds_read_b128 v[200:203], v24 offset:6144
    s_waitcnt lgkmcnt(0)
    s_lshl_b32 s61, s48, 2
    s_add_u32 s61, s61, s51
    s_mul_i32 s61, s61, 110592
    s_lshl_b32 s63, s67, 5
    buffer_load_dwordx4 v2, s[16:19], s60 offen offset:1024 lds
    s_add_u32 s61, s61, s63
    s_add_u32 s70, s61, 4096
    v_permlane16_swap_b32 v140, v142
    v_permlane16_swap_b32 v141, v143
    v_permlane16_swap_b32 v144, v146
    v_permlane16_swap_b32 v145, v147
    v_permlane16_swap_b32 v148, v150
    v_permlane16_swap_b32 v149, v151
    v_permlane16_swap_b32 v152, v154
    v_permlane16_swap_b32 v153, v155
    v_permlane16_swap_b32 v156, v158
    v_permlane16_swap_b32 v157, v159
    v_permlane16_swap_b32 v196, v198
    buffer_load_dwordx4 v3, s[16:19], s60 offen offset:2048 lds
    v_permlane16_swap_b32 v197, v199
    v_permlane16_swap_b32 v200, v202
    v_permlane16_swap_b32 v201, v203
    buffer_load_dwordx4 v4, s[16:19], s60 offen offset:3072 lds
    s_waitcnt vmcnt(21)
    s_barrier
    s_add_u32 m0, s54, 92160
    s_mov_b32 s60, 4128768
    buffer_load_dwordx4 v1, s[16:19], s60 offen offset:0 lds
    s_waitcnt vmcnt(5)
    v_xor_b32 v24, s71, v41
    v_xor_b32 v25, s71, v43
    v_xor_b32 v26, s71, v45
    v_xor_b32 v27, s71, v47
    v_or3_b32 v25, v25, v26, v27
    v_xor_b32 v26, s71, v49
    v_xor_b32 v27, s71, v51
    v_or3_b32 v24, v24, v26, v27
    v_xor_b32 v26, s71, v53
    v_xor_b32 v27, s71, v55
    v_or3_b32 v25, v25, v26, v27
    v_xor_b32 v26, s71, v57
    buffer_load_dwordx4 v2, s[16:19], s60 offen offset:1024 lds
    v_xor_b32 v27, s71, v59
    v_or3_b32 v24, v24, v26, v27
    v_xor_b32 v26, s71, v61
    v_xor_b32 v27, s71, v63
    v_or3_b32 v25, v25, v26, v27
    v_xor_b32 v26, s71, v65
    v_xor_b32 v27, s71, v67
    v_or3_b32 v24, v24, v26, v27
    v_xor_b32 v26, s71, v69
    v_xor_b32 v27, s71, v71
    v_or3_b32 v25, v25, v26, v27
    v_or_b32 v24, v24, v25
    buffer_load_dwordx4 v3, s[16:19], s60 offen offset:2048 lds
    v_cmp_ne_u32 vcc, 0, v24
    s_nop 4
    s_cbranch_vccz L_pok_0
    s_mov_b32 s63, 0
L_pspin_0:
    s_sleep 4
    buffer_load_dwordx4 v[40:43], v32, s[36:39], s64 offen offset:0 sc1
    buffer_load_dwordx4 v[44:47], v32, s[36:39], s64 offen offset:2048 sc1
    buffer_load_dwordx4 v[48:51], v32, s[36:39], s65 offen offset:0 sc1
    buffer_load_dwordx4 v[52:55], v32, s[36:39], s65 offen offset:2048 sc1
    buffer_load_dwordx4 v[56:59], v32, s[36:39], s64 offen offset:256 sc1
    buffer_load_dwordx4 v[60:63], v32, s[36:39], s64 offen offset:2304 sc1
    buffer_load_dwordx4 v[64:67], v32, s[36:39], s65 offen offset:256 sc1
    buffer_load_dwordx4 v[68:71], v32, s[36:39], s65 offen offset:2304 sc1
    s_add_u32 s63, s63, 1
    s_cmp_gt_u32 s63, 50000
    s_cbranch_scc1 L_pok_0
    s_waitcnt vmcnt(0)
    v_xor_b32 v24, s71, v41
    v_xor_b32 v25, s71, v43
    v_xor_b32 v26, s71, v45
    v_xor_b32 v27, s71, v47
    v_or3_b32 v25, v25, v26, v27
    v_xor_b32 v26, s71, v49
    v_xor_b32 v27, s71, v51
    v_or3_b32 v24, v24, v26, v27
    v_xor_b32 v26, s71, v53
    v_xor_b32 v27, s71, v55
    v_or3_b32 v25, v25, v26, v27
    v_xor_b32 v26, s71, v57
    v_xor_b32 v27, s71, v59
    v_or3_b32 v24, v24, v26, v27
    v_xor_b32 v26, s71, v61
    v_xor_b32 v27, s71, v63
    v_or3_b32 v25, v25, v26, v27
    v_xor_b32 v26, s71, v65
    v_xor_b32 v27, s71, v67
    v_or3_b32 v24, v24, v26, v27
    v_xor_b32 v26, s71, v69
    v_xor_b32 v27, s71, v71
    v_or3_b32 v25, v25, v26, v27
    v_or_b32 v24, v24, v25
    v_cmp_ne_u32 vcc, 0, v24
    s_nop 4
    s_cbranch_vccnz L_pspin_0
L_pok_0:
    v_add_f32 v40, v40, v44
    v_add_f32 v48, v48, v52
    v_add_f32 v42, v42, v46
    v_add_f32 v50, v50, v54
    v_add_f32 v56, v56, v60
    v_add_f32 v64, v64, v68
    v_add_f32 v58, v58, v62
    v_add_f32 v66, v66, v70
    v_add_f32 v14, v40, v48
    v_add_f32 v15, v42, v50
    buffer_load_dwordx4 v4, s[16:19], s60 offen offset:3072 lds
    v_add_f32 v18, v56, v64
    v_add_f32 v19, v58, v66
    v_mov_b32 v24, v14
    v_mov_b32 v25, v15
    v_mov_b32 v26, v18
    v_mov_b32 v27, v19
    v_permlane32_swap_b32 v14, v24
    v_permlane32_swap_b32 v15, v25
    v_permlane32_swap_b32 v18, v26
    v_permlane32_swap_b32 v19, v27
    v_add_f32 v14, v14, v24
    v_add_f32 v15, v15, v25
    s_add_u32 m0, s54, 73728
    s_mov_b32 s60, 4718592
    buffer_load_dwordx4 v1, s[16:19], s60 offen offset:0 lds
    v_add_f32 v18, v18, v26
    v_add_f32 v19, v19, v27
    v_mov_b32 v24, v14
    v_mov_b32 v25, v15
    v_mov_b32 v26, v18
    v_mov_b32 v27, v19
    v_permlane16_swap_b32 v14, v24
    v_permlane16_swap_b32 v15, v25
    v_permlane16_swap_b32 v18, v26
    v_permlane16_swap_b32 v19, v27
    v_add_f32 v14, v14, v24
    v_add_f32 v15, v15, v25
    buffer_load_dwordx4 v2, s[16:19], s60 offen offset:1024 lds
    v_add_f32 v18, v18, v26
    v_add_f32 v19, v19, v27
    v_mul_f32 v14, 0x39e38e39, v14
    v_mul_f32 v18, 0x39e38e39, v18
    v_mul_f32 v15, 0x39e38e39, v15
    v_mul_f32 v19, 0x39e38e39, v19
    v_fma_f32 v15, -v14, v14, v15
    v_fma_f32 v19, -v18, v18, v19
    v_max_f32 v15, 0, v15
    v_max_f32 v19, 0, v19
    v_add_f32 v15, 0x3727c5ac, v15
    v_add_f32 v19, 0x3727c5ac, v19
    buffer_load_dwordx4 v3, s[16:19], s60 offen offset:2048 lds
    v_rsq_f32 v16, v15
    v_rsq_f32 v20, v19
    v_mul_f32 v14, -v14, v16
    v_mul_f32 v18, -v18, v20
    v_bfe_u32 v33, v0, 4, 1
    v_lshlrev_b32 v33, 2, v33
    v_xor_b32 v33, v0, v33
    v_lshlrev_b32 v33, 4, v33
    s_lshl_b32 s66, s49, 6
    s_lshl_b32 s63, s48, 2
    s_add_u32 s66, s66, s63
    s_add_u32 s66, s66, s51
    buffer_load_dwordx4 v4, s[16:19], s60 offen offset:3072 lds
    s_mul_i32 s66, s66, 9216
    s_mov_b32 s14, 0
    s_mov_b32 s15, -1
    v_lshlrev_b32 v24, 16, v100
    v_and_b32 v25, s62, v100
    v_lshlrev_b32 v26, 16, v101
    v_and_b32 v27, s62, v101
    v_fma_f32 v24, v24, v16, v14
    v_fma_f32 v25, v25, v16, v14
    v_fma_f32 v26, v26, v16, v14
    v_fma_f32 v27, v27, v16, v14
    v_cvt_pk_bf16_f32 v100, v24, v25
    v_cvt_pk_bf16_f32 v101, v26, v27
    v_lshlrev_b32 v28, 16, v102
    v_and_b32 v29, s62, v102
    v_lshlrev_b32 v30, 16, v103
    v_and_b32 v31, s62, v103
    v_fma_f32 v28, v28, v20, v18
    v_fma_f32 v29, v29, v20, v18
    v_fma_f32 v30, v30, v20, v18
    v_fma_f32 v31, v31, v20, v18
    v_cvt_pk_bf16_f32 v102, v28, v29
    v_cvt_pk_bf16_f32 v103, v30, v31
    v_cndmask_b32 v40, v100, v102, s[14:15]
    v_cndmask_b32 v41, v101, v103, s[14:15]
    v_cndmask_b32 v42, v102, v100, s[14:15]
    s_barrier
    buffer_store_dwordx4 v[140:143], v6, s[32:35], s61 offen offset:0 sc1
    v_cndmask_b32 v43, v103, v101, s[14:15]
    s_add_u32 s63, s66, 0
    buffer_store_dwordx4 v[40:43], v33, s[24:27], s63 offen sc1
    v_lshlrev_b32 v24, 16, v104
    v_and_b32 v25, s62, v104
    v_lshlrev_b32 v26, 16, v105
    v_and_b32 v27, s62, v105
    v_fma_f32 v24, v24, v16, v14
    v_fma_f32 v25, v25, v16, v14
    v_fma_f32 v26, v26, v16, v14
    v_fma_f32 v27, v27, v16, v14
    v_cvt_pk_bf16_f32 v104, v24, v25
    v_cvt_pk_bf16_f32 v105, v26, v27
    v_lshlrev_b32 v28, 16, v106
    v_and_b32 v29, s62, v106
    v_lshlrev_b32 v30, 16, v107
    v_and_b32 v31, s62, v107
    v_fma_f32 v28, v28, v20, v18
    v_fma_f32 v29, v29, v20, v18
    v_fma_f32 v30, v30, v20, v18
    v_fma_f32 v31, v31, v20, v18
    v_cvt_pk_bf16_f32 v106, v28, v29
    v_cvt_pk_bf16_f32 v107, v30, v31
    v_cndmask_b32 v44, v104, v106, s[14:15]
    v_cndmask_b32 v45, v105, v107, s[14:15]
    v_cndmask_b32 v46, v106, v104, s[14:15]
    v_cndmask_b32 v47, v107, v105, s[14:15]
    s_add_u32 s63, s66, 1024
    buffer_store_dwordx4 v[44:47], v33, s[24:27], s63 offen sc1
    v_lshlrev_b32 v24, 16, v108
    v_and_b32 v25, s62, v108
    v_lshlrev_b32 v26, 16, v109
    v_and_b32 v27, s62, v109
    v_fma_f32 v24, v24, v16, v14
    v_fma_f32 v25, v25, v16, v14
    v_fma_f32 v26, v26, v16, v14
    v_fma_f32 v27, v27, v16, v14
    v_cvt_pk_bf16_f32 v108, v24, v25
    v_cvt_pk_bf16_f32 v109, v26, v27
    v_lshlrev_b32 v28, 16, v110
    v_and_b32 v29, s62, v110
    v_lshlrev_b32 v30, 16, v111
    v_and_b32 v31, s62, v111
    v_fma_f32 v28, v28, v20, v18
    v_fma_f32 v29, v29, v20, v18
    v_fma_f32 v30, v30, v20, v18
    v_fma_f32 v31, v31, v20, v18
    v_cvt_pk_bf16_f32 v110, v28, v29
    v_cvt_pk_bf16_f32 v111, v30, v31
    v_cndmask_b32 v48, v108, v110, s[14:15]
    v_cndmask_b32 v49, v109, v111, s[14:15]
    v_cndmask_b32 v50, v110, v108, s[14:15]
    v_cndmask_b32 v51, v111, v109, s[14:15]
    s_add_u32 s63, s66, 2048
    buffer_store_dwordx4 v[48:51], v33, s[24:27], s63 offen sc1
    v_lshlrev_b32 v24, 16, v112
    v_and_b32 v25, s62, v112
    v_lshlrev_b32 v26, 16, v113
    v_and_b32 v27, s62, v113
    v_fma_f32 v24, v24, v16, v14
    v_fma_f32 v25, v25, v16, v14
    v_fma_f32 v26, v26, v16, v14
    v_fma_f32 v27, v27, v16, v14
    v_cvt_pk_bf16_f32 v112, v24, v25
    v_cvt_pk_bf16_f32 v113, v26, v27
    v_lshlrev_b32 v28, 16, v114
    v_and_b32 v29, s62, v114
    v_lshlrev_b32 v30, 16, v115
    v_and_b32 v31, s62, v115
    v_fma_f32 v28, v28, v20, v18
    v_fma_f32 v29, v29, v20, v18
    v_fma_f32 v30, v30, v20, v18
    v_fma_f32 v31, v31, v20, v18
    v_cvt_pk_bf16_f32 v114, v28, v29
    v_cvt_pk_bf16_f32 v115, v30, v31
    v_cndmask_b32 v52, v112, v114, s[14:15]
    v_cndmask_b32 v53, v113, v115, s[14:15]
    v_cndmask_b32 v54, v114, v112, s[14:15]
    v_cndmask_b32 v55, v115, v113, s[14:15]
    s_add_u32 s63, s66, 3072
    buffer_store_dwordx4 v[52:55], v33, s[24:27], s63 offen sc1
    v_lshlrev_b32 v24, 16, v116
    v_and_b32 v25, s62, v116
    v_lshlrev_b32 v26, 16, v117
    v_and_b32 v27, s62, v117
    v_fma_f32 v24, v24, v16, v14
    v_fma_f32 v25, v25, v16, v14
    v_fma_f32 v26, v26, v16, v14
    v_fma_f32 v27, v27, v16, v14
    v_cvt_pk_bf16_f32 v116, v24, v25
    v_cvt_pk_bf16_f32 v117, v26, v27
    v_lshlrev_b32 v28, 16, v118
    v_and_b32 v29, s62, v118
    v_lshlrev_b32 v30, 16, v119
    v_and_b32 v31, s62, v119
    v_fma_f32 v28, v28, v20, v18
    v_fma_f32 v29, v29, v20, v18
    v_fma_f32 v30, v30, v20, v18
    v_fma_f32 v31, v31, v20, v18
    v_cvt_pk_bf16_f32 v118, v28, v29
    s_barrier
    buffer_store_dwordx4 v[144:147], v6, s[32:35], s61 offen offset:1024 sc1
    v_cvt_pk_bf16_f32 v119, v30, v31
    v_cndmask_b32 v56, v116, v118, s[14:15]
    v_cndmask_b32 v57, v117, v119, s[14:15]
    v_cndmask_b32 v58, v118, v116, s[14:15]
    v_cndmask_b32 v59, v119, v117, s[14:15]
    v_lshlrev_b32 v24, 16, v120
    v_and_b32 v25, s62, v120
    v_lshlrev_b32 v26, 16, v121
    v_and_b32 v27, s62, v121
    v_fma_f32 v24, v24, v16, v14
    v_fma_f32 v25, v25, v16, v14
    v_fma_f32 v26, v26, v16, v14
    v_fma_f32 v27, v27, v16, v14
    v_cvt_pk_bf16_f32 v120, v24, v25
    v_cvt_pk_bf16_f32 v121, v26, v27
    v_lshlrev_b32 v28, 16, v122
    v_and_b32 v29, s62, v122
    v_lshlrev_b32 v30, 16, v123
    v_and_b32 v31, s62, v123
    v_fma_f32 v28, v28, v20, v18
    v_fma_f32 v29, v29, v20, v18
    v_fma_f32 v30, v30, v20, v18
    v_fma_f32 v31, v31, v20, v18
    v_cvt_pk_bf16_f32 v122, v28, v29
    v_cvt_pk_bf16_f32 v123, v30, v31
    v_cndmask_b32 v60, v120, v122, s[14:15]
    v_cndmask_b32 v61, v121, v123, s[14:15]
    v_cndmask_b32 v62, v122, v120, s[14:15]
    v_cndmask_b32 v63, v123, v121, s[14:15]
    v_lshlrev_b32 v24, 16, v124
    v_and_b32 v25, s62, v124
    v_lshlrev_b32 v26, 16, v125
    v_and_b32 v27, s62, v125
    v_fma_f32 v24, v24, v16, v14
    v_fma_f32 v25, v25, v16, v14
    v_fma_f32 v26, v26, v16, v14
    v_fma_f32 v27, v27, v16, v14
    v_cvt_pk_bf16_f32 v124, v24, v25
    v_cvt_pk_bf16_f32 v125, v26, v27
    v_lshlrev_b32 v28, 16, v126
    v_and_b32 v29, s62, v126
    v_lshlrev_b32 v30, 16, v127
    v_and_b32 v31, s62, v127
    v_fma_f32 v28, v28, v20, v18
    v_fma_f32 v29, v29, v20, v18
    v_fma_f32 v30, v30, v20, v18
    v_fma_f32 v31, v31, v20, v18
    v_cvt_pk_bf16_f32 v126, v28, v29
    v_cvt_pk_bf16_f32 v127, v30, v31
    v_cndmask_b32 v64, v124, v126, s[14:15]
    v_cndmask_b32 v65, v125, v127, s[14:15]
    v_cndmask_b32 v66, v126, v124, s[14:15]
    v_cndmask_b32 v67, v127, v125, s[14:15]
    v_lshlrev_b32 v24, 16, v128
    v_and_b32 v25, s62, v128
    v_lshlrev_b32 v26, 16, v129
    v_and_b32 v27, s62, v129
    v_fma_f32 v24, v24, v16, v14
    v_fma_f32 v25, v25, v16, v14
    v_fma_f32 v26, v26, v16, v14
    v_fma_f32 v27, v27, v16, v14
    v_cvt_pk_bf16_f32 v128, v24, v25
    v_cvt_pk_bf16_f32 v129, v26, v27
    v_lshlrev_b32 v28, 16, v130
    v_and_b32 v29, s62, v130
    v_lshlrev_b32 v30, 16, v131
    v_and_b32 v31, s62, v131
    v_fma_f32 v28, v28, v20, v18
    v_fma_f32 v29, v29, v20, v18
    v_fma_f32 v30, v30, v20, v18
    v_fma_f32 v31, v31, v20, v18
    v_cvt_pk_bf16_f32 v130, v28, v29
    v_cvt_pk_bf16_f32 v131, v30, v31
    v_cndmask_b32 v68, v128, v130, s[14:15]
    v_cndmask_b32 v69, v129, v131, s[14:15]
    v_cndmask_b32 v70, v130, v128, s[14:15]
    v_cndmask_b32 v71, v131, v129, s[14:15]
    v_lshlrev_b32 v24, 16, v132
    v_and_b32 v25, s62, v132
    v_lshlrev_b32 v26, 16, v133
    v_and_b32 v27, s62, v133
    v_fma_f32 v24, v24, v16, v14
    v_fma_f32 v25, v25, v16, v14
    v_fma_f32 v26, v26, v16, v14
    v_fma_f32 v27, v27, v16, v14
    v_cvt_pk_bf16_f32 v132, v24, v25
    v_cvt_pk_bf16_f32 v133, v26, v27
    v_lshlrev_b32 v28, 16, v134
    v_and_b32 v29, s62, v134
    v_lshlrev_b32 v30, 16, v135
    v_and_b32 v31, s62, v135
    v_fma_f32 v28, v28, v20, v18
    v_fma_f32 v29, v29, v20, v18
    v_fma_f32 v30, v30, v20, v18
    v_fma_f32 v31, v31, v20, v18
    v_cvt_pk_bf16_f32 v134, v28, v29
    v_cvt_pk_bf16_f32 v135, v30, v31
    v_cndmask_b32 v72, v132, v134, s[14:15]
    v_cndmask_b32 v73, v133, v135, s[14:15]
    v_cndmask_b32 v74, v134, v132, s[14:15]
    v_cndmask_b32 v75, v135, v133, s[14:15]
    s_lshr_b32 s4, s49, 3
    s_lshl_b32 s4, s4, 4
    s_add_u32 s4, s4, s48
    s_lshl_b32 s4, s4, 2
    s_add_u32 s68, s4, s51
    s_and_b32 s59, s49, 7
    s_sub_u32 s4, s68, 18
    s_lshr_b32 s12, s4, 3
    s_and_b32 s13, s4, 7
    s_mul_i32 s12, s12, 288
    s_lshl_b32 s9, s13, 5
    s_add_u32 s12, s12, s9
    s_mul_i32 s4, s4, 288
    s_sub_u32 s4, s4, 18304
    s_cmp_ge_u32 s13, 4
    s_cselect_b32 s9, 16, 0
    s_add_u32 s12, s12, s9
    s_cmp_ge_u32 s68, 82
    s_cselect_b32 s4, s4, s12
    s_cselect_b32 s5, 144, 16
    s_mov_b32 s6, 8
    s_mov_b32 s7, 4
    s_mov_b32 s8, 2
    s_lshr_b32 s9, s68, 1
    s_mul_i32 s9, s9, 72
    s_and_b32 s12, s68, 1
    s_lshl_b32 s12, s12, 3
    s_add_u32 s9, s9, s12
    s_cmp_lt_u32 s68, 16
    s_cselect_b32 s4, s9, s4
    s_cselect_b32 s5, 4, s5
    s_cselect_b32 s6, 36, s6
    s_cselect_b32 s7, 18, s7
    s_mul_i32 s9, s68, 288
    s_sub_u32 s9, s9, 4592
    s_and_b32 s12, s68, 0xfffffffe
    s_cmp_eq_u32 s12, 16
    s_cselect_b32 s4, s9, s4
    s_cselect_b32 s5, 36, s5
    s_cselect_b32 s6, 144, s6
    s_cselect_b32 s7, 72, s7
    s_cselect_b32 s8, 18, s8
    s_mov_b32 s30, 663552
    s_cmp_lt_u32 s68, 18
    s_cselect_b32 s28, s72, s76
    s_cselect_b32 s29, s73, s77
    s_cselect_b32 s30, s30, 2654208
    s_mul_i32 s4, s4, 1152
    s_mul_i32 s9, s59, 144
    s_add_u32 s4, s4, s9
    s_mul_i32 s9, s51, 4608
    s_add_u32 s9, s9, 129024
    s_waitcnt vmcnt(14)
    s_waitcnt vmcnt(6)
    s_barrier
    s_add_u32 s63, s66, 4096
    buffer_store_dwordx4 v[56:59], v33, s[24:27], s63 offen sc1
    s_add_u32 s63, s66, 5120
    buffer_store_dwordx4 v[60:63], v33, s[24:27], s63 offen sc1
    s_add_u32 s63, s66, 6144
    buffer_store_dwordx4 v[64:67], v33, s[24:27], s63 offen sc1
    s_add_u32 s63, s66, 7168
    buffer_store_dwordx4 v[68:71], v33, s[24:27], s63 offen sc1
    s_add_u32 s63, s66, 8192
    buffer_store_dwordx4 v[72:75], v33, s[24:27], s63 offen sc1
    v_mul_u32_u24 v1, 7282, v0
    v_lshrrev_b32 v1, 16, v1
    v_mul_u32_u24 v2, 9, v1
    v_sub_u32 v2, v0, v2
    v_lshlrev_b32 v2, 4, v2
    v_add_u32 v3, 0, v1
    v_and_b32 v4, 1, v3
    v_bfe_u32 v5, v3, 1, 1
    v_mad_u32_u24 v4, v5, s8, v4
    v_bfe_u32 v5, v3, 2, 1
    v_mad_u32_u24 v4, v5, s7, v4
    v_bfe_u32 v5, v3, 3, 1
    v_mad_u32_u24 v4, v5, s6, v4
    v_bfe_u32 v5, v3, 4, 1
    v_mad_u32_u24 v4, v5, s5, v4
    v_mul_u32_u24 v4, 1152, v4
    v_add_u32 v4, v4, v2
    s_add_u32 m0, s9, 0
    s_mov_b32 exec_hi, 0x7fffffff
    buffer_load_dwordx4 v4, s[28:31], s4 offen lds
    s_mov_b64 exec, -1
    v_add_u32 v3, 7, v1
    v_and_b32 v4, 1, v3
    v_bfe_u32 v5, v3, 1, 1
    v_mad_u32_u24 v4, v5, s8, v4
    v_bfe_u32 v5, v3, 2, 1
    v_mad_u32_u24 v4, v5, s7, v4
    v_bfe_u32 v5, v3, 3, 1
    v_mad_u32_u24 v4, v5, s6, v4
    v_bfe_u32 v5, v3, 4, 1
    v_mad_u32_u24 v4, v5, s5, v4
    v_mul_u32_u24 v4, 1152, v4
    v_add_u32 v4, v4, v2
    s_add_u32 m0, s9, 1008
    s_mov_b32 exec_hi, 0x7fffffff
    buffer_load_dwordx4 v4, s[28:31], s4 offen lds
    s_mov_b64 exec, -1
    v_add_u32 v3, 14, v1
    v_and_b32 v4, 1, v3
    v_bfe_u32 v5, v3, 1, 1
    v_mad_u32_u24 v4, v5, s8, v4
    v_bfe_u32 v5, v3, 2, 1
    v_mad_u32_u24 v4, v5, s7, v4
    v_bfe_u32 v5, v3, 3, 1
    v_mad_u32_u24 v4, v5, s6, v4
    v_bfe_u32 v5, v3, 4, 1
    v_mad_u32_u24 v4, v5, s5, v4
    v_mul_u32_u24 v4, 1152, v4
    v_add_u32 v4, v4, v2
    s_add_u32 m0, s9, 2016
    s_mov_b32 exec_hi, 0x7fffffff
    buffer_load_dwordx4 v4, s[28:31], s4 offen lds
    s_mov_b64 exec, -1
    v_add_u32 v3, 21, v1
    v_and_b32 v4, 1, v3
    v_bfe_u32 v5, v3, 1, 1
    v_mad_u32_u24 v4, v5, s8, v4
    v_bfe_u32 v5, v3, 2, 1
    v_mad_u32_u24 v4, v5, s7, v4
    v_bfe_u32 v5, v3, 3, 1
    v_mad_u32_u24 v4, v5, s6, v4
    v_bfe_u32 v5, v3, 4, 1
    v_mad_u32_u24 v4, v5, s5, v4
    v_mul_u32_u24 v4, 1152, v4
    v_add_u32 v4, v4, v2
    s_add_u32 m0, s9, 3024
    s_mov_b32 exec_hi, 0x7fffffff
    buffer_load_dwordx4 v4, s[28:31], s4 offen lds
    s_mov_b64 exec, -1
    v_add_u32 v3, 28, v1
    v_and_b32 v4, 1, v3
    v_bfe_u32 v5, v3, 1, 1
    v_mad_u32_u24 v4, v5, s8, v4
    v_bfe_u32 v5, v3, 2, 1
    v_mad_u32_u24 v4, v5, s7, v4
    v_bfe_u32 v5, v3, 3, 1
    v_mad_u32_u24 v4, v5, s6, v4
    v_bfe_u32 v5, v3, 4, 1
    v_mad_u32_u24 v4, v5, s5, v4
    v_mul_u32_u24 v4, 1152, v4
    v_add_u32 v4, v4, v2
    s_add_u32 m0, s9, 4032
    s_mov_b32 exec_hi, 0xf
    buffer_load_dwordx4 v4, s[28:31], s4 offen lds
    s_mov_b64 exec, -1
    v_lshrrev_b32 v241, 2, v0
    v_mul_u32_u24 v241, 144, v241
    v_and_b32 v242, 3, v0
    v_lshl_add_u32 v241, v242, 3, v241
    v_add_u32 v241, s9, v241
    v_lshrrev_b32 v240, 4, v0
    v_lshlrev_b32 v240, 7, v240
    v_and_b32 v242, 7, v0
    v_lshl_add_u32 v240, v242, 4, v240
    v_and_b32 v242, 8, v0
    v_lshl_add_u32 v240, v242, 24, v240
    v_add_u32 v240, 4096, v240
    s_waitcnt vmcnt(5)
    s_add_u32 s40, s46, 41590784
    s_addc_u32 s41, s47, 0
    s_mov_b32 s42, 15360
    s_mov_b32 s43, 0x00020000
    s_lshl_b32 s63, s49, 4
    s_add_u32 s63, s63, s48
    s_lshl_b32 s63, s63, 2
    s_add_u32 s63, s63, s51
    s_lshl_b32 s63, s63, 2
    v_mov_b32 v13, s71
    s_mov_b64 exec, 1
    buffer_store_dword v13, off, s[40:43], s63 offset:3072 sc1
    s_mov_b64 exec, -1
    s_waitcnt vmcnt(1)
    ds_read_b64_tr_b16 v[220:221], v241 offset:0
    ds_read_b64_tr_b16 v[222:223], v241 offset:2304
    ds_read_b64_tr_b16 v[224:225], v241 offset:32
    ds_read_b64_tr_b16 v[226:227], v241 offset:2336
    ds_read_b64_tr_b16 v[228:229], v241 offset:64
    ds_read_b64_tr_b16 v[230:231], v241 offset:2368
    ds_read_b64_tr_b16 v[232:233], v241 offset:96
    ds_read_b64_tr_b16 v[234:235], v241 offset:2400
    ds_read_b64_tr_b16 v[236:237], v241 offset:128
    ds_read_b64_tr_b16 v[238:239], v241 offset:2432
    s_waitcnt lgkmcnt(0)
    s_barrier
    s_add_u32 s20, s46, 37748736
    s_addc_u32 s21, s47, 0
    s_mov_b32 s22, 3317760
    s_mul_i32 s4, s59, 90
    s_add_u32 s4, s4, s68
    s_mul_i32 s4, s4, 4608
    s_cmp_lt_u32 s68, 90
    s_cselect_b32 s4, s4, 3317760
    s_mov_b32 s32, s48
    s_mov_b32 s33, s49
    s_mov_b32 s34, s50
    s_add_u32 s72, s46, 41590784
    s_addc_u32 s73, s47, 0
    s_mov_b32 s74, 15360
    s_mov_b32 s75, 0x00020000
    s_sub_u32 s38, s34, 4
    v_lshrrev_b32 v5, 3, v0
    v_and_b32 v6, 7, v0
    v_xor_b32 v6, v6, v5
    v_lshlrev_b32 v6, 4, v6
    s_lshl_b32 s40, s32, 7
    s_lshl_b32 s41, s38, 5
    s_add_u32 s40, s40, s41
    v_add_u32 v5, s40, v5
    v_lshlrev_b32 v5, 12, v5
    v_add_u32 v1, v5, v6
    v_add_u32 v2, 31744, v1
    v_add_u32 v3, 63488, v1
    v_add_u32 v4, 95232, v1
    s_mul_i32 s41, s38, 5
    s_cmp_eq_u32 s38, 3
    s_cselect_b32 s41, 14, s41
    s_lshl_b32 s41, s41, 10
    v_lshlrev_b32 v6, 4, v0
    v_add_u32 v5, s41, v6
    s_lshl_b32 s40, s38, 12
    s_add_u32 s41, s41, 16384
    s_mov_b32 s12, s10
    s_mov_b32 s13, s11
    s_mov_b32 s14, 8388608
    s_mov_b32 s15, 0x00020000
    s_mul_i32 s37, s33, 589824
    s_add_u32 s16, s46, s37
    s_addc_u32 s17, s47, 0
    s_mov_b32 s18, 589824
    s_mov_b32 s19, 0x00020000
    s_add_u32 s24, s46, 18874368
    s_addc_u32 s25, s47, 0
    s_mov_b32 s26, 11796480
    s_mov_b32 s27, 0x00020000
    s_add_u32 s28, s46, 30670848
    s_addc_u32 s29, s47, 0
    s_mov_b32 s30, 7077888
    s_mov_b32 s31, 0x00020000
    s_add_u32 m0, s40, 0
    s_movk_i32 s42, 0
    buffer_load_dwordx4 v1, s[12:15], s42 offen offset:0  lds
    buffer_load_dwordx4 v2, s[12:15], s42 offen offset:1024  lds
    buffer_load_dwordx4 v3, s[12:15], s42 offen offset:2048  lds
    buffer_load_dwordx4 v4, s[12:15], s42 offen offset:3072  lds
    s_add_u32 m0, s40, 34816
    s_movk_i32 s42, 128
    buffer_load_dwordx4 v1, s[12:15], s42 offen offset:0  lds
    buffer_load_dwordx4 v2, s[12:15], s42 offen offset:1024  lds
    buffer_load_dwordx4 v3, s[12:15], s42 offen offset:2048  lds
    buffer_load_dwordx4 v4, s[12:15], s42 offen offset:3072  lds
    s_add_u32 m0, s40, 69632
    s_movk_i32 s42, 256
    buffer_load_dwordx4 v1, s[12:15], s42 offen offset:0  lds
    buffer_load_dwordx4 v2, s[12:15], s42 offen offset:1024  lds
    buffer_load_dwordx4 v3, s[12:15], s42 offen offset:2048  lds
    buffer_load_dwordx4 v4, s[12:15], s42 offen offset:3072  lds
    s_add_u32 m0, s40, 104448
    s_movk_i32 s42, 384
    buffer_load_dwordx4 v1, s[12:15], s42 offen offset:0  lds
    buffer_load_dwordx4 v2, s[12:15], s42 offen offset:1024  lds
    buffer_load_dwordx4 v3, s[12:15], s42 offen offset:2048  lds
    buffer_load_dwordx4 v4, s[12:15], s42 offen offset:3072  lds
    v_lshlrev_b32 v7, 2, v0
    s_lshl_b32 s57, s33, 8
    s_mov_b32 s69, 0
L_pf1_0:
    buffer_load_dword v244, v7, s[72:75], s57 offen offset:3072 sc1
    s_add_u32 s69, s69, 1
    s_cmp_gt_u32 s69, 50000
    s_cbranch_scc1 L_pf1ok_0
    s_waitcnt vmcnt(0)
    v_xor_b32 v244, s71, v244
    v_cmp_ne_u32 vcc, 0, v244
    s_nop 4
    s_cbranch_vccz L_pf1ok_0
    s_sleep 2
    s_branch L_pf1_0
L_pf1ok_0:
    s_add_u32 m0, s41, 0
    s_mov_b32 s43, 0
    buffer_load_dwordx4 v5, s[16:19], s43 offen offset:0 sc1 lds
    buffer_load_dwordx4 v5, s[16:19], s43 offen offset:1024 sc1 lds
    buffer_load_dwordx4 v5, s[16:19], s43 offen offset:2048 sc1 lds
    buffer_load_dwordx4 v5, s[16:19], s43 offen offset:3072 sc1 lds
    s_add_u32 m0, s41, 34816
    s_mov_b32 s43, 18432
    buffer_load_dwordx4 v5, s[16:19], s43 offen offset:0 sc1 lds
    buffer_load_dwordx4 v5, s[16:19], s43 offen offset:1024 sc1 lds
    buffer_load_dwordx4 v5, s[16:19], s43 offen offset:2048 sc1 lds
    buffer_load_dwordx4 v5, s[16:19], s43 offen offset:3072 sc1 lds
    s_add_u32 m0, s41, 69632
    s_mov_b32 s43, 36864
    buffer_load_dwordx4 v5, s[16:19], s43 offen offset:0 sc1 lds
    buffer_load_dwordx4 v5, s[16:19], s43 offen offset:1024 sc1 lds
    buffer_load_dwordx4 v5, s[16:19], s43 offen offset:2048 sc1 lds
    buffer_load_dwordx4 v5, s[16:19], s43 offen offset:3072 sc1 lds
    s_lshr_b32 s50, s2, 3
    s_and_b32 s51, s2, 7
    s_mul_i32 s52, s51, 4608
    s_lshl_b32 s53, s50, 1
    s_mul_i32 s53, s53, 110592
    v_lshrrev_b32 v216, 5, v0
    v_mul_u32_u24 v216, 110592, v216
    v_and_b32 v8, 31, v0
    v_lshl_add_u32 v216, v8, 4, v216
    v_add_u32 v216, s53, v216
    s_mul_i32 s54, s38, 192
    s_sub_u32 s53, s53, 110592
    v_add_u32 v7, s54, v0
    v_mul_u32_u24 v8, 820, v7
    v_lshrrev_b32 v8, 16, v8
    v_mul_u32_u24 v9, 80, v8
    v_sub_u32 v7, v7, v9
    v_add_u32 v7, 16, v7
    v_lshrrev_b32 v9, 5, v7
    v_mul_u32_u24 v9, 110592, v9
    v_lshl_add_u32 v9, v8, 9, v9
    v_and_b32 v7, 31, v7
    v_lshl_add_u32 v9, v7, 4, v9
    v_add_u32 v213, s53, v9
    v_add_u32 v7, s54, v0
    v_add_u32 v7, 64, v7
    v_mul_u32_u24 v8, 820, v7
    v_lshrrev_b32 v8, 16, v8
    v_mul_u32_u24 v9, 80, v8
    v_sub_u32 v7, v7, v9
    v_add_u32 v7, 16, v7
    v_lshrrev_b32 v9, 5, v7
    v_mul_u32_u24 v9, 110592, v9
    v_lshl_add_u32 v9, v8, 9, v9
    v_and_b32 v7, 31, v7
    v_lshl_add_u32 v9, v7, 4, v9
    v_add_u32 v214, s53, v9
    v_add_u32 v7, s54, v0
    v_add_u32 v7, 128, v7
    v_mul_u32_u24 v8, 820, v7
    v_lshrrev_b32 v8, 16, v8
    v_mul_u32_u24 v9, 80, v8
    v_sub_u32 v7, v7, v9
    v_add_u32 v7, 16, v7
    v_lshrrev_b32 v9, 5, v7
    v_mul_u32_u24 v9, 110592, v9
    v_lshl_add_u32 v9, v8, 9, v9
    v_and_b32 v7, 31, v7
    v_lshl_add_u32 v9, v7, 4, v9
    v_add_u32 v215, s53, v9
    s_mul_i32 s53, s38, 3072
    v_lshrrev_b32 v9, 2, v0
    s_lshl_b32 s54, s38, 4
    v_add_u32 v9, s54, v9
    s_lshl_b32 s54, s50, 6
    v_add_u32 v10, s54, v9
    v_and_b32 v11, 3, v0
    v_mul_u32_u24 v12, 36, v11
    v_lshlrev_b32 v13, 4, v9
    v_add_u32 v13, 139296, v13
    s_movk_i32 s55, 1280
    v_add_u32 v14, 0, v12
    v_lshrrev_b32 v15, 4, v14
    v_mad_u32_u24 v204, v15, s55, v13
    v_and_b32 v14, 15, v14
    v_add_u32 v204, v204, v14
    v_add_u32 v14, 4, v12
    v_lshrrev_b32 v15, 4, v14
    v_mad_u32_u24 v205, v15, s55, v13
    v_and_b32 v14, 15, v14
    v_add_u32 v205, v205, v14
    v_add_u32 v14, 8, v12
    v_lshrrev_b32 v15, 4, v14
    v_mad_u32_u24 v206, v15, s55, v13
    v_and_b32 v14, 15, v14
    v_add_u32 v206, v206, v14
    v_add_u32 v14, 12, v12
    v_lshrrev_b32 v15, 4, v14
    v_mad_u32_u24 v207, v15, s55, v13
    v_and_b32 v14, 15, v14
    v_add_u32 v207, v207, v14
    v_add_u32 v14, 16, v12
    v_lshrrev_b32 v15, 4, v14
    v_mad_u32_u24 v208, v15, s55, v13
    v_and_b32 v14, 15, v14
    v_add_u32 v208, v208, v14
    v_add_u32 v14, 20, v12
    v_lshrrev_b32 v15, 4, v14
    v_mad_u32_u24 v209, v15, s55, v13
    v_and_b32 v14, 15, v14
    v_add_u32 v209, v209, v14
    v_add_u32 v14, 24, v12
    v_lshrrev_b32 v15, 4, v14
    v_mad_u32_u24 v210, v15, s55, v13
    v_and_b32 v14, 15, v14
    v_add_u32 v210, v210, v14
    v_add_u32 v14, 28, v12
    v_lshrrev_b32 v15, 4, v14
    v_mad_u32_u24 v211, v15, s55, v13
    v_and_b32 v14, 15, v14
    v_add_u32 v211, v211, v14
    v_add_u32 v14, 32, v12
    v_lshrrev_b32 v15, 4, v14
    v_mad_u32_u24 v212, v15, s55, v13
    v_and_b32 v14, 15, v14
    v_add_u32 v212, v212, v14
    s_mov_b32 s56, 0xffff0000
    v_mov_b32 v138, 0xc0135761
    s_lshr_b32 s54, s50, 1
    s_lshl_b32 s54, s54, 7
    s_max_u32 s57, s50, 1
    s_sub_u32 s57, s57, 1
    s_lshr_b32 s57, s57, 1
    s_lshl_b32 s57, s57, 7
    v_mov_b32 v248, s54
    v_mov_b32 v249, s57
    v_cmp_lt_u32 vcc, 31, v0
    s_nop 1
    v_cndmask_b32 v248, v248, v249, vcc
    v_and_b32 v249, 15, v0
    v_lshl_add_u32 v248, v249, 2, v248
    v_add_u32 v248, 7168, v248
    s_waitcnt vmcnt(8)
    s_barrier
    s_mul_i32 s37, s38, 9216
    s_add_u32 s37, s37, 126976
    v_add_u32 v7, s37, v6
    ds_read_b128 v[160:163], v7 offset:0
    ds_read_b128 v[164:167], v7 offset:1024
    ds_read_b128 v[168:171], v7 offset:2048
    ds_read_b128 v[172:175], v7 offset:3072
    ds_read_b128 v[176:179], v7 offset:4096
    ds_read_b128 v[180:183], v7 offset:5120
    ds_read_b128 v[184:187], v7 offset:6144
    ds_read_b128 v[188:191], v7 offset:7168
    ds_read_b128 v[192:195], v7 offset:8192
    s_waitcnt vmcnt(4)
    s_waitcnt lgkmcnt(0)
    s_barrier
    s_add_u32 m0, s41, 104448
    s_mov_b32 s43, 55296
    buffer_load_dwordx4 v5, s[16:19], s43 offen offset:0 sc1 lds
    buffer_load_dwordx4 v5, s[16:19], s43 offen offset:1024 sc1 lds
    buffer_load_dwordx4 v5, s[16:19], s43 offen offset:2048 sc1 lds
    buffer_load_dwordx4 v5, s[16:19], s43 offen offset:3072 sc1 lds
    s_add_u32 m0, s40, 0
    s_movk_i32 s42, 512
    buffer_load_dwordx4 v1, s[12:15], s42 offen offset:0  lds
    buffer_load_dwordx4 v2, s[12:15], s42 offen offset:1024  lds
    buffer_load_dwordx4 v3, s[12:15], s42 offen offset:2048  lds
    buffer_load_dwordx4 v4, s[12:15], s42 offen offset:3072  lds
    s_add_u32 m0, s41, 0
    s_mov_b32 s43, 73728
    buffer_load_dwordx4 v5, s[16:19], s43 offen offset:0 sc1 lds
    buffer_load_dwordx4 v5, s[16:19], s43 offen offset:1024 sc1 lds
    buffer_load_dwordx4 v5, s[16:19], s43 offen offset:2048 sc1 lds
    buffer_load_dwordx4 v5, s[16:19], s43 offen offset:3072 sc1 lds
    buffer_store_dwordx4 v[148:151], v6, s[28:31], s61 offen offset:2048 sc1
    buffer_store_dwordx4 v[152:155], v6, s[28:31], s61 offen offset:3072 sc1
    s_waitcnt vmcnt(14)
    s_barrier
    s_add_u32 m0, s40, 34816
    s_movk_i32 s42, 640
    buffer_load_dwordx4 v1, s[12:15], s42 offen offset:0  lds
    buffer_load_dwordx4 v2, s[12:15], s42 offen offset:1024  lds
    buffer_load_dwordx4 v3, s[12:15], s42 offen offset:2048  lds
    buffer_load_dwordx4 v4, s[12:15], s42 offen offset:3072  lds
    s_add_u32 m0, s41, 34816
    s_mov_b32 s43, 92160
    buffer_load_dwordx4 v5, s[16:19], s43 offen offset:0 sc1 lds
    buffer_load_dwordx4 v5, s[16:19], s43 offen offset:1024 sc1 lds
    buffer_load_dwordx4 v5, s[16:19], s43 offen offset:2048 sc1 lds
    buffer_load_dwordx4 v5, s[16:19], s43 offen offset:3072 sc1 lds
    buffer_store_dwordx4 v[156:159], v6, s[28:31], s70 offen offset:0 sc1
    buffer_store_dwordx4 v[196:199], v6, s[28:31], s70 offen offset:1024 sc1
    s_waitcnt vmcnt(20)
    s_barrier
    s_add_u32 m0, s40, 69632
    s_movk_i32 s42, 768
    buffer_load_dwordx4 v1, s[12:15], s42 offen offset:0  lds
    buffer_load_dwordx4 v2, s[12:15], s42 offen offset:1024  lds
    buffer_load_dwordx4 v3, s[12:15], s42 offen offset:2048  lds
    buffer_load_dwordx4 v4, s[12:15], s42 offen offset:3072  lds
    s_add_u32 m0, s41, 69632
    s_mov_b32 s43, 110592
    buffer_load_dwordx4 v5, s[16:19], s43 offen offset:0 sc1 lds
    buffer_load_dwordx4 v5, s[16:19], s43 offen offset:1024 sc1 lds
    buffer_load_dwordx4 v5, s[16:19], s43 offen offset:2048 sc1 lds
    buffer_load_dwordx4 v5, s[16:19], s43 offen offset:3072 sc1 lds
    buffer_store_dwordx4 v[200:203], v6, s[28:31], s70 offen offset:2048 sc1
    s_waitcnt vmcnt(21)
    s_barrier
    s_add_u32 m0, s40, 104448
    s_movk_i32 s42, 896
    buffer_load_dwordx4 v1, s[12:15], s42 offen offset:0  lds
    buffer_load_dwordx4 v2, s[12:15], s42 offen offset:1024  lds
    buffer_load_dwordx4 v3, s[12:15], s42 offen offset:2048  lds
    buffer_load_dwordx4 v4, s[12:15], s42 offen offset:3072  lds
    s_add_u32 m0, s41, 104448
    s_mov_b32 s43, 129024
    buffer_load_dwordx4 v5, s[16:19], s43 offen offset:0 sc1 lds
    buffer_load_dwordx4 v5, s[16:19], s43 offen offset:1024 sc1 lds
    buffer_load_dwordx4 v5, s[16:19], s43 offen offset:2048 sc1 lds
    buffer_load_dwordx4 v5, s[16:19], s43 offen offset:3072 sc1 lds
    s_waitcnt vmcnt(19)
    s_barrier
    s_add_u32 m0, s40, 0
    s_movk_i32 s42, 1024
    buffer_load_dwordx4 v1, s[12:15], s42 offen offset:0  lds
    buffer_load_dwordx4 v2, s[12:15], s42 offen offset:1024  lds
    buffer_load_dwordx4 v3, s[12:15], s42 offen offset:2048  lds
    buffer_load_dwordx4 v4, s[12:15], s42 offen offset:3072  lds
    s_add_u32 m0, s41, 0
    s_mov_b32 s43, 147456
    buffer_load_dwordx4 v5, s[16:19], s43 offen offset:0 sc1 lds
    buffer_load_dwordx4 v5, s[16:19], s43 offen offset:1024 sc1 lds
    buffer_load_dwordx4 v5, s[16:19], s43 offen offset:2048 sc1 lds
    buffer_load_dwordx4 v5, s[16:19], s43 offen offset:3072 sc1 lds
    s_waitcnt vmcnt(16)
    s_barrier
    s_add_u32 m0, s40, 34816
    s_movk_i32 s42, 1152
    buffer_load_dwordx4 v1, s[12:15], s42 offen offset:0  lds
    buffer_load_dwordx4 v2, s[12:15], s42 offen offset:1024  lds
    buffer_load_dwordx4 v3, s[12:15], s42 offen offset:2048  lds
    buffer_load_dwordx4 v4, s[12:15], s42 offen offset:3072  lds
    s_add_u32 m0, s41, 34816
    s_mov_b32 s43, 165888
    buffer_load_dwordx4 v5, s[16:19], s43 offen offset:0 sc1 lds
    buffer_load_dwordx4 v5, s[16:19], s43 offen offset:1024 sc1 lds
    buffer_load_dwordx4 v5, s[16:19], s43 offen offset:2048 sc1 lds
    buffer_load_dwordx4 v5, s[16:19], s43 offen offset:3072 sc1 lds
    buffer_store_dwordx4 v[220:223], v6, s[20:23], s4 offen offset:0 sc1
    s_waitcnt vmcnt(17)
    s_barrier
    s_add_u32 m0, s40, 69632
    s_movk_i32 s42, 1280
    buffer_load_dwordx4 v1, s[12:15], s42 offen offset:0  lds
    buffer_load_dwordx4 v2, s[12:15], s42 offen offset:1024  lds
    buffer_load_dwordx4 v3, s[12:15], s42 offen offset:2048  lds
    buffer_load_dwordx4 v4, s[12:15], s42 offen offset:3072  lds
    s_add_u32 m0, s41, 69632
    s_mov_b32 s43, 184320
    buffer_load_dwordx4 v5, s[16:19], s43 offen offset:0 sc1 lds
    buffer_load_dwordx4 v5, s[16:19], s43 offen offset:1024 sc1 lds
    buffer_load_dwordx4 v5, s[16:19], s43 offen offset:2048 sc1 lds
    buffer_load_dwordx4 v5, s[16:19], s43 offen offset:3072 sc1 lds
    buffer_store_dwordx4 v[224:227], v6, s[20:23], s4 offen offset:1024 sc1
    s_waitcnt vmcnt(18)
    s_barrier
    s_add_u32 m0, s40, 104448
    s_movk_i32 s42, 1408
    buffer_load_dwordx4 v1, s[12:15], s42 offen offset:0  lds
    buffer_load_dwordx4 v2, s[12:15], s42 offen offset:1024  lds
    buffer_load_dwordx4 v3, s[12:15], s42 offen offset:2048  lds
    buffer_load_dwordx4 v4, s[12:15], s42 offen offset:3072  lds
    s_add_u32 m0, s41, 104448
    s_mov_b32 s43, 202752
    buffer_load_dwordx4 v5, s[16:19], s43 offen offset:0 sc1 lds
    buffer_load_dwordx4 v5, s[16:19], s43 offen offset:1024 sc1 lds
    buffer_load_dwordx4 v5, s[16:19], s43 offen offset:2048 sc1 lds
    buffer_load_dwordx4 v5, s[16:19], s43 offen offset:3072 sc1 lds
    buffer_store_dwordx4 v[228:231], v6, s[20:23], s4 offen offset:2048 sc1
    s_waitcnt vmcnt(19)
    s_barrier
    s_add_u32 m0, s40, 0
    s_movk_i32 s42, 1536
    buffer_load_dwordx4 v1, s[12:15], s42 offen offset:0  lds
    buffer_load_dwordx4 v2, s[12:15], s42 offen offset:1024  lds
    buffer_load_dwordx4 v3, s[12:15], s42 offen offset:2048  lds
    buffer_load_dwordx4 v4, s[12:15], s42 offen offset:3072  lds
    s_add_u32 m0, s41, 0
    s_mov_b32 s43, 221184
    buffer_load_dwordx4 v5, s[16:19], s43 offen offset:0 sc1 lds
    buffer_load_dwordx4 v5, s[16:19], s43 offen offset:1024 sc1 lds
    buffer_load_dwordx4 v5, s[16:19], s43 offen offset:2048 sc1 lds
    buffer_load_dwordx4 v5, s[16:19], s43 offen offset:3072 sc1 lds
    buffer_load_dword v244, v248, s[72:75], 0 offen offset:0 sc1
    s_waitcnt vmcnt(19)
    s_barrier
    s_waitcnt vmcnt(0)
    v_xor_b32 v244, s71, v244
    v_cmp_ne_u32 vcc, 0, v244
    s_nop 4
    s_cbranch_vccz L_pfaok_0
    s_mov_b32 s69, 0
L_pfa_0:
    buffer_load_dword v244, v248, s[72:75], 0 offen offset:0 sc1
    s_add_u32 s69, s69, 1
    s_cmp_gt_u32 s69, 50000
    s_cbranch_scc1 L_pfaok_0
    s_waitcnt vmcnt(0)
    v_xor_b32 v244, s71, v244
    v_cmp_ne_u32 vcc, 0, v244
    s_nop 4
    s_cbranch_vccz L_pfaok_0
    s_sleep 2
    s_branch L_pfa_0
L_pfaok_0:
    s_add_u32 s54, s38, 0
    s_min_u32 s54, s54, 8
    s_mul_i32 s57, s54, 1280
    s_add_u32 m0, s57, 151808
    s_lshl_b32 s54, s54, 9
    s_add_u32 s54, s54, s52
    buffer_load_dwordx4 v216, s[28:31], s54 offen sc1 lds
    s_add_u32 s54, s38, 4
    s_min_u32 s54, s54, 8
    s_mul_i32 s57, s54, 1280
    s_add_u32 m0, s57, 151808
    s_lshl_b32 s54, s54, 9
    s_add_u32 s54, s54, s52
    buffer_load_dwordx4 v216, s[28:31], s54 offen sc1 lds
    s_add_u32 s54, s38, 8
    s_min_u32 s54, s54, 8
    s_mul_i32 s57, s54, 1280
    s_add_u32 m0, s57, 151808
    s_lshl_b32 s54, s54, 9
    s_add_u32 s54, s54, s52
    buffer_load_dwordx4 v216, s[28:31], s54 offen sc1 lds
    s_add_u32 m0, s40, 34816
    s_movk_i32 s42, 1664
    buffer_load_dwordx4 v1, s[12:15], s42 offen offset:0  lds
    buffer_load_dwordx4 v2, s[12:15], s42 offen offset:1024  lds
    buffer_load_dwordx4 v3, s[12:15], s42 offen offset:2048  lds
    buffer_load_dwordx4 v4, s[12:15], s42 offen offset:3072  lds
    s_add_u32 m0, s41, 34816
    s_mov_b32 s43, 239616
    buffer_load_dwordx4 v5, s[16:19], s43 offen offset:0 sc1 lds
    buffer_load_dwordx4 v5, s[16:19], s43 offen offset:1024 sc1 lds
    buffer_load_dwordx4 v5, s[16:19], s43 offen offset:2048 sc1 lds
    buffer_load_dwordx4 v5, s[16:19], s43 offen offset:3072 sc1 lds
    s_barrier
    s_add_u32 s54, s52, 36864
    s_add_u32 m0, s53, 139264
    s_nop 0
    buffer_load_dwordx4 v213, s[28:31], s54 offen sc1 lds
    s_add_u32 m0, s53, 140288
    s_nop 0
    buffer_load_dwordx4 v214, s[28:31], s54 offen sc1 lds
    s_add_u32 m0, s53, 141312
    s_nop 0
    buffer_load_dwordx4 v215, s[28:31], s54 offen sc1 lds
    s_add_u32 m0, s40, 69632
    s_movk_i32 s42, 1792
    buffer_load_dwordx4 v1, s[12:15], s42 offen offset:0  lds
    buffer_load_dwordx4 v2, s[12:15], s42 offen offset:1024  lds
    buffer_load_dwordx4 v3, s[12:15], s42 offen offset:2048  lds
    buffer_load_dwordx4 v4, s[12:15], s42 offen offset:3072  lds
    s_add_u32 m0, s41, 69632
    s_mov_b32 s43, 258048
    buffer_load_dwordx4 v5, s[16:19], s43 offen offset:0 sc1 lds
    buffer_load_dwordx4 v5, s[16:19], s43 offen offset:1024 sc1 lds
    buffer_load_dwordx4 v5, s[16:19], s43 offen offset:2048 sc1 lds
    buffer_load_dwordx4 v5, s[16:19], s43 offen offset:3072 sc1 lds
    s_barrier
    s_add_u32 m0, s40, 104448
    s_movk_i32 s42, 1920
    buffer_load_dwordx4 v1, s[12:15], s42 offen offset:0  lds
    buffer_load_dwordx4 v2, s[12:15], s42 offen offset:1024  lds
    buffer_load_dwordx4 v3, s[12:15], s42 offen offset:2048  lds
    buffer_load_dwordx4 v4, s[12:15], s42 offen offset:3072  lds
    s_add_u32 m0, s41, 104448
    s_mov_b32 s43, 276480
    buffer_load_dwordx4 v5, s[16:19], s43 offen offset:0 sc1 lds
    buffer_load_dwordx4 v5, s[16:19], s43 offen offset:1024 sc1 lds
    buffer_load_dwordx4 v5, s[16:19], s43 offen offset:2048 sc1 lds
    buffer_load_dwordx4 v5, s[16:19], s43 offen offset:3072 sc1 lds
    s_waitcnt vmcnt(19)
    s_waitcnt vmcnt(16)
    s_barrier
    s_add_u32 m0, s40, 0
    s_movk_i32 s42, 2048
    buffer_load_dwordx4 v1, s[12:15], s42 offen offset:0  lds
    ds_read_b32 v16, v204 offset:12512
    ds_read_b32 v17, v205 offset:12512
    ds_read_b32 v18, v206 offset:12512
    ds_read_b32 v19, v207 offset:12512
    ds_read_b32 v20, v208 offset:12512
    buffer_load_dwordx4 v2, s[12:15], s42 offen offset:1024  lds
    ds_read_b32 v21, v209 offset:12512
    ds_read_b32 v22, v210 offset:12512
    ds_read_b32 v23, v211 offset:12512
    ds_read_b32 v24, v212 offset:12512
    buffer_load_dwordx4 v3, s[12:15], s42 offen offset:2048  lds
    buffer_load_dwordx4 v4, s[12:15], s42 offen offset:3072  lds
    s_waitcnt lgkmcnt(0)
    v_lshlrev_b32 v140, 16, v16
    v_and_b32 v141, s56, v16
    v_lshlrev_b32 v142, 16, v17
    v_and_b32 v143, s56, v17
    v_lshlrev_b32 v144, 16, v18
    s_add_u32 m0, s41, 0
    s_mov_b32 s43, 294912
    buffer_load_dwordx4 v5, s[16:19], s43 offen offset:0 sc1 lds
    v_and_b32 v145, s56, v18
    v_lshlrev_b32 v146, 16, v19
    v_and_b32 v147, s56, v19
    v_lshlrev_b32 v148, 16, v20
    v_and_b32 v149, s56, v20
    v_lshlrev_b32 v150, 16, v21
    v_and_b32 v151, s56, v21
    buffer_load_dwordx4 v5, s[16:19], s43 offen offset:1024 sc1 lds
    v_lshlrev_b32 v152, 16, v22
    v_and_b32 v153, s56, v22
    v_lshlrev_b32 v154, 16, v23
    v_and_b32 v155, s56, v23
    v_lshlrev_b32 v156, 16, v24
    v_and_b32 v157, s56, v24
    ds_read2_b32 v[28:29], v204 offset0:56 offset1:48
    buffer_load_dwordx4 v5, s[16:19], s43 offen offset:2048 sc1 lds
    ds_read2_b32 v[30:31], v205 offset0:56 offset1:48
    ds_read2_b32 v[32:33], v206 offset0:56 offset1:48
    ds_read2_b32 v[34:35], v207 offset0:56 offset1:48
    ds_read2_b32 v[36:37], v208 offset0:56 offset1:48
    ds_read2_b32 v[38:39], v209 offset0:56 offset1:48
    buffer_load_dwordx4 v5, s[16:19], s43 offen offset:3072 sc1 lds
    ds_read2_b32 v[40:41], v210 offset0:56 offset1:48
    ds_read2_b32 v[42:43], v211 offset0:56 offset1:48
    ds_read2_b32 v[44:45], v212 offset0:56 offset1:48
    ds_read2_b32 v[46:47], v204 offset0:40 offset1:32
    ds_read2_b32 v[48:49], v205 offset0:40 offset1:32
    ds_read2_b32 v[50:51], v206 offset0:40 offset1:32
    ds_read2_b32 v[52:53], v207 offset0:40 offset1:32
    s_waitcnt vmcnt(16)
    s_barrier
    s_add_u32 s54, s52, 73728
    s_add_u32 m0, s53, 151552
    s_nop 0
    buffer_load_dwordx4 v213, s[28:31], s54 offen sc1 lds
    s_add_u32 m0, s53, 152576
    s_nop 0
    buffer_load_dwordx4 v214, s[28:31], s54 offen sc1 lds
    s_add_u32 m0, s53, 153600
    s_nop 0
    buffer_load_dwordx4 v215, s[28:31], s54 offen sc1 lds
    s_add_u32 m0, s40, 34816
    s_movk_i32 s42, 2176
    buffer_load_dwordx4 v1, s[12:15], s42 offen offset:0  lds
    ds_read2_b32 v[54:55], v208 offset0:40 offset1:32
    ds_read2_b32 v[56:57], v209 offset0:40 offset1:32
    ds_read2_b32 v[58:59], v210 offset0:40 offset1:32
    ds_read2_b32 v[60:61], v211 offset0:40 offset1:32
    ds_read2_b32 v[62:63], v212 offset0:40 offset1:32
    buffer_load_dwordx4 v2, s[12:15], s42 offen offset:1024  lds
    s_waitcnt lgkmcnt(9)
    v_lshlrev_b32 v126, 16, v28
    v_and_b32 v127, s56, v28
    v_mul_f32 v130, v126, v140
    v_mul_f32 v131, v127, v141
    v_lshlrev_b32 v128, 16, v30
    v_and_b32 v129, s56, v30
    v_mul_f32 v132, v128, v142
    buffer_load_dwordx4 v3, s[12:15], s42 offen offset:2048  lds
    v_mul_f32 v133, v129, v143
    v_lshlrev_b32 v126, 16, v32
    v_and_b32 v127, s56, v32
    v_fmac_f32 v130, v126, v144
    v_fmac_f32 v131, v127, v145
    v_lshlrev_b32 v128, 16, v34
    v_and_b32 v129, s56, v34
    buffer_load_dwordx4 v4, s[12:15], s42 offen offset:3072  lds
    v_fmac_f32 v132, v128, v146
    v_fmac_f32 v133, v129, v147
    v_lshlrev_b32 v126, 16, v36
    v_and_b32 v127, s56, v36
    v_fmac_f32 v130, v126, v148
    v_fmac_f32 v131, v127, v149
    v_lshlrev_b32 v128, 16, v38
    s_add_u32 m0, s41, 34816
    s_mov_b32 s43, 313344
    buffer_load_dwordx4 v5, s[16:19], s43 offen offset:0 sc1 lds
    v_and_b32 v129, s56, v38
    v_fmac_f32 v132, v128, v150
    v_fmac_f32 v133, v129, v151
    v_lshlrev_b32 v126, 16, v40
    v_and_b32 v127, s56, v40
    v_fmac_f32 v130, v126, v152
    v_fmac_f32 v131, v127, v153
    buffer_load_dwordx4 v5, s[16:19], s43 offen offset:1024 sc1 lds
    v_lshlrev_b32 v128, 16, v42
    v_and_b32 v129, s56, v42
    v_fmac_f32 v132, v128, v154
    v_fmac_f32 v133, v129, v155
    v_lshlrev_b32 v126, 16, v44
    v_and_b32 v127, s56, v44
    v_fmac_f32 v130, v126, v156
    buffer_load_dwordx4 v5, s[16:19], s43 offen offset:2048 sc1 lds
    v_fmac_f32 v131, v127, v157
    v_add_f32 v130, v130, v131
    v_add_f32 v132, v132, v133
    v_add_f32 v100, v130, v132
    ds_read2_b32 v[64:65], v204 offset0:24 offset1:16
    ds_read2_b32 v[66:67], v205 offset0:24 offset1:16
    buffer_load_dwordx4 v5, s[16:19], s43 offen offset:3072 sc1 lds
    ds_read2_b32 v[68:69], v206 offset0:24 offset1:16
    ds_read2_b32 v[70:71], v207 offset0:24 offset1:16
    ds_read2_b32 v[72:73], v208 offset0:24 offset1:16
    ds_read2_b32 v[74:75], v209 offset0:24 offset1:16
    ds_read2_b32 v[76:77], v210 offset0:24 offset1:16
    ds_read2_b32 v[78:79], v211 offset0:24 offset1:16
    ds_read2_b32 v[80:81], v212 offset0:24 offset1:16
    v_lshlrev_b32 v126, 16, v29
    s_waitcnt vmcnt(19)
    s_barrier
    s_add_u32 m0, s40, 69632
    s_movk_i32 s42, 2304
    buffer_load_dwordx4 v1, s[12:15], s42 offen offset:0  lds
    v_and_b32 v127, s56, v29
    v_mul_f32 v130, v126, v140
    v_mul_f32 v131, v127, v141
    v_lshlrev_b32 v128, 16, v31
    v_and_b32 v129, s56, v31
    v_mul_f32 v132, v128, v142
    v_mul_f32 v133, v129, v143
    buffer_load_dwordx4 v2, s[12:15], s42 offen offset:1024  lds
    v_lshlrev_b32 v126, 16, v33
    v_and_b32 v127, s56, v33
    v_fmac_f32 v130, v126, v144
    v_fmac_f32 v131, v127, v145
    v_lshlrev_b32 v128, 16, v35
    v_and_b32 v129, s56, v35
    v_fmac_f32 v132, v128, v146
    buffer_load_dwordx4 v3, s[12:15], s42 offen offset:2048  lds
    v_fmac_f32 v133, v129, v147
    v_lshlrev_b32 v126, 16, v37
    v_and_b32 v127, s56, v37
    v_fmac_f32 v130, v126, v148
    v_fmac_f32 v131, v127, v149
    v_lshlrev_b32 v128, 16, v39
    v_and_b32 v129, s56, v39
    buffer_load_dwordx4 v4, s[12:15], s42 offen offset:3072  lds
    v_fmac_f32 v132, v128, v150
    v_fmac_f32 v133, v129, v151
    v_lshlrev_b32 v126, 16, v41
    v_and_b32 v127, s56, v41
    v_fmac_f32 v130, v126, v152
    v_fmac_f32 v131, v127, v153
    v_lshlrev_b32 v128, 16, v43
    s_add_u32 m0, s41, 69632
    s_mov_b32 s43, 331776
    buffer_load_dwordx4 v5, s[16:19], s43 offen offset:0 sc1 lds
    v_and_b32 v129, s56, v43
    v_fmac_f32 v132, v128, v154
    v_fmac_f32 v133, v129, v155
    v_lshlrev_b32 v126, 16, v45
    v_and_b32 v127, s56, v45
    v_fmac_f32 v130, v126, v156
    v_fmac_f32 v131, v127, v157
    buffer_load_dwordx4 v5, s[16:19], s43 offen offset:1024 sc1 lds
    v_add_f32 v130, v130, v131
    v_add_f32 v132, v132, v133
    v_add_f32 v101, v130, v132
    s_waitcnt lgkmcnt(9)
    v_lshlrev_b32 v126, 16, v46
    v_and_b32 v127, s56, v46
    v_mul_f32 v130, v126, v140
    v_mul_f32 v131, v127, v141
    buffer_load_dwordx4 v5, s[16:19], s43 offen offset:2048 sc1 lds
    v_lshlrev_b32 v128, 16, v48
    v_and_b32 v129, s56, v48
    v_mul_f32 v132, v128, v142
    v_mul_f32 v133, v129, v143
    v_lshlrev_b32 v126, 16, v50
    v_and_b32 v127, s56, v50
    v_fmac_f32 v130, v126, v144
    buffer_load_dwordx4 v5, s[16:19], s43 offen offset:3072 sc1 lds
    v_fmac_f32 v131, v127, v145
    v_lshlrev_b32 v128, 16, v52
    v_and_b32 v129, s56, v52
    v_fmac_f32 v132, v128, v146
    v_fmac_f32 v133, v129, v147
    v_lshlrev_b32 v126, 16, v54
    v_and_b32 v127, s56, v54
    buffer_store_dwordx4 v[232:235], v6, s[20:23], s4 offen offset:3072 sc1
    v_fmac_f32 v130, v126, v148
    v_fmac_f32 v131, v127, v149
    v_lshlrev_b32 v128, 16, v56
    v_and_b32 v129, s56, v56
    v_fmac_f32 v132, v128, v150
    s_waitcnt vmcnt(20)
    s_waitcnt vmcnt(17)
    s_barrier
    s_add_u32 m0, s40, 104448
    s_movk_i32 s42, 2432
    buffer_load_dwordx4 v1, s[12:15], s42 offen offset:0  lds
    v_fmac_f32 v133, v129, v151
    v_lshlrev_b32 v126, 16, v58
    v_and_b32 v127, s56, v58
    v_fmac_f32 v130, v126, v152
    v_fmac_f32 v131, v127, v153
    v_lshlrev_b32 v128, 16, v60
    v_and_b32 v129, s56, v60
    buffer_load_dwordx4 v2, s[12:15], s42 offen offset:1024  lds
    v_fmac_f32 v132, v128, v154
    v_fmac_f32 v133, v129, v155
    v_lshlrev_b32 v126, 16, v62
    v_and_b32 v127, s56, v62
    v_fmac_f32 v130, v126, v156
    v_fmac_f32 v131, v127, v157
    v_add_f32 v130, v130, v131
    buffer_load_dwordx4 v3, s[12:15], s42 offen offset:2048  lds
    v_add_f32 v132, v132, v133
    v_add_f32 v102, v130, v132
    ds_read2_b32 v[82:83], v204 offset0:8 offset1:0
    ds_read2_b32 v[84:85], v205 offset0:8 offset1:0
    ds_read2_b32 v[86:87], v206 offset0:8 offset1:0
    ds_read2_b32 v[88:89], v207 offset0:8 offset1:0
    buffer_load_dwordx4 v4, s[12:15], s42 offen offset:3072  lds
    ds_read2_b32 v[90:91], v208 offset0:8 offset1:0
    ds_read2_b32 v[92:93], v209 offset0:8 offset1:0
    ds_read2_b32 v[94:95], v210 offset0:8 offset1:0
    ds_read2_b32 v[96:97], v211 offset0:8 offset1:0
    ds_read2_b32 v[98:99], v212 offset0:8 offset1:0
    s_add_u32 m0, s41, 104448
    s_mov_b32 s43, 350208
    buffer_load_dwordx4 v5, s[16:19], s43 offen offset:0 sc1 lds
    v_lshlrev_b32 v126, 16, v47
    v_and_b32 v127, s56, v47
    v_mul_f32 v130, v126, v140
    v_mul_f32 v131, v127, v141
    v_lshlrev_b32 v128, 16, v49
    v_and_b32 v129, s56, v49
    v_mul_f32 v132, v128, v142
    buffer_load_dwordx4 v5, s[16:19], s43 offen offset:1024 sc1 lds
    v_mul_f32 v133, v129, v143
    v_lshlrev_b32 v126, 16, v51
    v_and_b32 v127, s56, v51
    v_fmac_f32 v130, v126, v144
    v_fmac_f32 v131, v127, v145
    v_lshlrev_b32 v128, 16, v53
    v_and_b32 v129, s56, v53
    buffer_load_dwordx4 v5, s[16:19], s43 offen offset:2048 sc1 lds
    v_fmac_f32 v132, v128, v146
    v_fmac_f32 v133, v129, v147
    v_lshlrev_b32 v126, 16, v55
    v_and_b32 v127, s56, v55
    v_fmac_f32 v130, v126, v148
    v_fmac_f32 v131, v127, v149
    v_lshlrev_b32 v128, 16, v57
    buffer_load_dwordx4 v5, s[16:19], s43 offen offset:3072 sc1 lds
    v_and_b32 v129, s56, v57
    v_fmac_f32 v132, v128, v150
    v_fmac_f32 v133, v129, v151
    v_lshlrev_b32 v126, 16, v59
    v_and_b32 v127, s56, v59
    v_fmac_f32 v130, v126, v152
    v_fmac_f32 v131, v127, v153
    v_lshlrev_b32 v128, 16, v61
    v_and_b32 v129, s56, v61
    v_fmac_f32 v132, v128, v154
    v_fmac_f32 v133, v129, v155
    s_waitcnt vmcnt(17)
    s_barrier
    s_add_u32 m0, s40, 0
    s_movk_i32 s42, 2560
    buffer_load_dwordx4 v1, s[12:15], s42 offen offset:0  lds
    v_lshlrev_b32 v126, 16, v63
    v_and_b32 v127, s56, v63
    v_fmac_f32 v130, v126, v156
    v_fmac_f32 v131, v127, v157
    v_add_f32 v130, v130, v131
    v_add_f32 v132, v132, v133
    v_add_f32 v103, v130, v132
    buffer_load_dwordx4 v2, s[12:15], s42 offen offset:1024  lds
    v_add_u32 v204, 12288, v204
    v_add_u32 v205, 12288, v205
    v_add_u32 v206, 12288, v206
    v_add_u32 v207, 12288, v207
    v_add_u32 v208, 12288, v208
    v_add_u32 v209, 12288, v209
    v_add_u32 v210, 12288, v210
    buffer_load_dwordx4 v3, s[12:15], s42 offen offset:2048  lds
    v_add_u32 v211, 12288, v211
    v_add_u32 v212, 12288, v212
    ds_read2_b32 v[28:29], v204 offset0:56 offset1:48
    ds_read2_b32 v[30:31], v205 offset0:56 offset1:48
    ds_read2_b32 v[32:33], v206 offset0:56 offset1:48
    ds_read2_b32 v[34:35], v207 offset0:56 offset1:48
    buffer_load_dwordx4 v4, s[12:15], s42 offen offset:3072  lds
    ds_read2_b32 v[36:37], v208 offset0:56 offset1:48
    ds_read2_b32 v[38:39], v209 offset0:56 offset1:48
    ds_read2_b32 v[40:41], v210 offset0:56 offset1:48
    ds_read2_b32 v[42:43], v211 offset0:56 offset1:48
    ds_read2_b32 v[44:45], v212 offset0:56 offset1:48
    s_add_u32 m0, s41, 0
    s_mov_b32 s43, 368640
    buffer_load_dwordx4 v5, s[16:19], s43 offen offset:0 sc1 lds
    s_waitcnt lgkmcnt(15)
    v_lshlrev_b32 v126, 16, v64
    v_and_b32 v127, s56, v64
    v_mul_f32 v130, v126, v140
    v_mul_f32 v131, v127, v141
    v_lshlrev_b32 v128, 16, v66
    v_and_b32 v129, s56, v66
    v_mul_f32 v132, v128, v142
    buffer_load_dwordx4 v5, s[16:19], s43 offen offset:1024 sc1 lds
    v_mul_f32 v133, v129, v143
    v_lshlrev_b32 v126, 16, v68
    v_and_b32 v127, s56, v68
    v_fmac_f32 v130, v126, v144
    v_fmac_f32 v131, v127, v145
    v_lshlrev_b32 v128, 16, v70
    v_and_b32 v129, s56, v70
    buffer_load_dwordx4 v5, s[16:19], s43 offen offset:2048 sc1 lds
    v_fmac_f32 v132, v128, v146
    v_fmac_f32 v133, v129, v147
    v_lshlrev_b32 v126, 16, v72
    v_and_b32 v127, s56, v72
    v_fmac_f32 v130, v126, v148
    v_fmac_f32 v131, v127, v149
    v_lshlrev_b32 v128, 16, v74
    buffer_load_dwordx4 v5, s[16:19], s43 offen offset:3072 sc1 lds
    v_and_b32 v129, s56, v74
    v_fmac_f32 v132, v128, v150
    v_fmac_f32 v133, v129, v151
    v_lshlrev_b32 v126, 16, v76
    v_and_b32 v127, s56, v76
    v_fmac_f32 v130, v126, v152
    v_fmac_f32 v131, v127, v153
    buffer_store_dwordx4 v[236:239], v240, s[20:23], s4 offen sc1
    v_lshlrev_b32 v128, 16, v78
    v_and_b32 v129, s56, v78
    v_fmac_f32 v132, v128, v154
    v_fmac_f32 v133, v129, v155
    s_waitcnt vmcnt(18)
    s_barrier
    s_add_u32 m0, s40, 34816
    s_movk_i32 s42, 2688
    buffer_load_dwordx4 v1, s[12:15], s42 offen offset:0  lds
    v_lshlrev_b32 v126, 16, v80
    v_and_b32 v127, s56, v80
    v_fmac_f32 v130, v126, v156
    v_fmac_f32 v131, v127, v157
    v_add_f32 v130, v130, v131
    v_add_f32 v132, v132, v133
    v_add_f32 v104, v130, v132
    buffer_load_dwordx4 v2, s[12:15], s42 offen offset:1024  lds
    v_lshlrev_b32 v126, 16, v65
    v_and_b32 v127, s56, v65
    v_mul_f32 v130, v126, v140
    v_mul_f32 v131, v127, v141
    v_lshlrev_b32 v128, 16, v67
    v_and_b32 v129, s56, v67
    v_mul_f32 v132, v128, v142
    buffer_load_dwordx4 v3, s[12:15], s42 offen offset:2048  lds
    v_mul_f32 v133, v129, v143
    v_lshlrev_b32 v126, 16, v69
    v_and_b32 v127, s56, v69
    v_fmac_f32 v130, v126, v144
    v_fmac_f32 v131, v127, v145
    v_lshlrev_b32 v128, 16, v71
    v_and_b32 v129, s56, v71
    buffer_load_dwordx4 v4, s[12:15], s42 offen offset:3072  lds
    v_fmac_f32 v132, v128, v146
    v_fmac_f32 v133, v129, v147
    v_lshlrev_b32 v126, 16, v73
    v_and_b32 v127, s56, v73
    v_fmac_f32 v130, v126, v148
    v_fmac_f32 v131, v127, v149
    v_lshlrev_b32 v128, 16, v75
    s_add_u32 m0, s41, 34816
    s_mov_b32 s43, 387072
    buffer_load_dwordx4 v5, s[16:19], s43 offen offset:0 sc1 lds
    v_and_b32 v129, s56, v75
    v_fmac_f32 v132, v128, v150
    v_fmac_f32 v133, v129, v151
    v_lshlrev_b32 v126, 16, v77
    v_and_b32 v127, s56, v77
    v_fmac_f32 v130, v126, v152
    v_fmac_f32 v131, v127, v153
    buffer_load_dwordx4 v5, s[16:19], s43 offen offset:1024 sc1 lds
    v_lshlrev_b32 v128, 16, v79
    v_and_b32 v129, s56, v79
    v_fmac_f32 v132, v128, v154
    v_fmac_f32 v133, v129, v155
    v_lshlrev_b32 v126, 16, v81
    v_and_b32 v127, s56, v81
    v_fmac_f32 v130, v126, v156
    buffer_load_dwordx4 v5, s[16:19], s43 offen offset:2048 sc1 lds
    v_fmac_f32 v131, v127, v157
    v_add_f32 v130, v130, v131
    v_add_f32 v132, v132, v133
    v_add_f32 v105, v130, v132
    ds_read2_b32 v[46:47], v204 offset0:40 offset1:32
    ds_read2_b32 v[48:49], v205 offset0:40 offset1:32
    buffer_load_dwordx4 v5, s[16:19], s43 offen offset:3072 sc1 lds
    ds_read2_b32 v[50:51], v206 offset0:40 offset1:32
    ds_read2_b32 v[52:53], v207 offset0:40 offset1:32
    ds_read2_b32 v[54:55], v208 offset0:40 offset1:32
    ds_read2_b32 v[56:57], v209 offset0:40 offset1:32
    ds_read2_b32 v[58:59], v210 offset0:40 offset1:32
    ds_read2_b32 v[60:61], v211 offset0:40 offset1:32
    ds_read2_b32 v[62:63], v212 offset0:40 offset1:32
    s_waitcnt lgkmcnt(15)
    v_lshlrev_b32 v126, 16, v82
    v_and_b32 v127, s56, v82
    s_waitcnt vmcnt(17)
    s_barrier
    s_add_u32 m0, s40, 69632
    s_movk_i32 s42, 2816
    buffer_load_dwordx4 v1, s[12:15], s42 offen offset:0  lds
    v_mul_f32 v130, v126, v140
    v_mul_f32 v131, v127, v141
    v_lshlrev_b32 v128, 16, v84
    v_and_b32 v129, s56, v84
    v_mul_f32 v132, v128, v142
    v_mul_f32 v133, v129, v143
    v_lshlrev_b32 v126, 16, v86
    buffer_load_dwordx4 v2, s[12:15], s42 offen offset:1024  lds
    v_and_b32 v127, s56, v86
    v_fmac_f32 v130, v126, v144
    v_fmac_f32 v131, v127, v145
    v_lshlrev_b32 v128, 16, v88
    v_and_b32 v129, s56, v88
    v_fmac_f32 v132, v128, v146
    v_fmac_f32 v133, v129, v147
    buffer_load_dwordx4 v3, s[12:15], s42 offen offset:2048  lds
    v_lshlrev_b32 v126, 16, v90
    v_and_b32 v127, s56, v90
    v_fmac_f32 v130, v126, v148
    v_fmac_f32 v131, v127, v149
    v_lshlrev_b32 v128, 16, v92
    v_and_b32 v129, s56, v92
    v_fmac_f32 v132, v128, v150
    buffer_load_dwordx4 v4, s[12:15], s42 offen offset:3072  lds
    v_fmac_f32 v133, v129, v151
    v_lshlrev_b32 v126, 16, v94
    v_and_b32 v127, s56, v94
    v_fmac_f32 v130, v126, v152
    v_fmac_f32 v131, v127, v153
    v_lshlrev_b32 v128, 16, v96
    v_and_b32 v129, s56, v96
    s_add_u32 m0, s41, 69632
    s_mov_b32 s43, 405504
    buffer_load_dwordx4 v5, s[16:19], s43 offen offset:0 sc1 lds
    v_fmac_f32 v132, v128, v154
    v_fmac_f32 v133, v129, v155
    v_lshlrev_b32 v126, 16, v98
    v_and_b32 v127, s56, v98
    v_fmac_f32 v130, v126, v156
    v_fmac_f32 v131, v127, v157
    v_add_f32 v130, v130, v131
    buffer_load_dwordx4 v5, s[16:19], s43 offen offset:1024 sc1 lds
    v_add_f32 v132, v132, v133
    v_add_f32 v106, v130, v132
    v_lshlrev_b32 v126, 16, v83
    v_and_b32 v127, s56, v83
    v_mul_f32 v130, v126, v140
    v_mul_f32 v131, v127, v141
    v_lshlrev_b32 v128, 16, v85
    buffer_load_dwordx4 v5, s[16:19], s43 offen offset:2048 sc1 lds
    v_and_b32 v129, s56, v85
    v_mul_f32 v132, v128, v142
    v_mul_f32 v133, v129, v143
    v_lshlrev_b32 v126, 16, v87
    v_and_b32 v127, s56, v87
    v_fmac_f32 v130, v126, v144
    v_fmac_f32 v131, v127, v145
    buffer_load_dwordx4 v5, s[16:19], s43 offen offset:3072 sc1 lds
    v_lshlrev_b32 v128, 16, v89
    v_and_b32 v129, s56, v89
    v_fmac_f32 v132, v128, v146
    v_fmac_f32 v133, v129, v147
    v_lshlrev_b32 v126, 16, v91
    v_and_b32 v127, s56, v91
    v_fmac_f32 v130, v126, v148
    v_fmac_f32 v131, v127, v149
    v_lshlrev_b32 v128, 16, v93
    v_and_b32 v129, s56, v93
    v_fmac_f32 v132, v128, v150
    v_fmac_f32 v133, v129, v151
    s_waitcnt vmcnt(17)
    s_barrier
    s_add_u32 m0, s40, 104448
    s_movk_i32 s42, 2944
    buffer_load_dwordx4 v1, s[12:15], s42 offen offset:0  lds
    v_lshlrev_b32 v126, 16, v95
    v_and_b32 v127, s56, v95
    v_fmac_f32 v130, v126, v152
    v_fmac_f32 v131, v127, v153
    v_lshlrev_b32 v128, 16, v97
    v_and_b32 v129, s56, v97
    v_fmac_f32 v132, v128, v154
    buffer_load_dwordx4 v2, s[12:15], s42 offen offset:1024  lds
    v_fmac_f32 v133, v129, v155
    v_lshlrev_b32 v126, 16, v99
    v_and_b32 v127, s56, v99
    v_fmac_f32 v130, v126, v156
    v_fmac_f32 v131, v127, v157
    v_add_f32 v130, v130, v131
    v_add_f32 v132, v132, v133
    buffer_load_dwordx4 v3, s[12:15], s42 offen offset:2048  lds
    v_add_f32 v107, v130, v132
    ds_read2_b32 v[64:65], v204 offset0:24 offset1:16
    ds_read2_b32 v[66:67], v205 offset0:24 offset1:16
    ds_read2_b32 v[68:69], v206 offset0:24 offset1:16
    ds_read2_b32 v[70:71], v207 offset0:24 offset1:16
    buffer_load_dwordx4 v4, s[12:15], s42 offen offset:3072  lds
    ds_read2_b32 v[72:73], v208 offset0:24 offset1:16
    ds_read2_b32 v[74:75], v209 offset0:24 offset1:16
    ds_read2_b32 v[76:77], v210 offset0:24 offset1:16
    ds_read2_b32 v[78:79], v211 offset0:24 offset1:16
    ds_read2_b32 v[80:81], v212 offset0:24 offset1:16
    s_add_u32 m0, s41, 104448
    s_mov_b32 s43, 423936
    buffer_load_dwordx4 v5, s[16:19], s43 offen offset:0 sc1 lds
    ds_read2_b32 v[82:83], v204 offset0:8 offset1:0
    ds_read2_b32 v[84:85], v205 offset0:8 offset1:0
    ds_read2_b32 v[86:87], v206 offset0:8 offset1:0
    ds_read2_b32 v[88:89], v207 offset0:8 offset1:0
    ds_read2_b32 v[90:91], v208 offset0:8 offset1:0
    buffer_load_dwordx4 v5, s[16:19], s43 offen offset:1024 sc1 lds
    ds_read2_b32 v[92:93], v209 offset0:8 offset1:0
    ds_read2_b32 v[94:95], v210 offset0:8 offset1:0
    ds_read2_b32 v[96:97], v211 offset0:8 offset1:0
    ds_read2_b32 v[98:99], v212 offset0:8 offset1:0
    v_mov_b32 v126, 0xce6e6b28
    buffer_load_dwordx4 v5, s[16:19], s43 offen offset:2048 sc1 lds
    v_mul_f32 v100, 0x3eae1a93, v100
    v_mul_f32 v101, 0x3eae1a93, v101
    v_mul_f32 v102, 0x3eae1a93, v102
    v_mul_f32 v103, 0x3eae1a93, v103
    v_mul_f32 v104, 0x3eae1a93, v104
    v_mul_f32 v105, 0x3eae1a93, v105
    v_mul_f32 v106, 0x3eae1a93, v106
    buffer_load_dwordx4 v5, s[16:19], s43 offen offset:3072 sc1 lds
    v_mul_f32 v107, 0x3eae1a93, v107
    v_cmp_gt_u32 vcc, 2, v10
    s_nop 1
    v_cndmask_b32 v101, v101, v126, vcc
    v_cmp_gt_u32 vcc, 4, v10
    s_nop 1
    v_cndmask_b32 v102, v102, v126, vcc
    v_cmp_gt_u32 vcc, 6, v10
    s_nop 1
    v_cndmask_b32 v103, v103, v126, vcc
    v_cmp_gt_u32 vcc, 8, v10
    s_nop 1
    v_cndmask_b32 v104, v104, v126, vcc
    v_cmp_gt_u32 vcc, 10, v10
    s_nop 1
    v_cndmask_b32 v105, v105, v126, vcc
    s_waitcnt vmcnt(16)
    s_barrier
    s_add_u32 m0, s40, 0
    s_movk_i32 s42, 3072
    buffer_load_dwordx4 v1, s[12:15], s42 offen offset:0  lds
    v_cmp_gt_u32 vcc, 12, v10
    s_nop 1
    v_cndmask_b32 v106, v106, v126, vcc
    v_cmp_gt_u32 vcc, 14, v10
    s_nop 1
    v_cndmask_b32 v107, v107, v126, vcc
    v_max3_f32 v127, v100, v101, v102
    v_max3_f32 v128, v103, v104, v105
    v_max3_f32 v127, v127, v106, v107
    buffer_load_dwordx4 v2, s[12:15], s42 offen offset:1024  lds
    v_max_f32 v127, v127, v128
    v_sub_f32 v100, v100, v127
    v_sub_f32 v101, v101, v127
    v_sub_f32 v102, v102, v127
    v_sub_f32 v103, v103, v127
    v_sub_f32 v104, v104, v127
    v_sub_f32 v105, v105, v127
    buffer_load_dwordx4 v3, s[12:15], s42 offen offset:2048  lds
    v_sub_f32 v106, v106, v127
    v_sub_f32 v107, v107, v127
    v_exp_f32 v100, v100
    v_exp_f32 v101, v101
    v_exp_f32 v102, v102
    buffer_load_dwordx4 v4, s[12:15], s42 offen offset:3072  lds
    v_exp_f32 v103, v103
    v_exp_f32 v104, v104
    v_exp_f32 v105, v105
    v_exp_f32 v106, v106
    s_add_u32 m0, s41, 0
    s_mov_b32 s43, 442368
    buffer_load_dwordx4 v5, s[16:19], s43 offen offset:0 sc1 lds
    v_exp_f32 v107, v107
    v_add_f32 v127, v100, v101
    v_add_f32 v128, v102, v103
    v_add_f32 v129, v104, v105
    v_add_f32 v130, v106, v107
    v_add_f32 v127, v127, v128
    buffer_load_dwordx4 v5, s[16:19], s43 offen offset:1024 sc1 lds
    v_add_f32 v129, v129, v130
    v_add_f32 v127, v127, v129
    v_rcp_f32 v134, v127
    s_nop 0
    v_mul_f32 v100, v100, v134
    v_mul_f32 v101, v101, v134
    buffer_load_dwordx4 v5, s[16:19], s43 offen offset:2048 sc1 lds
    v_mul_f32 v102, v102, v134
    v_mul_f32 v103, v103, v134
    v_mul_f32 v104, v104, v134
    v_mul_f32 v105, v105, v134
    v_mul_f32 v106, v106, v134
    v_mul_f32 v107, v107, v134
    s_waitcnt lgkmcnt(15)
    v_lshlrev_b32 v126, 16, v28
    buffer_load_dwordx4 v5, s[16:19], s43 offen offset:3072 sc1 lds
    v_and_b32 v127, s56, v28
    v_mul_f32 v108, v126, v100
    v_mul_f32 v109, v127, v100
    v_lshlrev_b32 v128, 16, v30
    v_and_b32 v129, s56, v30
    v_mul_f32 v110, v128, v100
    v_mul_f32 v111, v129, v100
    v_lshlrev_b32 v126, 16, v32
    v_and_b32 v127, s56, v32
    v_mul_f32 v112, v126, v100
    s_waitcnt vmcnt(16)
    s_barrier
    s_add_u32 m0, s40, 34816
    s_movk_i32 s42, 3200
    buffer_load_dwordx4 v1, s[12:15], s42 offen offset:0  lds
    v_mul_f32 v113, v127, v100
    v_lshlrev_b32 v128, 16, v34
    v_and_b32 v129, s56, v34
    v_mul_f32 v114, v128, v100
    v_mul_f32 v115, v129, v100
    v_lshlrev_b32 v126, 16, v36
    v_and_b32 v127, s56, v36
    buffer_load_dwordx4 v2, s[12:15], s42 offen offset:1024  lds
    v_mul_f32 v116, v126, v100
    v_mul_f32 v117, v127, v100
    v_lshlrev_b32 v128, 16, v38
    v_and_b32 v129, s56, v38
    v_mul_f32 v118, v128, v100
    v_mul_f32 v119, v129, v100
    v_lshlrev_b32 v126, 16, v40
    buffer_load_dwordx4 v3, s[12:15], s42 offen offset:2048  lds
    v_and_b32 v127, s56, v40
    v_mul_f32 v120, v126, v100
    v_mul_f32 v121, v127, v100
    v_lshlrev_b32 v128, 16, v42
    v_and_b32 v129, s56, v42
    v_mul_f32 v122, v128, v100
    v_mul_f32 v123, v129, v100
    buffer_load_dwordx4 v4, s[12:15], s42 offen offset:3072  lds
    v_lshlrev_b32 v126, 16, v44
    v_and_b32 v127, s56, v44
    v_mul_f32 v124, v126, v100
    v_mul_f32 v125, v127, v100
    v_lshlrev_b32 v126, 16, v29
    v_and_b32 v127, s56, v29
    v_fmac_f32 v108, v126, v101
    s_add_u32 m0, s41, 34816
    s_mov_b32 s43, 460800
    buffer_load_dwordx4 v5, s[16:19], s43 offen offset:0 sc1 lds
    v_fmac_f32 v109, v127, v101
    v_lshlrev_b32 v128, 16, v31
    v_and_b32 v129, s56, v31
    v_fmac_f32 v110, v128, v101
    v_fmac_f32 v111, v129, v101
    v_lshlrev_b32 v126, 16, v33
    v_and_b32 v127, s56, v33
    buffer_load_dwordx4 v5, s[16:19], s43 offen offset:1024 sc1 lds
    v_fmac_f32 v112, v126, v101
    v_fmac_f32 v113, v127, v101
    v_lshlrev_b32 v128, 16, v35
    v_and_b32 v129, s56, v35
    v_fmac_f32 v114, v128, v101
    v_fmac_f32 v115, v129, v101
    v_lshlrev_b32 v126, 16, v37
    buffer_load_dwordx4 v5, s[16:19], s43 offen offset:2048 sc1 lds
    v_and_b32 v127, s56, v37
    v_fmac_f32 v116, v126, v101
    v_fmac_f32 v117, v127, v101
    v_lshlrev_b32 v128, 16, v39
    v_and_b32 v129, s56, v39
    v_fmac_f32 v118, v128, v101
    v_fmac_f32 v119, v129, v101
    buffer_load_dwordx4 v5, s[16:19], s43 offen offset:3072 sc1 lds
    v_lshlrev_b32 v126, 16, v41
    v_and_b32 v127, s56, v41
    v_fmac_f32 v120, v126, v101
    v_fmac_f32 v121, v127, v101
    v_lshlrev_b32 v128, 16, v43
    v_and_b32 v129, s56, v43
    v_fmac_f32 v122, v128, v101
    v_fmac_f32 v123, v129, v101
    v_lshlrev_b32 v126, 16, v45
    v_and_b32 v127, s56, v45
    v_fmac_f32 v124, v126, v101
    v_fmac_f32 v125, v127, v101
    s_waitcnt vmcnt(16)
    s_barrier
    s_add_u32 m0, s40, 69632
    s_movk_i32 s42, 3328
    buffer_load_dwordx4 v1, s[12:15], s42 offen offset:0  lds
    v_lshlrev_b32 v126, 16, v46
    v_and_b32 v127, s56, v46
    v_fmac_f32 v108, v126, v102
    v_fmac_f32 v109, v127, v102
    v_lshlrev_b32 v128, 16, v48
    v_and_b32 v129, s56, v48
    v_fmac_f32 v110, v128, v102
    buffer_load_dwordx4 v2, s[12:15], s42 offen offset:1024  lds
    v_fmac_f32 v111, v129, v102
    v_lshlrev_b32 v126, 16, v50
    v_and_b32 v127, s56, v50
    v_fmac_f32 v112, v126, v102
    v_fmac_f32 v113, v127, v102
    v_lshlrev_b32 v128, 16, v52
    v_and_b32 v129, s56, v52
    buffer_load_dwordx4 v3, s[12:15], s42 offen offset:2048  lds
    v_fmac_f32 v114, v128, v102
    v_fmac_f32 v115, v129, v102
    v_lshlrev_b32 v126, 16, v54
    v_and_b32 v127, s56, v54
    v_fmac_f32 v116, v126, v102
    v_fmac_f32 v117, v127, v102
    v_lshlrev_b32 v128, 16, v56
    buffer_load_dwordx4 v4, s[12:15], s42 offen offset:3072  lds
    v_and_b32 v129, s56, v56
    v_fmac_f32 v118, v128, v102
    v_fmac_f32 v119, v129, v102
    v_lshlrev_b32 v126, 16, v58
    v_and_b32 v127, s56, v58
    v_fmac_f32 v120, v126, v102
    v_fmac_f32 v121, v127, v102
    s_add_u32 m0, s41, 69632
    s_mov_b32 s43, 479232
    buffer_load_dwordx4 v5, s[16:19], s43 offen offset:0 sc1 lds
    v_lshlrev_b32 v128, 16, v60
    v_and_b32 v129, s56, v60
    v_fmac_f32 v122, v128, v102
    v_fmac_f32 v123, v129, v102
    v_lshlrev_b32 v126, 16, v62
    v_and_b32 v127, s56, v62
    v_fmac_f32 v124, v126, v102
    buffer_load_dwordx4 v5, s[16:19], s43 offen offset:1024 sc1 lds
    v_fmac_f32 v125, v127, v102
    v_lshlrev_b32 v126, 16, v47
    v_and_b32 v127, s56, v47
    v_fmac_f32 v108, v126, v103
    v_fmac_f32 v109, v127, v103
    v_lshlrev_b32 v128, 16, v49
    v_and_b32 v129, s56, v49
    buffer_load_dwordx4 v5, s[16:19], s43 offen offset:2048 sc1 lds
    v_fmac_f32 v110, v128, v103
    v_fmac_f32 v111, v129, v103
    v_lshlrev_b32 v126, 16, v51
    v_and_b32 v127, s56, v51
    v_fmac_f32 v112, v126, v103
    v_fmac_f32 v113, v127, v103
    v_lshlrev_b32 v128, 16, v53
    buffer_load_dwordx4 v5, s[16:19], s43 offen offset:3072 sc1 lds
    v_and_b32 v129, s56, v53
    v_fmac_f32 v114, v128, v103
    v_fmac_f32 v115, v129, v103
    v_lshlrev_b32 v126, 16, v55
    v_and_b32 v127, s56, v55
    v_fmac_f32 v116, v126, v103
    v_fmac_f32 v117, v127, v103
    v_lshlrev_b32 v128, 16, v57
    v_and_b32 v129, s56, v57
    v_fmac_f32 v118, v128, v103
    v_fmac_f32 v119, v129, v103
    v_lshlrev_b32 v126, 16, v59
    s_waitcnt vmcnt(16)
    s_barrier
    s_add_u32 m0, s40, 104448
    s_movk_i32 s42, 3456
    buffer_load_dwordx4 v1, s[12:15], s42 offen offset:0  lds
    v_and_b32 v127, s56, v59
    v_fmac_f32 v120, v126, v103
    v_fmac_f32 v121, v127, v103
    v_lshlrev_b32 v128, 16, v61
    v_and_b32 v129, s56, v61
    v_fmac_f32 v122, v128, v103
    v_fmac_f32 v123, v129, v103
    buffer_load_dwordx4 v2, s[12:15], s42 offen offset:1024  lds
    v_lshlrev_b32 v126, 16, v63
    v_and_b32 v127, s56, v63
    v_fmac_f32 v124, v126, v103
    v_fmac_f32 v125, v127, v103
    s_waitcnt lgkmcnt(9)
    v_lshlrev_b32 v126, 16, v64
    v_and_b32 v127, s56, v64
    v_fmac_f32 v108, v126, v104
    buffer_load_dwordx4 v3, s[12:15], s42 offen offset:2048  lds
    v_fmac_f32 v109, v127, v104
    v_lshlrev_b32 v128, 16, v66
    v_and_b32 v129, s56, v66
    v_fmac_f32 v110, v128, v104
    v_fmac_f32 v111, v129, v104
    v_lshlrev_b32 v126, 16, v68
    v_and_b32 v127, s56, v68
    buffer_load_dwordx4 v4, s[12:15], s42 offen offset:3072  lds
    v_fmac_f32 v112, v126, v104
    v_fmac_f32 v113, v127, v104
    v_lshlrev_b32 v128, 16, v70
    v_and_b32 v129, s56, v70
    v_fmac_f32 v114, v128, v104
    v_fmac_f32 v115, v129, v104
    v_lshlrev_b32 v126, 16, v72
    s_add_u32 m0, s41, 104448
    s_mov_b32 s43, 497664
    buffer_load_dwordx4 v5, s[16:19], s43 offen offset:0 sc1 lds
    v_and_b32 v127, s56, v72
    v_fmac_f32 v116, v126, v104
    v_fmac_f32 v117, v127, v104
    v_lshlrev_b32 v128, 16, v74
    v_and_b32 v129, s56, v74
    v_fmac_f32 v118, v128, v104
    v_fmac_f32 v119, v129, v104
    buffer_load_dwordx4 v5, s[16:19], s43 offen offset:1024 sc1 lds
    v_lshlrev_b32 v126, 16, v76
    v_and_b32 v127, s56, v76
    v_fmac_f32 v120, v126, v104
    v_fmac_f32 v121, v127, v104
    v_lshlrev_b32 v128, 16, v78
    v_and_b32 v129, s56, v78
    v_fmac_f32 v122, v128, v104
    buffer_load_dwordx4 v5, s[16:19], s43 offen offset:2048 sc1 lds
    v_fmac_f32 v123, v129, v104
    v_lshlrev_b32 v126, 16, v80
    v_and_b32 v127, s56, v80
    v_fmac_f32 v124, v126, v104
    v_fmac_f32 v125, v127, v104
    v_lshlrev_b32 v126, 16, v65
    v_and_b32 v127, s56, v65
    buffer_load_dwordx4 v5, s[16:19], s43 offen offset:3072 sc1 lds
    v_fmac_f32 v108, v126, v105
    v_fmac_f32 v109, v127, v105
    v_lshlrev_b32 v128, 16, v67
    v_and_b32 v129, s56, v67
    v_fmac_f32 v110, v128, v105
    v_fmac_f32 v111, v129, v105
    v_lshlrev_b32 v126, 16, v69
    v_and_b32 v127, s56, v69
    v_fmac_f32 v112, v126, v105
    v_fmac_f32 v113, v127, v105
    v_lshlrev_b32 v128, 16, v71
    v_and_b32 v129, s56, v71
    s_waitcnt vmcnt(16)
    s_barrier
    s_add_u32 m0, s40, 0
    s_movk_i32 s42, 3584
    buffer_load_dwordx4 v1, s[12:15], s42 offen offset:0  lds
    v_fmac_f32 v114, v128, v105
    v_fmac_f32 v115, v129, v105
    v_lshlrev_b32 v126, 16, v73
    v_and_b32 v127, s56, v73
    v_fmac_f32 v116, v126, v105
    v_fmac_f32 v117, v127, v105
    v_lshlrev_b32 v128, 16, v75
    buffer_load_dwordx4 v2, s[12:15], s42 offen offset:1024  lds
    v_and_b32 v129, s56, v75
    v_fmac_f32 v118, v128, v105
    v_fmac_f32 v119, v129, v105
    v_lshlrev_b32 v126, 16, v77
    v_and_b32 v127, s56, v77
    v_fmac_f32 v120, v126, v105
    v_fmac_f32 v121, v127, v105
    buffer_load_dwordx4 v3, s[12:15], s42 offen offset:2048  lds
    v_lshlrev_b32 v128, 16, v79
    v_and_b32 v129, s56, v79
    v_fmac_f32 v122, v128, v105
    v_fmac_f32 v123, v129, v105
    v_lshlrev_b32 v126, 16, v81
    v_and_b32 v127, s56, v81
    v_fmac_f32 v124, v126, v105
    buffer_load_dwordx4 v4, s[12:15], s42 offen offset:3072  lds
    v_fmac_f32 v125, v127, v105
    s_waitcnt lgkmcnt(0)
    v_lshlrev_b32 v126, 16, v82
    v_and_b32 v127, s56, v82
    v_fmac_f32 v108, v126, v106
    v_fmac_f32 v109, v127, v106
    v_lshlrev_b32 v128, 16, v84
    v_and_b32 v129, s56, v84
    s_add_u32 m0, s41, 0
    s_mov_b32 s43, 516096
    buffer_load_dwordx4 v5, s[16:19], s43 offen offset:0 sc1 lds
    v_fmac_f32 v110, v128, v106
    v_fmac_f32 v111, v129, v106
    v_lshlrev_b32 v126, 16, v86
    v_and_b32 v127, s56, v86
    v_fmac_f32 v112, v126, v106
    v_fmac_f32 v113, v127, v106
    v_lshlrev_b32 v128, 16, v88
    buffer_load_dwordx4 v5, s[16:19], s43 offen offset:1024 sc1 lds
    v_and_b32 v129, s56, v88
    v_fmac_f32 v114, v128, v106
    v_fmac_f32 v115, v129, v106
    v_lshlrev_b32 v126, 16, v90
    v_and_b32 v127, s56, v90
    v_fmac_f32 v116, v126, v106
    v_fmac_f32 v117, v127, v106
    buffer_load_dwordx4 v5, s[16:19], s43 offen offset:2048 sc1 lds
    v_lshlrev_b32 v128, 16, v92
    v_and_b32 v129, s56, v92
    v_fmac_f32 v118, v128, v106
    v_fmac_f32 v119, v129, v106
    v_lshlrev_b32 v126, 16, v94
    v_and_b32 v127, s56, v94
    v_fmac_f32 v120, v126, v106
    buffer_load_dwordx4 v5, s[16:19], s43 offen offset:3072 sc1 lds
    v_fmac_f32 v121, v127, v106
    v_lshlrev_b32 v128, 16, v96
    v_and_b32 v129, s56, v96
    v_fmac_f32 v122, v128, v106
    v_fmac_f32 v123, v129, v106
    v_lshlrev_b32 v126, 16, v98
    v_and_b32 v127, s56, v98
    v_fmac_f32 v124, v126, v106
    v_fmac_f32 v125, v127, v106
    v_lshlrev_b32 v126, 16, v83
    v_and_b32 v127, s56, v83
    s_waitcnt vmcnt(16)
    s_barrier
    s_add_u32 m0, s40, 34816
    s_movk_i32 s42, 3712
    buffer_load_dwordx4 v1, s[12:15], s42 offen offset:0  lds
    v_fmac_f32 v108, v126, v107
    v_fmac_f32 v109, v127, v107
    v_lshlrev_b32 v128, 16, v85
    v_and_b32 v129, s56, v85
    v_fmac_f32 v110, v128, v107
    v_fmac_f32 v111, v129, v107
    v_lshlrev_b32 v126, 16, v87
    buffer_load_dwordx4 v2, s[12:15], s42 offen offset:1024  lds
    v_and_b32 v127, s56, v87
    v_fmac_f32 v112, v126, v107
    v_fmac_f32 v113, v127, v107
    v_lshlrev_b32 v128, 16, v89
    v_and_b32 v129, s56, v89
    v_fmac_f32 v114, v128, v107
    v_fmac_f32 v115, v129, v107
    buffer_load_dwordx4 v3, s[12:15], s42 offen offset:2048  lds
    v_lshlrev_b32 v126, 16, v91
    v_and_b32 v127, s56, v91
    v_fmac_f32 v116, v126, v107
    v_fmac_f32 v117, v127, v107
    v_lshlrev_b32 v128, 16, v93
    v_and_b32 v129, s56, v93
    v_fmac_f32 v118, v128, v107
    buffer_load_dwordx4 v4, s[12:15], s42 offen offset:3072  lds
    v_fmac_f32 v119, v129, v107
    v_lshlrev_b32 v126, 16, v95
    v_and_b32 v127, s56, v95
    v_fmac_f32 v120, v126, v107
    v_fmac_f32 v121, v127, v107
    v_lshlrev_b32 v128, 16, v97
    v_and_b32 v129, s56, v97
    s_add_u32 m0, s41, 34816
    s_mov_b32 s43, 534528
    buffer_load_dwordx4 v5, s[16:19], s43 offen offset:0 sc1 lds
    v_fmac_f32 v122, v128, v107
    v_fmac_f32 v123, v129, v107
    v_lshlrev_b32 v126, 16, v99
    v_and_b32 v127, s56, v99
    v_fmac_f32 v124, v126, v107
    v_fmac_f32 v125, v127, v107
    s_lshl_b32 s54, s50, 2
    s_add_u32 s54, s54, s38
    s_mul_i32 s54, s54, 92160
    buffer_load_dwordx4 v5, s[16:19], s43 offen offset:1024 sc1 lds
    s_lshl_b32 s58, s51, 11
    s_add_u32 s58, s58, s54
    s_lshr_b32 s59, s51, 2
    s_lshl_b32 s59, s59, 10
    s_add_u32 s54, s54, s59
    s_and_b32 s59, s51, 3
    s_lshl_b32 s59, s59, 8
    s_add_u32 s54, s54, s59
    s_add_u32 s54, s54, 16384
    v_lshlrev_b32 v140, 2, v0
    v_cvt_pk_bf16_f32 v28, v108, v109
    v_cvt_pk_bf16_f32 v29, v110, v111
    v_cvt_pk_bf16_f32 v30, v112, v113
    buffer_load_dwordx4 v5, s[16:19], s43 offen offset:2048 sc1 lds
    v_cvt_pk_bf16_f32 v31, v114, v115
    v_cvt_pk_bf16_f32 v32, v116, v117
    v_cvt_pk_bf16_f32 v33, v118, v119
    v_cvt_pk_bf16_f32 v34, v120, v121
    v_cvt_pk_bf16_f32 v35, v122, v123
    v_cvt_pk_bf16_f32 v36, v124, v125
    buffer_store_dwordx4 v[28:31], v6, s[24:27], s58 offen sc1
    buffer_load_dwordx4 v5, s[16:19], s43 offen offset:3072 sc1 lds
    buffer_store_dwordx4 v[32:35], v6, s[24:27], s58 offen offset:1024 sc1
    buffer_store_dword v36, v140, s[24:27], s54 offen sc1
    s_waitcnt vmcnt(19)
    s_barrier
    s_add_u32 m0, s40, 69632
    s_movk_i32 s42, 3840
    buffer_load_dwordx4 v1, s[12:15], s42 offen offset:0  lds
    buffer_load_dwordx4 v2, s[12:15], s42 offen offset:1024  lds
    buffer_load_dwordx4 v3, s[12:15], s42 offen offset:2048  lds
    buffer_load_dwordx4 v4, s[12:15], s42 offen offset:3072  lds
    s_add_u32 m0, s41, 69632
    s_mov_b32 s43, 552960
    buffer_load_dwordx4 v5, s[16:19], s43 offen offset:0 sc1 lds
    buffer_load_dwordx4 v5, s[16:19], s43 offen offset:1024 sc1 lds
    buffer_load_dwordx4 v5, s[16:19], s43 offen offset:2048 sc1 lds
    buffer_load_dwordx4 v5, s[16:19], s43 offen offset:3072 sc1 lds
    s_waitcnt vmcnt(19)
    s_barrier
    s_add_u32 m0, s40, 104448
    s_movk_i32 s42, 3968
    buffer_load_dwordx4 v1, s[12:15], s42 offen offset:0  lds
    buffer_load_dwordx4 v2, s[12:15], s42 offen offset:1024  lds
    buffer_load_dwordx4 v3, s[12:15], s42 offen offset:2048  lds
    buffer_load_dwordx4 v4, s[12:15], s42 offen offset:3072  lds
    s_add_u32 m0, s41, 104448
    s_mov_b32 s43, 571392
    buffer_load_dwordx4 v5, s[16:19], s43 offen offset:0 sc1 lds
    buffer_load_dwordx4 v5, s[16:19], s43 offen offset:1024 sc1 lds
    buffer_load_dwordx4 v5, s[16:19], s43 offen offset:2048 sc1 lds
    buffer_load_dwordx4 v5, s[16:19], s43 offen offset:3072 sc1 lds
    s_and_b32 s40, s2, 7
    s_lshr_b32 s41, s2, 3
    s_lshr_b32 s32, s40, 1
    s_lshl_b32 s32, s32, 3
    s_lshr_b32 s42, s41, 2
    s_add_u32 s32, s32, s42
    s_and_b32 s33, s40, 1
    s_lshl_b32 s33, s33, 2
    s_and_b32 s42, s41, 3
    s_add_u32 s33, s33, s42
    s_lshl_b32 s40, s32, 2
    s_add_u32 s40, s40, s38
    s_mul_i32 s41, s40, 92160
    v_add_u32 v1, s41, v6
    s_mul_i32 s41, s33, 414720
    s_lshl_b32 s40, s38, 11
    s_add_u32 s41, s41, s40
    v_add_u32 v2, s41, v6
    s_add_u32 s40, s40, 2048
    s_add_u32 s41, s40, 8192
    s_add_u32 s16, s46, 37748736
    s_addc_u32 s17, s47, 0
    s_mov_b32 s18, 3317760
    s_mov_b32 s19, 0x00020000
    v_and_b32 v4, 15, v0
    v_lshlrev_b32 v4, 2, v4
    s_lshl_b32 s54, s49, 7
    s_xor_b32 s58, s54, 1024
    v_mov_b32 v249, s54
    v_mov_b32 v248, s58
    v_cmp_lt_u32 vcc, 31, v0
    s_nop 1
    v_cndmask_b32 v249, v249, v248, vcc
    v_add_u32 v249, 9216, v249
    v_add_u32 v249, v4, v249
    s_lshl_b32 s54, s32, 5
    s_add_u32 s54, s54, 1024
    v_and_b32 v248, 28, v4
    v_add_u32 v248, s54, v248
    v_lshrrev_b32 v4, 1, v0
    v_and_b32 v4, 15, v4
    v_lshlrev_b32 v4, 4, v4
    v_and_b32 v3, 1, v0
    v_lshl_add_u32 v4, v3, 2, v4
    s_lshr_b32 s58, s32, 1
    s_lshl_b32 s58, s58, 8
    s_and_b32 s54, s32, 1
    s_lshl_b32 s54, s54, 3
    s_add_u32 s58, s58, s54
    s_add_u32 s58, s58, 11264
    s_waitcnt vmcnt(18)
    s_waitcnt vmcnt(16)
    s_barrier
    s_mul_i32 s37, s38, 9216
    v_add_u32 v7, s37, v6
    v_mov_b32 v8, 163832
    v_mov_b32 v9, s71
    ds_write_b32 v8, v9
    ds_write_b128 v7, v[160:163] offset:0
    ds_write_b128 v7, v[164:167] offset:1024
    ds_write_b128 v7, v[168:171] offset:2048
    buffer_load_dword v245, v249, s[72:75], 0 offen offset:0 sc1
    s_waitcnt vmcnt(9)
    s_barrier
    ds_write_b128 v7, v[172:175] offset:3072
    ds_write_b128 v7, v[176:179] offset:4096
    ds_write_b128 v7, v[180:183] offset:5120
    s_waitcnt vmcnt(0)
    v_xor_b32 v245, s71, v245
    v_cmp_ne_u32 vcc, 0, v245
    s_nop 4
    s_cbranch_vccz L_pfwok_0
    s_mov_b32 s69, 0
L_pfw_0:
    buffer_load_dword v245, v249, s[72:75], 0 offen offset:0 sc1
    s_add_u32 s69, s69, 1
    s_cmp_gt_u32 s69, 50000
    s_cbranch_scc1 L_pfwok_0
    s_waitcnt vmcnt(0)
    v_xor_b32 v245, s71, v245
    v_cmp_ne_u32 vcc, 0, v245
    s_nop 4
    s_cbranch_vccz L_pfwok_0
    s_sleep 2
    s_branch L_pfw_0
L_pfwok_0:
    s_add_u32 m0, s41, 34816
    s_mov_b32 s43, 0
    buffer_load_dwordx4 v2, s[16:19], s43 offen sc1 lds
    buffer_load_dwordx4 v2, s[16:19], s43 offen offset:1024 sc1 lds
    s_cmp_eq_u32 s38, 3
    s_cbranch_scc0 L_w3_0_0
    buffer_load_dwordx4 v2, s[16:19], s43 offen offset:2048 sc1 lds
L_w3_0_0:
    s_barrier
    ds_write_b128 v7, v[184:187] offset:6144
    ds_write_b128 v7, v[188:191] offset:7168
    ds_write_b128 v7, v[192:195] offset:8192
    s_add_u32 m0, s41, 52224
    s_mov_b32 s43, 9216
    buffer_load_dwordx4 v2, s[16:19], s43 offen sc1 lds
    buffer_load_dwordx4 v2, s[16:19], s43 offen offset:1024 sc1 lds
    s_cmp_eq_u32 s38, 3
    s_cbranch_scc0 L_w3_1_0
    buffer_load_dwordx4 v2, s[16:19], s43 offen offset:2048 sc1 lds
L_w3_1_0:
    s_add_u32 m0, s41, 69632
    s_mov_b32 s43, 18432
    buffer_load_dwordx4 v2, s[16:19], s43 offen sc1 lds
    buffer_load_dwordx4 v2, s[16:19], s43 offen offset:1024 sc1 lds
    s_cmp_eq_u32 s38, 3
    s_cbranch_scc0 L_w3_2_0
    buffer_load_dwordx4 v2, s[16:19], s43 offen offset:2048 sc1 lds
L_w3_2_0:
    buffer_load_dword v244, v248, s[72:75], 0 offen offset:0 sc1
    s_waitcnt lgkmcnt(0)
    s_barrier
    s_add_u32 m0, s41, 87040
    s_mov_b32 s43, 27648
    buffer_load_dwordx4 v2, s[16:19], s43 offen sc1 lds
    buffer_load_dwordx4 v2, s[16:19], s43 offen offset:1024 sc1 lds
    s_cmp_eq_u32 s38, 3
    s_cbranch_scc0 L_w3_3_0
    buffer_load_dwordx4 v2, s[16:19], s43 offen offset:2048 sc1 lds
L_w3_3_0:
    s_add_u32 m0, s41, 104448
    s_mov_b32 s43, 36864
    buffer_load_dwordx4 v2, s[16:19], s43 offen sc1 lds
    buffer_load_dwordx4 v2, s[16:19], s43 offen offset:1024 sc1 lds
    s_cmp_eq_u32 s38, 3
    s_cbranch_scc0 L_w3_4_0
    buffer_load_dwordx4 v2, s[16:19], s43 offen offset:2048 sc1 lds
L_w3_4_0:
    s_waitcnt vmcnt(4)
    v_xor_b32 v244, s71, v244
    v_cmp_ne_u32 vcc, 0, v244
    s_nop 4
    s_cbranch_vccz L_pfook_0
    s_mov_b32 s69, 0
L_pfo_0:
    buffer_load_dword v244, v248, s[72:75], 0 offen offset:0 sc1
    s_add_u32 s69, s69, 1
    s_cmp_gt_u32 s69, 50000
    s_cbranch_scc1 L_pfook_0
    s_waitcnt vmcnt(0)
    v_xor_b32 v244, s71, v244
    v_cmp_ne_u32 vcc, 0, v244
    s_nop 4
    s_cbranch_vccz L_pfook_0
    s_sleep 2
    s_branch L_pfo_0
L_pfook_0:
    s_add_u32 m0, s40, 34816
    s_mov_b32 s42, 0
    buffer_load_dwordx4 v1, s[24:27], s42 offen sc1 lds
    buffer_load_dwordx4 v1, s[24:27], s42 offen offset:1024 sc1 lds
    s_add_u32 m0, s40, 52224
    s_mov_b32 s42, 2048
    buffer_load_dwordx4 v1, s[24:27], s42 offen sc1 lds
    buffer_load_dwordx4 v1, s[24:27], s42 offen offset:1024 sc1 lds
    s_add_u32 m0, s40, 69632
    s_mov_b32 s42, 4096
    buffer_load_dwordx4 v1, s[24:27], s42 offen sc1 lds
    buffer_load_dwordx4 v1, s[24:27], s42 offen offset:1024 sc1 lds
    s_add_u32 m0, s40, 87040
    s_mov_b32 s42, 6144
    buffer_load_dwordx4 v1, s[24:27], s42 offen sc1 lds
    buffer_load_dwordx4 v1, s[24:27], s42 offen offset:1024 sc1 lds
    s_add_u32 m0, s40, 104448
    s_mov_b32 s42, 8192
    buffer_load_dwordx4 v1, s[24:27], s42 offen sc1 lds
    buffer_load_dwordx4 v1, s[24:27], s42 offen offset:1024 sc1 lds
    s_add_u32 m0, s41, 121856
    s_mov_b32 s43, 46080
    buffer_load_dwordx4 v2, s[16:19], s43 offen sc1 lds
    buffer_load_dwordx4 v2, s[16:19], s43 offen offset:1024 sc1 lds
    s_cmp_eq_u32 s38, 3
    s_cbranch_scc0 L_w3_5_0
    buffer_load_dwordx4 v2, s[16:19], s43 offen offset:2048 sc1 lds
L_w3_5_0:
    s_add_u32 m0, s40, 121856
    s_mov_b32 s42, 10240
    buffer_load_dwordx4 v1, s[24:27], s42 offen sc1 lds
    buffer_load_dwordx4 v1, s[24:27], s42 offen offset:1024 sc1 lds
    s_add_u32 m0, s41, 139264
    s_mov_b32 s43, 55296
    buffer_load_dwordx4 v2, s[16:19], s43 offen sc1 lds
    buffer_load_dwordx4 v2, s[16:19], s43 offen offset:1024 sc1 lds
    s_cmp_eq_u32 s38, 3
    s_cbranch_scc0 L_w3_6_0
    buffer_load_dwordx4 v2, s[16:19], s43 offen offset:2048 sc1 lds
L_w3_6_0:
    s_add_u32 m0, s40, 139264
    s_mov_b32 s42, 12288
    buffer_load_dwordx4 v1, s[24:27], s42 offen sc1 lds
    buffer_load_dwordx4 v1, s[24:27], s42 offen offset:1024 sc1 lds
    s_waitcnt vmcnt(16)
    s_barrier
    s_add_u32 m0, s41, 0
    s_mov_b32 s43, 64512
    buffer_load_dwordx4 v2, s[16:19], s43 offen sc1 lds
    buffer_load_dwordx4 v2, s[16:19], s43 offen offset:1024 sc1 lds
    s_cmp_eq_u32 s38, 3
    s_cbranch_scc0 L_w3_7_0
    buffer_load_dwordx4 v2, s[16:19], s43 offen offset:2048 sc1 lds
L_w3_7_0:
    s_add_u32 m0, s40, 0
    s_mov_b32 s42, 14336
    buffer_load_dwordx4 v1, s[24:27], s42 offen sc1 lds
    buffer_load_dwordx4 v1, s[24:27], s42 offen offset:1024 sc1 lds
    s_add_u32 m0, s41, 17408
    s_mov_b32 s43, 73728
    buffer_load_dwordx4 v2, s[16:19], s43 offen sc1 lds
    buffer_load_dwordx4 v2, s[16:19], s43 offen offset:1024 sc1 lds
    s_cmp_eq_u32 s38, 3
    s_cbranch_scc0 L_w3_8_0
    buffer_load_dwordx4 v2, s[16:19], s43 offen offset:2048 sc1 lds
L_w3_8_0:
    s_add_u32 m0, s40, 17408
    s_mov_b32 s42, 16384
    buffer_load_dwordx4 v1, s[24:27], s42 offen sc1 lds
    buffer_load_dwordx4 v1, s[24:27], s42 offen offset:1024 sc1 lds
    s_waitcnt vmcnt(22)
    s_barrier
    s_add_u32 m0, s41, 34816
    s_mov_b32 s43, 82944
    buffer_load_dwordx4 v2, s[16:19], s43 offen sc1 lds
    buffer_load_dwordx4 v2, s[16:19], s43 offen offset:1024 sc1 lds
    s_cmp_eq_u32 s38, 3
    s_cbranch_scc0 L_w3_9_0
    buffer_load_dwordx4 v2, s[16:19], s43 offen offset:2048 sc1 lds
L_w3_9_0:
    s_waitcnt vmcnt(22)
    s_barrier
    s_add_u32 m0, s41, 52224
    s_mov_b32 s43, 92160
    buffer_load_dwordx4 v2, s[16:19], s43 offen sc1 lds
    buffer_load_dwordx4 v2, s[16:19], s43 offen offset:1024 sc1 lds
    s_cmp_eq_u32 s38, 3
    s_cbranch_scc0 L_w3_10_0
    buffer_load_dwordx4 v2, s[16:19], s43 offen offset:2048 sc1 lds
L_w3_10_0:
    s_waitcnt vmcnt(22)
    s_barrier
    s_add_u32 m0, s41, 69632
    s_mov_b32 s43, 101376
    buffer_load_dwordx4 v2, s[16:19], s43 offen sc1 lds
    buffer_load_dwordx4 v2, s[16:19], s43 offen offset:1024 sc1 lds
    s_cmp_eq_u32 s38, 3
    s_cbranch_scc0 L_w3_11_0
    buffer_load_dwordx4 v2, s[16:19], s43 offen offset:2048 sc1 lds
L_w3_11_0:
    s_waitcnt vmcnt(22)
    s_barrier
    s_add_u32 m0, s41, 87040
    s_mov_b32 s43, 110592
    buffer_load_dwordx4 v2, s[16:19], s43 offen sc1 lds
    buffer_load_dwordx4 v2, s[16:19], s43 offen offset:1024 sc1 lds
    s_cmp_eq_u32 s38, 3
    s_cbranch_scc0 L_w3_12_0
    buffer_load_dwordx4 v2, s[16:19], s43 offen offset:2048 sc1 lds
L_w3_12_0:
    s_waitcnt vmcnt(20)
    s_barrier
    s_add_u32 m0, s41, 104448
    s_mov_b32 s43, 119808
    buffer_load_dwordx4 v2, s[16:19], s43 offen sc1 lds
    buffer_load_dwordx4 v2, s[16:19], s43 offen offset:1024 sc1 lds
    s_cmp_eq_u32 s38, 3
    s_cbranch_scc0 L_w3_13_0
    buffer_load_dwordx4 v2, s[16:19], s43 offen offset:2048 sc1 lds
L_w3_13_0:
    s_waitcnt vmcnt(18)
    s_barrier
    s_add_u32 m0, s41, 121856
    s_mov_b32 s43, 129024
    buffer_load_dwordx4 v2, s[16:19], s43 offen sc1 lds
    buffer_load_dwordx4 v2, s[16:19], s43 offen offset:1024 sc1 lds
    s_cmp_eq_u32 s38, 3
    s_cbranch_scc0 L_w3_14_0
    buffer_load_dwordx4 v2, s[16:19], s43 offen offset:2048 sc1 lds
L_w3_14_0:
    s_waitcnt vmcnt(16)
    s_barrier
    s_add_u32 m0, s41, 139264
    s_mov_b32 s43, 138240
    buffer_load_dwordx4 v2, s[16:19], s43 offen sc1 lds
    buffer_load_dwordx4 v2, s[16:19], s43 offen offset:1024 sc1 lds
    s_cmp_eq_u32 s38, 3
    s_cbranch_scc0 L_w3_15_0
    buffer_load_dwordx4 v2, s[16:19], s43 offen offset:2048 sc1 lds
L_w3_15_0:
    s_waitcnt vmcnt(14)
    s_barrier
    s_add_u32 m0, s41, 0
    s_mov_b32 s43, 147456
    buffer_load_dwordx4 v2, s[16:19], s43 offen sc1 lds
    buffer_load_dwordx4 v2, s[16:19], s43 offen offset:1024 sc1 lds
    s_cmp_eq_u32 s38, 3
    s_cbranch_scc0 L_w3_16_0
    buffer_load_dwordx4 v2, s[16:19], s43 offen offset:2048 sc1 lds
L_w3_16_0:
    v_add_u32 v5, s41, v6
    s_mov_b32 s69, 0
L_pfy_0:
    buffer_load_dword v244, v4, s[72:75], s58 offen offset:0 sc1
    s_add_u32 s69, s69, 1
    s_cmp_gt_u32 s69, 50000
    s_cbranch_scc1 L_pfyok_0
    s_waitcnt vmcnt(0)
    v_xor_b32 v244, s71, v244
    v_cmp_ne_u32 vcc, 0, v244
    s_nop 4
    s_cbranch_vccz L_pfyok_0
    s_sleep 1
    s_branch L_pfy_0
L_pfyok_0:
    s_add_u32 m0, s40, 34816
    s_mov_b32 s42, 18432
    buffer_load_dwordx4 v1, s[24:27], s42 offen sc1 lds
    buffer_load_dwordx4 v1, s[24:27], s42 offen offset:1024 sc1 lds
    s_add_u32 m0, s40, 52224
    s_mov_b32 s42, 20480
    buffer_load_dwordx4 v1, s[24:27], s42 offen sc1 lds
    buffer_load_dwordx4 v1, s[24:27], s42 offen offset:1024 sc1 lds
    s_add_u32 m0, s40, 69632
    s_mov_b32 s42, 22528
    buffer_load_dwordx4 v1, s[24:27], s42 offen sc1 lds
    buffer_load_dwordx4 v1, s[24:27], s42 offen offset:1024 sc1 lds
    s_add_u32 m0, s40, 87040
    s_mov_b32 s42, 24576
    buffer_load_dwordx4 v1, s[24:27], s42 offen sc1 lds
    buffer_load_dwordx4 v1, s[24:27], s42 offen offset:1024 sc1 lds
    s_add_u32 m0, s40, 104448
    s_mov_b32 s42, 26624
    buffer_load_dwordx4 v1, s[24:27], s42 offen sc1 lds
    buffer_load_dwordx4 v1, s[24:27], s42 offen offset:1024 sc1 lds
    s_add_u32 m0, s40, 121856
    s_mov_b32 s42, 28672
    buffer_load_dwordx4 v1, s[24:27], s42 offen sc1 lds
    buffer_load_dwordx4 v1, s[24:27], s42 offen offset:1024 sc1 lds
    s_add_u32 m0, s40, 139264
    s_mov_b32 s42, 30720
    buffer_load_dwordx4 v1, s[24:27], s42 offen sc1 lds
    buffer_load_dwordx4 v1, s[24:27], s42 offen offset:1024 sc1 lds
    s_add_u32 m0, s40, 0
    s_mov_b32 s42, 32768
    buffer_load_dwordx4 v1, s[24:27], s42 offen sc1 lds
    buffer_load_dwordx4 v1, s[24:27], s42 offen offset:1024 sc1 lds
    s_waitcnt vmcnt(14)
    s_barrier
    s_add_u32 m0, s40, 17408
    s_mov_b32 s42, 34816
    buffer_load_dwordx4 v1, s[24:27], s42 offen sc1 lds
    buffer_load_dwordx4 v1, s[24:27], s42 offen offset:1024 sc1 lds
    s_add_u32 m0, s41, 17408
    s_mov_b32 s43, 156672
    buffer_load_dwordx4 v2, s[16:19], s43 offen sc1 lds
    buffer_load_dwordx4 v2, s[16:19], s43 offen offset:1024 sc1 lds
    s_cmp_eq_u32 s38, 3
    s_cbranch_scc0 L_w3_17_0
    buffer_load_dwordx4 v2, s[16:19], s43 offen offset:2048 sc1 lds
L_w3_17_0:
    s_waitcnt vmcnt(16)
    s_barrier
    s_add_u32 m0, s40, 34816
    s_mov_b32 s42, 36864
    buffer_load_dwordx4 v1, s[24:27], s42 offen sc1 lds
    buffer_load_dwordx4 v1, s[24:27], s42 offen offset:1024 sc1 lds
    s_add_u32 m0, s41, 34816
    s_mov_b32 s43, 165888
    buffer_load_dwordx4 v2, s[16:19], s43 offen sc1 lds
    buffer_load_dwordx4 v2, s[16:19], s43 offen offset:1024 sc1 lds
    s_cmp_eq_u32 s38, 3
    s_cbranch_scc0 L_w3_18_0
    buffer_load_dwordx4 v2, s[16:19], s43 offen offset:2048 sc1 lds
L_w3_18_0:
    s_waitcnt vmcnt(18)
    s_barrier
    s_add_u32 m0, s40, 52224
    s_mov_b32 s42, 38912
    buffer_load_dwordx4 v1, s[24:27], s42 offen sc1 lds
    buffer_load_dwordx4 v1, s[24:27], s42 offen offset:1024 sc1 lds
    s_add_u32 m0, s41, 52224
    s_mov_b32 s43, 175104
    buffer_load_dwordx4 v2, s[16:19], s43 offen sc1 lds
    buffer_load_dwordx4 v2, s[16:19], s43 offen offset:1024 sc1 lds
    s_cmp_eq_u32 s38, 3
    s_cbranch_scc0 L_w3_19_0
    buffer_load_dwordx4 v2, s[16:19], s43 offen offset:2048 sc1 lds
L_w3_19_0:
    s_waitcnt vmcnt(20)
    s_barrier
    s_add_u32 m0, s40, 69632
    s_mov_b32 s42, 40960
    buffer_load_dwordx4 v1, s[24:27], s42 offen sc1 lds
    buffer_load_dwordx4 v1, s[24:27], s42 offen offset:1024 sc1 lds
    s_add_u32 m0, s41, 69632
    s_mov_b32 s43, 184320
    buffer_load_dwordx4 v2, s[16:19], s43 offen sc1 lds
    buffer_load_dwordx4 v2, s[16:19], s43 offen offset:1024 sc1 lds
    s_cmp_eq_u32 s38, 3
    s_cbranch_scc0 L_w3_20_0
    buffer_load_dwordx4 v2, s[16:19], s43 offen offset:2048 sc1 lds
L_w3_20_0:
    s_waitcnt vmcnt(22)
    s_barrier
    s_add_u32 m0, s40, 87040
    s_mov_b32 s42, 43008
    buffer_load_dwordx4 v1, s[24:27], s42 offen sc1 lds
    buffer_load_dwordx4 v1, s[24:27], s42 offen offset:1024 sc1 lds
    s_add_u32 m0, s41, 87040
    s_mov_b32 s43, 193536
    buffer_load_dwordx4 v2, s[16:19], s43 offen sc1 lds
    buffer_load_dwordx4 v2, s[16:19], s43 offen offset:1024 sc1 lds
    s_cmp_eq_u32 s38, 3
    s_cbranch_scc0 L_w3_21_0
    buffer_load_dwordx4 v2, s[16:19], s43 offen offset:2048 sc1 lds
L_w3_21_0:
    s_waitcnt vmcnt(24)
    s_barrier
    s_add_u32 m0, s40, 104448
    s_mov_b32 s42, 45056
    buffer_load_dwordx4 v1, s[24:27], s42 offen sc1 lds
    buffer_load_dwordx4 v1, s[24:27], s42 offen offset:1024 sc1 lds
    s_add_u32 m0, s41, 104448
    s_mov_b32 s43, 202752
    buffer_load_dwordx4 v2, s[16:19], s43 offen sc1 lds
    buffer_load_dwordx4 v2, s[16:19], s43 offen offset:1024 sc1 lds
    s_cmp_eq_u32 s38, 3
    s_cbranch_scc0 L_w3_22_0
    buffer_load_dwordx4 v2, s[16:19], s43 offen offset:2048 sc1 lds
L_w3_22_0:
    s_waitcnt vmcnt(26)
    s_barrier
    s_add_u32 m0, s40, 121856
    s_mov_b32 s42, 47104
    buffer_load_dwordx4 v1, s[24:27], s42 offen sc1 lds
    buffer_load_dwordx4 v1, s[24:27], s42 offen offset:1024 sc1 lds
    s_add_u32 m0, s41, 121856
    s_mov_b32 s43, 211968
    buffer_load_dwordx4 v2, s[16:19], s43 offen sc1 lds
    buffer_load_dwordx4 v2, s[16:19], s43 offen offset:1024 sc1 lds
    s_cmp_eq_u32 s38, 3
    s_cbranch_scc0 L_w3_23_0
    buffer_load_dwordx4 v2, s[16:19], s43 offen offset:2048 sc1 lds
L_w3_23_0:
    s_waitcnt vmcnt(28)
    s_barrier
    s_mov_b32 s42, 49152
    s_mov_b32 s43, 221184
    s_mov_b32 s57, 139264
    s_mov_b32 s59, 0
    s_cmp_eq_u32 s38, 3
    s_cbranch_scc1 L_q5
    s_branch L_q4
L_q4:
L_lloop4:
    s_add_u32 m0, s40, s57
    s_add_u32 s37, s41, s57
    buffer_load_dwordx4 v1, s[24:27], s42 offen sc1 lds
    buffer_load_dwordx4 v1, s[24:27], s42 offen offset:1024 sc1 lds
    s_mov_b32 m0, s37
    s_add_u32 s42, s42, 2048
    buffer_load_dwordx4 v2, s[16:19], s43 offen sc1 lds
    buffer_load_dwordx4 v2, s[16:19], s43 offen offset:1024 sc1 lds
    s_add_u32 s43, s43, 9216
    s_add_u32 s57, s57, 17408
    s_cmp_eq_u32 s57, 156672
    s_cselect_b32 s57, 0, s57
    s_add_u32 s59, s59, 1
    s_cmp_lt_u32 s59, 21
    s_waitcnt vmcnt(28)
    s_barrier
    s_cbranch_scc1 L_lloop4
    s_waitcnt vmcnt(24)
    s_barrier
    s_waitcnt vmcnt(20)
    s_barrier
    s_waitcnt vmcnt(16)
    s_barrier
    s_waitcnt vmcnt(12)
    s_barrier
    s_waitcnt vmcnt(8)
    s_barrier
    s_waitcnt vmcnt(4)
    s_barrier
    s_waitcnt vmcnt(0)
    s_barrier
    s_waitcnt vmcnt(0)
    s_barrier
    s_waitcnt vmcnt(0)
    s_barrier
    s_endpgm
L_q5:
L_lloop5:
    s_add_u32 m0, s40, s57
    s_add_u32 s37, s41, s57
    buffer_load_dwordx4 v1, s[24:27], s42 offen sc1 lds
    buffer_load_dwordx4 v1, s[24:27], s42 offen offset:1024 sc1 lds
    s_mov_b32 m0, s37
    s_add_u32 s42, s42, 2048
    buffer_load_dwordx4 v2, s[16:19], s43 offen sc1 lds
    buffer_load_dwordx4 v2, s[16:19], s43 offen offset:1024 sc1 lds
    buffer_load_dwordx4 v2, s[16:19], s43 offen offset:2048 sc1 lds
    s_add_u32 s43, s43, 9216
    s_add_u32 s57, s57, 17408
    s_cmp_eq_u32 s57, 156672
    s_cselect_b32 s57, 0, s57
    s_add_u32 s59, s59, 1
    s_cmp_lt_u32 s59, 21
    s_waitcnt vmcnt(35)
    s_barrier
    s_cbranch_scc1 L_lloop5
    s_waitcnt vmcnt(30)
    s_barrier
    s_waitcnt vmcnt(25)
    s_barrier
    s_waitcnt vmcnt(20)
    s_barrier
    s_waitcnt vmcnt(15)
    s_barrier
    s_waitcnt vmcnt(10)
    s_barrier
    s_waitcnt vmcnt(5)
    s_barrier
    s_waitcnt vmcnt(0)
    s_barrier
    s_waitcnt vmcnt(0)
    s_barrier
    s_waitcnt vmcnt(0)
    s_barrier
    s_endpgm
L_end:
    s_endpgm
.section .rodata,"a"
.p2align 6
.amdhsa_kernel recurrent_scan__sliding_local_dilated__mixer_gmlp__prompt_kernel
  .amdhsa_next_free_vgpr 256
  .amdhsa_next_free_sgpr 102
  .amdhsa_accum_offset 256
  .amdhsa_group_segment_fixed_size 0
  .amdhsa_kernarg_size 88
  .amdhsa_user_sgpr_count 2
  .amdhsa_user_sgpr_kernarg_segment_ptr 1
  .amdhsa_system_sgpr_workgroup_id_x 1
.end_amdhsa_kernel
```
